```python
import torch

def _softmax(x, axis=-1):
    return torch.softmax(x, dim=axis)

def _gelu(x):
    return torch.nn.functional.gelu(x, approximate='tanh')

def _silu(x):
    return torch.nn.functional.silu(x)

def _sigmoid(x):
    return torch.sigmoid(x)

def _layernorm(x, axis=-1, eps=1e-05):
    m = x.mean(dim=axis, keepdim=True)
    v = x.var(dim=axis, keepdim=True, unbiased=False)
    return (x - m) / torch.sqrt(v + eps)

def _scatter_add(tgt, idx, src, axis=0):
    return tgt.clone().index_add_(axis, idx, src)

def _segment_sum(src, seg, n):
    out = torch.zeros((n,) + src.shape[1:], dtype=src.dtype)
    return out.index_add_(0, seg, src)

def _pad(x, pw):
    flat = tuple((v for pair in reversed(pw) for v in pair))
    return torch.nn.functional.pad(x, flat)
kernel_name = 'sequential_preLN__memory_aug_recurrent_mem_tr__swiglu_ffn__prompt'

def setup_inputs():

    _w = lambda a: (lambda t: t.to(torch.bfloat16) if t.is_floating_point() else t)(torch.as_tensor(a))

    def _A_setup():
        B, S, Dm = (1, 2048, 640)
        H, Dh = (32, 192)
        M, seg = (8, 32)
        seg = min(seg, S)
        S = S // seg * seg
        return {'x': _w((lambda *s: torch.randn(*s, dtype=torch.bfloat16) * 0.05)(B, S, Dm)), 'mem0': _w((lambda *s: torch.randn(*s, dtype=torch.bfloat16) * 0.2)(B, M, Dm)), 'Wq': _w((lambda *s: torch.randn(*s, dtype=torch.bfloat16) * 1.6)(Dm, H, Dh) * Dm ** (-0.5)), 'Wk': _w((lambda *s: torch.randn(*s, dtype=torch.bfloat16) * 1.6)(Dm, H, Dh) * Dm ** (-0.5)), 'Wv': _w((lambda *s: torch.randn(*s, dtype=torch.bfloat16) * 0.2)(Dm, H, Dh) * Dm ** (-0.5)), 'Wo': _w((lambda *s: torch.randn(*s, dtype=torch.bfloat16) * 0.2)(H, Dh, Dm) * (H * Dh) ** (-0.5)), 'seg_len': seg}
    _A_in = _A_setup()

    def _B_setup():
        B, S, D, F = (1, 2048, 640, 1536)
        return {'x': _w((lambda *s: torch.randn(*s, dtype=torch.bfloat16) * 0.05)(B, S, D)), 'w_gate': _w((lambda *s: torch.randn(*s, dtype=torch.bfloat16) * 0.05)(D, F)), 'w_up': _w((lambda *s: torch.randn(*s, dtype=torch.bfloat16) * 0.05)(D, F)), 'w_down': _w((lambda *s: torch.randn(*s, dtype=torch.bfloat16) * 0.05)(F, D))}
    _B_in = _B_setup()
    return {'A_x': _A_in['x'], 'A_mem0': _A_in['mem0'], 'A_Wq': _A_in['Wq'], 'A_Wk': _A_in['Wk'], 'A_Wv': _A_in['Wv'], 'A_Wo': _A_in['Wo'], 'A_seg_len': _A_in['seg_len'], 'B_x': _B_in['x'], 'B_w_gate': _B_in['w_gate'], 'B_w_up': _B_in['w_up'], 'B_w_down': _B_in['w_down']}

def reference(A_x, A_mem0, A_Wq, A_Wk, A_Wv, A_Wo, A_seg_len, B_x, B_w_gate, B_w_up, B_w_down):

    def _A_ref(x, mem0, Wq, Wk, Wv, Wo, seg_len):
        B, S, Dm = x.shape
        H, Dh = (Wq.shape[1], Wq.shape[2])
        M = mem0.shape[1]
        scale = Dh ** (-0.5)
        n_seg = S // seg_len
        L = M + seg_len
        idx = torch.arange(L)
        mask = (idx[:, None] < M) | (idx[:, None] >= idx[None, :])
        mem = mem0
        outs = []
        for s in range(n_seg):
            xs = x[:, s * seg_len:(s + 1) * seg_len, :].clone()
            h = torch.concatenate([mem, xs], axis=1)
            q = torch.einsum('btd,dhe->bhte', h, Wq)
            k = torch.einsum('btd,dhe->bhte', h, Wk)
            v = torch.einsum('btd,dhe->bhte', h, Wv)
            scores = torch.einsum('bhqe,bhke->bhqk', q, k) * scale
            scores = torch.where(mask[None, None], scores, -1000000000.0)
            p = _softmax(scores, axis=-1)
            o = torch.einsum('bhqk,bhke->bhqe', p, v)
            o = torch.einsum('bhte,hed->btd', o, Wo)
            mem = o[:, :M, :].clone()
            outs.append(o[:, M:, :])
        return torch.concatenate(outs, axis=1)

    def _B_ref(x, w_gate, w_up, w_down):
        g = _silu(x @ w_gate)
        u = x @ w_up
        return g * u @ w_down
    x = A_x
    h = x + _A_ref(_layernorm(x, axis=-1), A_mem0, A_Wq, A_Wk, A_Wv, A_Wo, A_seg_len)
    h2 = h + _B_ref(_layernorm(h, axis=-1), B_w_gate, B_w_up, B_w_down)
    return h2
```

```asm
; @launch grid=(256,1,1) block=(256,1,1) lds=163840
.amdgcn_target "amdgcn-amd-amdhsa--gfx950"
.text
.globl sequential_preLN__memory_aug_recurrent_mem_tr__swiglu_ffn__prompt_kernel
.p2align 8
.type sequential_preLN__memory_aug_recurrent_mem_tr__swiglu_ffn__prompt_kernel,@function
sequential_preLN__memory_aug_recurrent_mem_tr__swiglu_ffn__prompt_kernel:
  s_cmp_ge_u32 s2, 256
  s_cbranch_scc1 L_exit
  s_load_dwordx2 s[8:9], s[0:1], 104
  s_load_dwordx2 s[12:13], s[0:1], 96
  v_lshrrev_b32 v1, 6, v0
  v_and_b32 v0, 63, v0
  s_getreg_b32 s25, hwreg(HW_REG_XCC_ID)
  v_readfirstlane_b32 s24, v1
  s_and_b32 s25, s25, 7
  s_waitcnt lgkmcnt(0)
  s_and_b32 s9, s9, 0xffff
  s_mov_b32 s10, 268435456
  s_mov_b32 s11, 0x20000
  s_and_b32 s13, s13, 0xffff
  s_mov_b32 s14, 256
  s_mov_b32 s15, 0x20000
  s_mov_b32 s27, 0
  s_cmp_eq_u32 s24, 0
  s_cbranch_scc0 L_st_wait
  s_mov_b64 exec, 1
  s_lshl_b32 s3, s25, 2
  v_mov_b32 v1, s3
  v_mov_b32 v2, 1
  buffer_atomic_add v2, v1, s[12:15], 0 offen sc0
  s_waitcnt vmcnt(0)
  v_mov_b32 v1, 0
  ds_write_b32 v1, v2
  s_waitcnt lgkmcnt(0)
  s_mov_b64 exec, -1
L_st_wait:
  s_barrier
  v_mov_b32 v1, 0
  ds_read_b32 v2, v1
  s_waitcnt lgkmcnt(0)
  v_readfirstlane_b32 s26, v2
  s_barrier
  s_cmp_lt_u32 s26, 32
  s_cbranch_scc1 L_st_done
  s_cmp_eq_u32 s24, 0
  s_cbranch_scc0 L_ov_wait
  s_mov_b64 exec, 1
  v_mov_b32 v1, 32
  v_mov_b32 v2, 1
  buffer_atomic_add v2, v1, s[12:15], 0 offen sc0
  s_waitcnt vmcnt(0)
  v_mov_b32 v1, 0
  ds_write_b32 v1, v2
  s_waitcnt lgkmcnt(0)
  s_mov_b64 exec, -1
L_ov_wait:
  s_barrier
  v_mov_b32 v1, 0
  ds_read_b32 v2, v1
  s_waitcnt lgkmcnt(0)
  v_readfirstlane_b32 s4, v2
  s_barrier
  s_mov_b32 s28, 131072
  s_mov_b32 s29, 1
  v_lshlrev_b32 v1, 2, v0
L_wc_ov:
  buffer_load_dword v2, v1, s[12:15], 0 offen sc1
  s_waitcnt vmcnt(0)
  s_sub_u32 s28, s28, 1
  s_cbranch_scc1 L_abort
  v_readlane_b32 s64, v2, 0
  v_readlane_b32 s65, v2, 1
  v_readlane_b32 s66, v2, 2
  v_readlane_b32 s67, v2, 3
  v_readlane_b32 s68, v2, 4
  v_readlane_b32 s69, v2, 5
  v_readlane_b32 s70, v2, 6
  v_readlane_b32 s71, v2, 7
  s_add_u32 s3, s64, s65
  s_add_u32 s3, s3, s66
  s_add_u32 s3, s3, s67
  s_add_u32 s3, s3, s68
  s_add_u32 s3, s3, s69
  s_add_u32 s3, s3, s70
  s_add_u32 s3, s3, s71
  s_cmp_ge_u32 s3, 256
  s_cbranch_scc0 L_wc_ov
  s_mov_b32 s25, 0
  s_min_u32 s5, s64, 32
  s_sub_u32 s6, 32, s5
  s_cmp_lt_u32 s4, s6
  s_cbranch_scc0 L_ov_n0
  s_mov_b32 s25, 0
  s_add_u32 s26, s5, s4
  s_branch L_st_done
L_ov_n0:
  s_sub_u32 s4, s4, s6
  s_min_u32 s5, s65, 32
  s_sub_u32 s6, 32, s5
  s_cmp_lt_u32 s4, s6
  s_cbranch_scc0 L_ov_n1
  s_mov_b32 s25, 1
  s_add_u32 s26, s5, s4
  s_branch L_st_done
L_ov_n1:
  s_sub_u32 s4, s4, s6
  s_min_u32 s5, s66, 32
  s_sub_u32 s6, 32, s5
  s_cmp_lt_u32 s4, s6
  s_cbranch_scc0 L_ov_n2
  s_mov_b32 s25, 2
  s_add_u32 s26, s5, s4
  s_branch L_st_done
L_ov_n2:
  s_sub_u32 s4, s4, s6
  s_min_u32 s5, s67, 32
  s_sub_u32 s6, 32, s5
  s_cmp_lt_u32 s4, s6
  s_cbranch_scc0 L_ov_n3
  s_mov_b32 s25, 3
  s_add_u32 s26, s5, s4
  s_branch L_st_done
L_ov_n3:
  s_sub_u32 s4, s4, s6
  s_min_u32 s5, s68, 32
  s_sub_u32 s6, 32, s5
  s_cmp_lt_u32 s4, s6
  s_cbranch_scc0 L_ov_n4
  s_mov_b32 s25, 4
  s_add_u32 s26, s5, s4
  s_branch L_st_done
L_ov_n4:
  s_sub_u32 s4, s4, s6
  s_min_u32 s5, s69, 32
  s_sub_u32 s6, 32, s5
  s_cmp_lt_u32 s4, s6
  s_cbranch_scc0 L_ov_n5
  s_mov_b32 s25, 5
  s_add_u32 s26, s5, s4
  s_branch L_st_done
L_ov_n5:
  s_sub_u32 s4, s4, s6
  s_min_u32 s5, s70, 32
  s_sub_u32 s6, 32, s5
  s_cmp_lt_u32 s4, s6
  s_cbranch_scc0 L_ov_n6
  s_mov_b32 s25, 6
  s_add_u32 s26, s5, s4
  s_branch L_st_done
L_ov_n6:
  s_sub_u32 s4, s4, s6
  s_min_u32 s5, s71, 32
  s_sub_u32 s6, 32, s5
  s_cmp_lt_u32 s4, s6
  s_cbranch_scc0 L_ov_n7
  s_mov_b32 s25, 7
  s_add_u32 s26, s5, s4
  s_branch L_st_done
L_ov_n7:
  s_sub_u32 s4, s4, s6
  s_mov_b32 s29, 99
  s_branch L_abort
L_st_done:
  s_cmp_lt_u32 s25, 4
  s_cbranch_scc1 L_chain
  s_sub_u32 s3, s25, 4
  s_lshl_b32 s3, s3, 5
  s_add_u32 s30, s3, s26
  v_lshlrev_b32 v20, 4, v0
  v_lshrrev_b32 v21, 4, v0
  v_and_b32 v22, 15, v0
  s_sub_u32 s3, s30, 0
  s_cmp_lt_u32 s3, 72
  s_cbranch_scc1 L_roleA
  s_sub_u32 s3, s30, 72
  s_cmp_lt_u32 s3, 16
  s_cbranch_scc1 L_roleB
  s_sub_u32 s3, s30, 88
  s_cmp_lt_u32 s3, 20
  s_cbranch_scc1 L_roleC
  s_sub_u32 s3, s30, 108
  s_cmp_lt_u32 s3, 12
  s_cbranch_scc1 L_roleD
  s_sub_u32 s3, s30, 120
  s_cmp_lt_u32 s3, 5
  s_cbranch_scc1 L_roleE
  s_sub_u32 s3, s30, 125
  s_cmp_lt_u32 s3, 3
  s_cbranch_scc1 L_roleR
  s_load_dwordx2 s[20:21], s[0:1], 0
  s_waitcnt lgkmcnt(0)
  s_and_b32 s21, s21, 0xffff
  s_mov_b32 s22, 2621440
  s_mov_b32 s23, 0x20000
  s_lshl_b32 s4, s30, 4
  s_mul_i32 s4, s4, 1280
  s_mul_i32 s5, s24, 320
  s_add_u32 s4, s4, s5
  v_mul_u32_u24 v28, 1280, v22
  v_lshlrev_b32 v29, 4, v21
  v_add_u32 v28, v28, v29
  buffer_load_dwordx4 v[40:43], v28, s[20:23], s4 offen offset:0
  buffer_load_dwordx4 v[44:47], v28, s[20:23], s4 offen offset:64
  buffer_load_dwordx4 v[48:51], v28, s[20:23], s4 offen offset:128
  buffer_load_dwordx4 v[52:55], v28, s[20:23], s4 offen offset:192
  buffer_load_dwordx4 v[56:59], v28, s[20:23], s4 offen offset:256
  s_waitcnt vmcnt(0)
  v_lshlrev_b32 v64, 16, v40
  v_and_b32 v65, 0xffff0000, v40
  v_lshlrev_b32 v66, 16, v41
  v_and_b32 v67, 0xffff0000, v41
  v_lshlrev_b32 v68, 16, v42
  v_and_b32 v69, 0xffff0000, v42
  v_lshlrev_b32 v70, 16, v43
  v_and_b32 v71, 0xffff0000, v43
  v_lshlrev_b32 v72, 16, v44
  v_and_b32 v73, 0xffff0000, v44
  v_lshlrev_b32 v74, 16, v45
  v_and_b32 v75, 0xffff0000, v45
  v_lshlrev_b32 v76, 16, v46
  v_and_b32 v77, 0xffff0000, v46
  v_lshlrev_b32 v78, 16, v47
  v_and_b32 v79, 0xffff0000, v47
  v_lshlrev_b32 v80, 16, v48
  v_and_b32 v81, 0xffff0000, v48
  v_lshlrev_b32 v82, 16, v49
  v_and_b32 v83, 0xffff0000, v49
  v_lshlrev_b32 v84, 16, v50
  v_and_b32 v85, 0xffff0000, v50
  v_lshlrev_b32 v86, 16, v51
  v_and_b32 v87, 0xffff0000, v51
  v_lshlrev_b32 v88, 16, v52
  v_and_b32 v89, 0xffff0000, v52
  v_lshlrev_b32 v90, 16, v53
  v_and_b32 v91, 0xffff0000, v53
  v_lshlrev_b32 v92, 16, v54
  v_and_b32 v93, 0xffff0000, v54
  v_lshlrev_b32 v94, 16, v55
  v_and_b32 v95, 0xffff0000, v55
  v_lshlrev_b32 v96, 16, v56
  v_and_b32 v97, 0xffff0000, v56
  v_lshlrev_b32 v98, 16, v57
  v_and_b32 v99, 0xffff0000, v57
  v_lshlrev_b32 v100, 16, v58
  v_and_b32 v101, 0xffff0000, v58
  v_lshlrev_b32 v102, 16, v59
  v_and_b32 v103, 0xffff0000, v59
  s_mov_b32 s47, 131072
  v_pk_add_f32 v[104:105], v[64:65], v[66:67]
  v_pk_mul_f32 v[106:107], v[64:65], v[64:65]
  v_pk_fma_f32 v[106:107], v[66:67], v[66:67], v[106:107]
  v_pk_add_f32 v[104:105], v[104:105], v[68:69]
  v_pk_fma_f32 v[106:107], v[68:69], v[68:69], v[106:107]
  v_pk_add_f32 v[104:105], v[104:105], v[70:71]
  v_pk_fma_f32 v[106:107], v[70:71], v[70:71], v[106:107]
  v_pk_add_f32 v[104:105], v[104:105], v[72:73]
  v_pk_fma_f32 v[106:107], v[72:73], v[72:73], v[106:107]
  v_pk_add_f32 v[104:105], v[104:105], v[74:75]
  v_pk_fma_f32 v[106:107], v[74:75], v[74:75], v[106:107]
  v_pk_add_f32 v[104:105], v[104:105], v[76:77]
  v_pk_fma_f32 v[106:107], v[76:77], v[76:77], v[106:107]
  v_pk_add_f32 v[104:105], v[104:105], v[78:79]
  v_pk_fma_f32 v[106:107], v[78:79], v[78:79], v[106:107]
  v_pk_add_f32 v[104:105], v[104:105], v[80:81]
  v_pk_fma_f32 v[106:107], v[80:81], v[80:81], v[106:107]
  v_pk_add_f32 v[104:105], v[104:105], v[82:83]
  v_pk_fma_f32 v[106:107], v[82:83], v[82:83], v[106:107]
  v_pk_add_f32 v[104:105], v[104:105], v[84:85]
  v_pk_fma_f32 v[106:107], v[84:85], v[84:85], v[106:107]
  v_pk_add_f32 v[104:105], v[104:105], v[86:87]
  v_pk_fma_f32 v[106:107], v[86:87], v[86:87], v[106:107]
  v_pk_add_f32 v[104:105], v[104:105], v[88:89]
  v_pk_fma_f32 v[106:107], v[88:89], v[88:89], v[106:107]
  v_pk_add_f32 v[104:105], v[104:105], v[90:91]
  v_pk_fma_f32 v[106:107], v[90:91], v[90:91], v[106:107]
  v_pk_add_f32 v[104:105], v[104:105], v[92:93]
  v_pk_fma_f32 v[106:107], v[92:93], v[92:93], v[106:107]
  v_pk_add_f32 v[104:105], v[104:105], v[94:95]
  v_pk_fma_f32 v[106:107], v[94:95], v[94:95], v[106:107]
  v_pk_add_f32 v[104:105], v[104:105], v[96:97]
  v_pk_fma_f32 v[106:107], v[96:97], v[96:97], v[106:107]
  v_pk_add_f32 v[104:105], v[104:105], v[98:99]
  v_pk_fma_f32 v[106:107], v[98:99], v[98:99], v[106:107]
  v_pk_add_f32 v[104:105], v[104:105], v[100:101]
  v_pk_fma_f32 v[106:107], v[100:101], v[100:101], v[106:107]
  v_pk_add_f32 v[104:105], v[104:105], v[102:103]
  v_pk_fma_f32 v[106:107], v[102:103], v[102:103], v[106:107]
  v_add_f32 v104, v104, v105
  v_add_f32 v105, v106, v107
  v_mov_b32 v108, v104
  v_mov_b32 v109, v105
  s_nop 0
  v_permlane16_swap_b32 v104, v108
  v_permlane16_swap_b32 v105, v109
  v_pk_add_f32 v[104:105], v[104:105], v[108:109]
  v_mov_b32 v108, v104
  v_mov_b32 v109, v105
  s_nop 0
  v_permlane32_swap_b32 v104, v108
  v_permlane32_swap_b32 v105, v109
  v_pk_add_f32 v[104:105], v[104:105], v[108:109]
  v_lshlrev_b32 v108, 3, v22
  v_add_u32 v108, s47, v108
  s_lshl_b32 s4, s24, 7
  v_add_u32 v109, s4, v108
  ds_write_b64 v109, v[104:105]
  s_waitcnt lgkmcnt(0)
  s_barrier
  ds_read_b64 v[104:105], v108
  ds_read_b64 v[106:107], v108 offset:128
  ds_read_b64 v[110:111], v108 offset:256
  ds_read_b64 v[112:113], v108 offset:384
  s_waitcnt lgkmcnt(2)
  v_pk_add_f32 v[104:105], v[104:105], v[106:107]
  s_waitcnt lgkmcnt(0)
  v_pk_add_f32 v[106:107], v[110:111], v[112:113]
  v_pk_add_f32 v[104:105], v[104:105], v[106:107]
  v_mul_f32 v104, 986500301, v104
  v_mul_f32 v106, v104, v104
  v_mov_b32 v107, 925353388
  v_fmac_f32 v107, 986500301, v105
  v_sub_f32 v107, v107, v106
  v_max_f32 v107, 925353388, v107
  v_rsq_f32 v106, v107
  s_nop 0
  v_mul_f32 v104, v104, v106
  v_pk_fma_f32 v[64:65], v[64:65], v[106:107], v[104:105] op_sel_hi:[1,0,0] neg_lo:[0,0,1] neg_hi:[0,0,1]
  v_pk_fma_f32 v[66:67], v[66:67], v[106:107], v[104:105] op_sel_hi:[1,0,0] neg_lo:[0,0,1] neg_hi:[0,0,1]
  v_pk_fma_f32 v[68:69], v[68:69], v[106:107], v[104:105] op_sel_hi:[1,0,0] neg_lo:[0,0,1] neg_hi:[0,0,1]
  v_pk_fma_f32 v[70:71], v[70:71], v[106:107], v[104:105] op_sel_hi:[1,0,0] neg_lo:[0,0,1] neg_hi:[0,0,1]
  v_pk_fma_f32 v[72:73], v[72:73], v[106:107], v[104:105] op_sel_hi:[1,0,0] neg_lo:[0,0,1] neg_hi:[0,0,1]
  v_pk_fma_f32 v[74:75], v[74:75], v[106:107], v[104:105] op_sel_hi:[1,0,0] neg_lo:[0,0,1] neg_hi:[0,0,1]
  v_pk_fma_f32 v[76:77], v[76:77], v[106:107], v[104:105] op_sel_hi:[1,0,0] neg_lo:[0,0,1] neg_hi:[0,0,1]
  v_pk_fma_f32 v[78:79], v[78:79], v[106:107], v[104:105] op_sel_hi:[1,0,0] neg_lo:[0,0,1] neg_hi:[0,0,1]
  v_pk_fma_f32 v[80:81], v[80:81], v[106:107], v[104:105] op_sel_hi:[1,0,0] neg_lo:[0,0,1] neg_hi:[0,0,1]
  v_pk_fma_f32 v[82:83], v[82:83], v[106:107], v[104:105] op_sel_hi:[1,0,0] neg_lo:[0,0,1] neg_hi:[0,0,1]
  v_pk_fma_f32 v[84:85], v[84:85], v[106:107], v[104:105] op_sel_hi:[1,0,0] neg_lo:[0,0,1] neg_hi:[0,0,1]
  v_pk_fma_f32 v[86:87], v[86:87], v[106:107], v[104:105] op_sel_hi:[1,0,0] neg_lo:[0,0,1] neg_hi:[0,0,1]
  v_pk_fma_f32 v[88:89], v[88:89], v[106:107], v[104:105] op_sel_hi:[1,0,0] neg_lo:[0,0,1] neg_hi:[0,0,1]
  v_pk_fma_f32 v[90:91], v[90:91], v[106:107], v[104:105] op_sel_hi:[1,0,0] neg_lo:[0,0,1] neg_hi:[0,0,1]
  v_pk_fma_f32 v[92:93], v[92:93], v[106:107], v[104:105] op_sel_hi:[1,0,0] neg_lo:[0,0,1] neg_hi:[0,0,1]
  v_pk_fma_f32 v[94:95], v[94:95], v[106:107], v[104:105] op_sel_hi:[1,0,0] neg_lo:[0,0,1] neg_hi:[0,0,1]
  v_pk_fma_f32 v[96:97], v[96:97], v[106:107], v[104:105] op_sel_hi:[1,0,0] neg_lo:[0,0,1] neg_hi:[0,0,1]
  v_pk_fma_f32 v[98:99], v[98:99], v[106:107], v[104:105] op_sel_hi:[1,0,0] neg_lo:[0,0,1] neg_hi:[0,0,1]
  v_pk_fma_f32 v[100:101], v[100:101], v[106:107], v[104:105] op_sel_hi:[1,0,0] neg_lo:[0,0,1] neg_hi:[0,0,1]
  v_pk_fma_f32 v[102:103], v[102:103], v[106:107], v[104:105] op_sel_hi:[1,0,0] neg_lo:[0,0,1] neg_hi:[0,0,1]
  v_cvt_pk_bf16_f32 v40, v64, v65
  v_cvt_pk_bf16_f32 v41, v66, v67
  v_cvt_pk_bf16_f32 v42, v68, v69
  v_cvt_pk_bf16_f32 v43, v70, v71
  v_cvt_pk_bf16_f32 v44, v72, v73
  v_cvt_pk_bf16_f32 v45, v74, v75
  v_cvt_pk_bf16_f32 v46, v76, v77
  v_cvt_pk_bf16_f32 v47, v78, v79
  v_cvt_pk_bf16_f32 v48, v80, v81
  v_cvt_pk_bf16_f32 v49, v82, v83
  v_cvt_pk_bf16_f32 v50, v84, v85
  v_cvt_pk_bf16_f32 v51, v86, v87
  v_cvt_pk_bf16_f32 v52, v88, v89
  v_cvt_pk_bf16_f32 v53, v90, v91
  v_cvt_pk_bf16_f32 v54, v92, v93
  v_cvt_pk_bf16_f32 v55, v94, v95
  v_cvt_pk_bf16_f32 v56, v96, v97
  v_cvt_pk_bf16_f32 v57, v98, v99
  v_cvt_pk_bf16_f32 v58, v100, v101
  v_cvt_pk_bf16_f32 v59, v102, v103
  s_lshr_b32 s4, s30, 1
  s_mul_i32 s4, s4, 40960
  s_and_b32 s5, s30, 1
  s_lshl_b32 s5, s5, 10
  s_add_u32 s4, s4, s5
  s_mul_i32 s5, s24, 10240
  s_add_u32 s4, s4, s5
  s_add_u32 s4, s4, 5656576
  s_add_u32 s5, s4, 0
  buffer_store_dwordx4 v[40:43], v20, s[8:11], s5 offen sc1
  s_add_u32 s5, s4, 2048
  buffer_store_dwordx4 v[44:47], v20, s[8:11], s5 offen sc1
  s_add_u32 s5, s4, 4096
  buffer_store_dwordx4 v[48:51], v20, s[8:11], s5 offen sc1
  s_add_u32 s5, s4, 6144
  buffer_store_dwordx4 v[52:55], v20, s[8:11], s5 offen sc1
  s_add_u32 s5, s4, 8192
  buffer_store_dwordx4 v[56:59], v20, s[8:11], s5 offen sc1
  s_waitcnt vmcnt(0)
  s_barrier
  s_cmp_eq_u32 s24, 0
  s_cbranch_scc0 L_ia_idle
  s_mov_b64 exec, 1
  v_mov_b32 v1, 36
  v_mov_b32 v2, 1
  buffer_atomic_add v2, v1, s[12:15], 0 offen
  s_mov_b64 exec, -1
L_ia_idle:
  s_branch L_exit
L_A_next:
  s_barrier
  s_mov_b32 s53, 1
  s_sub_u32 s55, s30, 0
  s_cmp_lt_u32 s55, 20
  s_cbranch_scc1 L_C_par
  s_sub_u32 s55, s30, 20
  s_cmp_lt_u32 s55, 12
  s_cbranch_scc1 L_D_par
  s_sub_u32 s55, s30, 32
  s_cmp_lt_u32 s55, 5
  s_cbranch_scc1 L_E_par
  s_sub_u32 s55, s30, 37
  s_cmp_lt_u32 s55, 3
  s_cbranch_scc1 L_R_par
  s_branch L_exit
L_roleA:
  s_mul_hi_u32 s36, s30, 178956971
  s_mul_i32 s4, s36, 24
  s_sub_u32 s37, s30, s4
  s_lshl_b32 s37, s37, 2
  s_add_u32 s37, s37, s24
  s_mul_hi_u32 s38, s37, 1431655766
  s_mul_i32 s4, s38, 3
  s_sub_u32 s39, s37, s4
  s_lshl_b32 s4, s30, 7
  s_lshl_b32 s5, s24, 2
  s_add_u32 s4, s4, s5
  s_add_u32 s35, s4, 0
  s_mov_b64 exec, 1
  v_mov_b32 v28, 0
  v_mov_b32 v29, 0
  buffer_store_dword v28, v29, s[8:11], s35 offen sc1
  s_mov_b64 exec, -1
  s_mov_b32 s53, 0
  s_mov_b32 s52, 64
  s_sub_u32 s4, s30, 0
  s_cmp_lt_u32 s4, 20
  s_cbranch_scc0 L_A_zC
  s_lshl_b32 s4, s4, 7
  s_lshl_b32 s5, s24, 2
  s_add_u32 s4, s4, s5
  s_add_u32 s47, s4, 80384
  s_mov_b64 exec, 1
  v_mov_b32 v28, 0
  v_mov_b32 v29, 0
  buffer_store_dword v28, v29, s[8:11], s47 offen sc1
  s_mov_b64 exec, -1
L_A_zC:
  s_sub_u32 s4, s30, 20
  s_cmp_lt_u32 s4, 12
  s_cbranch_scc0 L_A_zD
  s_lshl_b32 s4, s4, 7
  s_lshl_b32 s5, s24, 2
  s_add_u32 s4, s4, s5
  s_add_u32 s47, s4, 95744
  s_mov_b64 exec, 1
  v_mov_b32 v28, 0
  v_mov_b32 v29, 0
  buffer_store_dword v28, v29, s[8:11], s47 offen sc1
  s_mov_b64 exec, -1
L_A_zD:
  s_sub_u32 s4, s30, 37
  s_cmp_lt_u32 s4, 3
  s_cbranch_scc0 L_A_zR
  s_lshl_b32 s4, s4, 7
  s_lshl_b32 s5, s24, 2
  s_add_u32 s4, s4, s5
  s_add_u32 s47, s4, 90496
  s_mov_b64 exec, 1
  v_mov_b32 v28, 0
  v_mov_b32 v29, 0
  buffer_store_dword v28, v29, s[8:11], s47 offen sc1
  s_mov_b64 exec, -1
L_A_zR:
  s_load_dwordx2 s[20:21], s[0:1], 0
  s_waitcnt lgkmcnt(0)
  s_and_b32 s21, s21, 0xffff
  s_mov_b32 s22, 2621440
  s_mov_b32 s23, 0x20000
  s_lshl_b32 s4, s30, 4
  s_mul_i32 s4, s4, 1280
  s_mul_i32 s5, s24, 320
  s_add_u32 s4, s4, s5
  v_mul_u32_u24 v28, 1280, v22
  v_lshlrev_b32 v29, 4, v21
  v_add_u32 v28, v28, v29
  buffer_load_dwordx4 v[40:43], v28, s[20:23], s4 offen offset:0
  buffer_load_dwordx4 v[44:47], v28, s[20:23], s4 offen offset:64
  buffer_load_dwordx4 v[48:51], v28, s[20:23], s4 offen offset:128
  buffer_load_dwordx4 v[52:55], v28, s[20:23], s4 offen offset:192
  buffer_load_dwordx4 v[56:59], v28, s[20:23], s4 offen offset:256
  s_cmp_eq_u32 s36, 0
  s_cbranch_scc0 L_A_srd0
  s_load_dwordx2 s[16:17], s[0:1], 16
  s_waitcnt lgkmcnt(0)
  s_and_b32 s17, s17, 0xffff
  s_mov_b32 s18, 7864320
  s_mov_b32 s19, 0x20000
  s_branch L_A_srdd
L_A_srd0:
  s_cmp_eq_u32 s36, 1
  s_cbranch_scc0 L_A_srd1
  s_load_dwordx2 s[16:17], s[0:1], 24
  s_waitcnt lgkmcnt(0)
  s_and_b32 s17, s17, 0xffff
  s_mov_b32 s18, 7864320
  s_mov_b32 s19, 0x20000
  s_branch L_A_srdd
L_A_srd1:
  s_cmp_eq_u32 s36, 2
  s_cbranch_scc0 L_A_srd2
  s_load_dwordx2 s[16:17], s[0:1], 32
  s_waitcnt lgkmcnt(0)
  s_and_b32 s17, s17, 0xffff
  s_mov_b32 s18, 7864320
  s_mov_b32 s19, 0x20000
  s_branch L_A_srdd
L_A_srd2:
  s_mov_b32 s29, 98
  s_branch L_abort
L_A_srdd:
  s_sub_u32 s6, s37, s24
  s_lshl_b32 s44, s6, 7
  s_lshl_b32 s45, s24, 7
  v_lshrrev_b32 v28, 5, v0
  v_and_b32 v29, 31, v0
  v_mul_u32_u24 v32, 12288, v28
  v_lshlrev_b32 v29, 4, v29
  v_add_u32 v32, v32, v29
  v_bfe_u32 v28, v0, 2, 2
  v_and_b32 v29, 3, v0
  v_mul_u32_u24 v30, 8, v21
  v_add_u32 v30, v30, v28
  v_mul_u32_u24 v30, 512, v30
  v_lshlrev_b32 v29, 3, v29
  v_add_u32 v30, v30, v29
  v_add_u32 v30, s45, v30
  v_mov_b32 v36, v30
  s_lshl_b32 s4, s24, 10
  s_add_u32 s4, s4, 0
  s_mov_b32 m0, s4
  s_mul_i32 s5, s24, 24576
  s_add_u32 s5, s5, 0
  s_add_u32 s5, s5, s44
  buffer_load_dwordx4 v32, s[16:19], s5 offen lds
  s_lshl_b32 s4, s24, 10
  s_add_u32 s4, s4, 4096
  s_mov_b32 m0, s4
  s_mul_i32 s5, s24, 24576
  s_add_u32 s5, s5, 98304
  s_add_u32 s5, s5, s44
  buffer_load_dwordx4 v32, s[16:19], s5 offen lds
  s_lshl_b32 s4, s24, 10
  s_add_u32 s4, s4, 8192
  s_mov_b32 m0, s4
  s_mul_i32 s5, s24, 24576
  s_add_u32 s5, s5, 196608
  s_add_u32 s5, s5, s44
  buffer_load_dwordx4 v32, s[16:19], s5 offen lds
  s_lshl_b32 s4, s24, 10
  s_add_u32 s4, s4, 12288
  s_mov_b32 m0, s4
  s_mul_i32 s5, s24, 24576
  s_add_u32 s5, s5, 294912
  s_add_u32 s5, s5, s44
  buffer_load_dwordx4 v32, s[16:19], s5 offen lds
  s_lshl_b32 s4, s24, 10
  s_add_u32 s4, s4, 16384
  s_mov_b32 m0, s4
  s_mul_i32 s5, s24, 24576
  s_add_u32 s5, s5, 393216
  s_add_u32 s5, s5, s44
  buffer_load_dwordx4 v32, s[16:19], s5 offen lds
  s_lshl_b32 s4, s24, 10
  s_add_u32 s4, s4, 20480
  s_mov_b32 m0, s4
  s_mul_i32 s5, s24, 24576
  s_add_u32 s5, s5, 491520
  s_add_u32 s5, s5, s44
  buffer_load_dwordx4 v32, s[16:19], s5 offen lds
  s_lshl_b32 s4, s24, 10
  s_add_u32 s4, s4, 24576
  s_mov_b32 m0, s4
  s_mul_i32 s5, s24, 24576
  s_add_u32 s5, s5, 589824
  s_add_u32 s5, s5, s44
  buffer_load_dwordx4 v32, s[16:19], s5 offen lds
  s_lshl_b32 s4, s24, 10
  s_add_u32 s4, s4, 28672
  s_mov_b32 m0, s4
  s_mul_i32 s5, s24, 24576
  s_add_u32 s5, s5, 688128
  s_add_u32 s5, s5, s44
  buffer_load_dwordx4 v32, s[16:19], s5 offen lds
  s_lshl_b32 s4, s24, 10
  s_add_u32 s4, s4, 32768
  s_mov_b32 m0, s4
  s_mul_i32 s5, s24, 24576
  s_add_u32 s5, s5, 786432
  s_add_u32 s5, s5, s44
  buffer_load_dwordx4 v32, s[16:19], s5 offen lds
  s_lshl_b32 s4, s24, 10
  s_add_u32 s4, s4, 36864
  s_mov_b32 m0, s4
  s_mul_i32 s5, s24, 24576
  s_add_u32 s5, s5, 884736
  s_add_u32 s5, s5, s44
  buffer_load_dwordx4 v32, s[16:19], s5 offen lds
  s_lshl_b32 s4, s24, 10
  s_add_u32 s4, s4, 40960
  s_mov_b32 m0, s4
  s_mul_i32 s5, s24, 24576
  s_add_u32 s5, s5, 983040
  s_add_u32 s5, s5, s44
  buffer_load_dwordx4 v32, s[16:19], s5 offen lds
  s_lshl_b32 s4, s24, 10
  s_add_u32 s4, s4, 45056
  s_mov_b32 m0, s4
  s_mul_i32 s5, s24, 24576
  s_add_u32 s5, s5, 1081344
  s_add_u32 s5, s5, s44
  buffer_load_dwordx4 v32, s[16:19], s5 offen lds
  s_lshl_b32 s4, s24, 10
  s_add_u32 s4, s4, 49152
  s_mov_b32 m0, s4
  s_mul_i32 s5, s24, 24576
  s_add_u32 s5, s5, 1179648
  s_add_u32 s5, s5, s44
  buffer_load_dwordx4 v32, s[16:19], s5 offen lds
  s_lshl_b32 s4, s24, 10
  s_add_u32 s4, s4, 53248
  s_mov_b32 m0, s4
  s_mul_i32 s5, s24, 24576
  s_add_u32 s5, s5, 1277952
  s_add_u32 s5, s5, s44
  buffer_load_dwordx4 v32, s[16:19], s5 offen lds
  s_lshl_b32 s4, s24, 10
  s_add_u32 s4, s4, 57344
  s_mov_b32 m0, s4
  s_mul_i32 s5, s24, 24576
  s_add_u32 s5, s5, 1376256
  s_add_u32 s5, s5, s44
  buffer_load_dwordx4 v32, s[16:19], s5 offen lds
  s_lshl_b32 s4, s24, 10
  s_add_u32 s4, s4, 61440
  s_mov_b32 m0, s4
  s_mul_i32 s5, s24, 24576
  s_add_u32 s5, s5, 1474560
  s_add_u32 s5, s5, s44
  buffer_load_dwordx4 v32, s[16:19], s5 offen lds
  s_waitcnt vmcnt(16)
  v_lshlrev_b32 v64, 16, v40
  v_and_b32 v65, 0xffff0000, v40
  v_lshlrev_b32 v66, 16, v41
  v_and_b32 v67, 0xffff0000, v41
  v_lshlrev_b32 v68, 16, v42
  v_and_b32 v69, 0xffff0000, v42
  v_lshlrev_b32 v70, 16, v43
  v_and_b32 v71, 0xffff0000, v43
  v_lshlrev_b32 v72, 16, v44
  v_and_b32 v73, 0xffff0000, v44
  v_lshlrev_b32 v74, 16, v45
  v_and_b32 v75, 0xffff0000, v45
  v_lshlrev_b32 v76, 16, v46
  v_and_b32 v77, 0xffff0000, v46
  v_lshlrev_b32 v78, 16, v47
  v_and_b32 v79, 0xffff0000, v47
  v_lshlrev_b32 v80, 16, v48
  v_and_b32 v81, 0xffff0000, v48
  v_lshlrev_b32 v82, 16, v49
  v_and_b32 v83, 0xffff0000, v49
  v_lshlrev_b32 v84, 16, v50
  v_and_b32 v85, 0xffff0000, v50
  v_lshlrev_b32 v86, 16, v51
  v_and_b32 v87, 0xffff0000, v51
  v_lshlrev_b32 v88, 16, v52
  v_and_b32 v89, 0xffff0000, v52
  v_lshlrev_b32 v90, 16, v53
  v_and_b32 v91, 0xffff0000, v53
  v_lshlrev_b32 v92, 16, v54
  v_and_b32 v93, 0xffff0000, v54
  v_lshlrev_b32 v94, 16, v55
  v_and_b32 v95, 0xffff0000, v55
  v_lshlrev_b32 v96, 16, v56
  v_and_b32 v97, 0xffff0000, v56
  v_lshlrev_b32 v98, 16, v57
  v_and_b32 v99, 0xffff0000, v57
  v_lshlrev_b32 v100, 16, v58
  v_and_b32 v101, 0xffff0000, v58
  v_lshlrev_b32 v102, 16, v59
  v_and_b32 v103, 0xffff0000, v59
  s_mov_b32 s47, 131072
  v_pk_add_f32 v[104:105], v[64:65], v[66:67]
  v_pk_mul_f32 v[106:107], v[64:65], v[64:65]
  v_pk_fma_f32 v[106:107], v[66:67], v[66:67], v[106:107]
  v_pk_add_f32 v[104:105], v[104:105], v[68:69]
  v_pk_fma_f32 v[106:107], v[68:69], v[68:69], v[106:107]
  v_pk_add_f32 v[104:105], v[104:105], v[70:71]
  v_pk_fma_f32 v[106:107], v[70:71], v[70:71], v[106:107]
  v_pk_add_f32 v[104:105], v[104:105], v[72:73]
  v_pk_fma_f32 v[106:107], v[72:73], v[72:73], v[106:107]
  v_pk_add_f32 v[104:105], v[104:105], v[74:75]
  v_pk_fma_f32 v[106:107], v[74:75], v[74:75], v[106:107]
  v_pk_add_f32 v[104:105], v[104:105], v[76:77]
  v_pk_fma_f32 v[106:107], v[76:77], v[76:77], v[106:107]
  v_pk_add_f32 v[104:105], v[104:105], v[78:79]
  v_pk_fma_f32 v[106:107], v[78:79], v[78:79], v[106:107]
  v_pk_add_f32 v[104:105], v[104:105], v[80:81]
  v_pk_fma_f32 v[106:107], v[80:81], v[80:81], v[106:107]
  v_pk_add_f32 v[104:105], v[104:105], v[82:83]
  v_pk_fma_f32 v[106:107], v[82:83], v[82:83], v[106:107]
  v_pk_add_f32 v[104:105], v[104:105], v[84:85]
  v_pk_fma_f32 v[106:107], v[84:85], v[84:85], v[106:107]
  v_pk_add_f32 v[104:105], v[104:105], v[86:87]
  v_pk_fma_f32 v[106:107], v[86:87], v[86:87], v[106:107]
  v_pk_add_f32 v[104:105], v[104:105], v[88:89]
  v_pk_fma_f32 v[106:107], v[88:89], v[88:89], v[106:107]
  v_pk_add_f32 v[104:105], v[104:105], v[90:91]
  v_pk_fma_f32 v[106:107], v[90:91], v[90:91], v[106:107]
  v_pk_add_f32 v[104:105], v[104:105], v[92:93]
  v_pk_fma_f32 v[106:107], v[92:93], v[92:93], v[106:107]
  v_pk_add_f32 v[104:105], v[104:105], v[94:95]
  v_pk_fma_f32 v[106:107], v[94:95], v[94:95], v[106:107]
  v_pk_add_f32 v[104:105], v[104:105], v[96:97]
  v_pk_fma_f32 v[106:107], v[96:97], v[96:97], v[106:107]
  v_pk_add_f32 v[104:105], v[104:105], v[98:99]
  v_pk_fma_f32 v[106:107], v[98:99], v[98:99], v[106:107]
  v_pk_add_f32 v[104:105], v[104:105], v[100:101]
  v_pk_fma_f32 v[106:107], v[100:101], v[100:101], v[106:107]
  v_pk_add_f32 v[104:105], v[104:105], v[102:103]
  v_pk_fma_f32 v[106:107], v[102:103], v[102:103], v[106:107]
  v_add_f32 v104, v104, v105
  v_add_f32 v105, v106, v107
  v_mov_b32 v108, v104
  v_mov_b32 v109, v105
  s_nop 0
  v_permlane16_swap_b32 v104, v108
  v_permlane16_swap_b32 v105, v109
  v_pk_add_f32 v[104:105], v[104:105], v[108:109]
  v_mov_b32 v108, v104
  v_mov_b32 v109, v105
  s_nop 0
  v_permlane32_swap_b32 v104, v108
  v_permlane32_swap_b32 v105, v109
  v_pk_add_f32 v[104:105], v[104:105], v[108:109]
  v_lshlrev_b32 v108, 3, v22
  v_add_u32 v108, s47, v108
  s_lshl_b32 s4, s24, 7
  v_add_u32 v109, s4, v108
  ds_write_b64 v109, v[104:105]
  s_waitcnt lgkmcnt(0)
  s_barrier
  ds_read_b64 v[104:105], v108
  ds_read_b64 v[106:107], v108 offset:128
  ds_read_b64 v[110:111], v108 offset:256
  ds_read_b64 v[112:113], v108 offset:384
  s_waitcnt lgkmcnt(2)
  v_pk_add_f32 v[104:105], v[104:105], v[106:107]
  s_waitcnt lgkmcnt(0)
  v_pk_add_f32 v[106:107], v[110:111], v[112:113]
  v_pk_add_f32 v[104:105], v[104:105], v[106:107]
  v_mul_f32 v104, 986500301, v104
  v_mul_f32 v106, v104, v104
  v_mov_b32 v107, 925353388
  v_fmac_f32 v107, 986500301, v105
  v_sub_f32 v107, v107, v106
  v_max_f32 v107, 925353388, v107
  v_rsq_f32 v106, v107
  s_nop 0
  v_mul_f32 v104, v104, v106
  v_pk_fma_f32 v[64:65], v[64:65], v[106:107], v[104:105] op_sel_hi:[1,0,0] neg_lo:[0,0,1] neg_hi:[0,0,1]
  v_pk_fma_f32 v[66:67], v[66:67], v[106:107], v[104:105] op_sel_hi:[1,0,0] neg_lo:[0,0,1] neg_hi:[0,0,1]
  v_pk_fma_f32 v[68:69], v[68:69], v[106:107], v[104:105] op_sel_hi:[1,0,0] neg_lo:[0,0,1] neg_hi:[0,0,1]
  v_pk_fma_f32 v[70:71], v[70:71], v[106:107], v[104:105] op_sel_hi:[1,0,0] neg_lo:[0,0,1] neg_hi:[0,0,1]
  v_pk_fma_f32 v[72:73], v[72:73], v[106:107], v[104:105] op_sel_hi:[1,0,0] neg_lo:[0,0,1] neg_hi:[0,0,1]
  v_pk_fma_f32 v[74:75], v[74:75], v[106:107], v[104:105] op_sel_hi:[1,0,0] neg_lo:[0,0,1] neg_hi:[0,0,1]
  v_pk_fma_f32 v[76:77], v[76:77], v[106:107], v[104:105] op_sel_hi:[1,0,0] neg_lo:[0,0,1] neg_hi:[0,0,1]
  v_pk_fma_f32 v[78:79], v[78:79], v[106:107], v[104:105] op_sel_hi:[1,0,0] neg_lo:[0,0,1] neg_hi:[0,0,1]
  v_pk_fma_f32 v[80:81], v[80:81], v[106:107], v[104:105] op_sel_hi:[1,0,0] neg_lo:[0,0,1] neg_hi:[0,0,1]
  v_pk_fma_f32 v[82:83], v[82:83], v[106:107], v[104:105] op_sel_hi:[1,0,0] neg_lo:[0,0,1] neg_hi:[0,0,1]
  v_pk_fma_f32 v[84:85], v[84:85], v[106:107], v[104:105] op_sel_hi:[1,0,0] neg_lo:[0,0,1] neg_hi:[0,0,1]
  v_pk_fma_f32 v[86:87], v[86:87], v[106:107], v[104:105] op_sel_hi:[1,0,0] neg_lo:[0,0,1] neg_hi:[0,0,1]
  v_pk_fma_f32 v[88:89], v[88:89], v[106:107], v[104:105] op_sel_hi:[1,0,0] neg_lo:[0,0,1] neg_hi:[0,0,1]
  v_pk_fma_f32 v[90:91], v[90:91], v[106:107], v[104:105] op_sel_hi:[1,0,0] neg_lo:[0,0,1] neg_hi:[0,0,1]
  v_pk_fma_f32 v[92:93], v[92:93], v[106:107], v[104:105] op_sel_hi:[1,0,0] neg_lo:[0,0,1] neg_hi:[0,0,1]
  v_pk_fma_f32 v[94:95], v[94:95], v[106:107], v[104:105] op_sel_hi:[1,0,0] neg_lo:[0,0,1] neg_hi:[0,0,1]
  v_pk_fma_f32 v[96:97], v[96:97], v[106:107], v[104:105] op_sel_hi:[1,0,0] neg_lo:[0,0,1] neg_hi:[0,0,1]
  v_pk_fma_f32 v[98:99], v[98:99], v[106:107], v[104:105] op_sel_hi:[1,0,0] neg_lo:[0,0,1] neg_hi:[0,0,1]
  v_pk_fma_f32 v[100:101], v[100:101], v[106:107], v[104:105] op_sel_hi:[1,0,0] neg_lo:[0,0,1] neg_hi:[0,0,1]
  v_pk_fma_f32 v[102:103], v[102:103], v[106:107], v[104:105] op_sel_hi:[1,0,0] neg_lo:[0,0,1] neg_hi:[0,0,1]
  v_cvt_pk_bf16_f32 v40, v64, v65
  v_cvt_pk_bf16_f32 v41, v66, v67
  v_cvt_pk_bf16_f32 v42, v68, v69
  v_cvt_pk_bf16_f32 v43, v70, v71
  v_cvt_pk_bf16_f32 v44, v72, v73
  v_cvt_pk_bf16_f32 v45, v74, v75
  v_cvt_pk_bf16_f32 v46, v76, v77
  v_cvt_pk_bf16_f32 v47, v78, v79
  v_cvt_pk_bf16_f32 v48, v80, v81
  v_cvt_pk_bf16_f32 v49, v82, v83
  v_cvt_pk_bf16_f32 v50, v84, v85
  v_cvt_pk_bf16_f32 v51, v86, v87
  v_cvt_pk_bf16_f32 v52, v88, v89
  v_cvt_pk_bf16_f32 v53, v90, v91
  v_cvt_pk_bf16_f32 v54, v92, v93
  v_cvt_pk_bf16_f32 v55, v94, v95
  v_cvt_pk_bf16_f32 v56, v96, v97
  v_cvt_pk_bf16_f32 v57, v98, v99
  v_cvt_pk_bf16_f32 v58, v100, v101
  v_cvt_pk_bf16_f32 v59, v102, v103
  s_lshr_b32 s4, s30, 1
  s_mul_i32 s4, s4, 40960
  s_and_b32 s5, s30, 1
  s_lshl_b32 s5, s5, 10
  s_add_u32 s4, s4, s5
  s_mul_i32 s5, s24, 10240
  s_add_u32 s4, s4, s5
  s_add_u32 s4, s4, 5656576
  s_add_u32 s5, s4, 0
  buffer_store_dwordx4 v[40:43], v20, s[8:11], s5 offen sc1
  s_add_u32 s5, s4, 2048
  buffer_store_dwordx4 v[44:47], v20, s[8:11], s5 offen sc1
  s_add_u32 s5, s4, 4096
  buffer_store_dwordx4 v[48:51], v20, s[8:11], s5 offen sc1
  s_add_u32 s5, s4, 6144
  buffer_store_dwordx4 v[52:55], v20, s[8:11], s5 offen sc1
  s_add_u32 s5, s4, 8192
  buffer_store_dwordx4 v[56:59], v20, s[8:11], s5 offen sc1
  s_lshl_b32 s4, s24, 10
  s_add_u32 s4, s4, 65536
  s_mov_b32 m0, s4
  s_mul_i32 s5, s24, 24576
  s_add_u32 s5, s5, 1572864
  s_add_u32 s5, s5, s44
  buffer_load_dwordx4 v32, s[16:19], s5 offen lds
  s_lshl_b32 s4, s24, 10
  s_add_u32 s4, s4, 69632
  s_mov_b32 m0, s4
  s_mul_i32 s5, s24, 24576
  s_add_u32 s5, s5, 1671168
  s_add_u32 s5, s5, s44
  buffer_load_dwordx4 v32, s[16:19], s5 offen lds
  s_lshl_b32 s4, s24, 10
  s_add_u32 s4, s4, 73728
  s_mov_b32 m0, s4
  s_mul_i32 s5, s24, 24576
  s_add_u32 s5, s5, 1769472
  s_add_u32 s5, s5, s44
  buffer_load_dwordx4 v32, s[16:19], s5 offen lds
  s_lshl_b32 s4, s24, 10
  s_add_u32 s4, s4, 77824
  s_mov_b32 m0, s4
  s_mul_i32 s5, s24, 24576
  s_add_u32 s5, s5, 1867776
  s_add_u32 s5, s5, s44
  buffer_load_dwordx4 v32, s[16:19], s5 offen lds
  s_lshl_b32 s4, s24, 10
  s_add_u32 s4, s4, 81920
  s_mov_b32 m0, s4
  s_mul_i32 s5, s24, 24576
  s_add_u32 s5, s5, 1966080
  s_add_u32 s5, s5, s44
  buffer_load_dwordx4 v32, s[16:19], s5 offen lds
  s_lshl_b32 s4, s24, 10
  s_add_u32 s4, s4, 86016
  s_mov_b32 m0, s4
  s_mul_i32 s5, s24, 24576
  s_add_u32 s5, s5, 2064384
  s_add_u32 s5, s5, s44
  buffer_load_dwordx4 v32, s[16:19], s5 offen lds
  s_lshl_b32 s4, s24, 10
  s_add_u32 s4, s4, 90112
  s_mov_b32 m0, s4
  s_mul_i32 s5, s24, 24576
  s_add_u32 s5, s5, 2162688
  s_add_u32 s5, s5, s44
  buffer_load_dwordx4 v32, s[16:19], s5 offen lds
  s_lshl_b32 s4, s24, 10
  s_add_u32 s4, s4, 94208
  s_mov_b32 m0, s4
  s_mul_i32 s5, s24, 24576
  s_add_u32 s5, s5, 2260992
  s_add_u32 s5, s5, s44
  buffer_load_dwordx4 v32, s[16:19], s5 offen lds
  s_lshl_b32 s4, s24, 10
  s_add_u32 s4, s4, 98304
  s_mov_b32 m0, s4
  s_mul_i32 s5, s24, 24576
  s_add_u32 s5, s5, 2359296
  s_add_u32 s5, s5, s44
  buffer_load_dwordx4 v32, s[16:19], s5 offen lds
  s_lshl_b32 s4, s24, 10
  s_add_u32 s4, s4, 102400
  s_mov_b32 m0, s4
  s_mul_i32 s5, s24, 24576
  s_add_u32 s5, s5, 2457600
  s_add_u32 s5, s5, s44
  buffer_load_dwordx4 v32, s[16:19], s5 offen lds
  s_lshl_b32 s4, s24, 10
  s_add_u32 s4, s4, 106496
  s_mov_b32 m0, s4
  s_mul_i32 s5, s24, 24576
  s_add_u32 s5, s5, 2555904
  s_add_u32 s5, s5, s44
  buffer_load_dwordx4 v32, s[16:19], s5 offen lds
  s_lshl_b32 s4, s24, 10
  s_add_u32 s4, s4, 110592
  s_mov_b32 m0, s4
  s_mul_i32 s5, s24, 24576
  s_add_u32 s5, s5, 2654208
  s_add_u32 s5, s5, s44
  buffer_load_dwordx4 v32, s[16:19], s5 offen lds
  s_lshl_b32 s4, s24, 10
  s_add_u32 s4, s4, 114688
  s_mov_b32 m0, s4
  s_mul_i32 s5, s24, 24576
  s_add_u32 s5, s5, 2752512
  s_add_u32 s5, s5, s44
  buffer_load_dwordx4 v32, s[16:19], s5 offen lds
  s_lshl_b32 s4, s24, 10
  s_add_u32 s4, s4, 118784
  s_mov_b32 m0, s4
  s_mul_i32 s5, s24, 24576
  s_add_u32 s5, s5, 2850816
  s_add_u32 s5, s5, s44
  buffer_load_dwordx4 v32, s[16:19], s5 offen lds
  s_lshl_b32 s4, s24, 10
  s_add_u32 s4, s4, 122880
  s_mov_b32 m0, s4
  s_mul_i32 s5, s24, 24576
  s_add_u32 s5, s5, 2949120
  s_add_u32 s5, s5, s44
  buffer_load_dwordx4 v32, s[16:19], s5 offen lds
  s_lshl_b32 s4, s24, 10
  s_add_u32 s4, s4, 126976
  s_mov_b32 m0, s4
  s_mul_i32 s5, s24, 24576
  s_add_u32 s5, s5, 3047424
  s_add_u32 s5, s5, s44
  buffer_load_dwordx4 v32, s[16:19], s5 offen lds
  s_waitcnt vmcnt(16)
  s_barrier
  s_cmp_eq_u32 s24, 0
  s_cbranch_scc0 L_ao_Akv
  s_mov_b64 exec, 1
  v_mov_b32 v18, 36
  v_mov_b32 v19, 1
  buffer_atomic_add v19, v18, s[12:15], 0 offen
  s_mov_b64 exec, -1
L_ao_Akv:
  ds_read_b64_tr_b16 a[0:1], v36 offset:0
  ds_read_b64_tr_b16 a[2:3], v36 offset:2048
  ds_read_b64_tr_b16 a[4:5], v36 offset:32
  ds_read_b64_tr_b16 a[6:7], v36 offset:2080
  ds_read_b64_tr_b16 a[8:9], v36 offset:64
  ds_read_b64_tr_b16 a[10:11], v36 offset:2112
  ds_read_b64_tr_b16 a[12:13], v36 offset:96
  ds_read_b64_tr_b16 a[14:15], v36 offset:2144
  ds_read_b64_tr_b16 a[16:17], v36 offset:16384
  ds_read_b64_tr_b16 a[18:19], v36 offset:18432
  ds_read_b64_tr_b16 a[20:21], v36 offset:16416
  ds_read_b64_tr_b16 a[22:23], v36 offset:18464
  s_waitcnt lgkmcnt(0)
  ds_read_b64_tr_b16 a[24:25], v36 offset:16448
  ds_read_b64_tr_b16 a[26:27], v36 offset:18496
  ds_read_b64_tr_b16 a[28:29], v36 offset:16480
  ds_read_b64_tr_b16 a[30:31], v36 offset:18528
  ds_read_b64_tr_b16 a[32:33], v36 offset:32768
  ds_read_b64_tr_b16 a[34:35], v36 offset:34816
  ds_read_b64_tr_b16 a[36:37], v36 offset:32800
  ds_read_b64_tr_b16 a[38:39], v36 offset:34848
  ds_read_b64_tr_b16 a[40:41], v36 offset:32832
  ds_read_b64_tr_b16 a[42:43], v36 offset:34880
  ds_read_b64_tr_b16 a[44:45], v36 offset:32864
  ds_read_b64_tr_b16 a[46:47], v36 offset:34912
  s_waitcnt lgkmcnt(0)
  ds_read_b64_tr_b16 a[48:49], v36 offset:49152
  ds_read_b64_tr_b16 a[50:51], v36 offset:51200
  ds_read_b64_tr_b16 a[52:53], v36 offset:49184
  ds_read_b64_tr_b16 a[54:55], v36 offset:51232
  ds_read_b64_tr_b16 a[56:57], v36 offset:49216
  ds_read_b64_tr_b16 a[58:59], v36 offset:51264
  ds_read_b64_tr_b16 a[60:61], v36 offset:49248
  ds_read_b64_tr_b16 a[62:63], v36 offset:51296
  s_waitcnt lgkmcnt(0)
  s_barrier
  s_lshl_b32 s4, s24, 10
  s_add_u32 s4, s4, 0
  s_mov_b32 m0, s4
  s_mul_i32 s5, s24, 24576
  s_add_u32 s5, s5, 3145728
  s_add_u32 s5, s5, s44
  buffer_load_dwordx4 v32, s[16:19], s5 offen lds
  s_lshl_b32 s4, s24, 10
  s_add_u32 s4, s4, 4096
  s_mov_b32 m0, s4
  s_mul_i32 s5, s24, 24576
  s_add_u32 s5, s5, 3244032
  s_add_u32 s5, s5, s44
  buffer_load_dwordx4 v32, s[16:19], s5 offen lds
  s_lshl_b32 s4, s24, 10
  s_add_u32 s4, s4, 8192
  s_mov_b32 m0, s4
  s_mul_i32 s5, s24, 24576
  s_add_u32 s5, s5, 3342336
  s_add_u32 s5, s5, s44
  buffer_load_dwordx4 v32, s[16:19], s5 offen lds
  s_lshl_b32 s4, s24, 10
  s_add_u32 s4, s4, 12288
  s_mov_b32 m0, s4
  s_mul_i32 s5, s24, 24576
  s_add_u32 s5, s5, 3440640
  s_add_u32 s5, s5, s44
  buffer_load_dwordx4 v32, s[16:19], s5 offen lds
  s_lshl_b32 s4, s24, 10
  s_add_u32 s4, s4, 16384
  s_mov_b32 m0, s4
  s_mul_i32 s5, s24, 24576
  s_add_u32 s5, s5, 3538944
  s_add_u32 s5, s5, s44
  buffer_load_dwordx4 v32, s[16:19], s5 offen lds
  s_lshl_b32 s4, s24, 10
  s_add_u32 s4, s4, 20480
  s_mov_b32 m0, s4
  s_mul_i32 s5, s24, 24576
  s_add_u32 s5, s5, 3637248
  s_add_u32 s5, s5, s44
  buffer_load_dwordx4 v32, s[16:19], s5 offen lds
  s_lshl_b32 s4, s24, 10
  s_add_u32 s4, s4, 24576
  s_mov_b32 m0, s4
  s_mul_i32 s5, s24, 24576
  s_add_u32 s5, s5, 3735552
  s_add_u32 s5, s5, s44
  buffer_load_dwordx4 v32, s[16:19], s5 offen lds
  s_lshl_b32 s4, s24, 10
  s_add_u32 s4, s4, 28672
  s_mov_b32 m0, s4
  s_mul_i32 s5, s24, 24576
  s_add_u32 s5, s5, 3833856
  s_add_u32 s5, s5, s44
  buffer_load_dwordx4 v32, s[16:19], s5 offen lds
  s_lshl_b32 s4, s24, 10
  s_add_u32 s4, s4, 32768
  s_mov_b32 m0, s4
  s_mul_i32 s5, s24, 24576
  s_add_u32 s5, s5, 3932160
  s_add_u32 s5, s5, s44
  buffer_load_dwordx4 v32, s[16:19], s5 offen lds
  s_lshl_b32 s4, s24, 10
  s_add_u32 s4, s4, 36864
  s_mov_b32 m0, s4
  s_mul_i32 s5, s24, 24576
  s_add_u32 s5, s5, 4030464
  s_add_u32 s5, s5, s44
  buffer_load_dwordx4 v32, s[16:19], s5 offen lds
  s_lshl_b32 s4, s24, 10
  s_add_u32 s4, s4, 40960
  s_mov_b32 m0, s4
  s_mul_i32 s5, s24, 24576
  s_add_u32 s5, s5, 4128768
  s_add_u32 s5, s5, s44
  buffer_load_dwordx4 v32, s[16:19], s5 offen lds
  s_lshl_b32 s4, s24, 10
  s_add_u32 s4, s4, 45056
  s_mov_b32 m0, s4
  s_mul_i32 s5, s24, 24576
  s_add_u32 s5, s5, 4227072
  s_add_u32 s5, s5, s44
  buffer_load_dwordx4 v32, s[16:19], s5 offen lds
  s_lshl_b32 s4, s24, 10
  s_add_u32 s4, s4, 49152
  s_mov_b32 m0, s4
  s_mul_i32 s5, s24, 24576
  s_add_u32 s5, s5, 4325376
  s_add_u32 s5, s5, s44
  buffer_load_dwordx4 v32, s[16:19], s5 offen lds
  s_lshl_b32 s4, s24, 10
  s_add_u32 s4, s4, 53248
  s_mov_b32 m0, s4
  s_mul_i32 s5, s24, 24576
  s_add_u32 s5, s5, 4423680
  s_add_u32 s5, s5, s44
  buffer_load_dwordx4 v32, s[16:19], s5 offen lds
  s_lshl_b32 s4, s24, 10
  s_add_u32 s4, s4, 57344
  s_mov_b32 m0, s4
  s_mul_i32 s5, s24, 24576
  s_add_u32 s5, s5, 4521984
  s_add_u32 s5, s5, s44
  buffer_load_dwordx4 v32, s[16:19], s5 offen lds
  s_lshl_b32 s4, s24, 10
  s_add_u32 s4, s4, 61440
  s_mov_b32 m0, s4
  s_mul_i32 s5, s24, 24576
  s_add_u32 s5, s5, 4620288
  s_add_u32 s5, s5, s44
  buffer_load_dwordx4 v32, s[16:19], s5 offen lds
  s_waitcnt vmcnt(16)
  s_barrier
  v_add_u32 v28, 65536, v36
  ds_read_b64_tr_b16 a[64:65], v28 offset:0
  v_add_u32 v28, 65536, v36
  ds_read_b64_tr_b16 a[66:67], v28 offset:2048
  v_add_u32 v28, 65536, v36
  ds_read_b64_tr_b16 a[68:69], v28 offset:32
  v_add_u32 v28, 65536, v36
  ds_read_b64_tr_b16 a[70:71], v28 offset:2080
  v_add_u32 v28, 65536, v36
  ds_read_b64_tr_b16 a[72:73], v28 offset:64
  v_add_u32 v28, 65536, v36
  ds_read_b64_tr_b16 a[74:75], v28 offset:2112
  v_add_u32 v28, 65536, v36
  ds_read_b64_tr_b16 a[76:77], v28 offset:96
  v_add_u32 v28, 65536, v36
  ds_read_b64_tr_b16 a[78:79], v28 offset:2144
  v_add_u32 v28, 65536, v36
  ds_read_b64_tr_b16 a[80:81], v28 offset:16384
  v_add_u32 v28, 65536, v36
  ds_read_b64_tr_b16 a[82:83], v28 offset:18432
  v_add_u32 v28, 65536, v36
  ds_read_b64_tr_b16 a[84:85], v28 offset:16416
  v_add_u32 v28, 65536, v36
  ds_read_b64_tr_b16 a[86:87], v28 offset:18464
  s_waitcnt lgkmcnt(0)
  v_add_u32 v28, 65536, v36
  ds_read_b64_tr_b16 a[88:89], v28 offset:16448
  v_add_u32 v28, 65536, v36
  ds_read_b64_tr_b16 a[90:91], v28 offset:18496
  v_add_u32 v28, 65536, v36
  ds_read_b64_tr_b16 a[92:93], v28 offset:16480
  v_add_u32 v28, 65536, v36
  ds_read_b64_tr_b16 a[94:95], v28 offset:18528
  v_add_u32 v28, 65536, v36
  ds_read_b64_tr_b16 a[96:97], v28 offset:32768
  v_add_u32 v28, 65536, v36
  ds_read_b64_tr_b16 a[98:99], v28 offset:34816
  v_add_u32 v28, 65536, v36
  ds_read_b64_tr_b16 a[100:101], v28 offset:32800
  v_add_u32 v28, 65536, v36
  ds_read_b64_tr_b16 a[102:103], v28 offset:34848
  v_add_u32 v28, 65536, v36
  ds_read_b64_tr_b16 a[104:105], v28 offset:32832
  v_add_u32 v28, 65536, v36
  ds_read_b64_tr_b16 a[106:107], v28 offset:34880
  v_add_u32 v28, 65536, v36
  ds_read_b64_tr_b16 a[108:109], v28 offset:32864
  v_add_u32 v28, 65536, v36
  ds_read_b64_tr_b16 a[110:111], v28 offset:34912
  s_waitcnt lgkmcnt(0)
  v_add_u32 v28, 65536, v36
  ds_read_b64_tr_b16 a[112:113], v28 offset:49152
  v_add_u32 v28, 65536, v36
  ds_read_b64_tr_b16 a[114:115], v28 offset:51200
  v_add_u32 v28, 65536, v36
  ds_read_b64_tr_b16 a[116:117], v28 offset:49184
  v_add_u32 v28, 65536, v36
  ds_read_b64_tr_b16 a[118:119], v28 offset:51232
  v_add_u32 v28, 65536, v36
  ds_read_b64_tr_b16 a[120:121], v28 offset:49216
  v_add_u32 v28, 65536, v36
  ds_read_b64_tr_b16 a[122:123], v28 offset:51264
  v_add_u32 v28, 65536, v36
  ds_read_b64_tr_b16 a[124:125], v28 offset:49248
  v_add_u32 v28, 65536, v36
  ds_read_b64_tr_b16 a[126:127], v28 offset:51296
  s_waitcnt lgkmcnt(0)
  s_barrier
  s_lshl_b32 s4, s24, 10
  s_add_u32 s4, s4, 65536
  s_mov_b32 m0, s4
  s_mul_i32 s5, s24, 24576
  s_add_u32 s5, s5, 4718592
  s_add_u32 s5, s5, s44
  buffer_load_dwordx4 v32, s[16:19], s5 offen lds
  s_lshl_b32 s4, s24, 10
  s_add_u32 s4, s4, 69632
  s_mov_b32 m0, s4
  s_mul_i32 s5, s24, 24576
  s_add_u32 s5, s5, 4816896
  s_add_u32 s5, s5, s44
  buffer_load_dwordx4 v32, s[16:19], s5 offen lds
  s_lshl_b32 s4, s24, 10
  s_add_u32 s4, s4, 73728
  s_mov_b32 m0, s4
  s_mul_i32 s5, s24, 24576
  s_add_u32 s5, s5, 4915200
  s_add_u32 s5, s5, s44
  buffer_load_dwordx4 v32, s[16:19], s5 offen lds
  s_lshl_b32 s4, s24, 10
  s_add_u32 s4, s4, 77824
  s_mov_b32 m0, s4
  s_mul_i32 s5, s24, 24576
  s_add_u32 s5, s5, 5013504
  s_add_u32 s5, s5, s44
  buffer_load_dwordx4 v32, s[16:19], s5 offen lds
  s_lshl_b32 s4, s24, 10
  s_add_u32 s4, s4, 81920
  s_mov_b32 m0, s4
  s_mul_i32 s5, s24, 24576
  s_add_u32 s5, s5, 5111808
  s_add_u32 s5, s5, s44
  buffer_load_dwordx4 v32, s[16:19], s5 offen lds
  s_lshl_b32 s4, s24, 10
  s_add_u32 s4, s4, 86016
  s_mov_b32 m0, s4
  s_mul_i32 s5, s24, 24576
  s_add_u32 s5, s5, 5210112
  s_add_u32 s5, s5, s44
  buffer_load_dwordx4 v32, s[16:19], s5 offen lds
  s_lshl_b32 s4, s24, 10
  s_add_u32 s4, s4, 90112
  s_mov_b32 m0, s4
  s_mul_i32 s5, s24, 24576
  s_add_u32 s5, s5, 5308416
  s_add_u32 s5, s5, s44
  buffer_load_dwordx4 v32, s[16:19], s5 offen lds
  s_lshl_b32 s4, s24, 10
  s_add_u32 s4, s4, 94208
  s_mov_b32 m0, s4
  s_mul_i32 s5, s24, 24576
  s_add_u32 s5, s5, 5406720
  s_add_u32 s5, s5, s44
  buffer_load_dwordx4 v32, s[16:19], s5 offen lds
  s_lshl_b32 s4, s24, 10
  s_add_u32 s4, s4, 98304
  s_mov_b32 m0, s4
  s_mul_i32 s5, s24, 24576
  s_add_u32 s5, s5, 5505024
  s_add_u32 s5, s5, s44
  buffer_load_dwordx4 v32, s[16:19], s5 offen lds
  s_lshl_b32 s4, s24, 10
  s_add_u32 s4, s4, 102400
  s_mov_b32 m0, s4
  s_mul_i32 s5, s24, 24576
  s_add_u32 s5, s5, 5603328
  s_add_u32 s5, s5, s44
  buffer_load_dwordx4 v32, s[16:19], s5 offen lds
  s_lshl_b32 s4, s24, 10
  s_add_u32 s4, s4, 106496
  s_mov_b32 m0, s4
  s_mul_i32 s5, s24, 24576
  s_add_u32 s5, s5, 5701632
  s_add_u32 s5, s5, s44
  buffer_load_dwordx4 v32, s[16:19], s5 offen lds
  s_lshl_b32 s4, s24, 10
  s_add_u32 s4, s4, 110592
  s_mov_b32 m0, s4
  s_mul_i32 s5, s24, 24576
  s_add_u32 s5, s5, 5799936
  s_add_u32 s5, s5, s44
  buffer_load_dwordx4 v32, s[16:19], s5 offen lds
  s_lshl_b32 s4, s24, 10
  s_add_u32 s4, s4, 114688
  s_mov_b32 m0, s4
  s_mul_i32 s5, s24, 24576
  s_add_u32 s5, s5, 5898240
  s_add_u32 s5, s5, s44
  buffer_load_dwordx4 v32, s[16:19], s5 offen lds
  s_lshl_b32 s4, s24, 10
  s_add_u32 s4, s4, 118784
  s_mov_b32 m0, s4
  s_mul_i32 s5, s24, 24576
  s_add_u32 s5, s5, 5996544
  s_add_u32 s5, s5, s44
  buffer_load_dwordx4 v32, s[16:19], s5 offen lds
  s_lshl_b32 s4, s24, 10
  s_add_u32 s4, s4, 122880
  s_mov_b32 m0, s4
  s_mul_i32 s5, s24, 24576
  s_add_u32 s5, s5, 6094848
  s_add_u32 s5, s5, s44
  buffer_load_dwordx4 v32, s[16:19], s5 offen lds
  s_lshl_b32 s4, s24, 10
  s_add_u32 s4, s4, 126976
  s_mov_b32 m0, s4
  s_mul_i32 s5, s24, 24576
  s_add_u32 s5, s5, 6193152
  s_add_u32 s5, s5, s44
  buffer_load_dwordx4 v32, s[16:19], s5 offen lds
  s_waitcnt vmcnt(16)
  s_barrier
  ds_read_b64_tr_b16 a[128:129], v36 offset:0
  ds_read_b64_tr_b16 a[130:131], v36 offset:2048
  ds_read_b64_tr_b16 a[132:133], v36 offset:32
  ds_read_b64_tr_b16 a[134:135], v36 offset:2080
  ds_read_b64_tr_b16 a[136:137], v36 offset:64
  ds_read_b64_tr_b16 a[138:139], v36 offset:2112
  ds_read_b64_tr_b16 a[140:141], v36 offset:96
  ds_read_b64_tr_b16 a[142:143], v36 offset:2144
  ds_read_b64_tr_b16 a[144:145], v36 offset:16384
  ds_read_b64_tr_b16 a[146:147], v36 offset:18432
  ds_read_b64_tr_b16 a[148:149], v36 offset:16416
  ds_read_b64_tr_b16 a[150:151], v36 offset:18464
  s_waitcnt lgkmcnt(0)
  ds_read_b64_tr_b16 a[152:153], v36 offset:16448
  ds_read_b64_tr_b16 a[154:155], v36 offset:18496
  ds_read_b64_tr_b16 a[156:157], v36 offset:16480
  ds_read_b64_tr_b16 a[158:159], v36 offset:18528
  ds_read_b64_tr_b16 a[160:161], v36 offset:32768
  ds_read_b64_tr_b16 a[162:163], v36 offset:34816
  ds_read_b64_tr_b16 a[164:165], v36 offset:32800
  ds_read_b64_tr_b16 a[166:167], v36 offset:34848
  ds_read_b64_tr_b16 a[168:169], v36 offset:32832
  ds_read_b64_tr_b16 a[170:171], v36 offset:34880
  ds_read_b64_tr_b16 a[172:173], v36 offset:32864
  ds_read_b64_tr_b16 a[174:175], v36 offset:34912
  s_waitcnt lgkmcnt(0)
  ds_read_b64_tr_b16 a[176:177], v36 offset:49152
  ds_read_b64_tr_b16 a[178:179], v36 offset:51200
  ds_read_b64_tr_b16 a[180:181], v36 offset:49184
  ds_read_b64_tr_b16 a[182:183], v36 offset:51232
  ds_read_b64_tr_b16 a[184:185], v36 offset:49216
  ds_read_b64_tr_b16 a[186:187], v36 offset:51264
  ds_read_b64_tr_b16 a[188:189], v36 offset:49248
  ds_read_b64_tr_b16 a[190:191], v36 offset:51296
  s_waitcnt lgkmcnt(0)
  s_barrier
  s_lshl_b32 s4, s24, 10
  s_add_u32 s4, s4, 0
  s_mov_b32 m0, s4
  s_mul_i32 s5, s24, 24576
  s_add_u32 s5, s5, 6291456
  s_add_u32 s5, s5, s44
  buffer_load_dwordx4 v32, s[16:19], s5 offen lds
  s_lshl_b32 s4, s24, 10
  s_add_u32 s4, s4, 4096
  s_mov_b32 m0, s4
  s_mul_i32 s5, s24, 24576
  s_add_u32 s5, s5, 6389760
  s_add_u32 s5, s5, s44
  buffer_load_dwordx4 v32, s[16:19], s5 offen lds
  s_lshl_b32 s4, s24, 10
  s_add_u32 s4, s4, 8192
  s_mov_b32 m0, s4
  s_mul_i32 s5, s24, 24576
  s_add_u32 s5, s5, 6488064
  s_add_u32 s5, s5, s44
  buffer_load_dwordx4 v32, s[16:19], s5 offen lds
  s_lshl_b32 s4, s24, 10
  s_add_u32 s4, s4, 12288
  s_mov_b32 m0, s4
  s_mul_i32 s5, s24, 24576
  s_add_u32 s5, s5, 6586368
  s_add_u32 s5, s5, s44
  buffer_load_dwordx4 v32, s[16:19], s5 offen lds
  s_lshl_b32 s4, s24, 10
  s_add_u32 s4, s4, 16384
  s_mov_b32 m0, s4
  s_mul_i32 s5, s24, 24576
  s_add_u32 s5, s5, 6684672
  s_add_u32 s5, s5, s44
  buffer_load_dwordx4 v32, s[16:19], s5 offen lds
  s_lshl_b32 s4, s24, 10
  s_add_u32 s4, s4, 20480
  s_mov_b32 m0, s4
  s_mul_i32 s5, s24, 24576
  s_add_u32 s5, s5, 6782976
  s_add_u32 s5, s5, s44
  buffer_load_dwordx4 v32, s[16:19], s5 offen lds
  s_lshl_b32 s4, s24, 10
  s_add_u32 s4, s4, 24576
  s_mov_b32 m0, s4
  s_mul_i32 s5, s24, 24576
  s_add_u32 s5, s5, 6881280
  s_add_u32 s5, s5, s44
  buffer_load_dwordx4 v32, s[16:19], s5 offen lds
  s_lshl_b32 s4, s24, 10
  s_add_u32 s4, s4, 28672
  s_mov_b32 m0, s4
  s_mul_i32 s5, s24, 24576
  s_add_u32 s5, s5, 6979584
  s_add_u32 s5, s5, s44
  buffer_load_dwordx4 v32, s[16:19], s5 offen lds
  s_lshl_b32 s4, s24, 10
  s_add_u32 s4, s4, 32768
  s_mov_b32 m0, s4
  s_mul_i32 s5, s24, 24576
  s_add_u32 s5, s5, 7077888
  s_add_u32 s5, s5, s44
  buffer_load_dwordx4 v32, s[16:19], s5 offen lds
  s_lshl_b32 s4, s24, 10
  s_add_u32 s4, s4, 36864
  s_mov_b32 m0, s4
  s_mul_i32 s5, s24, 24576
  s_add_u32 s5, s5, 7176192
  s_add_u32 s5, s5, s44
  buffer_load_dwordx4 v32, s[16:19], s5 offen lds
  s_lshl_b32 s4, s24, 10
  s_add_u32 s4, s4, 40960
  s_mov_b32 m0, s4
  s_mul_i32 s5, s24, 24576
  s_add_u32 s5, s5, 7274496
  s_add_u32 s5, s5, s44
  buffer_load_dwordx4 v32, s[16:19], s5 offen lds
  s_lshl_b32 s4, s24, 10
  s_add_u32 s4, s4, 45056
  s_mov_b32 m0, s4
  s_mul_i32 s5, s24, 24576
  s_add_u32 s5, s5, 7372800
  s_add_u32 s5, s5, s44
  buffer_load_dwordx4 v32, s[16:19], s5 offen lds
  s_lshl_b32 s4, s24, 10
  s_add_u32 s4, s4, 49152
  s_mov_b32 m0, s4
  s_mul_i32 s5, s24, 24576
  s_add_u32 s5, s5, 7471104
  s_add_u32 s5, s5, s44
  buffer_load_dwordx4 v32, s[16:19], s5 offen lds
  s_lshl_b32 s4, s24, 10
  s_add_u32 s4, s4, 53248
  s_mov_b32 m0, s4
  s_mul_i32 s5, s24, 24576
  s_add_u32 s5, s5, 7569408
  s_add_u32 s5, s5, s44
  buffer_load_dwordx4 v32, s[16:19], s5 offen lds
  s_lshl_b32 s4, s24, 10
  s_add_u32 s4, s4, 57344
  s_mov_b32 m0, s4
  s_mul_i32 s5, s24, 24576
  s_add_u32 s5, s5, 7667712
  s_add_u32 s5, s5, s44
  buffer_load_dwordx4 v32, s[16:19], s5 offen lds
  s_lshl_b32 s4, s24, 10
  s_add_u32 s4, s4, 61440
  s_mov_b32 m0, s4
  s_mul_i32 s5, s24, 24576
  s_add_u32 s5, s5, 7766016
  s_add_u32 s5, s5, s44
  buffer_load_dwordx4 v32, s[16:19], s5 offen lds
  s_waitcnt vmcnt(16)
  s_barrier
  v_add_u32 v28, 65536, v36
  ds_read_b64_tr_b16 a[192:193], v28 offset:0
  v_add_u32 v28, 65536, v36
  ds_read_b64_tr_b16 a[194:195], v28 offset:2048
  v_add_u32 v28, 65536, v36
  ds_read_b64_tr_b16 a[196:197], v28 offset:32
  v_add_u32 v28, 65536, v36
  ds_read_b64_tr_b16 a[198:199], v28 offset:2080
  v_add_u32 v28, 65536, v36
  ds_read_b64_tr_b16 a[200:201], v28 offset:64
  v_add_u32 v28, 65536, v36
  ds_read_b64_tr_b16 a[202:203], v28 offset:2112
  v_add_u32 v28, 65536, v36
  ds_read_b64_tr_b16 a[204:205], v28 offset:96
  v_add_u32 v28, 65536, v36
  ds_read_b64_tr_b16 a[206:207], v28 offset:2144
  v_add_u32 v28, 65536, v36
  ds_read_b64_tr_b16 a[208:209], v28 offset:16384
  v_add_u32 v28, 65536, v36
  ds_read_b64_tr_b16 a[210:211], v28 offset:18432
  v_add_u32 v28, 65536, v36
  ds_read_b64_tr_b16 a[212:213], v28 offset:16416
  v_add_u32 v28, 65536, v36
  ds_read_b64_tr_b16 a[214:215], v28 offset:18464
  s_waitcnt lgkmcnt(0)
  v_add_u32 v28, 65536, v36
  ds_read_b64_tr_b16 a[216:217], v28 offset:16448
  v_add_u32 v28, 65536, v36
  ds_read_b64_tr_b16 a[218:219], v28 offset:18496
  v_add_u32 v28, 65536, v36
  ds_read_b64_tr_b16 a[220:221], v28 offset:16480
  v_add_u32 v28, 65536, v36
  ds_read_b64_tr_b16 a[222:223], v28 offset:18528
  v_add_u32 v28, 65536, v36
  ds_read_b64_tr_b16 a[224:225], v28 offset:32768
  v_add_u32 v28, 65536, v36
  ds_read_b64_tr_b16 a[226:227], v28 offset:34816
  v_add_u32 v28, 65536, v36
  ds_read_b64_tr_b16 a[228:229], v28 offset:32800
  v_add_u32 v28, 65536, v36
  ds_read_b64_tr_b16 a[230:231], v28 offset:34848
  v_add_u32 v28, 65536, v36
  ds_read_b64_tr_b16 a[232:233], v28 offset:32832
  v_add_u32 v28, 65536, v36
  ds_read_b64_tr_b16 a[234:235], v28 offset:34880
  v_add_u32 v28, 65536, v36
  ds_read_b64_tr_b16 a[236:237], v28 offset:32864
  v_add_u32 v28, 65536, v36
  ds_read_b64_tr_b16 a[238:239], v28 offset:34912
  s_waitcnt lgkmcnt(0)
  v_add_u32 v28, 65536, v36
  ds_read_b64_tr_b16 a[240:241], v28 offset:49152
  v_add_u32 v28, 65536, v36
  ds_read_b64_tr_b16 a[242:243], v28 offset:51200
  v_add_u32 v28, 65536, v36
  ds_read_b64_tr_b16 a[244:245], v28 offset:49184
  v_add_u32 v28, 65536, v36
  ds_read_b64_tr_b16 a[246:247], v28 offset:51232
  v_add_u32 v28, 65536, v36
  ds_read_b64_tr_b16 a[248:249], v28 offset:49216
  v_add_u32 v28, 65536, v36
  ds_read_b64_tr_b16 a[250:251], v28 offset:51264
  v_add_u32 v28, 65536, v36
  ds_read_b64_tr_b16 a[252:253], v28 offset:49248
  v_add_u32 v28, 65536, v36
  ds_read_b64_tr_b16 a[254:255], v28 offset:51296
  s_waitcnt lgkmcnt(0)
  s_barrier
  s_waitcnt vmcnt(0)
  s_barrier
  ds_read_b64_tr_b16 v[192:193], v36 offset:0
  ds_read_b64_tr_b16 v[194:195], v36 offset:2048
  ds_read_b64_tr_b16 v[196:197], v36 offset:32
  ds_read_b64_tr_b16 v[198:199], v36 offset:2080
  ds_read_b64_tr_b16 v[200:201], v36 offset:64
  ds_read_b64_tr_b16 v[202:203], v36 offset:2112
  ds_read_b64_tr_b16 v[204:205], v36 offset:96
  ds_read_b64_tr_b16 v[206:207], v36 offset:2144
  ds_read_b64_tr_b16 v[208:209], v36 offset:16384
  ds_read_b64_tr_b16 v[210:211], v36 offset:18432
  ds_read_b64_tr_b16 v[212:213], v36 offset:16416
  ds_read_b64_tr_b16 v[214:215], v36 offset:18464
  s_waitcnt lgkmcnt(0)
  ds_read_b64_tr_b16 v[216:217], v36 offset:16448
  ds_read_b64_tr_b16 v[218:219], v36 offset:18496
  ds_read_b64_tr_b16 v[220:221], v36 offset:16480
  ds_read_b64_tr_b16 v[222:223], v36 offset:18528
  ds_read_b64_tr_b16 v[224:225], v36 offset:32768
  ds_read_b64_tr_b16 v[226:227], v36 offset:34816
  ds_read_b64_tr_b16 v[228:229], v36 offset:32800
  ds_read_b64_tr_b16 v[230:231], v36 offset:34848
  ds_read_b64_tr_b16 v[232:233], v36 offset:32832
  ds_read_b64_tr_b16 v[234:235], v36 offset:34880
  ds_read_b64_tr_b16 v[236:237], v36 offset:32864
  ds_read_b64_tr_b16 v[238:239], v36 offset:34912
  s_waitcnt lgkmcnt(0)
  ds_read_b64_tr_b16 v[240:241], v36 offset:49152
  ds_read_b64_tr_b16 v[242:243], v36 offset:51200
  ds_read_b64_tr_b16 v[244:245], v36 offset:49184
  ds_read_b64_tr_b16 v[246:247], v36 offset:51232
  ds_read_b64_tr_b16 v[248:249], v36 offset:49216
  ds_read_b64_tr_b16 v[250:251], v36 offset:51264
  ds_read_b64_tr_b16 v[252:253], v36 offset:49248
  ds_read_b64_tr_b16 v[254:255], v36 offset:51296
  s_waitcnt lgkmcnt(0)
  s_barrier
  s_cmp_eq_u32 s24, 0
  s_cbranch_scc0 L_wd_iwA
  s_mov_b32 s28, 131072
  s_mov_b32 s29, 2
  v_mov_b32 v18, 36
L_wn_iwA:
  buffer_load_dword v19, v18, s[12:15], 0 offen sc1
  s_waitcnt vmcnt(0)
  v_readfirstlane_b32 s3, v19
  s_sub_u32 s28, s28, 1
  s_cbranch_scc1 L_abort
  s_cmp_ge_u32 s3, 256
  s_cbranch_scc1 L_wd_iwA
  s_sleep 8
  s_branch L_wn_iwA
L_wd_iwA:
  s_barrier
  s_mul_i32 s40, s38, 12288
  s_mov_b32 s4, 2048
  s_cmp_eq_u32 s36, 2
  s_cmov_b32 s4, 4096
  s_mul_i32 s4, s4, s39
  s_add_u32 s40, s40, s4
  s_mov_b32 s4, 8278016
  s_cmp_eq_u32 s36, 1
  s_cmov_b32 s4, 33443840
  s_cmp_eq_u32 s36, 2
  s_cmov_b32 s4, 58609664
  s_add_u32 s40, s40, s4
  s_cmp_eq_u32 s36, 2
  s_cbranch_scc1 L_A_V
  s_mov_b32 s31, 0
  s_mov_b32 s33, 0
  s_mov_b32 s34, 0
L_Aqk_top:
  s_mov_b32 s54, s31
  s_cmp_eq_u32 s33, 1
  s_cbranch_scc1 L_Aqk_pref
  s_waitcnt vmcnt(0)
  s_cmp_eq_u32 s34, 0
  s_cbranch_scc1 L_Aqk_npa
  s_mov_b64 exec, 1
  v_mov_b32 v29, s34
  v_mov_b32 v30, 0
  buffer_store_dword v29, v30, s[8:11], s35 offen sc1
  s_mov_b64 exec, -1
  s_mov_b32 s34, 0
L_Aqk_npa:
  s_mov_b32 s59, s31
  s_mul_i32 s32, s59, 40960
  s_add_u32 s32, s32, 5656576
  s_lshl_b32 s4, s24, 10
  s_add_u32 s32, s32, s4
  s_and_b32 s50, s31, 1
  s_mul_i32 s50, s50, 40960
  s_add_u32 s50, s50, s4
  s_add_u32 m0, s50, 0
  s_add_u32 s5, s32, 0
  buffer_load_dwordx4 v20, s[8:11], s5 offen sc1 lds
  s_add_u32 m0, s50, 4096
  s_add_u32 s5, s32, 4096
  buffer_load_dwordx4 v20, s[8:11], s5 offen sc1 lds
  s_add_u32 m0, s50, 8192
  s_add_u32 s5, s32, 8192
  buffer_load_dwordx4 v20, s[8:11], s5 offen sc1 lds
  s_add_u32 m0, s50, 12288
  s_add_u32 s5, s32, 12288
  buffer_load_dwordx4 v20, s[8:11], s5 offen sc1 lds
  s_add_u32 m0, s50, 16384
  s_add_u32 s5, s32, 16384
  buffer_load_dwordx4 v20, s[8:11], s5 offen sc1 lds
  s_add_u32 m0, s50, 20480
  s_add_u32 s5, s32, 20480
  buffer_load_dwordx4 v20, s[8:11], s5 offen sc1 lds
  s_add_u32 m0, s50, 24576
  s_add_u32 s5, s32, 24576
  buffer_load_dwordx4 v20, s[8:11], s5 offen sc1 lds
  s_add_u32 m0, s50, 28672
  s_add_u32 s5, s32, 28672
  buffer_load_dwordx4 v20, s[8:11], s5 offen sc1 lds
  s_add_u32 m0, s50, 32768
  s_add_u32 s5, s32, 32768
  buffer_load_dwordx4 v20, s[8:11], s5 offen sc1 lds
  s_add_u32 m0, s50, 36864
  s_add_u32 s5, s32, 36864
  buffer_load_dwordx4 v20, s[8:11], s5 offen sc1 lds
  s_mov_b32 s51, 1
  s_branch L_Aqk_go
L_Aqk_pref:
  s_waitcnt vmcnt(14)
  s_mov_b32 s51, 0
L_Aqk_go:
  s_and_b32 s6, s31, 1
  s_mul_i32 s6, s6, 40960
  v_add_u32 v24, s6, v20
  s_mov_b32 s33, 0
  s_add_u32 s7, s31, 1
  s_cmp_ge_u32 s7, s52
  s_cbranch_scc1 L_Aqk_cB
  s_mov_b32 s33, 1
  s_mov_b32 s59, s7
  s_mul_i32 s32, s59, 40960
  s_add_u32 s32, s32, 5656576
  s_lshl_b32 s4, s24, 10
  s_add_u32 s32, s32, s4
  s_and_b32 s50, s7, 1
  s_mul_i32 s50, s50, 40960
  s_add_u32 s50, s50, s4
  s_cmp_eq_u32 s51, 1
  s_cbranch_scc1 L_Aqk_cAc
  s_waitcnt vmcnt(5)
  s_barrier
  ds_read_b128 v[160:163], v24 offset:0
  ds_read_b128 v[164:167], v24 offset:1024
  ds_read_b128 v[168:171], v24 offset:2048
  ds_read_b128 v[172:175], v24 offset:3072
  s_waitcnt lgkmcnt(2)
  v_mfma_f32_16x16x32_bf16 v[128:131], a[0:3], v[160:163], 0
  v_mfma_f32_16x16x32_bf16 v[132:135], a[4:7], v[160:163], 0
  v_mfma_f32_16x16x32_bf16 v[136:139], a[8:11], v[160:163], 0
  v_mfma_f32_16x16x32_bf16 v[140:143], a[12:15], v[160:163], 0
  v_mfma_f32_16x16x32_bf16 v[144:147], a[0:3], v[164:167], 0
  v_mfma_f32_16x16x32_bf16 v[148:151], a[4:7], v[164:167], 0
  v_mfma_f32_16x16x32_bf16 v[152:155], a[8:11], v[164:167], 0
  v_mfma_f32_16x16x32_bf16 v[156:159], a[12:15], v[164:167], 0
  ds_read_b128 v[160:163], v24 offset:4096
  ds_read_b128 v[164:167], v24 offset:5120
  s_waitcnt lgkmcnt(2)
  v_mfma_f32_16x16x32_bf16 v[128:131], a[16:19], v[168:171], v[128:131]
  s_add_u32 m0, s50, 0
  s_add_u32 s5, s32, 0
  buffer_load_dwordx4 v20, s[8:11], s5 offen sc1 lds
  v_mfma_f32_16x16x32_bf16 v[132:135], a[20:23], v[168:171], v[132:135]
  v_mfma_f32_16x16x32_bf16 v[136:139], a[24:27], v[168:171], v[136:139]
  v_mfma_f32_16x16x32_bf16 v[140:143], a[28:31], v[168:171], v[140:143]
  v_mfma_f32_16x16x32_bf16 v[144:147], a[16:19], v[172:175], v[144:147]
  v_mfma_f32_16x16x32_bf16 v[148:151], a[20:23], v[172:175], v[148:151]
  v_mfma_f32_16x16x32_bf16 v[152:155], a[24:27], v[172:175], v[152:155]
  v_mfma_f32_16x16x32_bf16 v[156:159], a[28:31], v[172:175], v[156:159]
  ds_read_b128 v[168:171], v24 offset:6144
  ds_read_b128 v[172:175], v24 offset:7168
  s_waitcnt lgkmcnt(2)
  v_mfma_f32_16x16x32_bf16 v[128:131], a[32:35], v[160:163], v[128:131]
  v_mfma_f32_16x16x32_bf16 v[132:135], a[36:39], v[160:163], v[132:135]
  v_mfma_f32_16x16x32_bf16 v[136:139], a[40:43], v[160:163], v[136:139]
  v_mfma_f32_16x16x32_bf16 v[140:143], a[44:47], v[160:163], v[140:143]
  v_mfma_f32_16x16x32_bf16 v[144:147], a[32:35], v[164:167], v[144:147]
  v_mfma_f32_16x16x32_bf16 v[148:151], a[36:39], v[164:167], v[148:151]
  v_mfma_f32_16x16x32_bf16 v[152:155], a[40:43], v[164:167], v[152:155]
  v_mfma_f32_16x16x32_bf16 v[156:159], a[44:47], v[164:167], v[156:159]
  ds_read_b128 v[160:163], v24 offset:8192
  ds_read_b128 v[164:167], v24 offset:9216
  s_waitcnt lgkmcnt(2)
  v_mfma_f32_16x16x32_bf16 v[128:131], a[48:51], v[168:171], v[128:131]
  s_add_u32 m0, s50, 4096
  s_add_u32 s5, s32, 4096
  buffer_load_dwordx4 v20, s[8:11], s5 offen sc1 lds
  v_mfma_f32_16x16x32_bf16 v[132:135], a[52:55], v[168:171], v[132:135]
  v_mfma_f32_16x16x32_bf16 v[136:139], a[56:59], v[168:171], v[136:139]
  v_mfma_f32_16x16x32_bf16 v[140:143], a[60:63], v[168:171], v[140:143]
  v_mfma_f32_16x16x32_bf16 v[144:147], a[48:51], v[172:175], v[144:147]
  v_mfma_f32_16x16x32_bf16 v[148:151], a[52:55], v[172:175], v[148:151]
  v_mfma_f32_16x16x32_bf16 v[152:155], a[56:59], v[172:175], v[152:155]
  v_mfma_f32_16x16x32_bf16 v[156:159], a[60:63], v[172:175], v[156:159]
  ds_read_b128 v[168:171], v24 offset:10240
  ds_read_b128 v[172:175], v24 offset:11264
  s_waitcnt lgkmcnt(2)
  v_mfma_f32_16x16x32_bf16 v[128:131], a[64:67], v[160:163], v[128:131]
  v_mfma_f32_16x16x32_bf16 v[132:135], a[68:71], v[160:163], v[132:135]
  v_mfma_f32_16x16x32_bf16 v[136:139], a[72:75], v[160:163], v[136:139]
  v_mfma_f32_16x16x32_bf16 v[140:143], a[76:79], v[160:163], v[140:143]
  v_mfma_f32_16x16x32_bf16 v[144:147], a[64:67], v[164:167], v[144:147]
  v_mfma_f32_16x16x32_bf16 v[148:151], a[68:71], v[164:167], v[148:151]
  v_mfma_f32_16x16x32_bf16 v[152:155], a[72:75], v[164:167], v[152:155]
  v_mfma_f32_16x16x32_bf16 v[156:159], a[76:79], v[164:167], v[156:159]
  ds_read_b128 v[160:163], v24 offset:12288
  ds_read_b128 v[164:167], v24 offset:13312
  s_waitcnt lgkmcnt(2)
  v_mfma_f32_16x16x32_bf16 v[128:131], a[80:83], v[168:171], v[128:131]
  s_add_u32 m0, s50, 8192
  s_add_u32 s5, s32, 8192
  buffer_load_dwordx4 v20, s[8:11], s5 offen sc1 lds
  v_mfma_f32_16x16x32_bf16 v[132:135], a[84:87], v[168:171], v[132:135]
  v_mfma_f32_16x16x32_bf16 v[136:139], a[88:91], v[168:171], v[136:139]
  v_mfma_f32_16x16x32_bf16 v[140:143], a[92:95], v[168:171], v[140:143]
  v_mfma_f32_16x16x32_bf16 v[144:147], a[80:83], v[172:175], v[144:147]
  v_mfma_f32_16x16x32_bf16 v[148:151], a[84:87], v[172:175], v[148:151]
  v_mfma_f32_16x16x32_bf16 v[152:155], a[88:91], v[172:175], v[152:155]
  v_mfma_f32_16x16x32_bf16 v[156:159], a[92:95], v[172:175], v[156:159]
  ds_read_b128 v[168:171], v24 offset:14336
  ds_read_b128 v[172:175], v24 offset:15360
  s_waitcnt lgkmcnt(2)
  v_mfma_f32_16x16x32_bf16 v[128:131], a[96:99], v[160:163], v[128:131]
  v_mfma_f32_16x16x32_bf16 v[132:135], a[100:103], v[160:163], v[132:135]
  v_mfma_f32_16x16x32_bf16 v[136:139], a[104:107], v[160:163], v[136:139]
  v_mfma_f32_16x16x32_bf16 v[140:143], a[108:111], v[160:163], v[140:143]
  v_mfma_f32_16x16x32_bf16 v[144:147], a[96:99], v[164:167], v[144:147]
  v_mfma_f32_16x16x32_bf16 v[148:151], a[100:103], v[164:167], v[148:151]
  v_mfma_f32_16x16x32_bf16 v[152:155], a[104:107], v[164:167], v[152:155]
  v_mfma_f32_16x16x32_bf16 v[156:159], a[108:111], v[164:167], v[156:159]
  ds_read_b128 v[160:163], v24 offset:16384
  ds_read_b128 v[164:167], v24 offset:17408
  s_waitcnt lgkmcnt(2)
  v_mfma_f32_16x16x32_bf16 v[128:131], a[112:115], v[168:171], v[128:131]
  s_add_u32 m0, s50, 12288
  s_add_u32 s5, s32, 12288
  buffer_load_dwordx4 v20, s[8:11], s5 offen sc1 lds
  v_mfma_f32_16x16x32_bf16 v[132:135], a[116:119], v[168:171], v[132:135]
  v_mfma_f32_16x16x32_bf16 v[136:139], a[120:123], v[168:171], v[136:139]
  v_mfma_f32_16x16x32_bf16 v[140:143], a[124:127], v[168:171], v[140:143]
  v_mfma_f32_16x16x32_bf16 v[144:147], a[112:115], v[172:175], v[144:147]
  v_mfma_f32_16x16x32_bf16 v[148:151], a[116:119], v[172:175], v[148:151]
  v_mfma_f32_16x16x32_bf16 v[152:155], a[120:123], v[172:175], v[152:155]
  v_mfma_f32_16x16x32_bf16 v[156:159], a[124:127], v[172:175], v[156:159]
  ds_read_b128 v[168:171], v24 offset:18432
  ds_read_b128 v[172:175], v24 offset:19456
  s_waitcnt lgkmcnt(2)
  v_mfma_f32_16x16x32_bf16 v[128:131], a[128:131], v[160:163], v[128:131]
  v_mfma_f32_16x16x32_bf16 v[132:135], a[132:135], v[160:163], v[132:135]
  v_mfma_f32_16x16x32_bf16 v[136:139], a[136:139], v[160:163], v[136:139]
  v_mfma_f32_16x16x32_bf16 v[140:143], a[140:143], v[160:163], v[140:143]
  v_mfma_f32_16x16x32_bf16 v[144:147], a[128:131], v[164:167], v[144:147]
  v_mfma_f32_16x16x32_bf16 v[148:151], a[132:135], v[164:167], v[148:151]
  v_mfma_f32_16x16x32_bf16 v[152:155], a[136:139], v[164:167], v[152:155]
  v_mfma_f32_16x16x32_bf16 v[156:159], a[140:143], v[164:167], v[156:159]
  ds_read_b128 v[160:163], v24 offset:20480
  ds_read_b128 v[164:167], v24 offset:21504
  s_waitcnt lgkmcnt(2)
  v_mfma_f32_16x16x32_bf16 v[128:131], a[144:147], v[168:171], v[128:131]
  s_add_u32 m0, s50, 16384
  s_add_u32 s5, s32, 16384
  buffer_load_dwordx4 v20, s[8:11], s5 offen sc1 lds
  v_mfma_f32_16x16x32_bf16 v[132:135], a[148:151], v[168:171], v[132:135]
  v_mfma_f32_16x16x32_bf16 v[136:139], a[152:155], v[168:171], v[136:139]
  v_mfma_f32_16x16x32_bf16 v[140:143], a[156:159], v[168:171], v[140:143]
  v_mfma_f32_16x16x32_bf16 v[144:147], a[144:147], v[172:175], v[144:147]
  v_mfma_f32_16x16x32_bf16 v[148:151], a[148:151], v[172:175], v[148:151]
  v_mfma_f32_16x16x32_bf16 v[152:155], a[152:155], v[172:175], v[152:155]
  v_mfma_f32_16x16x32_bf16 v[156:159], a[156:159], v[172:175], v[156:159]
  ds_read_b128 v[168:171], v24 offset:22528
  ds_read_b128 v[172:175], v24 offset:23552
  s_waitcnt lgkmcnt(2)
  v_mfma_f32_16x16x32_bf16 v[128:131], a[160:163], v[160:163], v[128:131]
  v_mfma_f32_16x16x32_bf16 v[132:135], a[164:167], v[160:163], v[132:135]
  v_mfma_f32_16x16x32_bf16 v[136:139], a[168:171], v[160:163], v[136:139]
  v_mfma_f32_16x16x32_bf16 v[140:143], a[172:175], v[160:163], v[140:143]
  v_mfma_f32_16x16x32_bf16 v[144:147], a[160:163], v[164:167], v[144:147]
  v_mfma_f32_16x16x32_bf16 v[148:151], a[164:167], v[164:167], v[148:151]
  v_mfma_f32_16x16x32_bf16 v[152:155], a[168:171], v[164:167], v[152:155]
  v_mfma_f32_16x16x32_bf16 v[156:159], a[172:175], v[164:167], v[156:159]
  ds_read_b128 v[160:163], v24 offset:24576
  ds_read_b128 v[164:167], v24 offset:25600
  s_waitcnt lgkmcnt(2)
  v_mfma_f32_16x16x32_bf16 v[128:131], a[176:179], v[168:171], v[128:131]
  s_add_u32 m0, s50, 20480
  s_add_u32 s5, s32, 20480
  buffer_load_dwordx4 v20, s[8:11], s5 offen sc1 lds
  v_mfma_f32_16x16x32_bf16 v[132:135], a[180:183], v[168:171], v[132:135]
  v_mfma_f32_16x16x32_bf16 v[136:139], a[184:187], v[168:171], v[136:139]
  v_mfma_f32_16x16x32_bf16 v[140:143], a[188:191], v[168:171], v[140:143]
  v_mfma_f32_16x16x32_bf16 v[144:147], a[176:179], v[172:175], v[144:147]
  v_mfma_f32_16x16x32_bf16 v[148:151], a[180:183], v[172:175], v[148:151]
  v_mfma_f32_16x16x32_bf16 v[152:155], a[184:187], v[172:175], v[152:155]
  v_mfma_f32_16x16x32_bf16 v[156:159], a[188:191], v[172:175], v[156:159]
  ds_read_b128 v[168:171], v24 offset:26624
  ds_read_b128 v[172:175], v24 offset:27648
  s_waitcnt lgkmcnt(2)
  v_mfma_f32_16x16x32_bf16 v[128:131], a[192:195], v[160:163], v[128:131]
  v_mfma_f32_16x16x32_bf16 v[132:135], a[196:199], v[160:163], v[132:135]
  v_mfma_f32_16x16x32_bf16 v[136:139], a[200:203], v[160:163], v[136:139]
  v_mfma_f32_16x16x32_bf16 v[140:143], a[204:207], v[160:163], v[140:143]
  v_mfma_f32_16x16x32_bf16 v[144:147], a[192:195], v[164:167], v[144:147]
  v_mfma_f32_16x16x32_bf16 v[148:151], a[196:199], v[164:167], v[148:151]
  v_mfma_f32_16x16x32_bf16 v[152:155], a[200:203], v[164:167], v[152:155]
  v_mfma_f32_16x16x32_bf16 v[156:159], a[204:207], v[164:167], v[156:159]
  ds_read_b128 v[160:163], v24 offset:28672
  ds_read_b128 v[164:167], v24 offset:29696
  s_waitcnt lgkmcnt(2)
  v_mfma_f32_16x16x32_bf16 v[128:131], a[208:211], v[168:171], v[128:131]
  s_add_u32 m0, s50, 24576
  s_add_u32 s5, s32, 24576
  buffer_load_dwordx4 v20, s[8:11], s5 offen sc1 lds
  v_mfma_f32_16x16x32_bf16 v[132:135], a[212:215], v[168:171], v[132:135]
  v_mfma_f32_16x16x32_bf16 v[136:139], a[216:219], v[168:171], v[136:139]
  v_mfma_f32_16x16x32_bf16 v[140:143], a[220:223], v[168:171], v[140:143]
  v_mfma_f32_16x16x32_bf16 v[144:147], a[208:211], v[172:175], v[144:147]
  v_mfma_f32_16x16x32_bf16 v[148:151], a[212:215], v[172:175], v[148:151]
  v_mfma_f32_16x16x32_bf16 v[152:155], a[216:219], v[172:175], v[152:155]
  v_mfma_f32_16x16x32_bf16 v[156:159], a[220:223], v[172:175], v[156:159]
  ds_read_b128 v[168:171], v24 offset:30720
  ds_read_b128 v[172:175], v24 offset:31744
  s_waitcnt lgkmcnt(2)
  v_mfma_f32_16x16x32_bf16 v[128:131], a[224:227], v[160:163], v[128:131]
  v_mfma_f32_16x16x32_bf16 v[132:135], a[228:231], v[160:163], v[132:135]
  v_mfma_f32_16x16x32_bf16 v[136:139], a[232:235], v[160:163], v[136:139]
  v_mfma_f32_16x16x32_bf16 v[140:143], a[236:239], v[160:163], v[140:143]
  v_mfma_f32_16x16x32_bf16 v[144:147], a[224:227], v[164:167], v[144:147]
  v_mfma_f32_16x16x32_bf16 v[148:151], a[228:231], v[164:167], v[148:151]
  v_mfma_f32_16x16x32_bf16 v[152:155], a[232:235], v[164:167], v[152:155]
  v_mfma_f32_16x16x32_bf16 v[156:159], a[236:239], v[164:167], v[156:159]
  ds_read_b128 v[160:163], v24 offset:32768
  ds_read_b128 v[164:167], v24 offset:33792
  s_waitcnt lgkmcnt(2)
  v_mfma_f32_16x16x32_bf16 v[128:131], a[240:243], v[168:171], v[128:131]
  s_add_u32 m0, s50, 28672
  s_add_u32 s5, s32, 28672
  buffer_load_dwordx4 v20, s[8:11], s5 offen sc1 lds
  v_mfma_f32_16x16x32_bf16 v[132:135], a[244:247], v[168:171], v[132:135]
  v_mfma_f32_16x16x32_bf16 v[136:139], a[248:251], v[168:171], v[136:139]
  v_mfma_f32_16x16x32_bf16 v[140:143], a[252:255], v[168:171], v[140:143]
  v_mfma_f32_16x16x32_bf16 v[144:147], a[240:243], v[172:175], v[144:147]
  v_mfma_f32_16x16x32_bf16 v[148:151], a[244:247], v[172:175], v[148:151]
  v_mfma_f32_16x16x32_bf16 v[152:155], a[248:251], v[172:175], v[152:155]
  v_mfma_f32_16x16x32_bf16 v[156:159], a[252:255], v[172:175], v[156:159]
  ds_read_b128 v[168:171], v24 offset:34816
  ds_read_b128 v[172:175], v24 offset:35840
  s_waitcnt lgkmcnt(2)
  v_mfma_f32_16x16x32_bf16 v[128:131], v[192:195], v[160:163], v[128:131]
  v_mfma_f32_16x16x32_bf16 v[132:135], v[196:199], v[160:163], v[132:135]
  v_mfma_f32_16x16x32_bf16 v[136:139], v[200:203], v[160:163], v[136:139]
  v_mfma_f32_16x16x32_bf16 v[140:143], v[204:207], v[160:163], v[140:143]
  v_mfma_f32_16x16x32_bf16 v[144:147], v[192:195], v[164:167], v[144:147]
  v_mfma_f32_16x16x32_bf16 v[148:151], v[196:199], v[164:167], v[148:151]
  v_mfma_f32_16x16x32_bf16 v[152:155], v[200:203], v[164:167], v[152:155]
  v_mfma_f32_16x16x32_bf16 v[156:159], v[204:207], v[164:167], v[156:159]
  ds_read_b128 v[160:163], v24 offset:36864
  ds_read_b128 v[164:167], v24 offset:37888
  s_waitcnt lgkmcnt(2)
  v_mfma_f32_16x16x32_bf16 v[128:131], v[208:211], v[168:171], v[128:131]
  s_add_u32 m0, s50, 32768
  s_add_u32 s5, s32, 32768
  buffer_load_dwordx4 v20, s[8:11], s5 offen sc1 lds
  v_mfma_f32_16x16x32_bf16 v[132:135], v[212:215], v[168:171], v[132:135]
  v_mfma_f32_16x16x32_bf16 v[136:139], v[216:219], v[168:171], v[136:139]
  v_mfma_f32_16x16x32_bf16 v[140:143], v[220:223], v[168:171], v[140:143]
  v_mfma_f32_16x16x32_bf16 v[144:147], v[208:211], v[172:175], v[144:147]
  v_mfma_f32_16x16x32_bf16 v[148:151], v[212:215], v[172:175], v[148:151]
  v_mfma_f32_16x16x32_bf16 v[152:155], v[216:219], v[172:175], v[152:155]
  v_mfma_f32_16x16x32_bf16 v[156:159], v[220:223], v[172:175], v[156:159]
  ds_read_b128 v[168:171], v24 offset:38912
  ds_read_b128 v[172:175], v24 offset:39936
  s_waitcnt lgkmcnt(2)
  v_mfma_f32_16x16x32_bf16 v[128:131], v[224:227], v[160:163], v[128:131]
  v_mfma_f32_16x16x32_bf16 v[132:135], v[228:231], v[160:163], v[132:135]
  v_mfma_f32_16x16x32_bf16 v[136:139], v[232:235], v[160:163], v[136:139]
  v_mfma_f32_16x16x32_bf16 v[140:143], v[236:239], v[160:163], v[140:143]
  v_mfma_f32_16x16x32_bf16 v[144:147], v[224:227], v[164:167], v[144:147]
  v_mfma_f32_16x16x32_bf16 v[148:151], v[228:231], v[164:167], v[148:151]
  v_mfma_f32_16x16x32_bf16 v[152:155], v[232:235], v[164:167], v[152:155]
  v_mfma_f32_16x16x32_bf16 v[156:159], v[236:239], v[164:167], v[156:159]
  s_waitcnt lgkmcnt(0)
  v_mfma_f32_16x16x32_bf16 v[128:131], v[240:243], v[168:171], v[128:131]
  s_add_u32 m0, s50, 36864
  s_add_u32 s5, s32, 36864
  buffer_load_dwordx4 v20, s[8:11], s5 offen sc1 lds
  v_mfma_f32_16x16x32_bf16 v[132:135], v[244:247], v[168:171], v[132:135]
  v_mfma_f32_16x16x32_bf16 v[136:139], v[248:251], v[168:171], v[136:139]
  v_mfma_f32_16x16x32_bf16 v[140:143], v[252:255], v[168:171], v[140:143]
  v_mfma_f32_16x16x32_bf16 v[144:147], v[240:243], v[172:175], v[144:147]
  v_mfma_f32_16x16x32_bf16 v[148:151], v[244:247], v[172:175], v[148:151]
  v_mfma_f32_16x16x32_bf16 v[152:155], v[248:251], v[172:175], v[152:155]
  v_mfma_f32_16x16x32_bf16 v[156:159], v[252:255], v[172:175], v[156:159]
  s_waitcnt vmcnt(10)
  s_branch L_Aqk_ep
L_Aqk_cAc:
  s_waitcnt vmcnt(0)
  s_barrier
  ds_read_b128 v[160:163], v24 offset:0
  ds_read_b128 v[164:167], v24 offset:1024
  ds_read_b128 v[168:171], v24 offset:2048
  ds_read_b128 v[172:175], v24 offset:3072
  s_waitcnt lgkmcnt(2)
  v_mfma_f32_16x16x32_bf16 v[128:131], a[0:3], v[160:163], 0
  v_mfma_f32_16x16x32_bf16 v[132:135], a[4:7], v[160:163], 0
  v_mfma_f32_16x16x32_bf16 v[136:139], a[8:11], v[160:163], 0
  v_mfma_f32_16x16x32_bf16 v[140:143], a[12:15], v[160:163], 0
  v_mfma_f32_16x16x32_bf16 v[144:147], a[0:3], v[164:167], 0
  v_mfma_f32_16x16x32_bf16 v[148:151], a[4:7], v[164:167], 0
  v_mfma_f32_16x16x32_bf16 v[152:155], a[8:11], v[164:167], 0
  v_mfma_f32_16x16x32_bf16 v[156:159], a[12:15], v[164:167], 0
  ds_read_b128 v[160:163], v24 offset:4096
  ds_read_b128 v[164:167], v24 offset:5120
  s_waitcnt lgkmcnt(2)
  v_mfma_f32_16x16x32_bf16 v[128:131], a[16:19], v[168:171], v[128:131]
  s_add_u32 m0, s50, 0
  s_add_u32 s5, s32, 0
  buffer_load_dwordx4 v20, s[8:11], s5 offen sc1 lds
  v_mfma_f32_16x16x32_bf16 v[132:135], a[20:23], v[168:171], v[132:135]
  v_mfma_f32_16x16x32_bf16 v[136:139], a[24:27], v[168:171], v[136:139]
  v_mfma_f32_16x16x32_bf16 v[140:143], a[28:31], v[168:171], v[140:143]
  v_mfma_f32_16x16x32_bf16 v[144:147], a[16:19], v[172:175], v[144:147]
  v_mfma_f32_16x16x32_bf16 v[148:151], a[20:23], v[172:175], v[148:151]
  v_mfma_f32_16x16x32_bf16 v[152:155], a[24:27], v[172:175], v[152:155]
  v_mfma_f32_16x16x32_bf16 v[156:159], a[28:31], v[172:175], v[156:159]
  ds_read_b128 v[168:171], v24 offset:6144
  ds_read_b128 v[172:175], v24 offset:7168
  s_waitcnt lgkmcnt(2)
  v_mfma_f32_16x16x32_bf16 v[128:131], a[32:35], v[160:163], v[128:131]
  v_mfma_f32_16x16x32_bf16 v[132:135], a[36:39], v[160:163], v[132:135]
  v_mfma_f32_16x16x32_bf16 v[136:139], a[40:43], v[160:163], v[136:139]
  v_mfma_f32_16x16x32_bf16 v[140:143], a[44:47], v[160:163], v[140:143]
  v_mfma_f32_16x16x32_bf16 v[144:147], a[32:35], v[164:167], v[144:147]
  v_mfma_f32_16x16x32_bf16 v[148:151], a[36:39], v[164:167], v[148:151]
  v_mfma_f32_16x16x32_bf16 v[152:155], a[40:43], v[164:167], v[152:155]
  v_mfma_f32_16x16x32_bf16 v[156:159], a[44:47], v[164:167], v[156:159]
  ds_read_b128 v[160:163], v24 offset:8192
  ds_read_b128 v[164:167], v24 offset:9216
  s_waitcnt lgkmcnt(2)
  v_mfma_f32_16x16x32_bf16 v[128:131], a[48:51], v[168:171], v[128:131]
  s_add_u32 m0, s50, 4096
  s_add_u32 s5, s32, 4096
  buffer_load_dwordx4 v20, s[8:11], s5 offen sc1 lds
  v_mfma_f32_16x16x32_bf16 v[132:135], a[52:55], v[168:171], v[132:135]
  v_mfma_f32_16x16x32_bf16 v[136:139], a[56:59], v[168:171], v[136:139]
  v_mfma_f32_16x16x32_bf16 v[140:143], a[60:63], v[168:171], v[140:143]
  v_mfma_f32_16x16x32_bf16 v[144:147], a[48:51], v[172:175], v[144:147]
  v_mfma_f32_16x16x32_bf16 v[148:151], a[52:55], v[172:175], v[148:151]
  v_mfma_f32_16x16x32_bf16 v[152:155], a[56:59], v[172:175], v[152:155]
  v_mfma_f32_16x16x32_bf16 v[156:159], a[60:63], v[172:175], v[156:159]
  ds_read_b128 v[168:171], v24 offset:10240
  ds_read_b128 v[172:175], v24 offset:11264
  s_waitcnt lgkmcnt(2)
  v_mfma_f32_16x16x32_bf16 v[128:131], a[64:67], v[160:163], v[128:131]
  v_mfma_f32_16x16x32_bf16 v[132:135], a[68:71], v[160:163], v[132:135]
  v_mfma_f32_16x16x32_bf16 v[136:139], a[72:75], v[160:163], v[136:139]
  v_mfma_f32_16x16x32_bf16 v[140:143], a[76:79], v[160:163], v[140:143]
  v_mfma_f32_16x16x32_bf16 v[144:147], a[64:67], v[164:167], v[144:147]
  v_mfma_f32_16x16x32_bf16 v[148:151], a[68:71], v[164:167], v[148:151]
  v_mfma_f32_16x16x32_bf16 v[152:155], a[72:75], v[164:167], v[152:155]
  v_mfma_f32_16x16x32_bf16 v[156:159], a[76:79], v[164:167], v[156:159]
  ds_read_b128 v[160:163], v24 offset:12288
  ds_read_b128 v[164:167], v24 offset:13312
  s_waitcnt lgkmcnt(2)
  v_mfma_f32_16x16x32_bf16 v[128:131], a[80:83], v[168:171], v[128:131]
  s_add_u32 m0, s50, 8192
  s_add_u32 s5, s32, 8192
  buffer_load_dwordx4 v20, s[8:11], s5 offen sc1 lds
  v_mfma_f32_16x16x32_bf16 v[132:135], a[84:87], v[168:171], v[132:135]
  v_mfma_f32_16x16x32_bf16 v[136:139], a[88:91], v[168:171], v[136:139]
  v_mfma_f32_16x16x32_bf16 v[140:143], a[92:95], v[168:171], v[140:143]
  v_mfma_f32_16x16x32_bf16 v[144:147], a[80:83], v[172:175], v[144:147]
  v_mfma_f32_16x16x32_bf16 v[148:151], a[84:87], v[172:175], v[148:151]
  v_mfma_f32_16x16x32_bf16 v[152:155], a[88:91], v[172:175], v[152:155]
  v_mfma_f32_16x16x32_bf16 v[156:159], a[92:95], v[172:175], v[156:159]
  ds_read_b128 v[168:171], v24 offset:14336
  ds_read_b128 v[172:175], v24 offset:15360
  s_waitcnt lgkmcnt(2)
  v_mfma_f32_16x16x32_bf16 v[128:131], a[96:99], v[160:163], v[128:131]
  v_mfma_f32_16x16x32_bf16 v[132:135], a[100:103], v[160:163], v[132:135]
  v_mfma_f32_16x16x32_bf16 v[136:139], a[104:107], v[160:163], v[136:139]
  v_mfma_f32_16x16x32_bf16 v[140:143], a[108:111], v[160:163], v[140:143]
  v_mfma_f32_16x16x32_bf16 v[144:147], a[96:99], v[164:167], v[144:147]
  v_mfma_f32_16x16x32_bf16 v[148:151], a[100:103], v[164:167], v[148:151]
  v_mfma_f32_16x16x32_bf16 v[152:155], a[104:107], v[164:167], v[152:155]
  v_mfma_f32_16x16x32_bf16 v[156:159], a[108:111], v[164:167], v[156:159]
  ds_read_b128 v[160:163], v24 offset:16384
  ds_read_b128 v[164:167], v24 offset:17408
  s_waitcnt lgkmcnt(2)
  v_mfma_f32_16x16x32_bf16 v[128:131], a[112:115], v[168:171], v[128:131]
  s_add_u32 m0, s50, 12288
  s_add_u32 s5, s32, 12288
  buffer_load_dwordx4 v20, s[8:11], s5 offen sc1 lds
  v_mfma_f32_16x16x32_bf16 v[132:135], a[116:119], v[168:171], v[132:135]
  v_mfma_f32_16x16x32_bf16 v[136:139], a[120:123], v[168:171], v[136:139]
  v_mfma_f32_16x16x32_bf16 v[140:143], a[124:127], v[168:171], v[140:143]
  v_mfma_f32_16x16x32_bf16 v[144:147], a[112:115], v[172:175], v[144:147]
  v_mfma_f32_16x16x32_bf16 v[148:151], a[116:119], v[172:175], v[148:151]
  v_mfma_f32_16x16x32_bf16 v[152:155], a[120:123], v[172:175], v[152:155]
  v_mfma_f32_16x16x32_bf16 v[156:159], a[124:127], v[172:175], v[156:159]
  ds_read_b128 v[168:171], v24 offset:18432
  ds_read_b128 v[172:175], v24 offset:19456
  s_waitcnt lgkmcnt(2)
  v_mfma_f32_16x16x32_bf16 v[128:131], a[128:131], v[160:163], v[128:131]
  v_mfma_f32_16x16x32_bf16 v[132:135], a[132:135], v[160:163], v[132:135]
  v_mfma_f32_16x16x32_bf16 v[136:139], a[136:139], v[160:163], v[136:139]
  v_mfma_f32_16x16x32_bf16 v[140:143], a[140:143], v[160:163], v[140:143]
  v_mfma_f32_16x16x32_bf16 v[144:147], a[128:131], v[164:167], v[144:147]
  v_mfma_f32_16x16x32_bf16 v[148:151], a[132:135], v[164:167], v[148:151]
  v_mfma_f32_16x16x32_bf16 v[152:155], a[136:139], v[164:167], v[152:155]
  v_mfma_f32_16x16x32_bf16 v[156:159], a[140:143], v[164:167], v[156:159]
  ds_read_b128 v[160:163], v24 offset:20480
  ds_read_b128 v[164:167], v24 offset:21504
  s_waitcnt lgkmcnt(2)
  v_mfma_f32_16x16x32_bf16 v[128:131], a[144:147], v[168:171], v[128:131]
  s_add_u32 m0, s50, 16384
  s_add_u32 s5, s32, 16384
  buffer_load_dwordx4 v20, s[8:11], s5 offen sc1 lds
  v_mfma_f32_16x16x32_bf16 v[132:135], a[148:151], v[168:171], v[132:135]
  v_mfma_f32_16x16x32_bf16 v[136:139], a[152:155], v[168:171], v[136:139]
  v_mfma_f32_16x16x32_bf16 v[140:143], a[156:159], v[168:171], v[140:143]
  v_mfma_f32_16x16x32_bf16 v[144:147], a[144:147], v[172:175], v[144:147]
  v_mfma_f32_16x16x32_bf16 v[148:151], a[148:151], v[172:175], v[148:151]
  v_mfma_f32_16x16x32_bf16 v[152:155], a[152:155], v[172:175], v[152:155]
  v_mfma_f32_16x16x32_bf16 v[156:159], a[156:159], v[172:175], v[156:159]
  ds_read_b128 v[168:171], v24 offset:22528
  ds_read_b128 v[172:175], v24 offset:23552
  s_waitcnt lgkmcnt(2)
  v_mfma_f32_16x16x32_bf16 v[128:131], a[160:163], v[160:163], v[128:131]
  v_mfma_f32_16x16x32_bf16 v[132:135], a[164:167], v[160:163], v[132:135]
  v_mfma_f32_16x16x32_bf16 v[136:139], a[168:171], v[160:163], v[136:139]
  v_mfma_f32_16x16x32_bf16 v[140:143], a[172:175], v[160:163], v[140:143]
  v_mfma_f32_16x16x32_bf16 v[144:147], a[160:163], v[164:167], v[144:147]
  v_mfma_f32_16x16x32_bf16 v[148:151], a[164:167], v[164:167], v[148:151]
  v_mfma_f32_16x16x32_bf16 v[152:155], a[168:171], v[164:167], v[152:155]
  v_mfma_f32_16x16x32_bf16 v[156:159], a[172:175], v[164:167], v[156:159]
  ds_read_b128 v[160:163], v24 offset:24576
  ds_read_b128 v[164:167], v24 offset:25600
  s_waitcnt lgkmcnt(2)
  v_mfma_f32_16x16x32_bf16 v[128:131], a[176:179], v[168:171], v[128:131]
  s_add_u32 m0, s50, 20480
  s_add_u32 s5, s32, 20480
  buffer_load_dwordx4 v20, s[8:11], s5 offen sc1 lds
  v_mfma_f32_16x16x32_bf16 v[132:135], a[180:183], v[168:171], v[132:135]
  v_mfma_f32_16x16x32_bf16 v[136:139], a[184:187], v[168:171], v[136:139]
  v_mfma_f32_16x16x32_bf16 v[140:143], a[188:191], v[168:171], v[140:143]
  v_mfma_f32_16x16x32_bf16 v[144:147], a[176:179], v[172:175], v[144:147]
  v_mfma_f32_16x16x32_bf16 v[148:151], a[180:183], v[172:175], v[148:151]
  v_mfma_f32_16x16x32_bf16 v[152:155], a[184:187], v[172:175], v[152:155]
  v_mfma_f32_16x16x32_bf16 v[156:159], a[188:191], v[172:175], v[156:159]
  ds_read_b128 v[168:171], v24 offset:26624
  ds_read_b128 v[172:175], v24 offset:27648
  s_waitcnt lgkmcnt(2)
  v_mfma_f32_16x16x32_bf16 v[128:131], a[192:195], v[160:163], v[128:131]
  v_mfma_f32_16x16x32_bf16 v[132:135], a[196:199], v[160:163], v[132:135]
  v_mfma_f32_16x16x32_bf16 v[136:139], a[200:203], v[160:163], v[136:139]
  v_mfma_f32_16x16x32_bf16 v[140:143], a[204:207], v[160:163], v[140:143]
  v_mfma_f32_16x16x32_bf16 v[144:147], a[192:195], v[164:167], v[144:147]
  v_mfma_f32_16x16x32_bf16 v[148:151], a[196:199], v[164:167], v[148:151]
  v_mfma_f32_16x16x32_bf16 v[152:155], a[200:203], v[164:167], v[152:155]
  v_mfma_f32_16x16x32_bf16 v[156:159], a[204:207], v[164:167], v[156:159]
  ds_read_b128 v[160:163], v24 offset:28672
  ds_read_b128 v[164:167], v24 offset:29696
  s_waitcnt lgkmcnt(2)
  v_mfma_f32_16x16x32_bf16 v[128:131], a[208:211], v[168:171], v[128:131]
  s_add_u32 m0, s50, 24576
  s_add_u32 s5, s32, 24576
  buffer_load_dwordx4 v20, s[8:11], s5 offen sc1 lds
  v_mfma_f32_16x16x32_bf16 v[132:135], a[212:215], v[168:171], v[132:135]
  v_mfma_f32_16x16x32_bf16 v[136:139], a[216:219], v[168:171], v[136:139]
  v_mfma_f32_16x16x32_bf16 v[140:143], a[220:223], v[168:171], v[140:143]
  v_mfma_f32_16x16x32_bf16 v[144:147], a[208:211], v[172:175], v[144:147]
  v_mfma_f32_16x16x32_bf16 v[148:151], a[212:215], v[172:175], v[148:151]
  v_mfma_f32_16x16x32_bf16 v[152:155], a[216:219], v[172:175], v[152:155]
  v_mfma_f32_16x16x32_bf16 v[156:159], a[220:223], v[172:175], v[156:159]
  ds_read_b128 v[168:171], v24 offset:30720
  ds_read_b128 v[172:175], v24 offset:31744
  s_waitcnt lgkmcnt(2)
  v_mfma_f32_16x16x32_bf16 v[128:131], a[224:227], v[160:163], v[128:131]
  v_mfma_f32_16x16x32_bf16 v[132:135], a[228:231], v[160:163], v[132:135]
  v_mfma_f32_16x16x32_bf16 v[136:139], a[232:235], v[160:163], v[136:139]
  v_mfma_f32_16x16x32_bf16 v[140:143], a[236:239], v[160:163], v[140:143]
  v_mfma_f32_16x16x32_bf16 v[144:147], a[224:227], v[164:167], v[144:147]
  v_mfma_f32_16x16x32_bf16 v[148:151], a[228:231], v[164:167], v[148:151]
  v_mfma_f32_16x16x32_bf16 v[152:155], a[232:235], v[164:167], v[152:155]
  v_mfma_f32_16x16x32_bf16 v[156:159], a[236:239], v[164:167], v[156:159]
  ds_read_b128 v[160:163], v24 offset:32768
  ds_read_b128 v[164:167], v24 offset:33792
  s_waitcnt lgkmcnt(2)
  v_mfma_f32_16x16x32_bf16 v[128:131], a[240:243], v[168:171], v[128:131]
  s_add_u32 m0, s50, 28672
  s_add_u32 s5, s32, 28672
  buffer_load_dwordx4 v20, s[8:11], s5 offen sc1 lds
  v_mfma_f32_16x16x32_bf16 v[132:135], a[244:247], v[168:171], v[132:135]
  v_mfma_f32_16x16x32_bf16 v[136:139], a[248:251], v[168:171], v[136:139]
  v_mfma_f32_16x16x32_bf16 v[140:143], a[252:255], v[168:171], v[140:143]
  v_mfma_f32_16x16x32_bf16 v[144:147], a[240:243], v[172:175], v[144:147]
  v_mfma_f32_16x16x32_bf16 v[148:151], a[244:247], v[172:175], v[148:151]
  v_mfma_f32_16x16x32_bf16 v[152:155], a[248:251], v[172:175], v[152:155]
  v_mfma_f32_16x16x32_bf16 v[156:159], a[252:255], v[172:175], v[156:159]
  ds_read_b128 v[168:171], v24 offset:34816
  ds_read_b128 v[172:175], v24 offset:35840
  s_waitcnt lgkmcnt(2)
  v_mfma_f32_16x16x32_bf16 v[128:131], v[192:195], v[160:163], v[128:131]
  v_mfma_f32_16x16x32_bf16 v[132:135], v[196:199], v[160:163], v[132:135]
  v_mfma_f32_16x16x32_bf16 v[136:139], v[200:203], v[160:163], v[136:139]
  v_mfma_f32_16x16x32_bf16 v[140:143], v[204:207], v[160:163], v[140:143]
  v_mfma_f32_16x16x32_bf16 v[144:147], v[192:195], v[164:167], v[144:147]
  v_mfma_f32_16x16x32_bf16 v[148:151], v[196:199], v[164:167], v[148:151]
  v_mfma_f32_16x16x32_bf16 v[152:155], v[200:203], v[164:167], v[152:155]
  v_mfma_f32_16x16x32_bf16 v[156:159], v[204:207], v[164:167], v[156:159]
  ds_read_b128 v[160:163], v24 offset:36864
  ds_read_b128 v[164:167], v24 offset:37888
  s_waitcnt lgkmcnt(2)
  v_mfma_f32_16x16x32_bf16 v[128:131], v[208:211], v[168:171], v[128:131]
  s_add_u32 m0, s50, 32768
  s_add_u32 s5, s32, 32768
  buffer_load_dwordx4 v20, s[8:11], s5 offen sc1 lds
  v_mfma_f32_16x16x32_bf16 v[132:135], v[212:215], v[168:171], v[132:135]
  v_mfma_f32_16x16x32_bf16 v[136:139], v[216:219], v[168:171], v[136:139]
  v_mfma_f32_16x16x32_bf16 v[140:143], v[220:223], v[168:171], v[140:143]
  v_mfma_f32_16x16x32_bf16 v[144:147], v[208:211], v[172:175], v[144:147]
  v_mfma_f32_16x16x32_bf16 v[148:151], v[212:215], v[172:175], v[148:151]
  v_mfma_f32_16x16x32_bf16 v[152:155], v[216:219], v[172:175], v[152:155]
  v_mfma_f32_16x16x32_bf16 v[156:159], v[220:223], v[172:175], v[156:159]
  ds_read_b128 v[168:171], v24 offset:38912
  ds_read_b128 v[172:175], v24 offset:39936
  s_waitcnt lgkmcnt(2)
  v_mfma_f32_16x16x32_bf16 v[128:131], v[224:227], v[160:163], v[128:131]
  v_mfma_f32_16x16x32_bf16 v[132:135], v[228:231], v[160:163], v[132:135]
  v_mfma_f32_16x16x32_bf16 v[136:139], v[232:235], v[160:163], v[136:139]
  v_mfma_f32_16x16x32_bf16 v[140:143], v[236:239], v[160:163], v[140:143]
  v_mfma_f32_16x16x32_bf16 v[144:147], v[224:227], v[164:167], v[144:147]
  v_mfma_f32_16x16x32_bf16 v[148:151], v[228:231], v[164:167], v[148:151]
  v_mfma_f32_16x16x32_bf16 v[152:155], v[232:235], v[164:167], v[152:155]
  v_mfma_f32_16x16x32_bf16 v[156:159], v[236:239], v[164:167], v[156:159]
  s_waitcnt lgkmcnt(0)
  v_mfma_f32_16x16x32_bf16 v[128:131], v[240:243], v[168:171], v[128:131]
  s_add_u32 m0, s50, 36864
  s_add_u32 s5, s32, 36864
  buffer_load_dwordx4 v20, s[8:11], s5 offen sc1 lds
  v_mfma_f32_16x16x32_bf16 v[132:135], v[244:247], v[168:171], v[132:135]
  v_mfma_f32_16x16x32_bf16 v[136:139], v[248:251], v[168:171], v[136:139]
  v_mfma_f32_16x16x32_bf16 v[140:143], v[252:255], v[168:171], v[140:143]
  v_mfma_f32_16x16x32_bf16 v[144:147], v[240:243], v[172:175], v[144:147]
  v_mfma_f32_16x16x32_bf16 v[148:151], v[244:247], v[172:175], v[148:151]
  v_mfma_f32_16x16x32_bf16 v[152:155], v[248:251], v[172:175], v[152:155]
  v_mfma_f32_16x16x32_bf16 v[156:159], v[252:255], v[172:175], v[156:159]
  s_waitcnt vmcnt(10)
  s_branch L_Aqk_ep
L_Aqk_cB:
  s_cmp_eq_u32 s51, 1
  s_cbranch_scc1 L_Aqk_cBc
  s_waitcnt vmcnt(5)
  s_barrier
  ds_read_b128 v[160:163], v24 offset:0
  ds_read_b128 v[164:167], v24 offset:1024
  ds_read_b128 v[168:171], v24 offset:2048
  ds_read_b128 v[172:175], v24 offset:3072
  s_waitcnt lgkmcnt(2)
  v_mfma_f32_16x16x32_bf16 v[128:131], a[0:3], v[160:163], 0
  v_mfma_f32_16x16x32_bf16 v[132:135], a[4:7], v[160:163], 0
  v_mfma_f32_16x16x32_bf16 v[136:139], a[8:11], v[160:163], 0
  v_mfma_f32_16x16x32_bf16 v[140:143], a[12:15], v[160:163], 0
  v_mfma_f32_16x16x32_bf16 v[144:147], a[0:3], v[164:167], 0
  v_mfma_f32_16x16x32_bf16 v[148:151], a[4:7], v[164:167], 0
  v_mfma_f32_16x16x32_bf16 v[152:155], a[8:11], v[164:167], 0
  v_mfma_f32_16x16x32_bf16 v[156:159], a[12:15], v[164:167], 0
  ds_read_b128 v[160:163], v24 offset:4096
  ds_read_b128 v[164:167], v24 offset:5120
  s_waitcnt lgkmcnt(2)
  v_mfma_f32_16x16x32_bf16 v[128:131], a[16:19], v[168:171], v[128:131]
  v_mfma_f32_16x16x32_bf16 v[132:135], a[20:23], v[168:171], v[132:135]
  v_mfma_f32_16x16x32_bf16 v[136:139], a[24:27], v[168:171], v[136:139]
  v_mfma_f32_16x16x32_bf16 v[140:143], a[28:31], v[168:171], v[140:143]
  v_mfma_f32_16x16x32_bf16 v[144:147], a[16:19], v[172:175], v[144:147]
  v_mfma_f32_16x16x32_bf16 v[148:151], a[20:23], v[172:175], v[148:151]
  v_mfma_f32_16x16x32_bf16 v[152:155], a[24:27], v[172:175], v[152:155]
  v_mfma_f32_16x16x32_bf16 v[156:159], a[28:31], v[172:175], v[156:159]
  ds_read_b128 v[168:171], v24 offset:6144
  ds_read_b128 v[172:175], v24 offset:7168
  s_waitcnt lgkmcnt(2)
  v_mfma_f32_16x16x32_bf16 v[128:131], a[32:35], v[160:163], v[128:131]
  v_mfma_f32_16x16x32_bf16 v[132:135], a[36:39], v[160:163], v[132:135]
  v_mfma_f32_16x16x32_bf16 v[136:139], a[40:43], v[160:163], v[136:139]
  v_mfma_f32_16x16x32_bf16 v[140:143], a[44:47], v[160:163], v[140:143]
  v_mfma_f32_16x16x32_bf16 v[144:147], a[32:35], v[164:167], v[144:147]
  v_mfma_f32_16x16x32_bf16 v[148:151], a[36:39], v[164:167], v[148:151]
  v_mfma_f32_16x16x32_bf16 v[152:155], a[40:43], v[164:167], v[152:155]
  v_mfma_f32_16x16x32_bf16 v[156:159], a[44:47], v[164:167], v[156:159]
  ds_read_b128 v[160:163], v24 offset:8192
  ds_read_b128 v[164:167], v24 offset:9216
  s_waitcnt lgkmcnt(2)
  v_mfma_f32_16x16x32_bf16 v[128:131], a[48:51], v[168:171], v[128:131]
  v_mfma_f32_16x16x32_bf16 v[132:135], a[52:55], v[168:171], v[132:135]
  v_mfma_f32_16x16x32_bf16 v[136:139], a[56:59], v[168:171], v[136:139]
  v_mfma_f32_16x16x32_bf16 v[140:143], a[60:63], v[168:171], v[140:143]
  v_mfma_f32_16x16x32_bf16 v[144:147], a[48:51], v[172:175], v[144:147]
  v_mfma_f32_16x16x32_bf16 v[148:151], a[52:55], v[172:175], v[148:151]
  v_mfma_f32_16x16x32_bf16 v[152:155], a[56:59], v[172:175], v[152:155]
  v_mfma_f32_16x16x32_bf16 v[156:159], a[60:63], v[172:175], v[156:159]
  ds_read_b128 v[168:171], v24 offset:10240
  ds_read_b128 v[172:175], v24 offset:11264
  s_waitcnt lgkmcnt(2)
  v_mfma_f32_16x16x32_bf16 v[128:131], a[64:67], v[160:163], v[128:131]
  v_mfma_f32_16x16x32_bf16 v[132:135], a[68:71], v[160:163], v[132:135]
  v_mfma_f32_16x16x32_bf16 v[136:139], a[72:75], v[160:163], v[136:139]
  v_mfma_f32_16x16x32_bf16 v[140:143], a[76:79], v[160:163], v[140:143]
  v_mfma_f32_16x16x32_bf16 v[144:147], a[64:67], v[164:167], v[144:147]
  v_mfma_f32_16x16x32_bf16 v[148:151], a[68:71], v[164:167], v[148:151]
  v_mfma_f32_16x16x32_bf16 v[152:155], a[72:75], v[164:167], v[152:155]
  v_mfma_f32_16x16x32_bf16 v[156:159], a[76:79], v[164:167], v[156:159]
  ds_read_b128 v[160:163], v24 offset:12288
  ds_read_b128 v[164:167], v24 offset:13312
  s_waitcnt lgkmcnt(2)
  v_mfma_f32_16x16x32_bf16 v[128:131], a[80:83], v[168:171], v[128:131]
  v_mfma_f32_16x16x32_bf16 v[132:135], a[84:87], v[168:171], v[132:135]
  v_mfma_f32_16x16x32_bf16 v[136:139], a[88:91], v[168:171], v[136:139]
  v_mfma_f32_16x16x32_bf16 v[140:143], a[92:95], v[168:171], v[140:143]
  v_mfma_f32_16x16x32_bf16 v[144:147], a[80:83], v[172:175], v[144:147]
  v_mfma_f32_16x16x32_bf16 v[148:151], a[84:87], v[172:175], v[148:151]
  v_mfma_f32_16x16x32_bf16 v[152:155], a[88:91], v[172:175], v[152:155]
  v_mfma_f32_16x16x32_bf16 v[156:159], a[92:95], v[172:175], v[156:159]
  ds_read_b128 v[168:171], v24 offset:14336
  ds_read_b128 v[172:175], v24 offset:15360
  s_waitcnt lgkmcnt(2)
  v_mfma_f32_16x16x32_bf16 v[128:131], a[96:99], v[160:163], v[128:131]
  v_mfma_f32_16x16x32_bf16 v[132:135], a[100:103], v[160:163], v[132:135]
  v_mfma_f32_16x16x32_bf16 v[136:139], a[104:107], v[160:163], v[136:139]
  v_mfma_f32_16x16x32_bf16 v[140:143], a[108:111], v[160:163], v[140:143]
  v_mfma_f32_16x16x32_bf16 v[144:147], a[96:99], v[164:167], v[144:147]
  v_mfma_f32_16x16x32_bf16 v[148:151], a[100:103], v[164:167], v[148:151]
  v_mfma_f32_16x16x32_bf16 v[152:155], a[104:107], v[164:167], v[152:155]
  v_mfma_f32_16x16x32_bf16 v[156:159], a[108:111], v[164:167], v[156:159]
  ds_read_b128 v[160:163], v24 offset:16384
  ds_read_b128 v[164:167], v24 offset:17408
  s_waitcnt lgkmcnt(2)
  v_mfma_f32_16x16x32_bf16 v[128:131], a[112:115], v[168:171], v[128:131]
  v_mfma_f32_16x16x32_bf16 v[132:135], a[116:119], v[168:171], v[132:135]
  v_mfma_f32_16x16x32_bf16 v[136:139], a[120:123], v[168:171], v[136:139]
  v_mfma_f32_16x16x32_bf16 v[140:143], a[124:127], v[168:171], v[140:143]
  v_mfma_f32_16x16x32_bf16 v[144:147], a[112:115], v[172:175], v[144:147]
  v_mfma_f32_16x16x32_bf16 v[148:151], a[116:119], v[172:175], v[148:151]
  v_mfma_f32_16x16x32_bf16 v[152:155], a[120:123], v[172:175], v[152:155]
  v_mfma_f32_16x16x32_bf16 v[156:159], a[124:127], v[172:175], v[156:159]
  ds_read_b128 v[168:171], v24 offset:18432
  ds_read_b128 v[172:175], v24 offset:19456
  s_waitcnt lgkmcnt(2)
  v_mfma_f32_16x16x32_bf16 v[128:131], a[128:131], v[160:163], v[128:131]
  v_mfma_f32_16x16x32_bf16 v[132:135], a[132:135], v[160:163], v[132:135]
  v_mfma_f32_16x16x32_bf16 v[136:139], a[136:139], v[160:163], v[136:139]
  v_mfma_f32_16x16x32_bf16 v[140:143], a[140:143], v[160:163], v[140:143]
  v_mfma_f32_16x16x32_bf16 v[144:147], a[128:131], v[164:167], v[144:147]
  v_mfma_f32_16x16x32_bf16 v[148:151], a[132:135], v[164:167], v[148:151]
  v_mfma_f32_16x16x32_bf16 v[152:155], a[136:139], v[164:167], v[152:155]
  v_mfma_f32_16x16x32_bf16 v[156:159], a[140:143], v[164:167], v[156:159]
  ds_read_b128 v[160:163], v24 offset:20480
  ds_read_b128 v[164:167], v24 offset:21504
  s_waitcnt lgkmcnt(2)
  v_mfma_f32_16x16x32_bf16 v[128:131], a[144:147], v[168:171], v[128:131]
  v_mfma_f32_16x16x32_bf16 v[132:135], a[148:151], v[168:171], v[132:135]
  v_mfma_f32_16x16x32_bf16 v[136:139], a[152:155], v[168:171], v[136:139]
  v_mfma_f32_16x16x32_bf16 v[140:143], a[156:159], v[168:171], v[140:143]
  v_mfma_f32_16x16x32_bf16 v[144:147], a[144:147], v[172:175], v[144:147]
  v_mfma_f32_16x16x32_bf16 v[148:151], a[148:151], v[172:175], v[148:151]
  v_mfma_f32_16x16x32_bf16 v[152:155], a[152:155], v[172:175], v[152:155]
  v_mfma_f32_16x16x32_bf16 v[156:159], a[156:159], v[172:175], v[156:159]
  ds_read_b128 v[168:171], v24 offset:22528
  ds_read_b128 v[172:175], v24 offset:23552
  s_waitcnt lgkmcnt(2)
  v_mfma_f32_16x16x32_bf16 v[128:131], a[160:163], v[160:163], v[128:131]
  v_mfma_f32_16x16x32_bf16 v[132:135], a[164:167], v[160:163], v[132:135]
  v_mfma_f32_16x16x32_bf16 v[136:139], a[168:171], v[160:163], v[136:139]
  v_mfma_f32_16x16x32_bf16 v[140:143], a[172:175], v[160:163], v[140:143]
  v_mfma_f32_16x16x32_bf16 v[144:147], a[160:163], v[164:167], v[144:147]
  v_mfma_f32_16x16x32_bf16 v[148:151], a[164:167], v[164:167], v[148:151]
  v_mfma_f32_16x16x32_bf16 v[152:155], a[168:171], v[164:167], v[152:155]
  v_mfma_f32_16x16x32_bf16 v[156:159], a[172:175], v[164:167], v[156:159]
  ds_read_b128 v[160:163], v24 offset:24576
  ds_read_b128 v[164:167], v24 offset:25600
  s_waitcnt lgkmcnt(2)
  v_mfma_f32_16x16x32_bf16 v[128:131], a[176:179], v[168:171], v[128:131]
  v_mfma_f32_16x16x32_bf16 v[132:135], a[180:183], v[168:171], v[132:135]
  v_mfma_f32_16x16x32_bf16 v[136:139], a[184:187], v[168:171], v[136:139]
  v_mfma_f32_16x16x32_bf16 v[140:143], a[188:191], v[168:171], v[140:143]
  v_mfma_f32_16x16x32_bf16 v[144:147], a[176:179], v[172:175], v[144:147]
  v_mfma_f32_16x16x32_bf16 v[148:151], a[180:183], v[172:175], v[148:151]
  v_mfma_f32_16x16x32_bf16 v[152:155], a[184:187], v[172:175], v[152:155]
  v_mfma_f32_16x16x32_bf16 v[156:159], a[188:191], v[172:175], v[156:159]
  ds_read_b128 v[168:171], v24 offset:26624
  ds_read_b128 v[172:175], v24 offset:27648
  s_waitcnt lgkmcnt(2)
  v_mfma_f32_16x16x32_bf16 v[128:131], a[192:195], v[160:163], v[128:131]
  v_mfma_f32_16x16x32_bf16 v[132:135], a[196:199], v[160:163], v[132:135]
  v_mfma_f32_16x16x32_bf16 v[136:139], a[200:203], v[160:163], v[136:139]
  v_mfma_f32_16x16x32_bf16 v[140:143], a[204:207], v[160:163], v[140:143]
  v_mfma_f32_16x16x32_bf16 v[144:147], a[192:195], v[164:167], v[144:147]
  v_mfma_f32_16x16x32_bf16 v[148:151], a[196:199], v[164:167], v[148:151]
  v_mfma_f32_16x16x32_bf16 v[152:155], a[200:203], v[164:167], v[152:155]
  v_mfma_f32_16x16x32_bf16 v[156:159], a[204:207], v[164:167], v[156:159]
  ds_read_b128 v[160:163], v24 offset:28672
  ds_read_b128 v[164:167], v24 offset:29696
  s_waitcnt lgkmcnt(2)
  v_mfma_f32_16x16x32_bf16 v[128:131], a[208:211], v[168:171], v[128:131]
  v_mfma_f32_16x16x32_bf16 v[132:135], a[212:215], v[168:171], v[132:135]
  v_mfma_f32_16x16x32_bf16 v[136:139], a[216:219], v[168:171], v[136:139]
  v_mfma_f32_16x16x32_bf16 v[140:143], a[220:223], v[168:171], v[140:143]
  v_mfma_f32_16x16x32_bf16 v[144:147], a[208:211], v[172:175], v[144:147]
  v_mfma_f32_16x16x32_bf16 v[148:151], a[212:215], v[172:175], v[148:151]
  v_mfma_f32_16x16x32_bf16 v[152:155], a[216:219], v[172:175], v[152:155]
  v_mfma_f32_16x16x32_bf16 v[156:159], a[220:223], v[172:175], v[156:159]
  ds_read_b128 v[168:171], v24 offset:30720
  ds_read_b128 v[172:175], v24 offset:31744
  s_waitcnt lgkmcnt(2)
  v_mfma_f32_16x16x32_bf16 v[128:131], a[224:227], v[160:163], v[128:131]
  v_mfma_f32_16x16x32_bf16 v[132:135], a[228:231], v[160:163], v[132:135]
  v_mfma_f32_16x16x32_bf16 v[136:139], a[232:235], v[160:163], v[136:139]
  v_mfma_f32_16x16x32_bf16 v[140:143], a[236:239], v[160:163], v[140:143]
  v_mfma_f32_16x16x32_bf16 v[144:147], a[224:227], v[164:167], v[144:147]
  v_mfma_f32_16x16x32_bf16 v[148:151], a[228:231], v[164:167], v[148:151]
  v_mfma_f32_16x16x32_bf16 v[152:155], a[232:235], v[164:167], v[152:155]
  v_mfma_f32_16x16x32_bf16 v[156:159], a[236:239], v[164:167], v[156:159]
  ds_read_b128 v[160:163], v24 offset:32768
  ds_read_b128 v[164:167], v24 offset:33792
  s_waitcnt lgkmcnt(2)
  v_mfma_f32_16x16x32_bf16 v[128:131], a[240:243], v[168:171], v[128:131]
  v_mfma_f32_16x16x32_bf16 v[132:135], a[244:247], v[168:171], v[132:135]
  v_mfma_f32_16x16x32_bf16 v[136:139], a[248:251], v[168:171], v[136:139]
  v_mfma_f32_16x16x32_bf16 v[140:143], a[252:255], v[168:171], v[140:143]
  v_mfma_f32_16x16x32_bf16 v[144:147], a[240:243], v[172:175], v[144:147]
  v_mfma_f32_16x16x32_bf16 v[148:151], a[244:247], v[172:175], v[148:151]
  v_mfma_f32_16x16x32_bf16 v[152:155], a[248:251], v[172:175], v[152:155]
  v_mfma_f32_16x16x32_bf16 v[156:159], a[252:255], v[172:175], v[156:159]
  ds_read_b128 v[168:171], v24 offset:34816
  ds_read_b128 v[172:175], v24 offset:35840
  s_waitcnt lgkmcnt(2)
  v_mfma_f32_16x16x32_bf16 v[128:131], v[192:195], v[160:163], v[128:131]
  v_mfma_f32_16x16x32_bf16 v[132:135], v[196:199], v[160:163], v[132:135]
  v_mfma_f32_16x16x32_bf16 v[136:139], v[200:203], v[160:163], v[136:139]
  v_mfma_f32_16x16x32_bf16 v[140:143], v[204:207], v[160:163], v[140:143]
  v_mfma_f32_16x16x32_bf16 v[144:147], v[192:195], v[164:167], v[144:147]
  v_mfma_f32_16x16x32_bf16 v[148:151], v[196:199], v[164:167], v[148:151]
  v_mfma_f32_16x16x32_bf16 v[152:155], v[200:203], v[164:167], v[152:155]
  v_mfma_f32_16x16x32_bf16 v[156:159], v[204:207], v[164:167], v[156:159]
  ds_read_b128 v[160:163], v24 offset:36864
  ds_read_b128 v[164:167], v24 offset:37888
  s_waitcnt lgkmcnt(2)
  v_mfma_f32_16x16x32_bf16 v[128:131], v[208:211], v[168:171], v[128:131]
  v_mfma_f32_16x16x32_bf16 v[132:135], v[212:215], v[168:171], v[132:135]
  v_mfma_f32_16x16x32_bf16 v[136:139], v[216:219], v[168:171], v[136:139]
  v_mfma_f32_16x16x32_bf16 v[140:143], v[220:223], v[168:171], v[140:143]
  v_mfma_f32_16x16x32_bf16 v[144:147], v[208:211], v[172:175], v[144:147]
  v_mfma_f32_16x16x32_bf16 v[148:151], v[212:215], v[172:175], v[148:151]
  v_mfma_f32_16x16x32_bf16 v[152:155], v[216:219], v[172:175], v[152:155]
  v_mfma_f32_16x16x32_bf16 v[156:159], v[220:223], v[172:175], v[156:159]
  ds_read_b128 v[168:171], v24 offset:38912
  ds_read_b128 v[172:175], v24 offset:39936
  s_waitcnt lgkmcnt(2)
  v_mfma_f32_16x16x32_bf16 v[128:131], v[224:227], v[160:163], v[128:131]
  v_mfma_f32_16x16x32_bf16 v[132:135], v[228:231], v[160:163], v[132:135]
  v_mfma_f32_16x16x32_bf16 v[136:139], v[232:235], v[160:163], v[136:139]
  v_mfma_f32_16x16x32_bf16 v[140:143], v[236:239], v[160:163], v[140:143]
  v_mfma_f32_16x16x32_bf16 v[144:147], v[224:227], v[164:167], v[144:147]
  v_mfma_f32_16x16x32_bf16 v[148:151], v[228:231], v[164:167], v[148:151]
  v_mfma_f32_16x16x32_bf16 v[152:155], v[232:235], v[164:167], v[152:155]
  v_mfma_f32_16x16x32_bf16 v[156:159], v[236:239], v[164:167], v[156:159]
  s_waitcnt lgkmcnt(0)
  v_mfma_f32_16x16x32_bf16 v[128:131], v[240:243], v[168:171], v[128:131]
  v_mfma_f32_16x16x32_bf16 v[132:135], v[244:247], v[168:171], v[132:135]
  v_mfma_f32_16x16x32_bf16 v[136:139], v[248:251], v[168:171], v[136:139]
  v_mfma_f32_16x16x32_bf16 v[140:143], v[252:255], v[168:171], v[140:143]
  v_mfma_f32_16x16x32_bf16 v[144:147], v[240:243], v[172:175], v[144:147]
  v_mfma_f32_16x16x32_bf16 v[148:151], v[244:247], v[172:175], v[148:151]
  v_mfma_f32_16x16x32_bf16 v[152:155], v[248:251], v[172:175], v[152:155]
  v_mfma_f32_16x16x32_bf16 v[156:159], v[252:255], v[172:175], v[156:159]
  s_waitcnt vmcnt(0)
  s_branch L_Aqk_ep
L_Aqk_cBc:
  s_waitcnt vmcnt(0)
  s_barrier
  ds_read_b128 v[160:163], v24 offset:0
  ds_read_b128 v[164:167], v24 offset:1024
  ds_read_b128 v[168:171], v24 offset:2048
  ds_read_b128 v[172:175], v24 offset:3072
  s_waitcnt lgkmcnt(2)
  v_mfma_f32_16x16x32_bf16 v[128:131], a[0:3], v[160:163], 0
  v_mfma_f32_16x16x32_bf16 v[132:135], a[4:7], v[160:163], 0
  v_mfma_f32_16x16x32_bf16 v[136:139], a[8:11], v[160:163], 0
  v_mfma_f32_16x16x32_bf16 v[140:143], a[12:15], v[160:163], 0
  v_mfma_f32_16x16x32_bf16 v[144:147], a[0:3], v[164:167], 0
  v_mfma_f32_16x16x32_bf16 v[148:151], a[4:7], v[164:167], 0
  v_mfma_f32_16x16x32_bf16 v[152:155], a[8:11], v[164:167], 0
  v_mfma_f32_16x16x32_bf16 v[156:159], a[12:15], v[164:167], 0
  ds_read_b128 v[160:163], v24 offset:4096
  ds_read_b128 v[164:167], v24 offset:5120
  s_waitcnt lgkmcnt(2)
  v_mfma_f32_16x16x32_bf16 v[128:131], a[16:19], v[168:171], v[128:131]
  v_mfma_f32_16x16x32_bf16 v[132:135], a[20:23], v[168:171], v[132:135]
  v_mfma_f32_16x16x32_bf16 v[136:139], a[24:27], v[168:171], v[136:139]
  v_mfma_f32_16x16x32_bf16 v[140:143], a[28:31], v[168:171], v[140:143]
  v_mfma_f32_16x16x32_bf16 v[144:147], a[16:19], v[172:175], v[144:147]
  v_mfma_f32_16x16x32_bf16 v[148:151], a[20:23], v[172:175], v[148:151]
  v_mfma_f32_16x16x32_bf16 v[152:155], a[24:27], v[172:175], v[152:155]
  v_mfma_f32_16x16x32_bf16 v[156:159], a[28:31], v[172:175], v[156:159]
  ds_read_b128 v[168:171], v24 offset:6144
  ds_read_b128 v[172:175], v24 offset:7168
  s_waitcnt lgkmcnt(2)
  v_mfma_f32_16x16x32_bf16 v[128:131], a[32:35], v[160:163], v[128:131]
  v_mfma_f32_16x16x32_bf16 v[132:135], a[36:39], v[160:163], v[132:135]
  v_mfma_f32_16x16x32_bf16 v[136:139], a[40:43], v[160:163], v[136:139]
  v_mfma_f32_16x16x32_bf16 v[140:143], a[44:47], v[160:163], v[140:143]
  v_mfma_f32_16x16x32_bf16 v[144:147], a[32:35], v[164:167], v[144:147]
  v_mfma_f32_16x16x32_bf16 v[148:151], a[36:39], v[164:167], v[148:151]
  v_mfma_f32_16x16x32_bf16 v[152:155], a[40:43], v[164:167], v[152:155]
  v_mfma_f32_16x16x32_bf16 v[156:159], a[44:47], v[164:167], v[156:159]
  ds_read_b128 v[160:163], v24 offset:8192
  ds_read_b128 v[164:167], v24 offset:9216
  s_waitcnt lgkmcnt(2)
  v_mfma_f32_16x16x32_bf16 v[128:131], a[48:51], v[168:171], v[128:131]
  v_mfma_f32_16x16x32_bf16 v[132:135], a[52:55], v[168:171], v[132:135]
  v_mfma_f32_16x16x32_bf16 v[136:139], a[56:59], v[168:171], v[136:139]
  v_mfma_f32_16x16x32_bf16 v[140:143], a[60:63], v[168:171], v[140:143]
  v_mfma_f32_16x16x32_bf16 v[144:147], a[48:51], v[172:175], v[144:147]
  v_mfma_f32_16x16x32_bf16 v[148:151], a[52:55], v[172:175], v[148:151]
  v_mfma_f32_16x16x32_bf16 v[152:155], a[56:59], v[172:175], v[152:155]
  v_mfma_f32_16x16x32_bf16 v[156:159], a[60:63], v[172:175], v[156:159]
  ds_read_b128 v[168:171], v24 offset:10240
  ds_read_b128 v[172:175], v24 offset:11264
  s_waitcnt lgkmcnt(2)
  v_mfma_f32_16x16x32_bf16 v[128:131], a[64:67], v[160:163], v[128:131]
  v_mfma_f32_16x16x32_bf16 v[132:135], a[68:71], v[160:163], v[132:135]
  v_mfma_f32_16x16x32_bf16 v[136:139], a[72:75], v[160:163], v[136:139]
  v_mfma_f32_16x16x32_bf16 v[140:143], a[76:79], v[160:163], v[140:143]
  v_mfma_f32_16x16x32_bf16 v[144:147], a[64:67], v[164:167], v[144:147]
  v_mfma_f32_16x16x32_bf16 v[148:151], a[68:71], v[164:167], v[148:151]
  v_mfma_f32_16x16x32_bf16 v[152:155], a[72:75], v[164:167], v[152:155]
  v_mfma_f32_16x16x32_bf16 v[156:159], a[76:79], v[164:167], v[156:159]
  ds_read_b128 v[160:163], v24 offset:12288
  ds_read_b128 v[164:167], v24 offset:13312
  s_waitcnt lgkmcnt(2)
  v_mfma_f32_16x16x32_bf16 v[128:131], a[80:83], v[168:171], v[128:131]
  v_mfma_f32_16x16x32_bf16 v[132:135], a[84:87], v[168:171], v[132:135]
  v_mfma_f32_16x16x32_bf16 v[136:139], a[88:91], v[168:171], v[136:139]
  v_mfma_f32_16x16x32_bf16 v[140:143], a[92:95], v[168:171], v[140:143]
  v_mfma_f32_16x16x32_bf16 v[144:147], a[80:83], v[172:175], v[144:147]
  v_mfma_f32_16x16x32_bf16 v[148:151], a[84:87], v[172:175], v[148:151]
  v_mfma_f32_16x16x32_bf16 v[152:155], a[88:91], v[172:175], v[152:155]
  v_mfma_f32_16x16x32_bf16 v[156:159], a[92:95], v[172:175], v[156:159]
  ds_read_b128 v[168:171], v24 offset:14336
  ds_read_b128 v[172:175], v24 offset:15360
  s_waitcnt lgkmcnt(2)
  v_mfma_f32_16x16x32_bf16 v[128:131], a[96:99], v[160:163], v[128:131]
  v_mfma_f32_16x16x32_bf16 v[132:135], a[100:103], v[160:163], v[132:135]
  v_mfma_f32_16x16x32_bf16 v[136:139], a[104:107], v[160:163], v[136:139]
  v_mfma_f32_16x16x32_bf16 v[140:143], a[108:111], v[160:163], v[140:143]
  v_mfma_f32_16x16x32_bf16 v[144:147], a[96:99], v[164:167], v[144:147]
  v_mfma_f32_16x16x32_bf16 v[148:151], a[100:103], v[164:167], v[148:151]
  v_mfma_f32_16x16x32_bf16 v[152:155], a[104:107], v[164:167], v[152:155]
  v_mfma_f32_16x16x32_bf16 v[156:159], a[108:111], v[164:167], v[156:159]
  ds_read_b128 v[160:163], v24 offset:16384
  ds_read_b128 v[164:167], v24 offset:17408
  s_waitcnt lgkmcnt(2)
  v_mfma_f32_16x16x32_bf16 v[128:131], a[112:115], v[168:171], v[128:131]
  v_mfma_f32_16x16x32_bf16 v[132:135], a[116:119], v[168:171], v[132:135]
  v_mfma_f32_16x16x32_bf16 v[136:139], a[120:123], v[168:171], v[136:139]
  v_mfma_f32_16x16x32_bf16 v[140:143], a[124:127], v[168:171], v[140:143]
  v_mfma_f32_16x16x32_bf16 v[144:147], a[112:115], v[172:175], v[144:147]
  v_mfma_f32_16x16x32_bf16 v[148:151], a[116:119], v[172:175], v[148:151]
  v_mfma_f32_16x16x32_bf16 v[152:155], a[120:123], v[172:175], v[152:155]
  v_mfma_f32_16x16x32_bf16 v[156:159], a[124:127], v[172:175], v[156:159]
  ds_read_b128 v[168:171], v24 offset:18432
  ds_read_b128 v[172:175], v24 offset:19456
  s_waitcnt lgkmcnt(2)
  v_mfma_f32_16x16x32_bf16 v[128:131], a[128:131], v[160:163], v[128:131]
  v_mfma_f32_16x16x32_bf16 v[132:135], a[132:135], v[160:163], v[132:135]
  v_mfma_f32_16x16x32_bf16 v[136:139], a[136:139], v[160:163], v[136:139]
  v_mfma_f32_16x16x32_bf16 v[140:143], a[140:143], v[160:163], v[140:143]
  v_mfma_f32_16x16x32_bf16 v[144:147], a[128:131], v[164:167], v[144:147]
  v_mfma_f32_16x16x32_bf16 v[148:151], a[132:135], v[164:167], v[148:151]
  v_mfma_f32_16x16x32_bf16 v[152:155], a[136:139], v[164:167], v[152:155]
  v_mfma_f32_16x16x32_bf16 v[156:159], a[140:143], v[164:167], v[156:159]
  ds_read_b128 v[160:163], v24 offset:20480
  ds_read_b128 v[164:167], v24 offset:21504
  s_waitcnt lgkmcnt(2)
  v_mfma_f32_16x16x32_bf16 v[128:131], a[144:147], v[168:171], v[128:131]
  v_mfma_f32_16x16x32_bf16 v[132:135], a[148:151], v[168:171], v[132:135]
  v_mfma_f32_16x16x32_bf16 v[136:139], a[152:155], v[168:171], v[136:139]
  v_mfma_f32_16x16x32_bf16 v[140:143], a[156:159], v[168:171], v[140:143]
  v_mfma_f32_16x16x32_bf16 v[144:147], a[144:147], v[172:175], v[144:147]
  v_mfma_f32_16x16x32_bf16 v[148:151], a[148:151], v[172:175], v[148:151]
  v_mfma_f32_16x16x32_bf16 v[152:155], a[152:155], v[172:175], v[152:155]
  v_mfma_f32_16x16x32_bf16 v[156:159], a[156:159], v[172:175], v[156:159]
  ds_read_b128 v[168:171], v24 offset:22528
  ds_read_b128 v[172:175], v24 offset:23552
  s_waitcnt lgkmcnt(2)
  v_mfma_f32_16x16x32_bf16 v[128:131], a[160:163], v[160:163], v[128:131]
  v_mfma_f32_16x16x32_bf16 v[132:135], a[164:167], v[160:163], v[132:135]
  v_mfma_f32_16x16x32_bf16 v[136:139], a[168:171], v[160:163], v[136:139]
  v_mfma_f32_16x16x32_bf16 v[140:143], a[172:175], v[160:163], v[140:143]
  v_mfma_f32_16x16x32_bf16 v[144:147], a[160:163], v[164:167], v[144:147]
  v_mfma_f32_16x16x32_bf16 v[148:151], a[164:167], v[164:167], v[148:151]
  v_mfma_f32_16x16x32_bf16 v[152:155], a[168:171], v[164:167], v[152:155]
  v_mfma_f32_16x16x32_bf16 v[156:159], a[172:175], v[164:167], v[156:159]
  ds_read_b128 v[160:163], v24 offset:24576
  ds_read_b128 v[164:167], v24 offset:25600
  s_waitcnt lgkmcnt(2)
  v_mfma_f32_16x16x32_bf16 v[128:131], a[176:179], v[168:171], v[128:131]
  v_mfma_f32_16x16x32_bf16 v[132:135], a[180:183], v[168:171], v[132:135]
  v_mfma_f32_16x16x32_bf16 v[136:139], a[184:187], v[168:171], v[136:139]
  v_mfma_f32_16x16x32_bf16 v[140:143], a[188:191], v[168:171], v[140:143]
  v_mfma_f32_16x16x32_bf16 v[144:147], a[176:179], v[172:175], v[144:147]
  v_mfma_f32_16x16x32_bf16 v[148:151], a[180:183], v[172:175], v[148:151]
  v_mfma_f32_16x16x32_bf16 v[152:155], a[184:187], v[172:175], v[152:155]
  v_mfma_f32_16x16x32_bf16 v[156:159], a[188:191], v[172:175], v[156:159]
  ds_read_b128 v[168:171], v24 offset:26624
  ds_read_b128 v[172:175], v24 offset:27648
  s_waitcnt lgkmcnt(2)
  v_mfma_f32_16x16x32_bf16 v[128:131], a[192:195], v[160:163], v[128:131]
  v_mfma_f32_16x16x32_bf16 v[132:135], a[196:199], v[160:163], v[132:135]
  v_mfma_f32_16x16x32_bf16 v[136:139], a[200:203], v[160:163], v[136:139]
  v_mfma_f32_16x16x32_bf16 v[140:143], a[204:207], v[160:163], v[140:143]
  v_mfma_f32_16x16x32_bf16 v[144:147], a[192:195], v[164:167], v[144:147]
  v_mfma_f32_16x16x32_bf16 v[148:151], a[196:199], v[164:167], v[148:151]
  v_mfma_f32_16x16x32_bf16 v[152:155], a[200:203], v[164:167], v[152:155]
  v_mfma_f32_16x16x32_bf16 v[156:159], a[204:207], v[164:167], v[156:159]
  ds_read_b128 v[160:163], v24 offset:28672
  ds_read_b128 v[164:167], v24 offset:29696
  s_waitcnt lgkmcnt(2)
  v_mfma_f32_16x16x32_bf16 v[128:131], a[208:211], v[168:171], v[128:131]
  v_mfma_f32_16x16x32_bf16 v[132:135], a[212:215], v[168:171], v[132:135]
  v_mfma_f32_16x16x32_bf16 v[136:139], a[216:219], v[168:171], v[136:139]
  v_mfma_f32_16x16x32_bf16 v[140:143], a[220:223], v[168:171], v[140:143]
  v_mfma_f32_16x16x32_bf16 v[144:147], a[208:211], v[172:175], v[144:147]
  v_mfma_f32_16x16x32_bf16 v[148:151], a[212:215], v[172:175], v[148:151]
  v_mfma_f32_16x16x32_bf16 v[152:155], a[216:219], v[172:175], v[152:155]
  v_mfma_f32_16x16x32_bf16 v[156:159], a[220:223], v[172:175], v[156:159]
  ds_read_b128 v[168:171], v24 offset:30720
  ds_read_b128 v[172:175], v24 offset:31744
  s_waitcnt lgkmcnt(2)
  v_mfma_f32_16x16x32_bf16 v[128:131], a[224:227], v[160:163], v[128:131]
  v_mfma_f32_16x16x32_bf16 v[132:135], a[228:231], v[160:163], v[132:135]
  v_mfma_f32_16x16x32_bf16 v[136:139], a[232:235], v[160:163], v[136:139]
  v_mfma_f32_16x16x32_bf16 v[140:143], a[236:239], v[160:163], v[140:143]
  v_mfma_f32_16x16x32_bf16 v[144:147], a[224:227], v[164:167], v[144:147]
  v_mfma_f32_16x16x32_bf16 v[148:151], a[228:231], v[164:167], v[148:151]
  v_mfma_f32_16x16x32_bf16 v[152:155], a[232:235], v[164:167], v[152:155]
  v_mfma_f32_16x16x32_bf16 v[156:159], a[236:239], v[164:167], v[156:159]
  ds_read_b128 v[160:163], v24 offset:32768
  ds_read_b128 v[164:167], v24 offset:33792
  s_waitcnt lgkmcnt(2)
  v_mfma_f32_16x16x32_bf16 v[128:131], a[240:243], v[168:171], v[128:131]
  v_mfma_f32_16x16x32_bf16 v[132:135], a[244:247], v[168:171], v[132:135]
  v_mfma_f32_16x16x32_bf16 v[136:139], a[248:251], v[168:171], v[136:139]
  v_mfma_f32_16x16x32_bf16 v[140:143], a[252:255], v[168:171], v[140:143]
  v_mfma_f32_16x16x32_bf16 v[144:147], a[240:243], v[172:175], v[144:147]
  v_mfma_f32_16x16x32_bf16 v[148:151], a[244:247], v[172:175], v[148:151]
  v_mfma_f32_16x16x32_bf16 v[152:155], a[248:251], v[172:175], v[152:155]
  v_mfma_f32_16x16x32_bf16 v[156:159], a[252:255], v[172:175], v[156:159]
  ds_read_b128 v[168:171], v24 offset:34816
  ds_read_b128 v[172:175], v24 offset:35840
  s_waitcnt lgkmcnt(2)
  v_mfma_f32_16x16x32_bf16 v[128:131], v[192:195], v[160:163], v[128:131]
  v_mfma_f32_16x16x32_bf16 v[132:135], v[196:199], v[160:163], v[132:135]
  v_mfma_f32_16x16x32_bf16 v[136:139], v[200:203], v[160:163], v[136:139]
  v_mfma_f32_16x16x32_bf16 v[140:143], v[204:207], v[160:163], v[140:143]
  v_mfma_f32_16x16x32_bf16 v[144:147], v[192:195], v[164:167], v[144:147]
  v_mfma_f32_16x16x32_bf16 v[148:151], v[196:199], v[164:167], v[148:151]
  v_mfma_f32_16x16x32_bf16 v[152:155], v[200:203], v[164:167], v[152:155]
  v_mfma_f32_16x16x32_bf16 v[156:159], v[204:207], v[164:167], v[156:159]
  ds_read_b128 v[160:163], v24 offset:36864
  ds_read_b128 v[164:167], v24 offset:37888
  s_waitcnt lgkmcnt(2)
  v_mfma_f32_16x16x32_bf16 v[128:131], v[208:211], v[168:171], v[128:131]
  v_mfma_f32_16x16x32_bf16 v[132:135], v[212:215], v[168:171], v[132:135]
  v_mfma_f32_16x16x32_bf16 v[136:139], v[216:219], v[168:171], v[136:139]
  v_mfma_f32_16x16x32_bf16 v[140:143], v[220:223], v[168:171], v[140:143]
  v_mfma_f32_16x16x32_bf16 v[144:147], v[208:211], v[172:175], v[144:147]
  v_mfma_f32_16x16x32_bf16 v[148:151], v[212:215], v[172:175], v[148:151]
  v_mfma_f32_16x16x32_bf16 v[152:155], v[216:219], v[172:175], v[152:155]
  v_mfma_f32_16x16x32_bf16 v[156:159], v[220:223], v[172:175], v[156:159]
  ds_read_b128 v[168:171], v24 offset:38912
  ds_read_b128 v[172:175], v24 offset:39936
  s_waitcnt lgkmcnt(2)
  v_mfma_f32_16x16x32_bf16 v[128:131], v[224:227], v[160:163], v[128:131]
  v_mfma_f32_16x16x32_bf16 v[132:135], v[228:231], v[160:163], v[132:135]
  v_mfma_f32_16x16x32_bf16 v[136:139], v[232:235], v[160:163], v[136:139]
  v_mfma_f32_16x16x32_bf16 v[140:143], v[236:239], v[160:163], v[140:143]
  v_mfma_f32_16x16x32_bf16 v[144:147], v[224:227], v[164:167], v[144:147]
  v_mfma_f32_16x16x32_bf16 v[148:151], v[228:231], v[164:167], v[148:151]
  v_mfma_f32_16x16x32_bf16 v[152:155], v[232:235], v[164:167], v[152:155]
  v_mfma_f32_16x16x32_bf16 v[156:159], v[236:239], v[164:167], v[156:159]
  s_waitcnt lgkmcnt(0)
  v_mfma_f32_16x16x32_bf16 v[128:131], v[240:243], v[168:171], v[128:131]
  v_mfma_f32_16x16x32_bf16 v[132:135], v[244:247], v[168:171], v[132:135]
  v_mfma_f32_16x16x32_bf16 v[136:139], v[248:251], v[168:171], v[136:139]
  v_mfma_f32_16x16x32_bf16 v[140:143], v[252:255], v[168:171], v[140:143]
  v_mfma_f32_16x16x32_bf16 v[144:147], v[240:243], v[172:175], v[144:147]
  v_mfma_f32_16x16x32_bf16 v[148:151], v[244:247], v[172:175], v[148:151]
  v_mfma_f32_16x16x32_bf16 v[152:155], v[248:251], v[172:175], v[152:155]
  v_mfma_f32_16x16x32_bf16 v[156:159], v[252:255], v[172:175], v[156:159]
  s_waitcnt vmcnt(0)
L_Aqk_ep:
  s_mov_b64 exec, 1
  v_mov_b32 v29, s31
  v_mov_b32 v30, 0
  buffer_store_dword v29, v30, s[8:11], s35 offen sc1
  s_mov_b64 exec, -1
  s_mul_i32 s4, s54, 393216
  s_add_u32 s4, s4, s40
  v_cvt_pk_bf16_f32 v176, v128, v129
  v_cvt_pk_bf16_f32 v177, v130, v131
  v_cvt_pk_bf16_f32 v178, v132, v133
  v_cvt_pk_bf16_f32 v179, v134, v135
  s_add_u32 s5, s4, 0
  buffer_store_dwordx4 v[176:179], v20, s[8:11], s5 offen sc1
  v_cvt_pk_bf16_f32 v180, v136, v137
  v_cvt_pk_bf16_f32 v181, v138, v139
  v_cvt_pk_bf16_f32 v182, v140, v141
  v_cvt_pk_bf16_f32 v183, v142, v143
  s_add_u32 s5, s4, 1024
  buffer_store_dwordx4 v[180:183], v20, s[8:11], s5 offen sc1
  v_cvt_pk_bf16_f32 v184, v144, v145
  v_cvt_pk_bf16_f32 v185, v146, v147
  v_cvt_pk_bf16_f32 v186, v148, v149
  v_cvt_pk_bf16_f32 v187, v150, v151
  s_add_u32 s5, s4, 6144
  buffer_store_dwordx4 v[184:187], v20, s[8:11], s5 offen sc1
  v_cvt_pk_bf16_f32 v188, v152, v153
  v_cvt_pk_bf16_f32 v189, v154, v155
  v_cvt_pk_bf16_f32 v190, v156, v157
  v_cvt_pk_bf16_f32 v191, v158, v159
  s_add_u32 s5, s4, 7168
  buffer_store_dwordx4 v[188:191], v20, s[8:11], s5 offen sc1
  s_cmp_eq_u32 s31, 0
  s_cbranch_scc0 L_Aqk_nf0
  s_waitcnt vmcnt(0)
  s_mov_b64 exec, 1
  v_mov_b32 v29, 1
  v_mov_b32 v30, 0
  buffer_store_dword v29, v30, s[8:11], s35 offen sc1
  s_mov_b64 exec, -1
L_Aqk_nf0:
  s_add_u32 s31, s31, 1
  s_mov_b32 s34, s31
  s_cmp_lt_u32 s31, s52
  s_cbranch_scc1 L_Aqk_top
  s_waitcnt vmcnt(0)
  s_cmp_eq_u32 s34, 0
  s_cbranch_scc1 L_Aqk_npc
  s_mov_b64 exec, 1
  v_mov_b32 v29, s34
  v_mov_b32 v30, 0
  buffer_store_dword v29, v30, s[8:11], s35 offen sc1
  s_mov_b64 exec, -1
  s_mov_b32 s34, 0
L_Aqk_npc:
  s_waitcnt vmcnt(0)
  s_branch L_A_next
L_A_V:
  s_mov_b32 s31, 0
  s_mov_b32 s33, 0
  s_mov_b32 s34, 0
L_Av_top:
  s_mov_b32 s54, s31
  s_cmp_eq_u32 s33, 1
  s_cbranch_scc1 L_Av_pref
  s_waitcnt vmcnt(0)
  s_cmp_eq_u32 s34, 0
  s_cbranch_scc1 L_Av_npa
  s_mov_b64 exec, 1
  v_mov_b32 v29, s34
  v_mov_b32 v30, 0
  buffer_store_dword v29, v30, s[8:11], s35 offen sc1
  s_mov_b64 exec, -1
  s_mov_b32 s34, 0
L_Av_npa:
  s_mov_b32 s59, s31
  s_mul_i32 s32, s59, 40960
  s_add_u32 s32, s32, 5656576
  s_lshl_b32 s4, s24, 10
  s_add_u32 s32, s32, s4
  s_and_b32 s50, s31, 1
  s_mul_i32 s50, s50, 40960
  s_add_u32 s50, s50, s4
  s_add_u32 m0, s50, 0
  s_add_u32 s5, s32, 0
  buffer_load_dwordx4 v20, s[8:11], s5 offen sc1 lds
  s_add_u32 m0, s50, 4096
  s_add_u32 s5, s32, 4096
  buffer_load_dwordx4 v20, s[8:11], s5 offen sc1 lds
  s_add_u32 m0, s50, 8192
  s_add_u32 s5, s32, 8192
  buffer_load_dwordx4 v20, s[8:11], s5 offen sc1 lds
  s_add_u32 m0, s50, 12288
  s_add_u32 s5, s32, 12288
  buffer_load_dwordx4 v20, s[8:11], s5 offen sc1 lds
  s_add_u32 m0, s50, 16384
  s_add_u32 s5, s32, 16384
  buffer_load_dwordx4 v20, s[8:11], s5 offen sc1 lds
  s_add_u32 m0, s50, 20480
  s_add_u32 s5, s32, 20480
  buffer_load_dwordx4 v20, s[8:11], s5 offen sc1 lds
  s_add_u32 m0, s50, 24576
  s_add_u32 s5, s32, 24576
  buffer_load_dwordx4 v20, s[8:11], s5 offen sc1 lds
  s_add_u32 m0, s50, 28672
  s_add_u32 s5, s32, 28672
  buffer_load_dwordx4 v20, s[8:11], s5 offen sc1 lds
  s_add_u32 m0, s50, 32768
  s_add_u32 s5, s32, 32768
  buffer_load_dwordx4 v20, s[8:11], s5 offen sc1 lds
  s_add_u32 m0, s50, 36864
  s_add_u32 s5, s32, 36864
  buffer_load_dwordx4 v20, s[8:11], s5 offen sc1 lds
  s_mov_b32 s51, 1
  s_branch L_Av_go
L_Av_pref:
  s_waitcnt vmcnt(14)
  s_mov_b32 s51, 0
L_Av_go:
  s_and_b32 s6, s31, 1
  s_mul_i32 s6, s6, 40960
  v_add_u32 v24, s6, v20
  s_mov_b32 s33, 0
  s_add_u32 s7, s31, 1
  s_cmp_ge_u32 s7, s52
  s_cbranch_scc1 L_Av_cB
  s_mov_b32 s33, 1
  s_mov_b32 s59, s7
  s_mul_i32 s32, s59, 40960
  s_add_u32 s32, s32, 5656576
  s_lshl_b32 s4, s24, 10
  s_add_u32 s32, s32, s4
  s_and_b32 s50, s7, 1
  s_mul_i32 s50, s50, 40960
  s_add_u32 s50, s50, s4
  s_cmp_eq_u32 s51, 1
  s_cbranch_scc1 L_Av_cAc
  s_waitcnt vmcnt(5)
  s_barrier
  ds_read_b128 v[160:163], v24 offset:0
  ds_read_b128 v[164:167], v24 offset:1024
  ds_read_b128 v[168:171], v24 offset:2048
  ds_read_b128 v[172:175], v24 offset:3072
  s_waitcnt lgkmcnt(2)
  v_mfma_f32_16x16x32_bf16 v[128:131], v[160:163], a[0:3], 0
  v_mfma_f32_16x16x32_bf16 v[132:135], v[160:163], a[4:7], 0
  v_mfma_f32_16x16x32_bf16 v[136:139], v[160:163], a[8:11], 0
  v_mfma_f32_16x16x32_bf16 v[140:143], v[160:163], a[12:15], 0
  v_mfma_f32_16x16x32_bf16 v[144:147], v[164:167], a[0:3], 0
  v_mfma_f32_16x16x32_bf16 v[148:151], v[164:167], a[4:7], 0
  v_mfma_f32_16x16x32_bf16 v[152:155], v[164:167], a[8:11], 0
  v_mfma_f32_16x16x32_bf16 v[156:159], v[164:167], a[12:15], 0
  ds_read_b128 v[160:163], v24 offset:4096
  ds_read_b128 v[164:167], v24 offset:5120
  s_waitcnt lgkmcnt(2)
  v_mfma_f32_16x16x32_bf16 v[128:131], v[168:171], a[16:19], v[128:131]
  s_add_u32 m0, s50, 0
  s_add_u32 s5, s32, 0
  buffer_load_dwordx4 v20, s[8:11], s5 offen sc1 lds
  v_mfma_f32_16x16x32_bf16 v[132:135], v[168:171], a[20:23], v[132:135]
  v_mfma_f32_16x16x32_bf16 v[136:139], v[168:171], a[24:27], v[136:139]
  v_mfma_f32_16x16x32_bf16 v[140:143], v[168:171], a[28:31], v[140:143]
  v_mfma_f32_16x16x32_bf16 v[144:147], v[172:175], a[16:19], v[144:147]
  v_mfma_f32_16x16x32_bf16 v[148:151], v[172:175], a[20:23], v[148:151]
  v_mfma_f32_16x16x32_bf16 v[152:155], v[172:175], a[24:27], v[152:155]
  v_mfma_f32_16x16x32_bf16 v[156:159], v[172:175], a[28:31], v[156:159]
  ds_read_b128 v[168:171], v24 offset:6144
  ds_read_b128 v[172:175], v24 offset:7168
  s_waitcnt lgkmcnt(2)
  v_mfma_f32_16x16x32_bf16 v[128:131], v[160:163], a[32:35], v[128:131]
  v_mfma_f32_16x16x32_bf16 v[132:135], v[160:163], a[36:39], v[132:135]
  v_mfma_f32_16x16x32_bf16 v[136:139], v[160:163], a[40:43], v[136:139]
  v_mfma_f32_16x16x32_bf16 v[140:143], v[160:163], a[44:47], v[140:143]
  v_mfma_f32_16x16x32_bf16 v[144:147], v[164:167], a[32:35], v[144:147]
  v_mfma_f32_16x16x32_bf16 v[148:151], v[164:167], a[36:39], v[148:151]
  v_mfma_f32_16x16x32_bf16 v[152:155], v[164:167], a[40:43], v[152:155]
  v_mfma_f32_16x16x32_bf16 v[156:159], v[164:167], a[44:47], v[156:159]
  ds_read_b128 v[160:163], v24 offset:8192
  ds_read_b128 v[164:167], v24 offset:9216
  s_waitcnt lgkmcnt(2)
  v_mfma_f32_16x16x32_bf16 v[128:131], v[168:171], a[48:51], v[128:131]
  s_add_u32 m0, s50, 4096
  s_add_u32 s5, s32, 4096
  buffer_load_dwordx4 v20, s[8:11], s5 offen sc1 lds
  v_mfma_f32_16x16x32_bf16 v[132:135], v[168:171], a[52:55], v[132:135]
  v_mfma_f32_16x16x32_bf16 v[136:139], v[168:171], a[56:59], v[136:139]
  v_mfma_f32_16x16x32_bf16 v[140:143], v[168:171], a[60:63], v[140:143]
  v_mfma_f32_16x16x32_bf16 v[144:147], v[172:175], a[48:51], v[144:147]
  v_mfma_f32_16x16x32_bf16 v[148:151], v[172:175], a[52:55], v[148:151]
  v_mfma_f32_16x16x32_bf16 v[152:155], v[172:175], a[56:59], v[152:155]
  v_mfma_f32_16x16x32_bf16 v[156:159], v[172:175], a[60:63], v[156:159]
  ds_read_b128 v[168:171], v24 offset:10240
  ds_read_b128 v[172:175], v24 offset:11264
  s_waitcnt lgkmcnt(2)
  v_mfma_f32_16x16x32_bf16 v[128:131], v[160:163], a[64:67], v[128:131]
  v_mfma_f32_16x16x32_bf16 v[132:135], v[160:163], a[68:71], v[132:135]
  v_mfma_f32_16x16x32_bf16 v[136:139], v[160:163], a[72:75], v[136:139]
  v_mfma_f32_16x16x32_bf16 v[140:143], v[160:163], a[76:79], v[140:143]
  v_mfma_f32_16x16x32_bf16 v[144:147], v[164:167], a[64:67], v[144:147]
  v_mfma_f32_16x16x32_bf16 v[148:151], v[164:167], a[68:71], v[148:151]
  v_mfma_f32_16x16x32_bf16 v[152:155], v[164:167], a[72:75], v[152:155]
  v_mfma_f32_16x16x32_bf16 v[156:159], v[164:167], a[76:79], v[156:159]
  ds_read_b128 v[160:163], v24 offset:12288
  ds_read_b128 v[164:167], v24 offset:13312
  s_waitcnt lgkmcnt(2)
  v_mfma_f32_16x16x32_bf16 v[128:131], v[168:171], a[80:83], v[128:131]
  s_add_u32 m0, s50, 8192
  s_add_u32 s5, s32, 8192
  buffer_load_dwordx4 v20, s[8:11], s5 offen sc1 lds
  v_mfma_f32_16x16x32_bf16 v[132:135], v[168:171], a[84:87], v[132:135]
  v_mfma_f32_16x16x32_bf16 v[136:139], v[168:171], a[88:91], v[136:139]
  v_mfma_f32_16x16x32_bf16 v[140:143], v[168:171], a[92:95], v[140:143]
  v_mfma_f32_16x16x32_bf16 v[144:147], v[172:175], a[80:83], v[144:147]
  v_mfma_f32_16x16x32_bf16 v[148:151], v[172:175], a[84:87], v[148:151]
  v_mfma_f32_16x16x32_bf16 v[152:155], v[172:175], a[88:91], v[152:155]
  v_mfma_f32_16x16x32_bf16 v[156:159], v[172:175], a[92:95], v[156:159]
  ds_read_b128 v[168:171], v24 offset:14336
  ds_read_b128 v[172:175], v24 offset:15360
  s_waitcnt lgkmcnt(2)
  v_mfma_f32_16x16x32_bf16 v[128:131], v[160:163], a[96:99], v[128:131]
  v_mfma_f32_16x16x32_bf16 v[132:135], v[160:163], a[100:103], v[132:135]
  v_mfma_f32_16x16x32_bf16 v[136:139], v[160:163], a[104:107], v[136:139]
  v_mfma_f32_16x16x32_bf16 v[140:143], v[160:163], a[108:111], v[140:143]
  v_mfma_f32_16x16x32_bf16 v[144:147], v[164:167], a[96:99], v[144:147]
  v_mfma_f32_16x16x32_bf16 v[148:151], v[164:167], a[100:103], v[148:151]
  v_mfma_f32_16x16x32_bf16 v[152:155], v[164:167], a[104:107], v[152:155]
  v_mfma_f32_16x16x32_bf16 v[156:159], v[164:167], a[108:111], v[156:159]
  ds_read_b128 v[160:163], v24 offset:16384
  ds_read_b128 v[164:167], v24 offset:17408
  s_waitcnt lgkmcnt(2)
  v_mfma_f32_16x16x32_bf16 v[128:131], v[168:171], a[112:115], v[128:131]
  s_add_u32 m0, s50, 12288
  s_add_u32 s5, s32, 12288
  buffer_load_dwordx4 v20, s[8:11], s5 offen sc1 lds
  v_mfma_f32_16x16x32_bf16 v[132:135], v[168:171], a[116:119], v[132:135]
  v_mfma_f32_16x16x32_bf16 v[136:139], v[168:171], a[120:123], v[136:139]
  v_mfma_f32_16x16x32_bf16 v[140:143], v[168:171], a[124:127], v[140:143]
  v_mfma_f32_16x16x32_bf16 v[144:147], v[172:175], a[112:115], v[144:147]
  v_mfma_f32_16x16x32_bf16 v[148:151], v[172:175], a[116:119], v[148:151]
  v_mfma_f32_16x16x32_bf16 v[152:155], v[172:175], a[120:123], v[152:155]
  v_mfma_f32_16x16x32_bf16 v[156:159], v[172:175], a[124:127], v[156:159]
  ds_read_b128 v[168:171], v24 offset:18432
  ds_read_b128 v[172:175], v24 offset:19456
  s_waitcnt lgkmcnt(2)
  v_mfma_f32_16x16x32_bf16 v[128:131], v[160:163], a[128:131], v[128:131]
  v_mfma_f32_16x16x32_bf16 v[132:135], v[160:163], a[132:135], v[132:135]
  v_mfma_f32_16x16x32_bf16 v[136:139], v[160:163], a[136:139], v[136:139]
  v_mfma_f32_16x16x32_bf16 v[140:143], v[160:163], a[140:143], v[140:143]
  v_mfma_f32_16x16x32_bf16 v[144:147], v[164:167], a[128:131], v[144:147]
  v_mfma_f32_16x16x32_bf16 v[148:151], v[164:167], a[132:135], v[148:151]
  v_mfma_f32_16x16x32_bf16 v[152:155], v[164:167], a[136:139], v[152:155]
  v_mfma_f32_16x16x32_bf16 v[156:159], v[164:167], a[140:143], v[156:159]
  ds_read_b128 v[160:163], v24 offset:20480
  ds_read_b128 v[164:167], v24 offset:21504
  s_waitcnt lgkmcnt(2)
  v_mfma_f32_16x16x32_bf16 v[128:131], v[168:171], a[144:147], v[128:131]
  s_add_u32 m0, s50, 16384
  s_add_u32 s5, s32, 16384
  buffer_load_dwordx4 v20, s[8:11], s5 offen sc1 lds
  v_mfma_f32_16x16x32_bf16 v[132:135], v[168:171], a[148:151], v[132:135]
  v_mfma_f32_16x16x32_bf16 v[136:139], v[168:171], a[152:155], v[136:139]
  v_mfma_f32_16x16x32_bf16 v[140:143], v[168:171], a[156:159], v[140:143]
  v_mfma_f32_16x16x32_bf16 v[144:147], v[172:175], a[144:147], v[144:147]
  v_mfma_f32_16x16x32_bf16 v[148:151], v[172:175], a[148:151], v[148:151]
  v_mfma_f32_16x16x32_bf16 v[152:155], v[172:175], a[152:155], v[152:155]
  v_mfma_f32_16x16x32_bf16 v[156:159], v[172:175], a[156:159], v[156:159]
  ds_read_b128 v[168:171], v24 offset:22528
  ds_read_b128 v[172:175], v24 offset:23552
  s_waitcnt lgkmcnt(2)
  v_mfma_f32_16x16x32_bf16 v[128:131], v[160:163], a[160:163], v[128:131]
  v_mfma_f32_16x16x32_bf16 v[132:135], v[160:163], a[164:167], v[132:135]
  v_mfma_f32_16x16x32_bf16 v[136:139], v[160:163], a[168:171], v[136:139]
  v_mfma_f32_16x16x32_bf16 v[140:143], v[160:163], a[172:175], v[140:143]
  v_mfma_f32_16x16x32_bf16 v[144:147], v[164:167], a[160:163], v[144:147]
  v_mfma_f32_16x16x32_bf16 v[148:151], v[164:167], a[164:167], v[148:151]
  v_mfma_f32_16x16x32_bf16 v[152:155], v[164:167], a[168:171], v[152:155]
  v_mfma_f32_16x16x32_bf16 v[156:159], v[164:167], a[172:175], v[156:159]
  ds_read_b128 v[160:163], v24 offset:24576
  ds_read_b128 v[164:167], v24 offset:25600
  s_waitcnt lgkmcnt(2)
  v_mfma_f32_16x16x32_bf16 v[128:131], v[168:171], a[176:179], v[128:131]
  s_add_u32 m0, s50, 20480
  s_add_u32 s5, s32, 20480
  buffer_load_dwordx4 v20, s[8:11], s5 offen sc1 lds
  v_mfma_f32_16x16x32_bf16 v[132:135], v[168:171], a[180:183], v[132:135]
  v_mfma_f32_16x16x32_bf16 v[136:139], v[168:171], a[184:187], v[136:139]
  v_mfma_f32_16x16x32_bf16 v[140:143], v[168:171], a[188:191], v[140:143]
  v_mfma_f32_16x16x32_bf16 v[144:147], v[172:175], a[176:179], v[144:147]
  v_mfma_f32_16x16x32_bf16 v[148:151], v[172:175], a[180:183], v[148:151]
  v_mfma_f32_16x16x32_bf16 v[152:155], v[172:175], a[184:187], v[152:155]
  v_mfma_f32_16x16x32_bf16 v[156:159], v[172:175], a[188:191], v[156:159]
  ds_read_b128 v[168:171], v24 offset:26624
  ds_read_b128 v[172:175], v24 offset:27648
  s_waitcnt lgkmcnt(2)
  v_mfma_f32_16x16x32_bf16 v[128:131], v[160:163], a[192:195], v[128:131]
  v_mfma_f32_16x16x32_bf16 v[132:135], v[160:163], a[196:199], v[132:135]
  v_mfma_f32_16x16x32_bf16 v[136:139], v[160:163], a[200:203], v[136:139]
  v_mfma_f32_16x16x32_bf16 v[140:143], v[160:163], a[204:207], v[140:143]
  v_mfma_f32_16x16x32_bf16 v[144:147], v[164:167], a[192:195], v[144:147]
  v_mfma_f32_16x16x32_bf16 v[148:151], v[164:167], a[196:199], v[148:151]
  v_mfma_f32_16x16x32_bf16 v[152:155], v[164:167], a[200:203], v[152:155]
  v_mfma_f32_16x16x32_bf16 v[156:159], v[164:167], a[204:207], v[156:159]
  ds_read_b128 v[160:163], v24 offset:28672
  ds_read_b128 v[164:167], v24 offset:29696
  s_waitcnt lgkmcnt(2)
  v_mfma_f32_16x16x32_bf16 v[128:131], v[168:171], a[208:211], v[128:131]
  s_add_u32 m0, s50, 24576
  s_add_u32 s5, s32, 24576
  buffer_load_dwordx4 v20, s[8:11], s5 offen sc1 lds
  v_mfma_f32_16x16x32_bf16 v[132:135], v[168:171], a[212:215], v[132:135]
  v_mfma_f32_16x16x32_bf16 v[136:139], v[168:171], a[216:219], v[136:139]
  v_mfma_f32_16x16x32_bf16 v[140:143], v[168:171], a[220:223], v[140:143]
  v_mfma_f32_16x16x32_bf16 v[144:147], v[172:175], a[208:211], v[144:147]
  v_mfma_f32_16x16x32_bf16 v[148:151], v[172:175], a[212:215], v[148:151]
  v_mfma_f32_16x16x32_bf16 v[152:155], v[172:175], a[216:219], v[152:155]
  v_mfma_f32_16x16x32_bf16 v[156:159], v[172:175], a[220:223], v[156:159]
  ds_read_b128 v[168:171], v24 offset:30720
  ds_read_b128 v[172:175], v24 offset:31744
  s_waitcnt lgkmcnt(2)
  v_mfma_f32_16x16x32_bf16 v[128:131], v[160:163], a[224:227], v[128:131]
  v_mfma_f32_16x16x32_bf16 v[132:135], v[160:163], a[228:231], v[132:135]
  v_mfma_f32_16x16x32_bf16 v[136:139], v[160:163], a[232:235], v[136:139]
  v_mfma_f32_16x16x32_bf16 v[140:143], v[160:163], a[236:239], v[140:143]
  v_mfma_f32_16x16x32_bf16 v[144:147], v[164:167], a[224:227], v[144:147]
  v_mfma_f32_16x16x32_bf16 v[148:151], v[164:167], a[228:231], v[148:151]
  v_mfma_f32_16x16x32_bf16 v[152:155], v[164:167], a[232:235], v[152:155]
  v_mfma_f32_16x16x32_bf16 v[156:159], v[164:167], a[236:239], v[156:159]
  ds_read_b128 v[160:163], v24 offset:32768
  ds_read_b128 v[164:167], v24 offset:33792
  s_waitcnt lgkmcnt(2)
  v_mfma_f32_16x16x32_bf16 v[128:131], v[168:171], a[240:243], v[128:131]
  s_add_u32 m0, s50, 28672
  s_add_u32 s5, s32, 28672
  buffer_load_dwordx4 v20, s[8:11], s5 offen sc1 lds
  v_mfma_f32_16x16x32_bf16 v[132:135], v[168:171], a[244:247], v[132:135]
  v_mfma_f32_16x16x32_bf16 v[136:139], v[168:171], a[248:251], v[136:139]
  v_mfma_f32_16x16x32_bf16 v[140:143], v[168:171], a[252:255], v[140:143]
  v_mfma_f32_16x16x32_bf16 v[144:147], v[172:175], a[240:243], v[144:147]
  v_mfma_f32_16x16x32_bf16 v[148:151], v[172:175], a[244:247], v[148:151]
  v_mfma_f32_16x16x32_bf16 v[152:155], v[172:175], a[248:251], v[152:155]
  v_mfma_f32_16x16x32_bf16 v[156:159], v[172:175], a[252:255], v[156:159]
  ds_read_b128 v[168:171], v24 offset:34816
  ds_read_b128 v[172:175], v24 offset:35840
  s_waitcnt lgkmcnt(2)
  v_mfma_f32_16x16x32_bf16 v[128:131], v[160:163], v[192:195], v[128:131]
  v_mfma_f32_16x16x32_bf16 v[132:135], v[160:163], v[196:199], v[132:135]
  v_mfma_f32_16x16x32_bf16 v[136:139], v[160:163], v[200:203], v[136:139]
  v_mfma_f32_16x16x32_bf16 v[140:143], v[160:163], v[204:207], v[140:143]
  v_mfma_f32_16x16x32_bf16 v[144:147], v[164:167], v[192:195], v[144:147]
  v_mfma_f32_16x16x32_bf16 v[148:151], v[164:167], v[196:199], v[148:151]
  v_mfma_f32_16x16x32_bf16 v[152:155], v[164:167], v[200:203], v[152:155]
  v_mfma_f32_16x16x32_bf16 v[156:159], v[164:167], v[204:207], v[156:159]
  ds_read_b128 v[160:163], v24 offset:36864
  ds_read_b128 v[164:167], v24 offset:37888
  s_waitcnt lgkmcnt(2)
  v_mfma_f32_16x16x32_bf16 v[128:131], v[168:171], v[208:211], v[128:131]
  s_add_u32 m0, s50, 32768
  s_add_u32 s5, s32, 32768
  buffer_load_dwordx4 v20, s[8:11], s5 offen sc1 lds
  v_mfma_f32_16x16x32_bf16 v[132:135], v[168:171], v[212:215], v[132:135]
  v_mfma_f32_16x16x32_bf16 v[136:139], v[168:171], v[216:219], v[136:139]
  v_mfma_f32_16x16x32_bf16 v[140:143], v[168:171], v[220:223], v[140:143]
  v_mfma_f32_16x16x32_bf16 v[144:147], v[172:175], v[208:211], v[144:147]
  v_mfma_f32_16x16x32_bf16 v[148:151], v[172:175], v[212:215], v[148:151]
  v_mfma_f32_16x16x32_bf16 v[152:155], v[172:175], v[216:219], v[152:155]
  v_mfma_f32_16x16x32_bf16 v[156:159], v[172:175], v[220:223], v[156:159]
  ds_read_b128 v[168:171], v24 offset:38912
  ds_read_b128 v[172:175], v24 offset:39936
  s_waitcnt lgkmcnt(2)
  v_mfma_f32_16x16x32_bf16 v[128:131], v[160:163], v[224:227], v[128:131]
  v_mfma_f32_16x16x32_bf16 v[132:135], v[160:163], v[228:231], v[132:135]
  v_mfma_f32_16x16x32_bf16 v[136:139], v[160:163], v[232:235], v[136:139]
  v_mfma_f32_16x16x32_bf16 v[140:143], v[160:163], v[236:239], v[140:143]
  v_mfma_f32_16x16x32_bf16 v[144:147], v[164:167], v[224:227], v[144:147]
  v_mfma_f32_16x16x32_bf16 v[148:151], v[164:167], v[228:231], v[148:151]
  v_mfma_f32_16x16x32_bf16 v[152:155], v[164:167], v[232:235], v[152:155]
  v_mfma_f32_16x16x32_bf16 v[156:159], v[164:167], v[236:239], v[156:159]
  s_waitcnt lgkmcnt(0)
  v_mfma_f32_16x16x32_bf16 v[128:131], v[168:171], v[240:243], v[128:131]
  s_add_u32 m0, s50, 36864
  s_add_u32 s5, s32, 36864
  buffer_load_dwordx4 v20, s[8:11], s5 offen sc1 lds
  v_mfma_f32_16x16x32_bf16 v[132:135], v[168:171], v[244:247], v[132:135]
  v_mfma_f32_16x16x32_bf16 v[136:139], v[168:171], v[248:251], v[136:139]
  v_mfma_f32_16x16x32_bf16 v[140:143], v[168:171], v[252:255], v[140:143]
  v_mfma_f32_16x16x32_bf16 v[144:147], v[172:175], v[240:243], v[144:147]
  v_mfma_f32_16x16x32_bf16 v[148:151], v[172:175], v[244:247], v[148:151]
  v_mfma_f32_16x16x32_bf16 v[152:155], v[172:175], v[248:251], v[152:155]
  v_mfma_f32_16x16x32_bf16 v[156:159], v[172:175], v[252:255], v[156:159]
  s_waitcnt vmcnt(10)
  s_branch L_Av_ep
L_Av_cAc:
  s_waitcnt vmcnt(0)
  s_barrier
  ds_read_b128 v[160:163], v24 offset:0
  ds_read_b128 v[164:167], v24 offset:1024
  ds_read_b128 v[168:171], v24 offset:2048
  ds_read_b128 v[172:175], v24 offset:3072
  s_waitcnt lgkmcnt(2)
  v_mfma_f32_16x16x32_bf16 v[128:131], v[160:163], a[0:3], 0
  v_mfma_f32_16x16x32_bf16 v[132:135], v[160:163], a[4:7], 0
  v_mfma_f32_16x16x32_bf16 v[136:139], v[160:163], a[8:11], 0
  v_mfma_f32_16x16x32_bf16 v[140:143], v[160:163], a[12:15], 0
  v_mfma_f32_16x16x32_bf16 v[144:147], v[164:167], a[0:3], 0
  v_mfma_f32_16x16x32_bf16 v[148:151], v[164:167], a[4:7], 0
  v_mfma_f32_16x16x32_bf16 v[152:155], v[164:167], a[8:11], 0
  v_mfma_f32_16x16x32_bf16 v[156:159], v[164:167], a[12:15], 0
  ds_read_b128 v[160:163], v24 offset:4096
  ds_read_b128 v[164:167], v24 offset:5120
  s_waitcnt lgkmcnt(2)
  v_mfma_f32_16x16x32_bf16 v[128:131], v[168:171], a[16:19], v[128:131]
  s_add_u32 m0, s50, 0
  s_add_u32 s5, s32, 0
  buffer_load_dwordx4 v20, s[8:11], s5 offen sc1 lds
  v_mfma_f32_16x16x32_bf16 v[132:135], v[168:171], a[20:23], v[132:135]
  v_mfma_f32_16x16x32_bf16 v[136:139], v[168:171], a[24:27], v[136:139]
  v_mfma_f32_16x16x32_bf16 v[140:143], v[168:171], a[28:31], v[140:143]
  v_mfma_f32_16x16x32_bf16 v[144:147], v[172:175], a[16:19], v[144:147]
  v_mfma_f32_16x16x32_bf16 v[148:151], v[172:175], a[20:23], v[148:151]
  v_mfma_f32_16x16x32_bf16 v[152:155], v[172:175], a[24:27], v[152:155]
  v_mfma_f32_16x16x32_bf16 v[156:159], v[172:175], a[28:31], v[156:159]
  ds_read_b128 v[168:171], v24 offset:6144
  ds_read_b128 v[172:175], v24 offset:7168
  s_waitcnt lgkmcnt(2)
  v_mfma_f32_16x16x32_bf16 v[128:131], v[160:163], a[32:35], v[128:131]
  v_mfma_f32_16x16x32_bf16 v[132:135], v[160:163], a[36:39], v[132:135]
  v_mfma_f32_16x16x32_bf16 v[136:139], v[160:163], a[40:43], v[136:139]
  v_mfma_f32_16x16x32_bf16 v[140:143], v[160:163], a[44:47], v[140:143]
  v_mfma_f32_16x16x32_bf16 v[144:147], v[164:167], a[32:35], v[144:147]
  v_mfma_f32_16x16x32_bf16 v[148:151], v[164:167], a[36:39], v[148:151]
  v_mfma_f32_16x16x32_bf16 v[152:155], v[164:167], a[40:43], v[152:155]
  v_mfma_f32_16x16x32_bf16 v[156:159], v[164:167], a[44:47], v[156:159]
  ds_read_b128 v[160:163], v24 offset:8192
  ds_read_b128 v[164:167], v24 offset:9216
  s_waitcnt lgkmcnt(2)
  v_mfma_f32_16x16x32_bf16 v[128:131], v[168:171], a[48:51], v[128:131]
  s_add_u32 m0, s50, 4096
  s_add_u32 s5, s32, 4096
  buffer_load_dwordx4 v20, s[8:11], s5 offen sc1 lds
  v_mfma_f32_16x16x32_bf16 v[132:135], v[168:171], a[52:55], v[132:135]
  v_mfma_f32_16x16x32_bf16 v[136:139], v[168:171], a[56:59], v[136:139]
  v_mfma_f32_16x16x32_bf16 v[140:143], v[168:171], a[60:63], v[140:143]
  v_mfma_f32_16x16x32_bf16 v[144:147], v[172:175], a[48:51], v[144:147]
  v_mfma_f32_16x16x32_bf16 v[148:151], v[172:175], a[52:55], v[148:151]
  v_mfma_f32_16x16x32_bf16 v[152:155], v[172:175], a[56:59], v[152:155]
  v_mfma_f32_16x16x32_bf16 v[156:159], v[172:175], a[60:63], v[156:159]
  ds_read_b128 v[168:171], v24 offset:10240
  ds_read_b128 v[172:175], v24 offset:11264
  s_waitcnt lgkmcnt(2)
  v_mfma_f32_16x16x32_bf16 v[128:131], v[160:163], a[64:67], v[128:131]
  v_mfma_f32_16x16x32_bf16 v[132:135], v[160:163], a[68:71], v[132:135]
  v_mfma_f32_16x16x32_bf16 v[136:139], v[160:163], a[72:75], v[136:139]
  v_mfma_f32_16x16x32_bf16 v[140:143], v[160:163], a[76:79], v[140:143]
  v_mfma_f32_16x16x32_bf16 v[144:147], v[164:167], a[64:67], v[144:147]
  v_mfma_f32_16x16x32_bf16 v[148:151], v[164:167], a[68:71], v[148:151]
  v_mfma_f32_16x16x32_bf16 v[152:155], v[164:167], a[72:75], v[152:155]
  v_mfma_f32_16x16x32_bf16 v[156:159], v[164:167], a[76:79], v[156:159]
  ds_read_b128 v[160:163], v24 offset:12288
  ds_read_b128 v[164:167], v24 offset:13312
  s_waitcnt lgkmcnt(2)
  v_mfma_f32_16x16x32_bf16 v[128:131], v[168:171], a[80:83], v[128:131]
  s_add_u32 m0, s50, 8192
  s_add_u32 s5, s32, 8192
  buffer_load_dwordx4 v20, s[8:11], s5 offen sc1 lds
  v_mfma_f32_16x16x32_bf16 v[132:135], v[168:171], a[84:87], v[132:135]
  v_mfma_f32_16x16x32_bf16 v[136:139], v[168:171], a[88:91], v[136:139]
  v_mfma_f32_16x16x32_bf16 v[140:143], v[168:171], a[92:95], v[140:143]
  v_mfma_f32_16x16x32_bf16 v[144:147], v[172:175], a[80:83], v[144:147]
  v_mfma_f32_16x16x32_bf16 v[148:151], v[172:175], a[84:87], v[148:151]
  v_mfma_f32_16x16x32_bf16 v[152:155], v[172:175], a[88:91], v[152:155]
  v_mfma_f32_16x16x32_bf16 v[156:159], v[172:175], a[92:95], v[156:159]
  ds_read_b128 v[168:171], v24 offset:14336
  ds_read_b128 v[172:175], v24 offset:15360
  s_waitcnt lgkmcnt(2)
  v_mfma_f32_16x16x32_bf16 v[128:131], v[160:163], a[96:99], v[128:131]
  v_mfma_f32_16x16x32_bf16 v[132:135], v[160:163], a[100:103], v[132:135]
  v_mfma_f32_16x16x32_bf16 v[136:139], v[160:163], a[104:107], v[136:139]
  v_mfma_f32_16x16x32_bf16 v[140:143], v[160:163], a[108:111], v[140:143]
  v_mfma_f32_16x16x32_bf16 v[144:147], v[164:167], a[96:99], v[144:147]
  v_mfma_f32_16x16x32_bf16 v[148:151], v[164:167], a[100:103], v[148:151]
  v_mfma_f32_16x16x32_bf16 v[152:155], v[164:167], a[104:107], v[152:155]
  v_mfma_f32_16x16x32_bf16 v[156:159], v[164:167], a[108:111], v[156:159]
  ds_read_b128 v[160:163], v24 offset:16384
  ds_read_b128 v[164:167], v24 offset:17408
  s_waitcnt lgkmcnt(2)
  v_mfma_f32_16x16x32_bf16 v[128:131], v[168:171], a[112:115], v[128:131]
  s_add_u32 m0, s50, 12288
  s_add_u32 s5, s32, 12288
  buffer_load_dwordx4 v20, s[8:11], s5 offen sc1 lds
  v_mfma_f32_16x16x32_bf16 v[132:135], v[168:171], a[116:119], v[132:135]
  v_mfma_f32_16x16x32_bf16 v[136:139], v[168:171], a[120:123], v[136:139]
  v_mfma_f32_16x16x32_bf16 v[140:143], v[168:171], a[124:127], v[140:143]
  v_mfma_f32_16x16x32_bf16 v[144:147], v[172:175], a[112:115], v[144:147]
  v_mfma_f32_16x16x32_bf16 v[148:151], v[172:175], a[116:119], v[148:151]
  v_mfma_f32_16x16x32_bf16 v[152:155], v[172:175], a[120:123], v[152:155]
  v_mfma_f32_16x16x32_bf16 v[156:159], v[172:175], a[124:127], v[156:159]
  ds_read_b128 v[168:171], v24 offset:18432
  ds_read_b128 v[172:175], v24 offset:19456
  s_waitcnt lgkmcnt(2)
  v_mfma_f32_16x16x32_bf16 v[128:131], v[160:163], a[128:131], v[128:131]
  v_mfma_f32_16x16x32_bf16 v[132:135], v[160:163], a[132:135], v[132:135]
  v_mfma_f32_16x16x32_bf16 v[136:139], v[160:163], a[136:139], v[136:139]
  v_mfma_f32_16x16x32_bf16 v[140:143], v[160:163], a[140:143], v[140:143]
  v_mfma_f32_16x16x32_bf16 v[144:147], v[164:167], a[128:131], v[144:147]
  v_mfma_f32_16x16x32_bf16 v[148:151], v[164:167], a[132:135], v[148:151]
  v_mfma_f32_16x16x32_bf16 v[152:155], v[164:167], a[136:139], v[152:155]
  v_mfma_f32_16x16x32_bf16 v[156:159], v[164:167], a[140:143], v[156:159]
  ds_read_b128 v[160:163], v24 offset:20480
  ds_read_b128 v[164:167], v24 offset:21504
  s_waitcnt lgkmcnt(2)
  v_mfma_f32_16x16x32_bf16 v[128:131], v[168:171], a[144:147], v[128:131]
  s_add_u32 m0, s50, 16384
  s_add_u32 s5, s32, 16384
  buffer_load_dwordx4 v20, s[8:11], s5 offen sc1 lds
  v_mfma_f32_16x16x32_bf16 v[132:135], v[168:171], a[148:151], v[132:135]
  v_mfma_f32_16x16x32_bf16 v[136:139], v[168:171], a[152:155], v[136:139]
  v_mfma_f32_16x16x32_bf16 v[140:143], v[168:171], a[156:159], v[140:143]
  v_mfma_f32_16x16x32_bf16 v[144:147], v[172:175], a[144:147], v[144:147]
  v_mfma_f32_16x16x32_bf16 v[148:151], v[172:175], a[148:151], v[148:151]
  v_mfma_f32_16x16x32_bf16 v[152:155], v[172:175], a[152:155], v[152:155]
  v_mfma_f32_16x16x32_bf16 v[156:159], v[172:175], a[156:159], v[156:159]
  ds_read_b128 v[168:171], v24 offset:22528
  ds_read_b128 v[172:175], v24 offset:23552
  s_waitcnt lgkmcnt(2)
  v_mfma_f32_16x16x32_bf16 v[128:131], v[160:163], a[160:163], v[128:131]
  v_mfma_f32_16x16x32_bf16 v[132:135], v[160:163], a[164:167], v[132:135]
  v_mfma_f32_16x16x32_bf16 v[136:139], v[160:163], a[168:171], v[136:139]
  v_mfma_f32_16x16x32_bf16 v[140:143], v[160:163], a[172:175], v[140:143]
  v_mfma_f32_16x16x32_bf16 v[144:147], v[164:167], a[160:163], v[144:147]
  v_mfma_f32_16x16x32_bf16 v[148:151], v[164:167], a[164:167], v[148:151]
  v_mfma_f32_16x16x32_bf16 v[152:155], v[164:167], a[168:171], v[152:155]
  v_mfma_f32_16x16x32_bf16 v[156:159], v[164:167], a[172:175], v[156:159]
  ds_read_b128 v[160:163], v24 offset:24576
  ds_read_b128 v[164:167], v24 offset:25600
  s_waitcnt lgkmcnt(2)
  v_mfma_f32_16x16x32_bf16 v[128:131], v[168:171], a[176:179], v[128:131]
  s_add_u32 m0, s50, 20480
  s_add_u32 s5, s32, 20480
  buffer_load_dwordx4 v20, s[8:11], s5 offen sc1 lds
  v_mfma_f32_16x16x32_bf16 v[132:135], v[168:171], a[180:183], v[132:135]
  v_mfma_f32_16x16x32_bf16 v[136:139], v[168:171], a[184:187], v[136:139]
  v_mfma_f32_16x16x32_bf16 v[140:143], v[168:171], a[188:191], v[140:143]
  v_mfma_f32_16x16x32_bf16 v[144:147], v[172:175], a[176:179], v[144:147]
  v_mfma_f32_16x16x32_bf16 v[148:151], v[172:175], a[180:183], v[148:151]
  v_mfma_f32_16x16x32_bf16 v[152:155], v[172:175], a[184:187], v[152:155]
  v_mfma_f32_16x16x32_bf16 v[156:159], v[172:175], a[188:191], v[156:159]
  ds_read_b128 v[168:171], v24 offset:26624
  ds_read_b128 v[172:175], v24 offset:27648
  s_waitcnt lgkmcnt(2)
  v_mfma_f32_16x16x32_bf16 v[128:131], v[160:163], a[192:195], v[128:131]
  v_mfma_f32_16x16x32_bf16 v[132:135], v[160:163], a[196:199], v[132:135]
  v_mfma_f32_16x16x32_bf16 v[136:139], v[160:163], a[200:203], v[136:139]
  v_mfma_f32_16x16x32_bf16 v[140:143], v[160:163], a[204:207], v[140:143]
  v_mfma_f32_16x16x32_bf16 v[144:147], v[164:167], a[192:195], v[144:147]
  v_mfma_f32_16x16x32_bf16 v[148:151], v[164:167], a[196:199], v[148:151]
  v_mfma_f32_16x16x32_bf16 v[152:155], v[164:167], a[200:203], v[152:155]
  v_mfma_f32_16x16x32_bf16 v[156:159], v[164:167], a[204:207], v[156:159]
  ds_read_b128 v[160:163], v24 offset:28672
  ds_read_b128 v[164:167], v24 offset:29696
  s_waitcnt lgkmcnt(2)
  v_mfma_f32_16x16x32_bf16 v[128:131], v[168:171], a[208:211], v[128:131]
  s_add_u32 m0, s50, 24576
  s_add_u32 s5, s32, 24576
  buffer_load_dwordx4 v20, s[8:11], s5 offen sc1 lds
  v_mfma_f32_16x16x32_bf16 v[132:135], v[168:171], a[212:215], v[132:135]
  v_mfma_f32_16x16x32_bf16 v[136:139], v[168:171], a[216:219], v[136:139]
  v_mfma_f32_16x16x32_bf16 v[140:143], v[168:171], a[220:223], v[140:143]
  v_mfma_f32_16x16x32_bf16 v[144:147], v[172:175], a[208:211], v[144:147]
  v_mfma_f32_16x16x32_bf16 v[148:151], v[172:175], a[212:215], v[148:151]
  v_mfma_f32_16x16x32_bf16 v[152:155], v[172:175], a[216:219], v[152:155]
  v_mfma_f32_16x16x32_bf16 v[156:159], v[172:175], a[220:223], v[156:159]
  ds_read_b128 v[168:171], v24 offset:30720
  ds_read_b128 v[172:175], v24 offset:31744
  s_waitcnt lgkmcnt(2)
  v_mfma_f32_16x16x32_bf16 v[128:131], v[160:163], a[224:227], v[128:131]
  v_mfma_f32_16x16x32_bf16 v[132:135], v[160:163], a[228:231], v[132:135]
  v_mfma_f32_16x16x32_bf16 v[136:139], v[160:163], a[232:235], v[136:139]
  v_mfma_f32_16x16x32_bf16 v[140:143], v[160:163], a[236:239], v[140:143]
  v_mfma_f32_16x16x32_bf16 v[144:147], v[164:167], a[224:227], v[144:147]
  v_mfma_f32_16x16x32_bf16 v[148:151], v[164:167], a[228:231], v[148:151]
  v_mfma_f32_16x16x32_bf16 v[152:155], v[164:167], a[232:235], v[152:155]
  v_mfma_f32_16x16x32_bf16 v[156:159], v[164:167], a[236:239], v[156:159]
  ds_read_b128 v[160:163], v24 offset:32768
  ds_read_b128 v[164:167], v24 offset:33792
  s_waitcnt lgkmcnt(2)
  v_mfma_f32_16x16x32_bf16 v[128:131], v[168:171], a[240:243], v[128:131]
  s_add_u32 m0, s50, 28672
  s_add_u32 s5, s32, 28672
  buffer_load_dwordx4 v20, s[8:11], s5 offen sc1 lds
  v_mfma_f32_16x16x32_bf16 v[132:135], v[168:171], a[244:247], v[132:135]
  v_mfma_f32_16x16x32_bf16 v[136:139], v[168:171], a[248:251], v[136:139]
  v_mfma_f32_16x16x32_bf16 v[140:143], v[168:171], a[252:255], v[140:143]
  v_mfma_f32_16x16x32_bf16 v[144:147], v[172:175], a[240:243], v[144:147]
  v_mfma_f32_16x16x32_bf16 v[148:151], v[172:175], a[244:247], v[148:151]
  v_mfma_f32_16x16x32_bf16 v[152:155], v[172:175], a[248:251], v[152:155]
  v_mfma_f32_16x16x32_bf16 v[156:159], v[172:175], a[252:255], v[156:159]
  ds_read_b128 v[168:171], v24 offset:34816
  ds_read_b128 v[172:175], v24 offset:35840
  s_waitcnt lgkmcnt(2)
  v_mfma_f32_16x16x32_bf16 v[128:131], v[160:163], v[192:195], v[128:131]
  v_mfma_f32_16x16x32_bf16 v[132:135], v[160:163], v[196:199], v[132:135]
  v_mfma_f32_16x16x32_bf16 v[136:139], v[160:163], v[200:203], v[136:139]
  v_mfma_f32_16x16x32_bf16 v[140:143], v[160:163], v[204:207], v[140:143]
  v_mfma_f32_16x16x32_bf16 v[144:147], v[164:167], v[192:195], v[144:147]
  v_mfma_f32_16x16x32_bf16 v[148:151], v[164:167], v[196:199], v[148:151]
  v_mfma_f32_16x16x32_bf16 v[152:155], v[164:167], v[200:203], v[152:155]
  v_mfma_f32_16x16x32_bf16 v[156:159], v[164:167], v[204:207], v[156:159]
  ds_read_b128 v[160:163], v24 offset:36864
  ds_read_b128 v[164:167], v24 offset:37888
  s_waitcnt lgkmcnt(2)
  v_mfma_f32_16x16x32_bf16 v[128:131], v[168:171], v[208:211], v[128:131]
  s_add_u32 m0, s50, 32768
  s_add_u32 s5, s32, 32768
  buffer_load_dwordx4 v20, s[8:11], s5 offen sc1 lds
  v_mfma_f32_16x16x32_bf16 v[132:135], v[168:171], v[212:215], v[132:135]
  v_mfma_f32_16x16x32_bf16 v[136:139], v[168:171], v[216:219], v[136:139]
  v_mfma_f32_16x16x32_bf16 v[140:143], v[168:171], v[220:223], v[140:143]
  v_mfma_f32_16x16x32_bf16 v[144:147], v[172:175], v[208:211], v[144:147]
  v_mfma_f32_16x16x32_bf16 v[148:151], v[172:175], v[212:215], v[148:151]
  v_mfma_f32_16x16x32_bf16 v[152:155], v[172:175], v[216:219], v[152:155]
  v_mfma_f32_16x16x32_bf16 v[156:159], v[172:175], v[220:223], v[156:159]
  ds_read_b128 v[168:171], v24 offset:38912
  ds_read_b128 v[172:175], v24 offset:39936
  s_waitcnt lgkmcnt(2)
  v_mfma_f32_16x16x32_bf16 v[128:131], v[160:163], v[224:227], v[128:131]
  v_mfma_f32_16x16x32_bf16 v[132:135], v[160:163], v[228:231], v[132:135]
  v_mfma_f32_16x16x32_bf16 v[136:139], v[160:163], v[232:235], v[136:139]
  v_mfma_f32_16x16x32_bf16 v[140:143], v[160:163], v[236:239], v[140:143]
  v_mfma_f32_16x16x32_bf16 v[144:147], v[164:167], v[224:227], v[144:147]
  v_mfma_f32_16x16x32_bf16 v[148:151], v[164:167], v[228:231], v[148:151]
  v_mfma_f32_16x16x32_bf16 v[152:155], v[164:167], v[232:235], v[152:155]
  v_mfma_f32_16x16x32_bf16 v[156:159], v[164:167], v[236:239], v[156:159]
  s_waitcnt lgkmcnt(0)
  v_mfma_f32_16x16x32_bf16 v[128:131], v[168:171], v[240:243], v[128:131]
  s_add_u32 m0, s50, 36864
  s_add_u32 s5, s32, 36864
  buffer_load_dwordx4 v20, s[8:11], s5 offen sc1 lds
  v_mfma_f32_16x16x32_bf16 v[132:135], v[168:171], v[244:247], v[132:135]
  v_mfma_f32_16x16x32_bf16 v[136:139], v[168:171], v[248:251], v[136:139]
  v_mfma_f32_16x16x32_bf16 v[140:143], v[168:171], v[252:255], v[140:143]
  v_mfma_f32_16x16x32_bf16 v[144:147], v[172:175], v[240:243], v[144:147]
  v_mfma_f32_16x16x32_bf16 v[148:151], v[172:175], v[244:247], v[148:151]
  v_mfma_f32_16x16x32_bf16 v[152:155], v[172:175], v[248:251], v[152:155]
  v_mfma_f32_16x16x32_bf16 v[156:159], v[172:175], v[252:255], v[156:159]
  s_waitcnt vmcnt(10)
  s_branch L_Av_ep
L_Av_cB:
  s_cmp_eq_u32 s51, 1
  s_cbranch_scc1 L_Av_cBc
  s_waitcnt vmcnt(5)
  s_barrier
  ds_read_b128 v[160:163], v24 offset:0
  ds_read_b128 v[164:167], v24 offset:1024
  ds_read_b128 v[168:171], v24 offset:2048
  ds_read_b128 v[172:175], v24 offset:3072
  s_waitcnt lgkmcnt(2)
  v_mfma_f32_16x16x32_bf16 v[128:131], v[160:163], a[0:3], 0
  v_mfma_f32_16x16x32_bf16 v[132:135], v[160:163], a[4:7], 0
  v_mfma_f32_16x16x32_bf16 v[136:139], v[160:163], a[8:11], 0
  v_mfma_f32_16x16x32_bf16 v[140:143], v[160:163], a[12:15], 0
  v_mfma_f32_16x16x32_bf16 v[144:147], v[164:167], a[0:3], 0
  v_mfma_f32_16x16x32_bf16 v[148:151], v[164:167], a[4:7], 0
  v_mfma_f32_16x16x32_bf16 v[152:155], v[164:167], a[8:11], 0
  v_mfma_f32_16x16x32_bf16 v[156:159], v[164:167], a[12:15], 0
  ds_read_b128 v[160:163], v24 offset:4096
  ds_read_b128 v[164:167], v24 offset:5120
  s_waitcnt lgkmcnt(2)
  v_mfma_f32_16x16x32_bf16 v[128:131], v[168:171], a[16:19], v[128:131]
  v_mfma_f32_16x16x32_bf16 v[132:135], v[168:171], a[20:23], v[132:135]
  v_mfma_f32_16x16x32_bf16 v[136:139], v[168:171], a[24:27], v[136:139]
  v_mfma_f32_16x16x32_bf16 v[140:143], v[168:171], a[28:31], v[140:143]
  v_mfma_f32_16x16x32_bf16 v[144:147], v[172:175], a[16:19], v[144:147]
  v_mfma_f32_16x16x32_bf16 v[148:151], v[172:175], a[20:23], v[148:151]
  v_mfma_f32_16x16x32_bf16 v[152:155], v[172:175], a[24:27], v[152:155]
  v_mfma_f32_16x16x32_bf16 v[156:159], v[172:175], a[28:31], v[156:159]
  ds_read_b128 v[168:171], v24 offset:6144
  ds_read_b128 v[172:175], v24 offset:7168
  s_waitcnt lgkmcnt(2)
  v_mfma_f32_16x16x32_bf16 v[128:131], v[160:163], a[32:35], v[128:131]
  v_mfma_f32_16x16x32_bf16 v[132:135], v[160:163], a[36:39], v[132:135]
  v_mfma_f32_16x16x32_bf16 v[136:139], v[160:163], a[40:43], v[136:139]
  v_mfma_f32_16x16x32_bf16 v[140:143], v[160:163], a[44:47], v[140:143]
  v_mfma_f32_16x16x32_bf16 v[144:147], v[164:167], a[32:35], v[144:147]
  v_mfma_f32_16x16x32_bf16 v[148:151], v[164:167], a[36:39], v[148:151]
  v_mfma_f32_16x16x32_bf16 v[152:155], v[164:167], a[40:43], v[152:155]
  v_mfma_f32_16x16x32_bf16 v[156:159], v[164:167], a[44:47], v[156:159]
  ds_read_b128 v[160:163], v24 offset:8192
  ds_read_b128 v[164:167], v24 offset:9216
  s_waitcnt lgkmcnt(2)
  v_mfma_f32_16x16x32_bf16 v[128:131], v[168:171], a[48:51], v[128:131]
  v_mfma_f32_16x16x32_bf16 v[132:135], v[168:171], a[52:55], v[132:135]
  v_mfma_f32_16x16x32_bf16 v[136:139], v[168:171], a[56:59], v[136:139]
  v_mfma_f32_16x16x32_bf16 v[140:143], v[168:171], a[60:63], v[140:143]
  v_mfma_f32_16x16x32_bf16 v[144:147], v[172:175], a[48:51], v[144:147]
  v_mfma_f32_16x16x32_bf16 v[148:151], v[172:175], a[52:55], v[148:151]
  v_mfma_f32_16x16x32_bf16 v[152:155], v[172:175], a[56:59], v[152:155]
  v_mfma_f32_16x16x32_bf16 v[156:159], v[172:175], a[60:63], v[156:159]
  ds_read_b128 v[168:171], v24 offset:10240
  ds_read_b128 v[172:175], v24 offset:11264
  s_waitcnt lgkmcnt(2)
  v_mfma_f32_16x16x32_bf16 v[128:131], v[160:163], a[64:67], v[128:131]
  v_mfma_f32_16x16x32_bf16 v[132:135], v[160:163], a[68:71], v[132:135]
  v_mfma_f32_16x16x32_bf16 v[136:139], v[160:163], a[72:75], v[136:139]
  v_mfma_f32_16x16x32_bf16 v[140:143], v[160:163], a[76:79], v[140:143]
  v_mfma_f32_16x16x32_bf16 v[144:147], v[164:167], a[64:67], v[144:147]
  v_mfma_f32_16x16x32_bf16 v[148:151], v[164:167], a[68:71], v[148:151]
  v_mfma_f32_16x16x32_bf16 v[152:155], v[164:167], a[72:75], v[152:155]
  v_mfma_f32_16x16x32_bf16 v[156:159], v[164:167], a[76:79], v[156:159]
  ds_read_b128 v[160:163], v24 offset:12288
  ds_read_b128 v[164:167], v24 offset:13312
  s_waitcnt lgkmcnt(2)
  v_mfma_f32_16x16x32_bf16 v[128:131], v[168:171], a[80:83], v[128:131]
  v_mfma_f32_16x16x32_bf16 v[132:135], v[168:171], a[84:87], v[132:135]
  v_mfma_f32_16x16x32_bf16 v[136:139], v[168:171], a[88:91], v[136:139]
  v_mfma_f32_16x16x32_bf16 v[140:143], v[168:171], a[92:95], v[140:143]
  v_mfma_f32_16x16x32_bf16 v[144:147], v[172:175], a[80:83], v[144:147]
  v_mfma_f32_16x16x32_bf16 v[148:151], v[172:175], a[84:87], v[148:151]
  v_mfma_f32_16x16x32_bf16 v[152:155], v[172:175], a[88:91], v[152:155]
  v_mfma_f32_16x16x32_bf16 v[156:159], v[172:175], a[92:95], v[156:159]
  ds_read_b128 v[168:171], v24 offset:14336
  ds_read_b128 v[172:175], v24 offset:15360
  s_waitcnt lgkmcnt(2)
  v_mfma_f32_16x16x32_bf16 v[128:131], v[160:163], a[96:99], v[128:131]
  v_mfma_f32_16x16x32_bf16 v[132:135], v[160:163], a[100:103], v[132:135]
  v_mfma_f32_16x16x32_bf16 v[136:139], v[160:163], a[104:107], v[136:139]
  v_mfma_f32_16x16x32_bf16 v[140:143], v[160:163], a[108:111], v[140:143]
  v_mfma_f32_16x16x32_bf16 v[144:147], v[164:167], a[96:99], v[144:147]
  v_mfma_f32_16x16x32_bf16 v[148:151], v[164:167], a[100:103], v[148:151]
  v_mfma_f32_16x16x32_bf16 v[152:155], v[164:167], a[104:107], v[152:155]
  v_mfma_f32_16x16x32_bf16 v[156:159], v[164:167], a[108:111], v[156:159]
  ds_read_b128 v[160:163], v24 offset:16384
  ds_read_b128 v[164:167], v24 offset:17408
  s_waitcnt lgkmcnt(2)
  v_mfma_f32_16x16x32_bf16 v[128:131], v[168:171], a[112:115], v[128:131]
  v_mfma_f32_16x16x32_bf16 v[132:135], v[168:171], a[116:119], v[132:135]
  v_mfma_f32_16x16x32_bf16 v[136:139], v[168:171], a[120:123], v[136:139]
  v_mfma_f32_16x16x32_bf16 v[140:143], v[168:171], a[124:127], v[140:143]
  v_mfma_f32_16x16x32_bf16 v[144:147], v[172:175], a[112:115], v[144:147]
  v_mfma_f32_16x16x32_bf16 v[148:151], v[172:175], a[116:119], v[148:151]
  v_mfma_f32_16x16x32_bf16 v[152:155], v[172:175], a[120:123], v[152:155]
  v_mfma_f32_16x16x32_bf16 v[156:159], v[172:175], a[124:127], v[156:159]
  ds_read_b128 v[168:171], v24 offset:18432
  ds_read_b128 v[172:175], v24 offset:19456
  s_waitcnt lgkmcnt(2)
  v_mfma_f32_16x16x32_bf16 v[128:131], v[160:163], a[128:131], v[128:131]
  v_mfma_f32_16x16x32_bf16 v[132:135], v[160:163], a[132:135], v[132:135]
  v_mfma_f32_16x16x32_bf16 v[136:139], v[160:163], a[136:139], v[136:139]
  v_mfma_f32_16x16x32_bf16 v[140:143], v[160:163], a[140:143], v[140:143]
  v_mfma_f32_16x16x32_bf16 v[144:147], v[164:167], a[128:131], v[144:147]
  v_mfma_f32_16x16x32_bf16 v[148:151], v[164:167], a[132:135], v[148:151]
  v_mfma_f32_16x16x32_bf16 v[152:155], v[164:167], a[136:139], v[152:155]
  v_mfma_f32_16x16x32_bf16 v[156:159], v[164:167], a[140:143], v[156:159]
  ds_read_b128 v[160:163], v24 offset:20480
  ds_read_b128 v[164:167], v24 offset:21504
  s_waitcnt lgkmcnt(2)
  v_mfma_f32_16x16x32_bf16 v[128:131], v[168:171], a[144:147], v[128:131]
  v_mfma_f32_16x16x32_bf16 v[132:135], v[168:171], a[148:151], v[132:135]
  v_mfma_f32_16x16x32_bf16 v[136:139], v[168:171], a[152:155], v[136:139]
  v_mfma_f32_16x16x32_bf16 v[140:143], v[168:171], a[156:159], v[140:143]
  v_mfma_f32_16x16x32_bf16 v[144:147], v[172:175], a[144:147], v[144:147]
  v_mfma_f32_16x16x32_bf16 v[148:151], v[172:175], a[148:151], v[148:151]
  v_mfma_f32_16x16x32_bf16 v[152:155], v[172:175], a[152:155], v[152:155]
  v_mfma_f32_16x16x32_bf16 v[156:159], v[172:175], a[156:159], v[156:159]
  ds_read_b128 v[168:171], v24 offset:22528
  ds_read_b128 v[172:175], v24 offset:23552
  s_waitcnt lgkmcnt(2)
  v_mfma_f32_16x16x32_bf16 v[128:131], v[160:163], a[160:163], v[128:131]
  v_mfma_f32_16x16x32_bf16 v[132:135], v[160:163], a[164:167], v[132:135]
  v_mfma_f32_16x16x32_bf16 v[136:139], v[160:163], a[168:171], v[136:139]
  v_mfma_f32_16x16x32_bf16 v[140:143], v[160:163], a[172:175], v[140:143]
  v_mfma_f32_16x16x32_bf16 v[144:147], v[164:167], a[160:163], v[144:147]
  v_mfma_f32_16x16x32_bf16 v[148:151], v[164:167], a[164:167], v[148:151]
  v_mfma_f32_16x16x32_bf16 v[152:155], v[164:167], a[168:171], v[152:155]
  v_mfma_f32_16x16x32_bf16 v[156:159], v[164:167], a[172:175], v[156:159]
  ds_read_b128 v[160:163], v24 offset:24576
  ds_read_b128 v[164:167], v24 offset:25600
  s_waitcnt lgkmcnt(2)
  v_mfma_f32_16x16x32_bf16 v[128:131], v[168:171], a[176:179], v[128:131]
  v_mfma_f32_16x16x32_bf16 v[132:135], v[168:171], a[180:183], v[132:135]
  v_mfma_f32_16x16x32_bf16 v[136:139], v[168:171], a[184:187], v[136:139]
  v_mfma_f32_16x16x32_bf16 v[140:143], v[168:171], a[188:191], v[140:143]
  v_mfma_f32_16x16x32_bf16 v[144:147], v[172:175], a[176:179], v[144:147]
  v_mfma_f32_16x16x32_bf16 v[148:151], v[172:175], a[180:183], v[148:151]
  v_mfma_f32_16x16x32_bf16 v[152:155], v[172:175], a[184:187], v[152:155]
  v_mfma_f32_16x16x32_bf16 v[156:159], v[172:175], a[188:191], v[156:159]
  ds_read_b128 v[168:171], v24 offset:26624
  ds_read_b128 v[172:175], v24 offset:27648
  s_waitcnt lgkmcnt(2)
  v_mfma_f32_16x16x32_bf16 v[128:131], v[160:163], a[192:195], v[128:131]
  v_mfma_f32_16x16x32_bf16 v[132:135], v[160:163], a[196:199], v[132:135]
  v_mfma_f32_16x16x32_bf16 v[136:139], v[160:163], a[200:203], v[136:139]
  v_mfma_f32_16x16x32_bf16 v[140:143], v[160:163], a[204:207], v[140:143]
  v_mfma_f32_16x16x32_bf16 v[144:147], v[164:167], a[192:195], v[144:147]
  v_mfma_f32_16x16x32_bf16 v[148:151], v[164:167], a[196:199], v[148:151]
  v_mfma_f32_16x16x32_bf16 v[152:155], v[164:167], a[200:203], v[152:155]
  v_mfma_f32_16x16x32_bf16 v[156:159], v[164:167], a[204:207], v[156:159]
  ds_read_b128 v[160:163], v24 offset:28672
  ds_read_b128 v[164:167], v24 offset:29696
  s_waitcnt lgkmcnt(2)
  v_mfma_f32_16x16x32_bf16 v[128:131], v[168:171], a[208:211], v[128:131]
  v_mfma_f32_16x16x32_bf16 v[132:135], v[168:171], a[212:215], v[132:135]
  v_mfma_f32_16x16x32_bf16 v[136:139], v[168:171], a[216:219], v[136:139]
  v_mfma_f32_16x16x32_bf16 v[140:143], v[168:171], a[220:223], v[140:143]
  v_mfma_f32_16x16x32_bf16 v[144:147], v[172:175], a[208:211], v[144:147]
  v_mfma_f32_16x16x32_bf16 v[148:151], v[172:175], a[212:215], v[148:151]
  v_mfma_f32_16x16x32_bf16 v[152:155], v[172:175], a[216:219], v[152:155]
  v_mfma_f32_16x16x32_bf16 v[156:159], v[172:175], a[220:223], v[156:159]
  ds_read_b128 v[168:171], v24 offset:30720
  ds_read_b128 v[172:175], v24 offset:31744
  s_waitcnt lgkmcnt(2)
  v_mfma_f32_16x16x32_bf16 v[128:131], v[160:163], a[224:227], v[128:131]
  v_mfma_f32_16x16x32_bf16 v[132:135], v[160:163], a[228:231], v[132:135]
  v_mfma_f32_16x16x32_bf16 v[136:139], v[160:163], a[232:235], v[136:139]
  v_mfma_f32_16x16x32_bf16 v[140:143], v[160:163], a[236:239], v[140:143]
  v_mfma_f32_16x16x32_bf16 v[144:147], v[164:167], a[224:227], v[144:147]
  v_mfma_f32_16x16x32_bf16 v[148:151], v[164:167], a[228:231], v[148:151]
  v_mfma_f32_16x16x32_bf16 v[152:155], v[164:167], a[232:235], v[152:155]
  v_mfma_f32_16x16x32_bf16 v[156:159], v[164:167], a[236:239], v[156:159]
  ds_read_b128 v[160:163], v24 offset:32768
  ds_read_b128 v[164:167], v24 offset:33792
  s_waitcnt lgkmcnt(2)
  v_mfma_f32_16x16x32_bf16 v[128:131], v[168:171], a[240:243], v[128:131]
  v_mfma_f32_16x16x32_bf16 v[132:135], v[168:171], a[244:247], v[132:135]
  v_mfma_f32_16x16x32_bf16 v[136:139], v[168:171], a[248:251], v[136:139]
  v_mfma_f32_16x16x32_bf16 v[140:143], v[168:171], a[252:255], v[140:143]
  v_mfma_f32_16x16x32_bf16 v[144:147], v[172:175], a[240:243], v[144:147]
  v_mfma_f32_16x16x32_bf16 v[148:151], v[172:175], a[244:247], v[148:151]
  v_mfma_f32_16x16x32_bf16 v[152:155], v[172:175], a[248:251], v[152:155]
  v_mfma_f32_16x16x32_bf16 v[156:159], v[172:175], a[252:255], v[156:159]
  ds_read_b128 v[168:171], v24 offset:34816
  ds_read_b128 v[172:175], v24 offset:35840
  s_waitcnt lgkmcnt(2)
  v_mfma_f32_16x16x32_bf16 v[128:131], v[160:163], v[192:195], v[128:131]
  v_mfma_f32_16x16x32_bf16 v[132:135], v[160:163], v[196:199], v[132:135]
  v_mfma_f32_16x16x32_bf16 v[136:139], v[160:163], v[200:203], v[136:139]
  v_mfma_f32_16x16x32_bf16 v[140:143], v[160:163], v[204:207], v[140:143]
  v_mfma_f32_16x16x32_bf16 v[144:147], v[164:167], v[192:195], v[144:147]
  v_mfma_f32_16x16x32_bf16 v[148:151], v[164:167], v[196:199], v[148:151]
  v_mfma_f32_16x16x32_bf16 v[152:155], v[164:167], v[200:203], v[152:155]
  v_mfma_f32_16x16x32_bf16 v[156:159], v[164:167], v[204:207], v[156:159]
  ds_read_b128 v[160:163], v24 offset:36864
  ds_read_b128 v[164:167], v24 offset:37888
  s_waitcnt lgkmcnt(2)
  v_mfma_f32_16x16x32_bf16 v[128:131], v[168:171], v[208:211], v[128:131]
  v_mfma_f32_16x16x32_bf16 v[132:135], v[168:171], v[212:215], v[132:135]
  v_mfma_f32_16x16x32_bf16 v[136:139], v[168:171], v[216:219], v[136:139]
  v_mfma_f32_16x16x32_bf16 v[140:143], v[168:171], v[220:223], v[140:143]
  v_mfma_f32_16x16x32_bf16 v[144:147], v[172:175], v[208:211], v[144:147]
  v_mfma_f32_16x16x32_bf16 v[148:151], v[172:175], v[212:215], v[148:151]
  v_mfma_f32_16x16x32_bf16 v[152:155], v[172:175], v[216:219], v[152:155]
  v_mfma_f32_16x16x32_bf16 v[156:159], v[172:175], v[220:223], v[156:159]
  ds_read_b128 v[168:171], v24 offset:38912
  ds_read_b128 v[172:175], v24 offset:39936
  s_waitcnt lgkmcnt(2)
  v_mfma_f32_16x16x32_bf16 v[128:131], v[160:163], v[224:227], v[128:131]
  v_mfma_f32_16x16x32_bf16 v[132:135], v[160:163], v[228:231], v[132:135]
  v_mfma_f32_16x16x32_bf16 v[136:139], v[160:163], v[232:235], v[136:139]
  v_mfma_f32_16x16x32_bf16 v[140:143], v[160:163], v[236:239], v[140:143]
  v_mfma_f32_16x16x32_bf16 v[144:147], v[164:167], v[224:227], v[144:147]
  v_mfma_f32_16x16x32_bf16 v[148:151], v[164:167], v[228:231], v[148:151]
  v_mfma_f32_16x16x32_bf16 v[152:155], v[164:167], v[232:235], v[152:155]
  v_mfma_f32_16x16x32_bf16 v[156:159], v[164:167], v[236:239], v[156:159]
  s_waitcnt lgkmcnt(0)
  v_mfma_f32_16x16x32_bf16 v[128:131], v[168:171], v[240:243], v[128:131]
  v_mfma_f32_16x16x32_bf16 v[132:135], v[168:171], v[244:247], v[132:135]
  v_mfma_f32_16x16x32_bf16 v[136:139], v[168:171], v[248:251], v[136:139]
  v_mfma_f32_16x16x32_bf16 v[140:143], v[168:171], v[252:255], v[140:143]
  v_mfma_f32_16x16x32_bf16 v[144:147], v[172:175], v[240:243], v[144:147]
  v_mfma_f32_16x16x32_bf16 v[148:151], v[172:175], v[244:247], v[148:151]
  v_mfma_f32_16x16x32_bf16 v[152:155], v[172:175], v[248:251], v[152:155]
  v_mfma_f32_16x16x32_bf16 v[156:159], v[172:175], v[252:255], v[156:159]
  s_waitcnt vmcnt(0)
  s_branch L_Av_ep
L_Av_cBc:
  s_waitcnt vmcnt(0)
  s_barrier
  ds_read_b128 v[160:163], v24 offset:0
  ds_read_b128 v[164:167], v24 offset:1024
  ds_read_b128 v[168:171], v24 offset:2048
  ds_read_b128 v[172:175], v24 offset:3072
  s_waitcnt lgkmcnt(2)
  v_mfma_f32_16x16x32_bf16 v[128:131], v[160:163], a[0:3], 0
  v_mfma_f32_16x16x32_bf16 v[132:135], v[160:163], a[4:7], 0
  v_mfma_f32_16x16x32_bf16 v[136:139], v[160:163], a[8:11], 0
  v_mfma_f32_16x16x32_bf16 v[140:143], v[160:163], a[12:15], 0
  v_mfma_f32_16x16x32_bf16 v[144:147], v[164:167], a[0:3], 0
  v_mfma_f32_16x16x32_bf16 v[148:151], v[164:167], a[4:7], 0
  v_mfma_f32_16x16x32_bf16 v[152:155], v[164:167], a[8:11], 0
  v_mfma_f32_16x16x32_bf16 v[156:159], v[164:167], a[12:15], 0
  ds_read_b128 v[160:163], v24 offset:4096
  ds_read_b128 v[164:167], v24 offset:5120
  s_waitcnt lgkmcnt(2)
  v_mfma_f32_16x16x32_bf16 v[128:131], v[168:171], a[16:19], v[128:131]
  v_mfma_f32_16x16x32_bf16 v[132:135], v[168:171], a[20:23], v[132:135]
  v_mfma_f32_16x16x32_bf16 v[136:139], v[168:171], a[24:27], v[136:139]
  v_mfma_f32_16x16x32_bf16 v[140:143], v[168:171], a[28:31], v[140:143]
  v_mfma_f32_16x16x32_bf16 v[144:147], v[172:175], a[16:19], v[144:147]
  v_mfma_f32_16x16x32_bf16 v[148:151], v[172:175], a[20:23], v[148:151]
  v_mfma_f32_16x16x32_bf16 v[152:155], v[172:175], a[24:27], v[152:155]
  v_mfma_f32_16x16x32_bf16 v[156:159], v[172:175], a[28:31], v[156:159]
  ds_read_b128 v[168:171], v24 offset:6144
  ds_read_b128 v[172:175], v24 offset:7168
  s_waitcnt lgkmcnt(2)
  v_mfma_f32_16x16x32_bf16 v[128:131], v[160:163], a[32:35], v[128:131]
  v_mfma_f32_16x16x32_bf16 v[132:135], v[160:163], a[36:39], v[132:135]
  v_mfma_f32_16x16x32_bf16 v[136:139], v[160:163], a[40:43], v[136:139]
  v_mfma_f32_16x16x32_bf16 v[140:143], v[160:163], a[44:47], v[140:143]
  v_mfma_f32_16x16x32_bf16 v[144:147], v[164:167], a[32:35], v[144:147]
  v_mfma_f32_16x16x32_bf16 v[148:151], v[164:167], a[36:39], v[148:151]
  v_mfma_f32_16x16x32_bf16 v[152:155], v[164:167], a[40:43], v[152:155]
  v_mfma_f32_16x16x32_bf16 v[156:159], v[164:167], a[44:47], v[156:159]
  ds_read_b128 v[160:163], v24 offset:8192
  ds_read_b128 v[164:167], v24 offset:9216
  s_waitcnt lgkmcnt(2)
  v_mfma_f32_16x16x32_bf16 v[128:131], v[168:171], a[48:51], v[128:131]
  v_mfma_f32_16x16x32_bf16 v[132:135], v[168:171], a[52:55], v[132:135]
  v_mfma_f32_16x16x32_bf16 v[136:139], v[168:171], a[56:59], v[136:139]
  v_mfma_f32_16x16x32_bf16 v[140:143], v[168:171], a[60:63], v[140:143]
  v_mfma_f32_16x16x32_bf16 v[144:147], v[172:175], a[48:51], v[144:147]
  v_mfma_f32_16x16x32_bf16 v[148:151], v[172:175], a[52:55], v[148:151]
  v_mfma_f32_16x16x32_bf16 v[152:155], v[172:175], a[56:59], v[152:155]
  v_mfma_f32_16x16x32_bf16 v[156:159], v[172:175], a[60:63], v[156:159]
  ds_read_b128 v[168:171], v24 offset:10240
  ds_read_b128 v[172:175], v24 offset:11264
  s_waitcnt lgkmcnt(2)
  v_mfma_f32_16x16x32_bf16 v[128:131], v[160:163], a[64:67], v[128:131]
  v_mfma_f32_16x16x32_bf16 v[132:135], v[160:163], a[68:71], v[132:135]
  v_mfma_f32_16x16x32_bf16 v[136:139], v[160:163], a[72:75], v[136:139]
  v_mfma_f32_16x16x32_bf16 v[140:143], v[160:163], a[76:79], v[140:143]
  v_mfma_f32_16x16x32_bf16 v[144:147], v[164:167], a[64:67], v[144:147]
  v_mfma_f32_16x16x32_bf16 v[148:151], v[164:167], a[68:71], v[148:151]
  v_mfma_f32_16x16x32_bf16 v[152:155], v[164:167], a[72:75], v[152:155]
  v_mfma_f32_16x16x32_bf16 v[156:159], v[164:167], a[76:79], v[156:159]
  ds_read_b128 v[160:163], v24 offset:12288
  ds_read_b128 v[164:167], v24 offset:13312
  s_waitcnt lgkmcnt(2)
  v_mfma_f32_16x16x32_bf16 v[128:131], v[168:171], a[80:83], v[128:131]
  v_mfma_f32_16x16x32_bf16 v[132:135], v[168:171], a[84:87], v[132:135]
  v_mfma_f32_16x16x32_bf16 v[136:139], v[168:171], a[88:91], v[136:139]
  v_mfma_f32_16x16x32_bf16 v[140:143], v[168:171], a[92:95], v[140:143]
  v_mfma_f32_16x16x32_bf16 v[144:147], v[172:175], a[80:83], v[144:147]
  v_mfma_f32_16x16x32_bf16 v[148:151], v[172:175], a[84:87], v[148:151]
  v_mfma_f32_16x16x32_bf16 v[152:155], v[172:175], a[88:91], v[152:155]
  v_mfma_f32_16x16x32_bf16 v[156:159], v[172:175], a[92:95], v[156:159]
  ds_read_b128 v[168:171], v24 offset:14336
  ds_read_b128 v[172:175], v24 offset:15360
  s_waitcnt lgkmcnt(2)
  v_mfma_f32_16x16x32_bf16 v[128:131], v[160:163], a[96:99], v[128:131]
  v_mfma_f32_16x16x32_bf16 v[132:135], v[160:163], a[100:103], v[132:135]
  v_mfma_f32_16x16x32_bf16 v[136:139], v[160:163], a[104:107], v[136:139]
  v_mfma_f32_16x16x32_bf16 v[140:143], v[160:163], a[108:111], v[140:143]
  v_mfma_f32_16x16x32_bf16 v[144:147], v[164:167], a[96:99], v[144:147]
  v_mfma_f32_16x16x32_bf16 v[148:151], v[164:167], a[100:103], v[148:151]
  v_mfma_f32_16x16x32_bf16 v[152:155], v[164:167], a[104:107], v[152:155]
  v_mfma_f32_16x16x32_bf16 v[156:159], v[164:167], a[108:111], v[156:159]
  ds_read_b128 v[160:163], v24 offset:16384
  ds_read_b128 v[164:167], v24 offset:17408
  s_waitcnt lgkmcnt(2)
  v_mfma_f32_16x16x32_bf16 v[128:131], v[168:171], a[112:115], v[128:131]
  v_mfma_f32_16x16x32_bf16 v[132:135], v[168:171], a[116:119], v[132:135]
  v_mfma_f32_16x16x32_bf16 v[136:139], v[168:171], a[120:123], v[136:139]
  v_mfma_f32_16x16x32_bf16 v[140:143], v[168:171], a[124:127], v[140:143]
  v_mfma_f32_16x16x32_bf16 v[144:147], v[172:175], a[112:115], v[144:147]
  v_mfma_f32_16x16x32_bf16 v[148:151], v[172:175], a[116:119], v[148:151]
  v_mfma_f32_16x16x32_bf16 v[152:155], v[172:175], a[120:123], v[152:155]
  v_mfma_f32_16x16x32_bf16 v[156:159], v[172:175], a[124:127], v[156:159]
  ds_read_b128 v[168:171], v24 offset:18432
  ds_read_b128 v[172:175], v24 offset:19456
  s_waitcnt lgkmcnt(2)
  v_mfma_f32_16x16x32_bf16 v[128:131], v[160:163], a[128:131], v[128:131]
  v_mfma_f32_16x16x32_bf16 v[132:135], v[160:163], a[132:135], v[132:135]
  v_mfma_f32_16x16x32_bf16 v[136:139], v[160:163], a[136:139], v[136:139]
  v_mfma_f32_16x16x32_bf16 v[140:143], v[160:163], a[140:143], v[140:143]
  v_mfma_f32_16x16x32_bf16 v[144:147], v[164:167], a[128:131], v[144:147]
  v_mfma_f32_16x16x32_bf16 v[148:151], v[164:167], a[132:135], v[148:151]
  v_mfma_f32_16x16x32_bf16 v[152:155], v[164:167], a[136:139], v[152:155]
  v_mfma_f32_16x16x32_bf16 v[156:159], v[164:167], a[140:143], v[156:159]
  ds_read_b128 v[160:163], v24 offset:20480
  ds_read_b128 v[164:167], v24 offset:21504
  s_waitcnt lgkmcnt(2)
  v_mfma_f32_16x16x32_bf16 v[128:131], v[168:171], a[144:147], v[128:131]
  v_mfma_f32_16x16x32_bf16 v[132:135], v[168:171], a[148:151], v[132:135]
  v_mfma_f32_16x16x32_bf16 v[136:139], v[168:171], a[152:155], v[136:139]
  v_mfma_f32_16x16x32_bf16 v[140:143], v[168:171], a[156:159], v[140:143]
  v_mfma_f32_16x16x32_bf16 v[144:147], v[172:175], a[144:147], v[144:147]
  v_mfma_f32_16x16x32_bf16 v[148:151], v[172:175], a[148:151], v[148:151]
  v_mfma_f32_16x16x32_bf16 v[152:155], v[172:175], a[152:155], v[152:155]
  v_mfma_f32_16x16x32_bf16 v[156:159], v[172:175], a[156:159], v[156:159]
  ds_read_b128 v[168:171], v24 offset:22528
  ds_read_b128 v[172:175], v24 offset:23552
  s_waitcnt lgkmcnt(2)
  v_mfma_f32_16x16x32_bf16 v[128:131], v[160:163], a[160:163], v[128:131]
  v_mfma_f32_16x16x32_bf16 v[132:135], v[160:163], a[164:167], v[132:135]
  v_mfma_f32_16x16x32_bf16 v[136:139], v[160:163], a[168:171], v[136:139]
  v_mfma_f32_16x16x32_bf16 v[140:143], v[160:163], a[172:175], v[140:143]
  v_mfma_f32_16x16x32_bf16 v[144:147], v[164:167], a[160:163], v[144:147]
  v_mfma_f32_16x16x32_bf16 v[148:151], v[164:167], a[164:167], v[148:151]
  v_mfma_f32_16x16x32_bf16 v[152:155], v[164:167], a[168:171], v[152:155]
  v_mfma_f32_16x16x32_bf16 v[156:159], v[164:167], a[172:175], v[156:159]
  ds_read_b128 v[160:163], v24 offset:24576
  ds_read_b128 v[164:167], v24 offset:25600
  s_waitcnt lgkmcnt(2)
  v_mfma_f32_16x16x32_bf16 v[128:131], v[168:171], a[176:179], v[128:131]
  v_mfma_f32_16x16x32_bf16 v[132:135], v[168:171], a[180:183], v[132:135]
  v_mfma_f32_16x16x32_bf16 v[136:139], v[168:171], a[184:187], v[136:139]
  v_mfma_f32_16x16x32_bf16 v[140:143], v[168:171], a[188:191], v[140:143]
  v_mfma_f32_16x16x32_bf16 v[144:147], v[172:175], a[176:179], v[144:147]
  v_mfma_f32_16x16x32_bf16 v[148:151], v[172:175], a[180:183], v[148:151]
  v_mfma_f32_16x16x32_bf16 v[152:155], v[172:175], a[184:187], v[152:155]
  v_mfma_f32_16x16x32_bf16 v[156:159], v[172:175], a[188:191], v[156:159]
  ds_read_b128 v[168:171], v24 offset:26624
  ds_read_b128 v[172:175], v24 offset:27648
  s_waitcnt lgkmcnt(2)
  v_mfma_f32_16x16x32_bf16 v[128:131], v[160:163], a[192:195], v[128:131]
  v_mfma_f32_16x16x32_bf16 v[132:135], v[160:163], a[196:199], v[132:135]
  v_mfma_f32_16x16x32_bf16 v[136:139], v[160:163], a[200:203], v[136:139]
  v_mfma_f32_16x16x32_bf16 v[140:143], v[160:163], a[204:207], v[140:143]
  v_mfma_f32_16x16x32_bf16 v[144:147], v[164:167], a[192:195], v[144:147]
  v_mfma_f32_16x16x32_bf16 v[148:151], v[164:167], a[196:199], v[148:151]
  v_mfma_f32_16x16x32_bf16 v[152:155], v[164:167], a[200:203], v[152:155]
  v_mfma_f32_16x16x32_bf16 v[156:159], v[164:167], a[204:207], v[156:159]
  ds_read_b128 v[160:163], v24 offset:28672
  ds_read_b128 v[164:167], v24 offset:29696
  s_waitcnt lgkmcnt(2)
  v_mfma_f32_16x16x32_bf16 v[128:131], v[168:171], a[208:211], v[128:131]
  v_mfma_f32_16x16x32_bf16 v[132:135], v[168:171], a[212:215], v[132:135]
  v_mfma_f32_16x16x32_bf16 v[136:139], v[168:171], a[216:219], v[136:139]
  v_mfma_f32_16x16x32_bf16 v[140:143], v[168:171], a[220:223], v[140:143]
  v_mfma_f32_16x16x32_bf16 v[144:147], v[172:175], a[208:211], v[144:147]
  v_mfma_f32_16x16x32_bf16 v[148:151], v[172:175], a[212:215], v[148:151]
  v_mfma_f32_16x16x32_bf16 v[152:155], v[172:175], a[216:219], v[152:155]
  v_mfma_f32_16x16x32_bf16 v[156:159], v[172:175], a[220:223], v[156:159]
  ds_read_b128 v[168:171], v24 offset:30720
  ds_read_b128 v[172:175], v24 offset:31744
  s_waitcnt lgkmcnt(2)
  v_mfma_f32_16x16x32_bf16 v[128:131], v[160:163], a[224:227], v[128:131]
  v_mfma_f32_16x16x32_bf16 v[132:135], v[160:163], a[228:231], v[132:135]
  v_mfma_f32_16x16x32_bf16 v[136:139], v[160:163], a[232:235], v[136:139]
  v_mfma_f32_16x16x32_bf16 v[140:143], v[160:163], a[236:239], v[140:143]
  v_mfma_f32_16x16x32_bf16 v[144:147], v[164:167], a[224:227], v[144:147]
  v_mfma_f32_16x16x32_bf16 v[148:151], v[164:167], a[228:231], v[148:151]
  v_mfma_f32_16x16x32_bf16 v[152:155], v[164:167], a[232:235], v[152:155]
  v_mfma_f32_16x16x32_bf16 v[156:159], v[164:167], a[236:239], v[156:159]
  ds_read_b128 v[160:163], v24 offset:32768
  ds_read_b128 v[164:167], v24 offset:33792
  s_waitcnt lgkmcnt(2)
  v_mfma_f32_16x16x32_bf16 v[128:131], v[168:171], a[240:243], v[128:131]
  v_mfma_f32_16x16x32_bf16 v[132:135], v[168:171], a[244:247], v[132:135]
  v_mfma_f32_16x16x32_bf16 v[136:139], v[168:171], a[248:251], v[136:139]
  v_mfma_f32_16x16x32_bf16 v[140:143], v[168:171], a[252:255], v[140:143]
  v_mfma_f32_16x16x32_bf16 v[144:147], v[172:175], a[240:243], v[144:147]
  v_mfma_f32_16x16x32_bf16 v[148:151], v[172:175], a[244:247], v[148:151]
  v_mfma_f32_16x16x32_bf16 v[152:155], v[172:175], a[248:251], v[152:155]
  v_mfma_f32_16x16x32_bf16 v[156:159], v[172:175], a[252:255], v[156:159]
  ds_read_b128 v[168:171], v24 offset:34816
  ds_read_b128 v[172:175], v24 offset:35840
  s_waitcnt lgkmcnt(2)
  v_mfma_f32_16x16x32_bf16 v[128:131], v[160:163], v[192:195], v[128:131]
  v_mfma_f32_16x16x32_bf16 v[132:135], v[160:163], v[196:199], v[132:135]
  v_mfma_f32_16x16x32_bf16 v[136:139], v[160:163], v[200:203], v[136:139]
  v_mfma_f32_16x16x32_bf16 v[140:143], v[160:163], v[204:207], v[140:143]
  v_mfma_f32_16x16x32_bf16 v[144:147], v[164:167], v[192:195], v[144:147]
  v_mfma_f32_16x16x32_bf16 v[148:151], v[164:167], v[196:199], v[148:151]
  v_mfma_f32_16x16x32_bf16 v[152:155], v[164:167], v[200:203], v[152:155]
  v_mfma_f32_16x16x32_bf16 v[156:159], v[164:167], v[204:207], v[156:159]
  ds_read_b128 v[160:163], v24 offset:36864
  ds_read_b128 v[164:167], v24 offset:37888
  s_waitcnt lgkmcnt(2)
  v_mfma_f32_16x16x32_bf16 v[128:131], v[168:171], v[208:211], v[128:131]
  v_mfma_f32_16x16x32_bf16 v[132:135], v[168:171], v[212:215], v[132:135]
  v_mfma_f32_16x16x32_bf16 v[136:139], v[168:171], v[216:219], v[136:139]
  v_mfma_f32_16x16x32_bf16 v[140:143], v[168:171], v[220:223], v[140:143]
  v_mfma_f32_16x16x32_bf16 v[144:147], v[172:175], v[208:211], v[144:147]
  v_mfma_f32_16x16x32_bf16 v[148:151], v[172:175], v[212:215], v[148:151]
  v_mfma_f32_16x16x32_bf16 v[152:155], v[172:175], v[216:219], v[152:155]
  v_mfma_f32_16x16x32_bf16 v[156:159], v[172:175], v[220:223], v[156:159]
  ds_read_b128 v[168:171], v24 offset:38912
  ds_read_b128 v[172:175], v24 offset:39936
  s_waitcnt lgkmcnt(2)
  v_mfma_f32_16x16x32_bf16 v[128:131], v[160:163], v[224:227], v[128:131]
  v_mfma_f32_16x16x32_bf16 v[132:135], v[160:163], v[228:231], v[132:135]
  v_mfma_f32_16x16x32_bf16 v[136:139], v[160:163], v[232:235], v[136:139]
  v_mfma_f32_16x16x32_bf16 v[140:143], v[160:163], v[236:239], v[140:143]
  v_mfma_f32_16x16x32_bf16 v[144:147], v[164:167], v[224:227], v[144:147]
  v_mfma_f32_16x16x32_bf16 v[148:151], v[164:167], v[228:231], v[148:151]
  v_mfma_f32_16x16x32_bf16 v[152:155], v[164:167], v[232:235], v[152:155]
  v_mfma_f32_16x16x32_bf16 v[156:159], v[164:167], v[236:239], v[156:159]
  s_waitcnt lgkmcnt(0)
  v_mfma_f32_16x16x32_bf16 v[128:131], v[168:171], v[240:243], v[128:131]
  v_mfma_f32_16x16x32_bf16 v[132:135], v[168:171], v[244:247], v[132:135]
  v_mfma_f32_16x16x32_bf16 v[136:139], v[168:171], v[248:251], v[136:139]
  v_mfma_f32_16x16x32_bf16 v[140:143], v[168:171], v[252:255], v[140:143]
  v_mfma_f32_16x16x32_bf16 v[144:147], v[172:175], v[240:243], v[144:147]
  v_mfma_f32_16x16x32_bf16 v[148:151], v[172:175], v[244:247], v[148:151]
  v_mfma_f32_16x16x32_bf16 v[152:155], v[172:175], v[248:251], v[152:155]
  v_mfma_f32_16x16x32_bf16 v[156:159], v[172:175], v[252:255], v[156:159]
  s_waitcnt vmcnt(0)
L_Av_ep:
  s_mov_b64 exec, 1
  v_mov_b32 v29, s31
  v_mov_b32 v30, 0
  buffer_store_dword v29, v30, s[8:11], s35 offen sc1
  s_mov_b64 exec, -1
  s_mul_i32 s4, s54, 393216
  s_add_u32 s4, s4, s40
  v_cvt_pk_bf16_f32 v176, v128, v129
  v_cvt_pk_bf16_f32 v177, v130, v131
  v_cvt_pk_bf16_f32 v178, v144, v145
  v_cvt_pk_bf16_f32 v179, v146, v147
  buffer_store_dwordx4 v[176:179], v20, s[8:11], s4 offen offset:0 sc1
  v_cvt_pk_bf16_f32 v180, v132, v133
  v_cvt_pk_bf16_f32 v181, v134, v135
  v_cvt_pk_bf16_f32 v182, v148, v149
  v_cvt_pk_bf16_f32 v183, v150, v151
  buffer_store_dwordx4 v[180:183], v20, s[8:11], s4 offen offset:1024 sc1
  v_cvt_pk_bf16_f32 v184, v136, v137
  v_cvt_pk_bf16_f32 v185, v138, v139
  v_cvt_pk_bf16_f32 v186, v152, v153
  v_cvt_pk_bf16_f32 v187, v154, v155
  buffer_store_dwordx4 v[184:187], v20, s[8:11], s4 offen offset:2048 sc1
  v_cvt_pk_bf16_f32 v188, v140, v141
  v_cvt_pk_bf16_f32 v189, v142, v143
  v_cvt_pk_bf16_f32 v190, v156, v157
  v_cvt_pk_bf16_f32 v191, v158, v159
  buffer_store_dwordx4 v[188:191], v20, s[8:11], s4 offen offset:3072 sc1
  s_cmp_eq_u32 s31, 0
  s_cbranch_scc0 L_Av_nf0
  s_waitcnt vmcnt(0)
  s_mov_b64 exec, 1
  v_mov_b32 v29, 1
  v_mov_b32 v30, 0
  buffer_store_dword v29, v30, s[8:11], s35 offen sc1
  s_mov_b64 exec, -1
L_Av_nf0:
  s_add_u32 s31, s31, 1
  s_mov_b32 s34, s31
  s_cmp_lt_u32 s31, s52
  s_cbranch_scc1 L_Av_top
  s_waitcnt vmcnt(0)
  s_cmp_eq_u32 s34, 0
  s_cbranch_scc1 L_Av_npc
  s_mov_b64 exec, 1
  v_mov_b32 v29, s34
  v_mov_b32 v30, 0
  buffer_store_dword v29, v30, s[8:11], s35 offen sc1
  s_mov_b64 exec, -1
  s_mov_b32 s34, 0
L_Av_npc:
  s_waitcnt vmcnt(0)
  s_branch L_A_next
L_roleB:
  s_sub_u32 s4, s30, 72
  s_lshl_b32 s4, s4, 2
  s_add_u32 s4, s4, s24
  s_lshr_b32 s36, s4, 1
  s_and_b32 s37, s4, 1
  s_lshr_b32 s5, s4, 2
  s_lshl_b32 s5, s5, 7
  s_and_b32 s4, s4, 3
  s_lshl_b32 s4, s4, 2
  s_add_u32 s4, s4, s5
  s_add_u32 s35, s4, 69632
  s_mov_b64 exec, 1
  v_mov_b32 v28, 0
  v_mov_b32 v29, 0
  buffer_store_dword v28, v29, s[8:11], s35 offen sc1
  s_mov_b64 exec, -1
  s_load_dwordx2 s[20:21], s[0:1], 0
  s_waitcnt lgkmcnt(0)
  s_and_b32 s21, s21, 0xffff
  s_mov_b32 s22, 2621440
  s_mov_b32 s23, 0x20000
  s_lshl_b32 s4, s30, 4
  s_mul_i32 s4, s4, 1280
  s_mul_i32 s5, s24, 320
  s_add_u32 s4, s4, s5
  v_mul_u32_u24 v28, 1280, v22
  v_lshlrev_b32 v29, 4, v21
  v_add_u32 v28, v28, v29
  buffer_load_dwordx4 v[40:43], v28, s[20:23], s4 offen offset:0
  buffer_load_dwordx4 v[44:47], v28, s[20:23], s4 offen offset:64
  buffer_load_dwordx4 v[48:51], v28, s[20:23], s4 offen offset:128
  buffer_load_dwordx4 v[52:55], v28, s[20:23], s4 offen offset:192
  buffer_load_dwordx4 v[56:59], v28, s[20:23], s4 offen offset:256
  s_waitcnt vmcnt(0)
  v_lshlrev_b32 v64, 16, v40
  v_and_b32 v65, 0xffff0000, v40
  v_lshlrev_b32 v66, 16, v41
  v_and_b32 v67, 0xffff0000, v41
  v_lshlrev_b32 v68, 16, v42
  v_and_b32 v69, 0xffff0000, v42
  v_lshlrev_b32 v70, 16, v43
  v_and_b32 v71, 0xffff0000, v43
  v_lshlrev_b32 v72, 16, v44
  v_and_b32 v73, 0xffff0000, v44
  v_lshlrev_b32 v74, 16, v45
  v_and_b32 v75, 0xffff0000, v45
  v_lshlrev_b32 v76, 16, v46
  v_and_b32 v77, 0xffff0000, v46
  v_lshlrev_b32 v78, 16, v47
  v_and_b32 v79, 0xffff0000, v47
  v_lshlrev_b32 v80, 16, v48
  v_and_b32 v81, 0xffff0000, v48
  v_lshlrev_b32 v82, 16, v49
  v_and_b32 v83, 0xffff0000, v49
  v_lshlrev_b32 v84, 16, v50
  v_and_b32 v85, 0xffff0000, v50
  v_lshlrev_b32 v86, 16, v51
  v_and_b32 v87, 0xffff0000, v51
  v_lshlrev_b32 v88, 16, v52
  v_and_b32 v89, 0xffff0000, v52
  v_lshlrev_b32 v90, 16, v53
  v_and_b32 v91, 0xffff0000, v53
  v_lshlrev_b32 v92, 16, v54
  v_and_b32 v93, 0xffff0000, v54
  v_lshlrev_b32 v94, 16, v55
  v_and_b32 v95, 0xffff0000, v55
  v_lshlrev_b32 v96, 16, v56
  v_and_b32 v97, 0xffff0000, v56
  v_lshlrev_b32 v98, 16, v57
  v_and_b32 v99, 0xffff0000, v57
  v_lshlrev_b32 v100, 16, v58
  v_and_b32 v101, 0xffff0000, v58
  v_lshlrev_b32 v102, 16, v59
  v_and_b32 v103, 0xffff0000, v59
  s_mov_b32 s47, 131072
  v_pk_add_f32 v[104:105], v[64:65], v[66:67]
  v_pk_mul_f32 v[106:107], v[64:65], v[64:65]
  v_pk_fma_f32 v[106:107], v[66:67], v[66:67], v[106:107]
  v_pk_add_f32 v[104:105], v[104:105], v[68:69]
  v_pk_fma_f32 v[106:107], v[68:69], v[68:69], v[106:107]
  v_pk_add_f32 v[104:105], v[104:105], v[70:71]
  v_pk_fma_f32 v[106:107], v[70:71], v[70:71], v[106:107]
  v_pk_add_f32 v[104:105], v[104:105], v[72:73]
  v_pk_fma_f32 v[106:107], v[72:73], v[72:73], v[106:107]
  v_pk_add_f32 v[104:105], v[104:105], v[74:75]
  v_pk_fma_f32 v[106:107], v[74:75], v[74:75], v[106:107]
  v_pk_add_f32 v[104:105], v[104:105], v[76:77]
  v_pk_fma_f32 v[106:107], v[76:77], v[76:77], v[106:107]
  v_pk_add_f32 v[104:105], v[104:105], v[78:79]
  v_pk_fma_f32 v[106:107], v[78:79], v[78:79], v[106:107]
  v_pk_add_f32 v[104:105], v[104:105], v[80:81]
  v_pk_fma_f32 v[106:107], v[80:81], v[80:81], v[106:107]
  v_pk_add_f32 v[104:105], v[104:105], v[82:83]
  v_pk_fma_f32 v[106:107], v[82:83], v[82:83], v[106:107]
  v_pk_add_f32 v[104:105], v[104:105], v[84:85]
  v_pk_fma_f32 v[106:107], v[84:85], v[84:85], v[106:107]
  v_pk_add_f32 v[104:105], v[104:105], v[86:87]
  v_pk_fma_f32 v[106:107], v[86:87], v[86:87], v[106:107]
  v_pk_add_f32 v[104:105], v[104:105], v[88:89]
  v_pk_fma_f32 v[106:107], v[88:89], v[88:89], v[106:107]
  v_pk_add_f32 v[104:105], v[104:105], v[90:91]
  v_pk_fma_f32 v[106:107], v[90:91], v[90:91], v[106:107]
  v_pk_add_f32 v[104:105], v[104:105], v[92:93]
  v_pk_fma_f32 v[106:107], v[92:93], v[92:93], v[106:107]
  v_pk_add_f32 v[104:105], v[104:105], v[94:95]
  v_pk_fma_f32 v[106:107], v[94:95], v[94:95], v[106:107]
  v_pk_add_f32 v[104:105], v[104:105], v[96:97]
  v_pk_fma_f32 v[106:107], v[96:97], v[96:97], v[106:107]
  v_pk_add_f32 v[104:105], v[104:105], v[98:99]
  v_pk_fma_f32 v[106:107], v[98:99], v[98:99], v[106:107]
  v_pk_add_f32 v[104:105], v[104:105], v[100:101]
  v_pk_fma_f32 v[106:107], v[100:101], v[100:101], v[106:107]
  v_pk_add_f32 v[104:105], v[104:105], v[102:103]
  v_pk_fma_f32 v[106:107], v[102:103], v[102:103], v[106:107]
  v_add_f32 v104, v104, v105
  v_add_f32 v105, v106, v107
  v_mov_b32 v108, v104
  v_mov_b32 v109, v105
  s_nop 0
  v_permlane16_swap_b32 v104, v108
  v_permlane16_swap_b32 v105, v109
  v_pk_add_f32 v[104:105], v[104:105], v[108:109]
  v_mov_b32 v108, v104
  v_mov_b32 v109, v105
  s_nop 0
  v_permlane32_swap_b32 v104, v108
  v_permlane32_swap_b32 v105, v109
  v_pk_add_f32 v[104:105], v[104:105], v[108:109]
  v_lshlrev_b32 v108, 3, v22
  v_add_u32 v108, s47, v108
  s_lshl_b32 s4, s24, 7
  v_add_u32 v109, s4, v108
  ds_write_b64 v109, v[104:105]
  s_waitcnt lgkmcnt(0)
  s_barrier
  ds_read_b64 v[104:105], v108
  ds_read_b64 v[106:107], v108 offset:128
  ds_read_b64 v[110:111], v108 offset:256
  ds_read_b64 v[112:113], v108 offset:384
  s_waitcnt lgkmcnt(2)
  v_pk_add_f32 v[104:105], v[104:105], v[106:107]
  s_waitcnt lgkmcnt(0)
  v_pk_add_f32 v[106:107], v[110:111], v[112:113]
  v_pk_add_f32 v[104:105], v[104:105], v[106:107]
  v_mul_f32 v104, 986500301, v104
  v_mul_f32 v106, v104, v104
  v_mov_b32 v107, 925353388
  v_fmac_f32 v107, 986500301, v105
  v_sub_f32 v107, v107, v106
  v_max_f32 v107, 925353388, v107
  v_rsq_f32 v106, v107
  s_nop 0
  v_mul_f32 v104, v104, v106
  v_pk_fma_f32 v[64:65], v[64:65], v[106:107], v[104:105] op_sel_hi:[1,0,0] neg_lo:[0,0,1] neg_hi:[0,0,1]
  v_pk_fma_f32 v[66:67], v[66:67], v[106:107], v[104:105] op_sel_hi:[1,0,0] neg_lo:[0,0,1] neg_hi:[0,0,1]
  v_pk_fma_f32 v[68:69], v[68:69], v[106:107], v[104:105] op_sel_hi:[1,0,0] neg_lo:[0,0,1] neg_hi:[0,0,1]
  v_pk_fma_f32 v[70:71], v[70:71], v[106:107], v[104:105] op_sel_hi:[1,0,0] neg_lo:[0,0,1] neg_hi:[0,0,1]
  v_pk_fma_f32 v[72:73], v[72:73], v[106:107], v[104:105] op_sel_hi:[1,0,0] neg_lo:[0,0,1] neg_hi:[0,0,1]
  v_pk_fma_f32 v[74:75], v[74:75], v[106:107], v[104:105] op_sel_hi:[1,0,0] neg_lo:[0,0,1] neg_hi:[0,0,1]
  v_pk_fma_f32 v[76:77], v[76:77], v[106:107], v[104:105] op_sel_hi:[1,0,0] neg_lo:[0,0,1] neg_hi:[0,0,1]
  v_pk_fma_f32 v[78:79], v[78:79], v[106:107], v[104:105] op_sel_hi:[1,0,0] neg_lo:[0,0,1] neg_hi:[0,0,1]
  v_pk_fma_f32 v[80:81], v[80:81], v[106:107], v[104:105] op_sel_hi:[1,0,0] neg_lo:[0,0,1] neg_hi:[0,0,1]
  v_pk_fma_f32 v[82:83], v[82:83], v[106:107], v[104:105] op_sel_hi:[1,0,0] neg_lo:[0,0,1] neg_hi:[0,0,1]
  v_pk_fma_f32 v[84:85], v[84:85], v[106:107], v[104:105] op_sel_hi:[1,0,0] neg_lo:[0,0,1] neg_hi:[0,0,1]
  v_pk_fma_f32 v[86:87], v[86:87], v[106:107], v[104:105] op_sel_hi:[1,0,0] neg_lo:[0,0,1] neg_hi:[0,0,1]
  v_pk_fma_f32 v[88:89], v[88:89], v[106:107], v[104:105] op_sel_hi:[1,0,0] neg_lo:[0,0,1] neg_hi:[0,0,1]
  v_pk_fma_f32 v[90:91], v[90:91], v[106:107], v[104:105] op_sel_hi:[1,0,0] neg_lo:[0,0,1] neg_hi:[0,0,1]
  v_pk_fma_f32 v[92:93], v[92:93], v[106:107], v[104:105] op_sel_hi:[1,0,0] neg_lo:[0,0,1] neg_hi:[0,0,1]
  v_pk_fma_f32 v[94:95], v[94:95], v[106:107], v[104:105] op_sel_hi:[1,0,0] neg_lo:[0,0,1] neg_hi:[0,0,1]
  v_pk_fma_f32 v[96:97], v[96:97], v[106:107], v[104:105] op_sel_hi:[1,0,0] neg_lo:[0,0,1] neg_hi:[0,0,1]
  v_pk_fma_f32 v[98:99], v[98:99], v[106:107], v[104:105] op_sel_hi:[1,0,0] neg_lo:[0,0,1] neg_hi:[0,0,1]
  v_pk_fma_f32 v[100:101], v[100:101], v[106:107], v[104:105] op_sel_hi:[1,0,0] neg_lo:[0,0,1] neg_hi:[0,0,1]
  v_pk_fma_f32 v[102:103], v[102:103], v[106:107], v[104:105] op_sel_hi:[1,0,0] neg_lo:[0,0,1] neg_hi:[0,0,1]
  v_cvt_pk_bf16_f32 v40, v64, v65
  v_cvt_pk_bf16_f32 v41, v66, v67
  v_cvt_pk_bf16_f32 v42, v68, v69
  v_cvt_pk_bf16_f32 v43, v70, v71
  v_cvt_pk_bf16_f32 v44, v72, v73
  v_cvt_pk_bf16_f32 v45, v74, v75
  v_cvt_pk_bf16_f32 v46, v76, v77
  v_cvt_pk_bf16_f32 v47, v78, v79
  v_cvt_pk_bf16_f32 v48, v80, v81
  v_cvt_pk_bf16_f32 v49, v82, v83
  v_cvt_pk_bf16_f32 v50, v84, v85
  v_cvt_pk_bf16_f32 v51, v86, v87
  v_cvt_pk_bf16_f32 v52, v88, v89
  v_cvt_pk_bf16_f32 v53, v90, v91
  v_cvt_pk_bf16_f32 v54, v92, v93
  v_cvt_pk_bf16_f32 v55, v94, v95
  v_cvt_pk_bf16_f32 v56, v96, v97
  v_cvt_pk_bf16_f32 v57, v98, v99
  v_cvt_pk_bf16_f32 v58, v100, v101
  v_cvt_pk_bf16_f32 v59, v102, v103
  s_lshr_b32 s4, s30, 1
  s_mul_i32 s4, s4, 40960
  s_and_b32 s5, s30, 1
  s_lshl_b32 s5, s5, 10
  s_add_u32 s4, s4, s5
  s_mul_i32 s5, s24, 10240
  s_add_u32 s4, s4, s5
  s_add_u32 s4, s4, 5656576
  s_add_u32 s5, s4, 0
  buffer_store_dwordx4 v[40:43], v20, s[8:11], s5 offen sc1
  s_add_u32 s5, s4, 2048
  buffer_store_dwordx4 v[44:47], v20, s[8:11], s5 offen sc1
  s_add_u32 s5, s4, 4096
  buffer_store_dwordx4 v[48:51], v20, s[8:11], s5 offen sc1
  s_add_u32 s5, s4, 6144
  buffer_store_dwordx4 v[52:55], v20, s[8:11], s5 offen sc1
  s_add_u32 s5, s4, 8192
  buffer_store_dwordx4 v[56:59], v20, s[8:11], s5 offen sc1
  s_waitcnt vmcnt(0)
  s_barrier
  s_cmp_eq_u32 s24, 0
  s_cbranch_scc0 L_ia_B
  s_mov_b64 exec, 1
  v_mov_b32 v1, 36
  v_mov_b32 v2, 1
  buffer_atomic_add v2, v1, s[12:15], 0 offen
  s_mov_b64 exec, -1
L_ia_B:
  v_min_u32 v28, 8, v0
  v_mul_u32_u24 v29, 86, v28
  v_lshrrev_b32 v29, 8, v29
  v_mul_u32_u24 v30, 3, v29
  v_sub_u32 v30, v28, v30
  v_mul_u32_u24 v29, 96, v29
  v_add_u32 v29, v29, v30
  s_mul_i32 s4, s36, 3
  v_add_u32 v29, s4, v29
  v_lshrrev_b32 v30, 2, v29
  v_lshlrev_b32 v30, 7, v30
  v_and_b32 v29, 3, v29
  v_lshlrev_b32 v29, 2, v29
  v_add_u32 v29, v29, v30
  v_add_u32 v23, 0, v29
  v_and_b32 v28, 3, v0
  s_lshl_b32 s4, s36, 2
  v_add_u32 v28, s4, v28
  v_lshlrev_b32 v28, 7, v28
  v_bfe_u32 v29, v0, 2, 1
  v_mul_u32_u24 v29, 16384, v29
  v_add_u32 v28, v28, v29
  v_add_u32 v24, 36864, v28
  v_bfe_u32 v28, v0, 2, 2
  v_lshlrev_b32 v28, 4, v28
  v_and_b32 v29, 1, v0
  v_lshlrev_b32 v29, 6, v29
  v_add_u32 v28, v28, v29
  v_lshlrev_b32 v29, 8, v21
  v_add_u32 v25, v28, v29
  v_lshrrev_b32 v17, 1, v28
  v_lshlrev_b32 v29, 6, v21
  v_add_u32 v17, v17, v29
  v_lshlrev_b32 v26, 3, v0
  v_lshlrev_b32 v28, 2, v21
  v_add_u32 v29, 0, v28
  v_cmp_le_u32 s[48:49], v29, v22
  v_add_u32 v29, 1, v28
  v_cmp_le_u32 s[50:51], v29, v22
  v_add_u32 v29, 2, v28
  v_cmp_le_u32 s[52:53], v29, v22
  v_add_u32 v29, 3, v28
  v_cmp_le_u32 s[54:55], v29, v22
  s_mov_b32 s56, 1037384597
  s_mov_b32 s57, 4048155338
  v_mov_b32 v27, s57
  s_cmp_eq_u32 s24, 0
  s_cbranch_scc0 L_wd_iwB
  s_mov_b32 s28, 131072
  s_mov_b32 s29, 2
  v_mov_b32 v18, 36
L_wn_iwB:
  buffer_load_dword v19, v18, s[12:15], 0 offen sc1
  s_waitcnt vmcnt(0)
  v_readfirstlane_b32 s3, v19
  s_sub_u32 s28, s28, 1
  s_cbranch_scc1 L_abort
  s_cmp_ge_u32 s3, 256
  s_cbranch_scc1 L_wd_iwB
  s_sleep 8
  s_branch L_wn_iwB
L_wd_iwB:
  s_barrier
  s_mov_b32 s31, s37
L_B_top:
  s_mov_b32 s28, 131072
  s_mov_b32 s29, 70
  s_add_u32 s41, s31, 1
L_B_pa:
  buffer_load_dword v28, v23, s[8:11], 0 offen sc1
  s_sub_u32 s28, s28, 1
  s_cbranch_scc1 L_abort
  s_waitcnt vmcnt(0)
  v_cmp_gt_u32 vcc, s41, v28
  s_and_b64 vcc, vcc, 0x1ff
  s_cmp_eq_u64 vcc, 0
  s_cbranch_scc0 L_B_pa
  s_mul_i32 s4, s31, 393216
  s_mul_i32 s5, s36, 12288
  s_add_u32 s4, s4, s5
  s_add_u32 s6, s4, 8278016
  buffer_load_dwordx4 a[0:3], v20, s[8:11], s6 offen offset:0 sc1
  buffer_load_dwordx4 a[4:7], v20, s[8:11], s6 offen offset:1024 sc1
  buffer_load_dwordx4 a[8:11], v20, s[8:11], s6 offen offset:2048 sc1
  buffer_load_dwordx4 a[12:15], v20, s[8:11], s6 offen offset:3072 sc1
  s_add_u32 s6, s4, 8282112
  buffer_load_dwordx4 a[16:19], v20, s[8:11], s6 offen offset:0 sc1
  buffer_load_dwordx4 a[20:23], v20, s[8:11], s6 offen offset:1024 sc1
  buffer_load_dwordx4 a[24:27], v20, s[8:11], s6 offen offset:2048 sc1
  buffer_load_dwordx4 a[28:31], v20, s[8:11], s6 offen offset:3072 sc1
  s_add_u32 s6, s4, 8286208
  buffer_load_dwordx4 a[32:35], v20, s[8:11], s6 offen offset:0 sc1
  buffer_load_dwordx4 a[36:39], v20, s[8:11], s6 offen offset:1024 sc1
  buffer_load_dwordx4 a[40:43], v20, s[8:11], s6 offen offset:2048 sc1
  buffer_load_dwordx4 a[44:47], v20, s[8:11], s6 offen offset:3072 sc1
  s_add_u32 s6, s4, 33443840
  buffer_load_dwordx4 a[48:51], v20, s[8:11], s6 offen offset:0 sc1
  buffer_load_dwordx4 a[52:55], v20, s[8:11], s6 offen offset:1024 sc1
  buffer_load_dwordx4 a[56:59], v20, s[8:11], s6 offen offset:2048 sc1
  buffer_load_dwordx4 a[60:63], v20, s[8:11], s6 offen offset:3072 sc1
  s_add_u32 s6, s4, 33447936
  buffer_load_dwordx4 a[64:67], v20, s[8:11], s6 offen offset:0 sc1
  buffer_load_dwordx4 a[68:71], v20, s[8:11], s6 offen offset:1024 sc1
  buffer_load_dwordx4 a[72:75], v20, s[8:11], s6 offen offset:2048 sc1
  buffer_load_dwordx4 a[76:79], v20, s[8:11], s6 offen offset:3072 sc1
  s_add_u32 s6, s4, 33452032
  buffer_load_dwordx4 a[80:83], v20, s[8:11], s6 offen offset:0 sc1
  buffer_load_dwordx4 a[84:87], v20, s[8:11], s6 offen offset:1024 sc1
  buffer_load_dwordx4 a[88:91], v20, s[8:11], s6 offen offset:2048 sc1
  buffer_load_dwordx4 a[92:95], v20, s[8:11], s6 offen offset:3072 sc1
  s_add_u32 s6, s4, 58609664
  buffer_load_dwordx4 a[96:99], v20, s[8:11], s6 offen offset:0 sc1
  buffer_load_dwordx4 a[100:103], v20, s[8:11], s6 offen offset:1024 sc1
  buffer_load_dwordx4 a[104:107], v20, s[8:11], s6 offen offset:2048 sc1
  buffer_load_dwordx4 a[108:111], v20, s[8:11], s6 offen offset:3072 sc1
  s_add_u32 s6, s4, 58613760
  buffer_load_dwordx4 a[112:115], v20, s[8:11], s6 offen offset:0 sc1
  buffer_load_dwordx4 a[116:119], v20, s[8:11], s6 offen offset:1024 sc1
  buffer_load_dwordx4 a[120:123], v20, s[8:11], s6 offen offset:2048 sc1
  buffer_load_dwordx4 a[124:127], v20, s[8:11], s6 offen offset:3072 sc1
  s_add_u32 s6, s4, 58617856
  buffer_load_dwordx4 a[128:131], v20, s[8:11], s6 offen offset:0 sc1
  buffer_load_dwordx4 a[132:135], v20, s[8:11], s6 offen offset:1024 sc1
  buffer_load_dwordx4 a[136:139], v20, s[8:11], s6 offen offset:2048 sc1
  buffer_load_dwordx4 a[140:143], v20, s[8:11], s6 offen offset:3072 sc1
  s_mov_b32 s28, 131072
  s_mov_b32 s29, 71
L_B_pc:
  buffer_load_dword v28, v24, s[8:11], 0 offen sc1
  s_sub_u32 s28, s28, 1
  s_cbranch_scc1 L_abort
  s_waitcnt vmcnt(0)
  v_cmp_gt_u32 vcc, s41, v28
  s_and_b64 vcc, vcc, 0xff
  s_cmp_eq_u64 vcc, 0
  s_cbranch_scc0 L_B_pc
  s_mul_i32 s4, s31, 196608
  s_mul_i32 s5, s36, 6144
  s_add_u32 s4, s4, s5
  s_add_u32 s6, s4, 83775488
  buffer_load_dwordx4 a[144:147], v25, s[8:11], s6 offen offset:0 sc1
  buffer_load_dwordx2 a[148:149], v17, s[8:11], s6 offen offset:1024 sc1
  buffer_load_dwordx2 a[150:151], v17, s[8:11], s6 offen offset:1536 sc1
  buffer_load_dwordx4 a[152:155], v25, s[8:11], s6 offen offset:2048 sc1
  buffer_load_dwordx4 a[156:159], v25, s[8:11], s6 offen offset:3072 sc1
  s_add_u32 s6, s4, 83779584
  buffer_load_dwordx2 a[160:161], v17, s[8:11], s6 offen offset:0 sc1
  buffer_load_dwordx2 a[162:163], v17, s[8:11], s6 offen offset:512 sc1
  buffer_load_dwordx4 a[164:167], v25, s[8:11], s6 offen offset:1024 sc1
  s_add_u32 s6, s4, 96358400
  buffer_load_dwordx2 a[168:169], v26, s[8:11], s6 offen offset:0 sc1
  buffer_load_dwordx2 a[170:171], v26, s[8:11], s6 offen offset:512 sc1
  buffer_load_dwordx2 a[172:173], v26, s[8:11], s6 offen offset:1024 sc1
  buffer_load_dwordx2 a[174:175], v26, s[8:11], s6 offen offset:1536 sc1
  buffer_load_dwordx2 a[176:177], v26, s[8:11], s6 offen offset:2048 sc1
  buffer_load_dwordx2 a[178:179], v26, s[8:11], s6 offen offset:2560 sc1
  buffer_load_dwordx2 a[180:181], v26, s[8:11], s6 offen offset:3072 sc1
  buffer_load_dwordx2 a[182:183], v26, s[8:11], s6 offen offset:3584 sc1
  s_add_u32 s6, s4, 96362496
  buffer_load_dwordx2 a[184:185], v26, s[8:11], s6 offen offset:0 sc1
  buffer_load_dwordx2 a[186:187], v26, s[8:11], s6 offen offset:512 sc1
  buffer_load_dwordx2 a[188:189], v26, s[8:11], s6 offen offset:1024 sc1
  buffer_load_dwordx2 a[190:191], v26, s[8:11], s6 offen offset:1536 sc1
  v_mfma_f32_16x16x32_bf16 v[68:71], a[48:51], a[0:3], 0
  v_mfma_f32_16x16x32_bf16 v[76:79], a[48:51], a[24:27], 0
  v_mfma_f32_16x16x32_bf16 v[80:83], a[72:75], a[24:27], 0
  v_mfma_f32_16x16x32_bf16 v[68:71], a[52:55], a[4:7], v[68:71]
  v_mfma_f32_16x16x32_bf16 v[76:79], a[52:55], a[28:31], v[76:79]
  v_mfma_f32_16x16x32_bf16 v[80:83], a[76:79], a[28:31], v[80:83]
  v_mfma_f32_16x16x32_bf16 v[68:71], a[56:59], a[8:11], v[68:71]
  v_mfma_f32_16x16x32_bf16 v[76:79], a[56:59], a[32:35], v[76:79]
  v_mfma_f32_16x16x32_bf16 v[80:83], a[80:83], a[32:35], v[80:83]
  v_mfma_f32_16x16x32_bf16 v[68:71], a[60:63], a[12:15], v[68:71]
  v_mfma_f32_16x16x32_bf16 v[76:79], a[60:63], a[36:39], v[76:79]
  v_mfma_f32_16x16x32_bf16 v[80:83], a[84:87], a[36:39], v[80:83]
  v_mfma_f32_16x16x32_bf16 v[68:71], a[64:67], a[16:19], v[68:71]
  v_mfma_f32_16x16x32_bf16 v[76:79], a[64:67], a[40:43], v[76:79]
  v_mfma_f32_16x16x32_bf16 v[80:83], a[88:91], a[40:43], v[80:83]
  v_mfma_f32_16x16x32_bf16 v[68:71], a[68:71], a[20:23], v[68:71]
  v_mfma_f32_16x16x32_bf16 v[76:79], a[68:71], a[44:47], v[76:79]
  v_mfma_f32_16x16x32_bf16 v[80:83], a[92:95], a[44:47], v[80:83]
  s_waitcnt vmcnt(12)
  v_mfma_f32_16x16x32_bf16 v[64:67], a[144:147], a[0:3], 0
  v_mfma_f32_16x16x32_bf16 v[72:75], a[144:147], a[24:27], 0
  v_mfma_f32_16x16x32_bf16 v[64:67], a[148:151], a[4:7], v[64:67]
  v_mfma_f32_16x16x32_bf16 v[72:75], a[148:151], a[28:31], v[72:75]
  v_mfma_f32_16x16x32_bf16 v[64:67], a[152:155], a[8:11], v[64:67]
  v_mfma_f32_16x16x32_bf16 v[72:75], a[152:155], a[32:35], v[72:75]
  v_mfma_f32_16x16x32_bf16 v[64:67], a[156:159], a[12:15], v[64:67]
  v_mfma_f32_16x16x32_bf16 v[72:75], a[156:159], a[36:39], v[72:75]
  v_mfma_f32_16x16x32_bf16 v[64:67], a[160:163], a[16:19], v[64:67]
  v_mfma_f32_16x16x32_bf16 v[72:75], a[160:163], a[40:43], v[72:75]
  v_mfma_f32_16x16x32_bf16 v[64:67], a[164:167], a[20:23], v[64:67]
  v_mfma_f32_16x16x32_bf16 v[72:75], a[164:167], a[44:47], v[72:75]
  s_waitcnt vmcnt(0)
  s_lshl_b32 s4, s31, 1
  s_mul_i32 s4, s4, 196608
  s_mul_i32 s5, s36, 6144
  s_add_u32 s4, s4, s5
  s_add_u32 s44, s4, 108941312
  v_cndmask_b32 v68, v27, v68, s[48:49]
  v_cndmask_b32 v69, v27, v69, s[50:51]
  v_cndmask_b32 v70, v27, v70, s[52:53]
  v_cndmask_b32 v71, v27, v71, s[54:55]
  v_max3_f32 v144, v64, v65, v66
  v_max3_f32 v144, v144, v67, v68
  v_max3_f32 v144, v144, v69, v70
  v_max_f32 v144, v144, v71
  v_mov_b32 v145, v144
  s_nop 1
  v_permlane16_swap_b32 v144, v145
  v_max_f32 v144, v144, v145
  v_mov_b32 v145, v144
  s_nop 1
  v_permlane32_swap_b32 v144, v145
  v_max_f32 v144, v144, v145
  v_mul_f32 v144, s56, v144
  v_fma_f32 v64, v64, s56, -v144
  v_fma_f32 v65, v65, s56, -v144
  v_fma_f32 v66, v66, s56, -v144
  v_fma_f32 v67, v67, s56, -v144
  v_fma_f32 v68, v68, s56, -v144
  v_fma_f32 v69, v69, s56, -v144
  v_fma_f32 v70, v70, s56, -v144
  v_fma_f32 v71, v71, s56, -v144
  v_exp_f32 v64, v64
  v_exp_f32 v65, v65
  v_exp_f32 v66, v66
  v_exp_f32 v67, v67
  v_exp_f32 v68, v68
  v_exp_f32 v69, v69
  v_exp_f32 v70, v70
  v_exp_f32 v71, v71
  v_cvt_pk_bf16_f32 v84, v68, v69
  v_cvt_pk_bf16_f32 v85, v70, v71
  v_cvt_pk_bf16_f32 v88, v64, v65
  v_cvt_pk_bf16_f32 v89, v66, v67
  v_mov_b32 v86, 0
  v_mov_b32 v87, 0
  v_mfma_f32_16x16x16_bf16 v[96:99], a[168:169], v[88:89], 0
  v_mfma_f32_16x16x16_bf16 v[100:103], a[170:171], v[88:89], 0
  v_mfma_f32_16x16x16_bf16 v[104:107], a[172:173], v[88:89], 0
  v_mfma_f32_16x16x16_bf16 v[108:111], a[174:175], v[88:89], 0
  v_mfma_f32_16x16x16_bf16 v[112:115], a[176:177], v[88:89], 0
  v_mfma_f32_16x16x16_bf16 v[116:119], a[178:179], v[88:89], 0
  v_mfma_f32_16x16x16_bf16 v[120:123], a[180:181], v[88:89], 0
  v_mfma_f32_16x16x16_bf16 v[124:127], a[182:183], v[88:89], 0
  v_mfma_f32_16x16x16_bf16 v[128:131], a[184:185], v[88:89], 0
  v_mfma_f32_16x16x16_bf16 v[132:135], a[186:187], v[88:89], 0
  v_mfma_f32_16x16x16_bf16 v[136:139], a[188:189], v[88:89], 0
  v_mfma_f32_16x16x16_bf16 v[140:143], a[190:191], v[88:89], 0
  v_mfma_f32_16x16x32_bf16 v[96:99], a[96:99], v[84:87], v[96:99]
  v_mfma_f32_16x16x32_bf16 v[100:103], a[100:103], v[84:87], v[100:103]
  v_mfma_f32_16x16x32_bf16 v[104:107], a[104:107], v[84:87], v[104:107]
  v_mfma_f32_16x16x32_bf16 v[108:111], a[108:111], v[84:87], v[108:111]
  v_mfma_f32_16x16x32_bf16 v[112:115], a[112:115], v[84:87], v[112:115]
  v_mfma_f32_16x16x32_bf16 v[116:119], a[116:119], v[84:87], v[116:119]
  v_mfma_f32_16x16x32_bf16 v[120:123], a[120:123], v[84:87], v[120:123]
  v_mfma_f32_16x16x32_bf16 v[124:127], a[124:127], v[84:87], v[124:127]
  v_mfma_f32_16x16x32_bf16 v[128:131], a[128:131], v[84:87], v[128:131]
  v_mfma_f32_16x16x32_bf16 v[132:135], a[132:135], v[84:87], v[132:135]
  v_mfma_f32_16x16x32_bf16 v[136:139], a[136:139], v[84:87], v[136:139]
  v_mfma_f32_16x16x32_bf16 v[140:143], a[140:143], v[84:87], v[140:143]
  v_add_f32 v144, v64, v65
  v_add_f32 v145, v66, v67
  v_add_f32 v144, v144, v145
  v_mul_f32 v144, 0.5, v144
  v_add_f32 v144, v144, v68
  v_add_f32 v144, v144, v69
  v_add_f32 v144, v144, v70
  v_add_f32 v144, v144, v71
  v_mov_b32 v145, v144
  s_nop 1
  v_permlane16_swap_b32 v144, v145
  v_add_f32 v144, v144, v145
  v_mov_b32 v145, v144
  s_nop 1
  v_permlane32_swap_b32 v144, v145
  v_add_f32 v144, v144, v145
  v_rcp_f32 v144, v144
  s_nop 0
  v_mul_f32 v96, v96, v144
  v_mul_f32 v97, v97, v144
  v_mul_f32 v98, v98, v144
  v_mul_f32 v99, v99, v144
  v_mul_f32 v100, v100, v144
  v_mul_f32 v101, v101, v144
  v_mul_f32 v102, v102, v144
  v_mul_f32 v103, v103, v144
  v_mul_f32 v104, v104, v144
  v_mul_f32 v105, v105, v144
  v_mul_f32 v106, v106, v144
  v_mul_f32 v107, v107, v144
  v_mul_f32 v108, v108, v144
  v_mul_f32 v109, v109, v144
  v_mul_f32 v110, v110, v144
  v_mul_f32 v111, v111, v144
  v_mul_f32 v112, v112, v144
  v_mul_f32 v113, v113, v144
  v_mul_f32 v114, v114, v144
  v_mul_f32 v115, v115, v144
  v_mul_f32 v116, v116, v144
  v_mul_f32 v117, v117, v144
  v_mul_f32 v118, v118, v144
  v_mul_f32 v119, v119, v144
  v_mul_f32 v120, v120, v144
  v_mul_f32 v121, v121, v144
  v_mul_f32 v122, v122, v144
  v_mul_f32 v123, v123, v144
  v_mul_f32 v124, v124, v144
  v_mul_f32 v125, v125, v144
  v_mul_f32 v126, v126, v144
  v_mul_f32 v127, v127, v144
  v_mul_f32 v128, v128, v144
  v_mul_f32 v129, v129, v144
  v_mul_f32 v130, v130, v144
  v_mul_f32 v131, v131, v144
  v_mul_f32 v132, v132, v144
  v_mul_f32 v133, v133, v144
  v_mul_f32 v134, v134, v144
  v_mul_f32 v135, v135, v144
  v_mul_f32 v136, v136, v144
  v_mul_f32 v137, v137, v144
  v_mul_f32 v138, v138, v144
  v_mul_f32 v139, v139, v144
  v_mul_f32 v140, v140, v144
  v_mul_f32 v141, v141, v144
  v_mul_f32 v142, v142, v144
  v_mul_f32 v143, v143, v144
  v_cvt_pk_bf16_f32 v148, v96, v97
  v_cvt_pk_bf16_f32 v149, v98, v99
  v_cvt_pk_bf16_f32 v150, v100, v101
  v_cvt_pk_bf16_f32 v151, v102, v103
  s_add_u32 s6, s44, 0
  buffer_store_dwordx4 v[148:151], v20, s[8:11], s6 offen offset:0 sc1
  v_cvt_pk_bf16_f32 v152, v104, v105
  v_cvt_pk_bf16_f32 v153, v106, v107
  v_cvt_pk_bf16_f32 v154, v108, v109
  v_cvt_pk_bf16_f32 v155, v110, v111
  buffer_store_dwordx4 v[152:155], v20, s[8:11], s6 offen offset:1024 sc1
  v_cvt_pk_bf16_f32 v156, v112, v113
  v_cvt_pk_bf16_f32 v157, v114, v115
  v_cvt_pk_bf16_f32 v158, v116, v117
  v_cvt_pk_bf16_f32 v159, v118, v119
  buffer_store_dwordx4 v[156:159], v20, s[8:11], s6 offen offset:2048 sc1
  v_cvt_pk_bf16_f32 v148, v120, v121
  v_cvt_pk_bf16_f32 v149, v122, v123
  v_cvt_pk_bf16_f32 v150, v124, v125
  v_cvt_pk_bf16_f32 v151, v126, v127
  buffer_store_dwordx4 v[148:151], v20, s[8:11], s6 offen offset:3072 sc1
  v_cvt_pk_bf16_f32 v152, v128, v129
  v_cvt_pk_bf16_f32 v153, v130, v131
  v_cvt_pk_bf16_f32 v154, v132, v133
  v_cvt_pk_bf16_f32 v155, v134, v135
  s_add_u32 s6, s44, 4096
  buffer_store_dwordx4 v[152:155], v20, s[8:11], s6 offen offset:0 sc1
  v_cvt_pk_bf16_f32 v156, v136, v137
  v_cvt_pk_bf16_f32 v157, v138, v139
  v_cvt_pk_bf16_f32 v158, v140, v141
  v_cvt_pk_bf16_f32 v159, v142, v143
  buffer_store_dwordx4 v[156:159], v20, s[8:11], s6 offen offset:1024 sc1
  v_cndmask_b32 v80, v27, v80, s[48:49]
  v_cndmask_b32 v81, v27, v81, s[50:51]
  v_cndmask_b32 v82, v27, v82, s[52:53]
  v_cndmask_b32 v83, v27, v83, s[54:55]
  v_max3_f32 v144, v72, v73, v74
  v_max3_f32 v144, v144, v75, v76
  v_max3_f32 v144, v144, v77, v78
  v_max3_f32 v144, v144, v79, v80
  v_max3_f32 v144, v144, v81, v82
  v_max_f32 v144, v144, v83
  v_mov_b32 v145, v144
  s_nop 1
  v_permlane16_swap_b32 v144, v145
  v_max_f32 v144, v144, v145
  v_mov_b32 v145, v144
  s_nop 1
  v_permlane32_swap_b32 v144, v145
  v_max_f32 v144, v144, v145
  v_mul_f32 v144, s56, v144
  v_fma_f32 v72, v72, s56, -v144
  v_fma_f32 v73, v73, s56, -v144
  v_fma_f32 v74, v74, s56, -v144
  v_fma_f32 v75, v75, s56, -v144
  v_fma_f32 v76, v76, s56, -v144
  v_fma_f32 v77, v77, s56, -v144
  v_fma_f32 v78, v78, s56, -v144
  v_fma_f32 v79, v79, s56, -v144
  v_fma_f32 v80, v80, s56, -v144
  v_fma_f32 v81, v81, s56, -v144
  v_fma_f32 v82, v82, s56, -v144
  v_fma_f32 v83, v83, s56, -v144
  v_exp_f32 v72, v72
  v_exp_f32 v73, v73
  v_exp_f32 v74, v74
  v_exp_f32 v75, v75
  v_exp_f32 v76, v76
  v_exp_f32 v77, v77
  v_exp_f32 v78, v78
  v_exp_f32 v79, v79
  v_exp_f32 v80, v80
  v_exp_f32 v81, v81
  v_exp_f32 v82, v82
  v_exp_f32 v83, v83
  v_cvt_pk_bf16_f32 v84, v76, v77
  v_cvt_pk_bf16_f32 v85, v78, v79
  v_cvt_pk_bf16_f32 v88, v72, v73
  v_cvt_pk_bf16_f32 v89, v74, v75
  v_cvt_pk_bf16_f32 v86, v80, v81
  v_cvt_pk_bf16_f32 v87, v82, v83
  v_mfma_f32_16x16x16_bf16 v[96:99], a[168:169], v[88:89], 0
  v_mfma_f32_16x16x16_bf16 v[100:103], a[170:171], v[88:89], 0
  v_mfma_f32_16x16x16_bf16 v[104:107], a[172:173], v[88:89], 0
  v_mfma_f32_16x16x16_bf16 v[108:111], a[174:175], v[88:89], 0
  v_mfma_f32_16x16x16_bf16 v[112:115], a[176:177], v[88:89], 0
  v_mfma_f32_16x16x16_bf16 v[116:119], a[178:179], v[88:89], 0
  v_mfma_f32_16x16x16_bf16 v[120:123], a[180:181], v[88:89], 0
  v_mfma_f32_16x16x16_bf16 v[124:127], a[182:183], v[88:89], 0
  v_mfma_f32_16x16x16_bf16 v[128:131], a[184:185], v[88:89], 0
  v_mfma_f32_16x16x16_bf16 v[132:135], a[186:187], v[88:89], 0
  v_mfma_f32_16x16x16_bf16 v[136:139], a[188:189], v[88:89], 0
  v_mfma_f32_16x16x16_bf16 v[140:143], a[190:191], v[88:89], 0
  v_mfma_f32_16x16x32_bf16 v[96:99], a[96:99], v[84:87], v[96:99]
  v_mfma_f32_16x16x32_bf16 v[100:103], a[100:103], v[84:87], v[100:103]
  v_mfma_f32_16x16x32_bf16 v[104:107], a[104:107], v[84:87], v[104:107]
  v_mfma_f32_16x16x32_bf16 v[108:111], a[108:111], v[84:87], v[108:111]
  v_mfma_f32_16x16x32_bf16 v[112:115], a[112:115], v[84:87], v[112:115]
  v_mfma_f32_16x16x32_bf16 v[116:119], a[116:119], v[84:87], v[116:119]
  v_mfma_f32_16x16x32_bf16 v[120:123], a[120:123], v[84:87], v[120:123]
  v_mfma_f32_16x16x32_bf16 v[124:127], a[124:127], v[84:87], v[124:127]
  v_mfma_f32_16x16x32_bf16 v[128:131], a[128:131], v[84:87], v[128:131]
  v_mfma_f32_16x16x32_bf16 v[132:135], a[132:135], v[84:87], v[132:135]
  v_mfma_f32_16x16x32_bf16 v[136:139], a[136:139], v[84:87], v[136:139]
  v_mfma_f32_16x16x32_bf16 v[140:143], a[140:143], v[84:87], v[140:143]
  v_add_f32 v144, v72, v73
  v_add_f32 v145, v74, v75
  v_add_f32 v144, v144, v145
  v_mul_f32 v144, 0.5, v144
  v_add_f32 v144, v144, v76
  v_add_f32 v144, v144, v77
  v_add_f32 v144, v144, v78
  v_add_f32 v144, v144, v79
  v_add_f32 v144, v144, v80
  v_add_f32 v144, v144, v81
  v_add_f32 v144, v144, v82
  v_add_f32 v144, v144, v83
  v_mov_b32 v145, v144
  s_nop 1
  v_permlane16_swap_b32 v144, v145
  v_add_f32 v144, v144, v145
  v_mov_b32 v145, v144
  s_nop 1
  v_permlane32_swap_b32 v144, v145
  v_add_f32 v144, v144, v145
  v_rcp_f32 v144, v144
  s_nop 0
  v_mul_f32 v96, v96, v144
  v_mul_f32 v97, v97, v144
  v_mul_f32 v98, v98, v144
  v_mul_f32 v99, v99, v144
  v_mul_f32 v100, v100, v144
  v_mul_f32 v101, v101, v144
  v_mul_f32 v102, v102, v144
  v_mul_f32 v103, v103, v144
  v_mul_f32 v104, v104, v144
  v_mul_f32 v105, v105, v144
  v_mul_f32 v106, v106, v144
  v_mul_f32 v107, v107, v144
  v_mul_f32 v108, v108, v144
  v_mul_f32 v109, v109, v144
  v_mul_f32 v110, v110, v144
  v_mul_f32 v111, v111, v144
  v_mul_f32 v112, v112, v144
  v_mul_f32 v113, v113, v144
  v_mul_f32 v114, v114, v144
  v_mul_f32 v115, v115, v144
  v_mul_f32 v116, v116, v144
  v_mul_f32 v117, v117, v144
  v_mul_f32 v118, v118, v144
  v_mul_f32 v119, v119, v144
  v_mul_f32 v120, v120, v144
  v_mul_f32 v121, v121, v144
  v_mul_f32 v122, v122, v144
  v_mul_f32 v123, v123, v144
  v_mul_f32 v124, v124, v144
  v_mul_f32 v125, v125, v144
  v_mul_f32 v126, v126, v144
  v_mul_f32 v127, v127, v144
  v_mul_f32 v128, v128, v144
  v_mul_f32 v129, v129, v144
  v_mul_f32 v130, v130, v144
  v_mul_f32 v131, v131, v144
  v_mul_f32 v132, v132, v144
  v_mul_f32 v133, v133, v144
  v_mul_f32 v134, v134, v144
  v_mul_f32 v135, v135, v144
  v_mul_f32 v136, v136, v144
  v_mul_f32 v137, v137, v144
  v_mul_f32 v138, v138, v144
  v_mul_f32 v139, v139, v144
  v_mul_f32 v140, v140, v144
  v_mul_f32 v141, v141, v144
  v_mul_f32 v142, v142, v144
  v_mul_f32 v143, v143, v144
  v_cvt_pk_bf16_f32 v148, v96, v97
  v_cvt_pk_bf16_f32 v149, v98, v99
  v_cvt_pk_bf16_f32 v150, v100, v101
  v_cvt_pk_bf16_f32 v151, v102, v103
  s_add_u32 s6, s44, 196608
  buffer_store_dwordx4 v[148:151], v20, s[8:11], s6 offen offset:0 sc1
  v_cvt_pk_bf16_f32 v152, v104, v105
  v_cvt_pk_bf16_f32 v153, v106, v107
  v_cvt_pk_bf16_f32 v154, v108, v109
  v_cvt_pk_bf16_f32 v155, v110, v111
  buffer_store_dwordx4 v[152:155], v20, s[8:11], s6 offen offset:1024 sc1
  v_cvt_pk_bf16_f32 v156, v112, v113
  v_cvt_pk_bf16_f32 v157, v114, v115
  v_cvt_pk_bf16_f32 v158, v116, v117
  v_cvt_pk_bf16_f32 v159, v118, v119
  buffer_store_dwordx4 v[156:159], v20, s[8:11], s6 offen offset:2048 sc1
  v_cvt_pk_bf16_f32 v148, v120, v121
  v_cvt_pk_bf16_f32 v149, v122, v123
  v_cvt_pk_bf16_f32 v150, v124, v125
  v_cvt_pk_bf16_f32 v151, v126, v127
  buffer_store_dwordx4 v[148:151], v20, s[8:11], s6 offen offset:3072 sc1
  v_cvt_pk_bf16_f32 v152, v128, v129
  v_cvt_pk_bf16_f32 v153, v130, v131
  v_cvt_pk_bf16_f32 v154, v132, v133
  v_cvt_pk_bf16_f32 v155, v134, v135
  s_add_u32 s6, s44, 200704
  buffer_store_dwordx4 v[152:155], v20, s[8:11], s6 offen offset:0 sc1
  v_cvt_pk_bf16_f32 v156, v136, v137
  v_cvt_pk_bf16_f32 v157, v138, v139
  v_cvt_pk_bf16_f32 v158, v140, v141
  v_cvt_pk_bf16_f32 v159, v142, v143
  buffer_store_dwordx4 v[156:159], v20, s[8:11], s6 offen offset:1024 sc1
  s_waitcnt vmcnt(0)
  s_mov_b64 exec, 1
  v_mov_b32 v28, s41
  v_mov_b32 v29, 0
  buffer_store_dword v28, v29, s[8:11], s35 offen sc1
  s_mov_b64 exec, -1
  s_add_u32 s31, s31, 2
  s_cmp_lt_u32 s31, 64
  s_cbranch_scc1 L_B_top
  s_waitcnt vmcnt(0)
  s_branch L_exit
L_roleC:
  s_sub_u32 s55, s30, 88
  s_mov_b32 s53, 0
L_C_par:
  s_mov_b32 s4, s55
  s_mul_hi_u32 s36, s4, 858993460
  s_mul_i32 s5, s36, 5
  s_sub_u32 s37, s4, s5
  s_lshl_b32 s4, s4, 7
  s_lshl_b32 s5, s24, 2
  s_add_u32 s4, s4, s5
  s_mul_i32 s5, s53, 2560
  s_add_u32 s4, s4, s5
  s_add_u32 s35, s4, 77824
  s_mov_b32 s52, 104
  s_cmp_eq_u32 s53, 1
  s_cmov_b32 s52, 24
  s_cmp_eq_u32 s53, 1
  s_cbranch_scc1 L_C_second
  s_mov_b64 exec, 1
  v_mov_b32 v28, 0
  v_mov_b32 v29, 0
  buffer_store_dword v28, v29, s[8:11], s35 offen sc1
  s_mov_b64 exec, -1
  s_load_dwordx2 s[20:21], s[0:1], 0
  s_waitcnt lgkmcnt(0)
  s_and_b32 s21, s21, 0xffff
  s_mov_b32 s22, 2621440
  s_mov_b32 s23, 0x20000
  s_lshl_b32 s4, s30, 4
  s_mul_i32 s4, s4, 1280
  s_mul_i32 s5, s24, 320
  s_add_u32 s4, s4, s5
  v_mul_u32_u24 v28, 1280, v22
  v_lshlrev_b32 v29, 4, v21
  v_add_u32 v28, v28, v29
  buffer_load_dwordx4 v[40:43], v28, s[20:23], s4 offen offset:0
  buffer_load_dwordx4 v[44:47], v28, s[20:23], s4 offen offset:64
  buffer_load_dwordx4 v[48:51], v28, s[20:23], s4 offen offset:128
  buffer_load_dwordx4 v[52:55], v28, s[20:23], s4 offen offset:192
  buffer_load_dwordx4 v[56:59], v28, s[20:23], s4 offen offset:256
  s_waitcnt vmcnt(0)
  v_lshlrev_b32 v64, 16, v40
  v_and_b32 v65, 0xffff0000, v40
  v_lshlrev_b32 v66, 16, v41
  v_and_b32 v67, 0xffff0000, v41
  v_lshlrev_b32 v68, 16, v42
  v_and_b32 v69, 0xffff0000, v42
  v_lshlrev_b32 v70, 16, v43
  v_and_b32 v71, 0xffff0000, v43
  v_lshlrev_b32 v72, 16, v44
  v_and_b32 v73, 0xffff0000, v44
  v_lshlrev_b32 v74, 16, v45
  v_and_b32 v75, 0xffff0000, v45
  v_lshlrev_b32 v76, 16, v46
  v_and_b32 v77, 0xffff0000, v46
  v_lshlrev_b32 v78, 16, v47
  v_and_b32 v79, 0xffff0000, v47
  v_lshlrev_b32 v80, 16, v48
  v_and_b32 v81, 0xffff0000, v48
  v_lshlrev_b32 v82, 16, v49
  v_and_b32 v83, 0xffff0000, v49
  v_lshlrev_b32 v84, 16, v50
  v_and_b32 v85, 0xffff0000, v50
  v_lshlrev_b32 v86, 16, v51
  v_and_b32 v87, 0xffff0000, v51
  v_lshlrev_b32 v88, 16, v52
  v_and_b32 v89, 0xffff0000, v52
  v_lshlrev_b32 v90, 16, v53
  v_and_b32 v91, 0xffff0000, v53
  v_lshlrev_b32 v92, 16, v54
  v_and_b32 v93, 0xffff0000, v54
  v_lshlrev_b32 v94, 16, v55
  v_and_b32 v95, 0xffff0000, v55
  v_lshlrev_b32 v96, 16, v56
  v_and_b32 v97, 0xffff0000, v56
  v_lshlrev_b32 v98, 16, v57
  v_and_b32 v99, 0xffff0000, v57
  v_lshlrev_b32 v100, 16, v58
  v_and_b32 v101, 0xffff0000, v58
  v_lshlrev_b32 v102, 16, v59
  v_and_b32 v103, 0xffff0000, v59
  s_mov_b32 s47, 131072
  v_pk_add_f32 v[104:105], v[64:65], v[66:67]
  v_pk_mul_f32 v[106:107], v[64:65], v[64:65]
  v_pk_fma_f32 v[106:107], v[66:67], v[66:67], v[106:107]
  v_pk_add_f32 v[104:105], v[104:105], v[68:69]
  v_pk_fma_f32 v[106:107], v[68:69], v[68:69], v[106:107]
  v_pk_add_f32 v[104:105], v[104:105], v[70:71]
  v_pk_fma_f32 v[106:107], v[70:71], v[70:71], v[106:107]
  v_pk_add_f32 v[104:105], v[104:105], v[72:73]
  v_pk_fma_f32 v[106:107], v[72:73], v[72:73], v[106:107]
  v_pk_add_f32 v[104:105], v[104:105], v[74:75]
  v_pk_fma_f32 v[106:107], v[74:75], v[74:75], v[106:107]
  v_pk_add_f32 v[104:105], v[104:105], v[76:77]
  v_pk_fma_f32 v[106:107], v[76:77], v[76:77], v[106:107]
  v_pk_add_f32 v[104:105], v[104:105], v[78:79]
  v_pk_fma_f32 v[106:107], v[78:79], v[78:79], v[106:107]
  v_pk_add_f32 v[104:105], v[104:105], v[80:81]
  v_pk_fma_f32 v[106:107], v[80:81], v[80:81], v[106:107]
  v_pk_add_f32 v[104:105], v[104:105], v[82:83]
  v_pk_fma_f32 v[106:107], v[82:83], v[82:83], v[106:107]
  v_pk_add_f32 v[104:105], v[104:105], v[84:85]
  v_pk_fma_f32 v[106:107], v[84:85], v[84:85], v[106:107]
  v_pk_add_f32 v[104:105], v[104:105], v[86:87]
  v_pk_fma_f32 v[106:107], v[86:87], v[86:87], v[106:107]
  v_pk_add_f32 v[104:105], v[104:105], v[88:89]
  v_pk_fma_f32 v[106:107], v[88:89], v[88:89], v[106:107]
  v_pk_add_f32 v[104:105], v[104:105], v[90:91]
  v_pk_fma_f32 v[106:107], v[90:91], v[90:91], v[106:107]
  v_pk_add_f32 v[104:105], v[104:105], v[92:93]
  v_pk_fma_f32 v[106:107], v[92:93], v[92:93], v[106:107]
  v_pk_add_f32 v[104:105], v[104:105], v[94:95]
  v_pk_fma_f32 v[106:107], v[94:95], v[94:95], v[106:107]
  v_pk_add_f32 v[104:105], v[104:105], v[96:97]
  v_pk_fma_f32 v[106:107], v[96:97], v[96:97], v[106:107]
  v_pk_add_f32 v[104:105], v[104:105], v[98:99]
  v_pk_fma_f32 v[106:107], v[98:99], v[98:99], v[106:107]
  v_pk_add_f32 v[104:105], v[104:105], v[100:101]
  v_pk_fma_f32 v[106:107], v[100:101], v[100:101], v[106:107]
  v_pk_add_f32 v[104:105], v[104:105], v[102:103]
  v_pk_fma_f32 v[106:107], v[102:103], v[102:103], v[106:107]
  v_add_f32 v104, v104, v105
  v_add_f32 v105, v106, v107
  v_mov_b32 v108, v104
  v_mov_b32 v109, v105
  s_nop 0
  v_permlane16_swap_b32 v104, v108
  v_permlane16_swap_b32 v105, v109
  v_pk_add_f32 v[104:105], v[104:105], v[108:109]
  v_mov_b32 v108, v104
  v_mov_b32 v109, v105
  s_nop 0
  v_permlane32_swap_b32 v104, v108
  v_permlane32_swap_b32 v105, v109
  v_pk_add_f32 v[104:105], v[104:105], v[108:109]
  v_lshlrev_b32 v108, 3, v22
  v_add_u32 v108, s47, v108
  s_lshl_b32 s4, s24, 7
  v_add_u32 v109, s4, v108
  ds_write_b64 v109, v[104:105]
  s_waitcnt lgkmcnt(0)
  s_barrier
  ds_read_b64 v[104:105], v108
  ds_read_b64 v[106:107], v108 offset:128
  ds_read_b64 v[110:111], v108 offset:256
  ds_read_b64 v[112:113], v108 offset:384
  s_waitcnt lgkmcnt(2)
  v_pk_add_f32 v[104:105], v[104:105], v[106:107]
  s_waitcnt lgkmcnt(0)
  v_pk_add_f32 v[106:107], v[110:111], v[112:113]
  v_pk_add_f32 v[104:105], v[104:105], v[106:107]
  v_mul_f32 v104, 986500301, v104
  v_mul_f32 v106, v104, v104
  v_mov_b32 v107, 925353388
  v_fmac_f32 v107, 986500301, v105
  v_sub_f32 v107, v107, v106
  v_max_f32 v107, 925353388, v107
  v_rsq_f32 v106, v107
  s_nop 0
  v_mul_f32 v104, v104, v106
  v_pk_fma_f32 v[64:65], v[64:65], v[106:107], v[104:105] op_sel_hi:[1,0,0] neg_lo:[0,0,1] neg_hi:[0,0,1]
  v_pk_fma_f32 v[66:67], v[66:67], v[106:107], v[104:105] op_sel_hi:[1,0,0] neg_lo:[0,0,1] neg_hi:[0,0,1]
  v_pk_fma_f32 v[68:69], v[68:69], v[106:107], v[104:105] op_sel_hi:[1,0,0] neg_lo:[0,0,1] neg_hi:[0,0,1]
  v_pk_fma_f32 v[70:71], v[70:71], v[106:107], v[104:105] op_sel_hi:[1,0,0] neg_lo:[0,0,1] neg_hi:[0,0,1]
  v_pk_fma_f32 v[72:73], v[72:73], v[106:107], v[104:105] op_sel_hi:[1,0,0] neg_lo:[0,0,1] neg_hi:[0,0,1]
  v_pk_fma_f32 v[74:75], v[74:75], v[106:107], v[104:105] op_sel_hi:[1,0,0] neg_lo:[0,0,1] neg_hi:[0,0,1]
  v_pk_fma_f32 v[76:77], v[76:77], v[106:107], v[104:105] op_sel_hi:[1,0,0] neg_lo:[0,0,1] neg_hi:[0,0,1]
  v_pk_fma_f32 v[78:79], v[78:79], v[106:107], v[104:105] op_sel_hi:[1,0,0] neg_lo:[0,0,1] neg_hi:[0,0,1]
  v_pk_fma_f32 v[80:81], v[80:81], v[106:107], v[104:105] op_sel_hi:[1,0,0] neg_lo:[0,0,1] neg_hi:[0,0,1]
  v_pk_fma_f32 v[82:83], v[82:83], v[106:107], v[104:105] op_sel_hi:[1,0,0] neg_lo:[0,0,1] neg_hi:[0,0,1]
  v_pk_fma_f32 v[84:85], v[84:85], v[106:107], v[104:105] op_sel_hi:[1,0,0] neg_lo:[0,0,1] neg_hi:[0,0,1]
  v_pk_fma_f32 v[86:87], v[86:87], v[106:107], v[104:105] op_sel_hi:[1,0,0] neg_lo:[0,0,1] neg_hi:[0,0,1]
  v_pk_fma_f32 v[88:89], v[88:89], v[106:107], v[104:105] op_sel_hi:[1,0,0] neg_lo:[0,0,1] neg_hi:[0,0,1]
  v_pk_fma_f32 v[90:91], v[90:91], v[106:107], v[104:105] op_sel_hi:[1,0,0] neg_lo:[0,0,1] neg_hi:[0,0,1]
  v_pk_fma_f32 v[92:93], v[92:93], v[106:107], v[104:105] op_sel_hi:[1,0,0] neg_lo:[0,0,1] neg_hi:[0,0,1]
  v_pk_fma_f32 v[94:95], v[94:95], v[106:107], v[104:105] op_sel_hi:[1,0,0] neg_lo:[0,0,1] neg_hi:[0,0,1]
  v_pk_fma_f32 v[96:97], v[96:97], v[106:107], v[104:105] op_sel_hi:[1,0,0] neg_lo:[0,0,1] neg_hi:[0,0,1]
  v_pk_fma_f32 v[98:99], v[98:99], v[106:107], v[104:105] op_sel_hi:[1,0,0] neg_lo:[0,0,1] neg_hi:[0,0,1]
  v_pk_fma_f32 v[100:101], v[100:101], v[106:107], v[104:105] op_sel_hi:[1,0,0] neg_lo:[0,0,1] neg_hi:[0,0,1]
  v_pk_fma_f32 v[102:103], v[102:103], v[106:107], v[104:105] op_sel_hi:[1,0,0] neg_lo:[0,0,1] neg_hi:[0,0,1]
  v_cvt_pk_bf16_f32 v40, v64, v65
  v_cvt_pk_bf16_f32 v41, v66, v67
  v_cvt_pk_bf16_f32 v42, v68, v69
  v_cvt_pk_bf16_f32 v43, v70, v71
  v_cvt_pk_bf16_f32 v44, v72, v73
  v_cvt_pk_bf16_f32 v45, v74, v75
  v_cvt_pk_bf16_f32 v46, v76, v77
  v_cvt_pk_bf16_f32 v47, v78, v79
  v_cvt_pk_bf16_f32 v48, v80, v81
  v_cvt_pk_bf16_f32 v49, v82, v83
  v_cvt_pk_bf16_f32 v50, v84, v85
  v_cvt_pk_bf16_f32 v51, v86, v87
  v_cvt_pk_bf16_f32 v52, v88, v89
  v_cvt_pk_bf16_f32 v53, v90, v91
  v_cvt_pk_bf16_f32 v54, v92, v93
  v_cvt_pk_bf16_f32 v55, v94, v95
  v_cvt_pk_bf16_f32 v56, v96, v97
  v_cvt_pk_bf16_f32 v57, v98, v99
  v_cvt_pk_bf16_f32 v58, v100, v101
  v_cvt_pk_bf16_f32 v59, v102, v103
  s_lshr_b32 s4, s30, 1
  s_mul_i32 s4, s4, 40960
  s_and_b32 s5, s30, 1
  s_lshl_b32 s5, s5, 10
  s_add_u32 s4, s4, s5
  s_mul_i32 s5, s24, 10240
  s_add_u32 s4, s4, s5
  s_add_u32 s4, s4, 5656576
  s_add_u32 s5, s4, 0
  buffer_store_dwordx4 v[40:43], v20, s[8:11], s5 offen sc1
  s_add_u32 s5, s4, 2048
  buffer_store_dwordx4 v[44:47], v20, s[8:11], s5 offen sc1
  s_add_u32 s5, s4, 4096
  buffer_store_dwordx4 v[48:51], v20, s[8:11], s5 offen sc1
  s_add_u32 s5, s4, 6144
  buffer_store_dwordx4 v[52:55], v20, s[8:11], s5 offen sc1
  s_add_u32 s5, s4, 8192
  buffer_store_dwordx4 v[56:59], v20, s[8:11], s5 offen sc1
  s_waitcnt vmcnt(0)
  s_barrier
  s_cmp_eq_u32 s24, 0
  s_cbranch_scc0 L_ia_C
  s_mov_b64 exec, 1
  v_mov_b32 v1, 36
  v_mov_b32 v2, 1
  buffer_atomic_add v2, v1, s[12:15], 0 offen
  s_mov_b64 exec, -1
L_ia_C:
L_C_second:
  s_load_dwordx2 s[16:17], s[0:1], 40
  s_waitcnt lgkmcnt(0)
  s_and_b32 s17, s17, 0xffff
  s_mov_b32 s18, 7864320
  s_mov_b32 s19, 0x20000
  s_mul_i32 s44, s36, 1966080
  s_lshl_b32 s4, s37, 8
  s_add_u32 s44, s44, s4
  s_lshl_b32 s45, s24, 6
  v_lshrrev_b32 v28, 4, v0
  v_and_b32 v29, 15, v0
  v_mul_u32_u24 v32, 1280, v28
  v_lshlrev_b32 v29, 4, v29
  v_add_u32 v32, v32, v29
  v_bfe_u32 v28, v0, 2, 2
  v_and_b32 v29, 3, v0
  v_mul_u32_u24 v30, 4, v21
  v_add_u32 v30, v30, v28
  v_mul_u32_u24 v30, 256, v30
  v_lshlrev_b32 v29, 3, v29
  v_add_u32 v30, v30, v29
  v_add_u32 v30, s45, v30
  v_mov_b32 v36, v30
  s_lshl_b32 s4, s24, 10
  s_add_u32 s4, s4, 0
  s_mov_b32 m0, s4
  s_mul_i32 s5, s24, 5120
  s_add_u32 s5, s5, 0
  s_add_u32 s5, s5, s44
  buffer_load_dwordx4 v32, s[16:19], s5 offen lds
  s_lshl_b32 s4, s24, 10
  s_add_u32 s4, s4, 4096
  s_mov_b32 m0, s4
  s_mul_i32 s5, s24, 5120
  s_add_u32 s5, s5, 20480
  s_add_u32 s5, s5, s44
  buffer_load_dwordx4 v32, s[16:19], s5 offen lds
  s_lshl_b32 s4, s24, 10
  s_add_u32 s4, s4, 8192
  s_mov_b32 m0, s4
  s_mul_i32 s5, s24, 5120
  s_add_u32 s5, s5, 40960
  s_add_u32 s5, s5, s44
  buffer_load_dwordx4 v32, s[16:19], s5 offen lds
  s_lshl_b32 s4, s24, 10
  s_add_u32 s4, s4, 12288
  s_mov_b32 m0, s4
  s_mul_i32 s5, s24, 5120
  s_add_u32 s5, s5, 61440
  s_add_u32 s5, s5, s44
  buffer_load_dwordx4 v32, s[16:19], s5 offen lds
  s_lshl_b32 s4, s24, 10
  s_add_u32 s4, s4, 16384
  s_mov_b32 m0, s4
  s_mul_i32 s5, s24, 5120
  s_add_u32 s5, s5, 81920
  s_add_u32 s5, s5, s44
  buffer_load_dwordx4 v32, s[16:19], s5 offen lds
  s_lshl_b32 s4, s24, 10
  s_add_u32 s4, s4, 20480
  s_mov_b32 m0, s4
  s_mul_i32 s5, s24, 5120
  s_add_u32 s5, s5, 102400
  s_add_u32 s5, s5, s44
  buffer_load_dwordx4 v32, s[16:19], s5 offen lds
  s_lshl_b32 s4, s24, 10
  s_add_u32 s4, s4, 24576
  s_mov_b32 m0, s4
  s_mul_i32 s5, s24, 5120
  s_add_u32 s5, s5, 122880
  s_add_u32 s5, s5, s44
  buffer_load_dwordx4 v32, s[16:19], s5 offen lds
  s_lshl_b32 s4, s24, 10
  s_add_u32 s4, s4, 28672
  s_mov_b32 m0, s4
  s_mul_i32 s5, s24, 5120
  s_add_u32 s5, s5, 143360
  s_add_u32 s5, s5, s44
  buffer_load_dwordx4 v32, s[16:19], s5 offen lds
  s_lshl_b32 s4, s24, 10
  s_add_u32 s4, s4, 32768
  s_mov_b32 m0, s4
  s_mul_i32 s5, s24, 5120
  s_add_u32 s5, s5, 163840
  s_add_u32 s5, s5, s44
  buffer_load_dwordx4 v32, s[16:19], s5 offen lds
  s_lshl_b32 s4, s24, 10
  s_add_u32 s4, s4, 36864
  s_mov_b32 m0, s4
  s_mul_i32 s5, s24, 5120
  s_add_u32 s5, s5, 184320
  s_add_u32 s5, s5, s44
  buffer_load_dwordx4 v32, s[16:19], s5 offen lds
  s_lshl_b32 s4, s24, 10
  s_add_u32 s4, s4, 40960
  s_mov_b32 m0, s4
  s_mul_i32 s5, s24, 5120
  s_add_u32 s5, s5, 204800
  s_add_u32 s5, s5, s44
  buffer_load_dwordx4 v32, s[16:19], s5 offen lds
  s_lshl_b32 s4, s24, 10
  s_add_u32 s4, s4, 45056
  s_mov_b32 m0, s4
  s_mul_i32 s5, s24, 5120
  s_add_u32 s5, s5, 225280
  s_add_u32 s5, s5, s44
  buffer_load_dwordx4 v32, s[16:19], s5 offen lds
  s_lshl_b32 s4, s24, 10
  s_add_u32 s4, s4, 49152
  s_mov_b32 m0, s4
  s_mul_i32 s5, s24, 5120
  s_add_u32 s5, s5, 245760
  s_add_u32 s5, s5, s44
  buffer_load_dwordx4 v32, s[16:19], s5 offen lds
  s_lshl_b32 s4, s24, 10
  s_add_u32 s4, s4, 53248
  s_mov_b32 m0, s4
  s_mul_i32 s5, s24, 5120
  s_add_u32 s5, s5, 266240
  s_add_u32 s5, s5, s44
  buffer_load_dwordx4 v32, s[16:19], s5 offen lds
  s_lshl_b32 s4, s24, 10
  s_add_u32 s4, s4, 57344
  s_mov_b32 m0, s4
  s_mul_i32 s5, s24, 5120
  s_add_u32 s5, s5, 286720
  s_add_u32 s5, s5, s44
  buffer_load_dwordx4 v32, s[16:19], s5 offen lds
  s_lshl_b32 s4, s24, 10
  s_add_u32 s4, s4, 61440
  s_mov_b32 m0, s4
  s_mul_i32 s5, s24, 5120
  s_add_u32 s5, s5, 307200
  s_add_u32 s5, s5, s44
  buffer_load_dwordx4 v32, s[16:19], s5 offen lds
  s_lshl_b32 s4, s24, 10
  s_add_u32 s4, s4, 65536
  s_mov_b32 m0, s4
  s_mul_i32 s5, s24, 5120
  s_add_u32 s5, s5, 327680
  s_add_u32 s5, s5, s44
  buffer_load_dwordx4 v32, s[16:19], s5 offen lds
  s_lshl_b32 s4, s24, 10
  s_add_u32 s4, s4, 69632
  s_mov_b32 m0, s4
  s_mul_i32 s5, s24, 5120
  s_add_u32 s5, s5, 348160
  s_add_u32 s5, s5, s44
  buffer_load_dwordx4 v32, s[16:19], s5 offen lds
  s_lshl_b32 s4, s24, 10
  s_add_u32 s4, s4, 73728
  s_mov_b32 m0, s4
  s_mul_i32 s5, s24, 5120
  s_add_u32 s5, s5, 368640
  s_add_u32 s5, s5, s44
  buffer_load_dwordx4 v32, s[16:19], s5 offen lds
  s_lshl_b32 s4, s24, 10
  s_add_u32 s4, s4, 77824
  s_mov_b32 m0, s4
  s_mul_i32 s5, s24, 5120
  s_add_u32 s5, s5, 389120
  s_add_u32 s5, s5, s44
  buffer_load_dwordx4 v32, s[16:19], s5 offen lds
  s_lshl_b32 s4, s24, 10
  s_add_u32 s4, s4, 81920
  s_mov_b32 m0, s4
  s_mul_i32 s5, s24, 5120
  s_add_u32 s5, s5, 409600
  s_add_u32 s5, s5, s44
  buffer_load_dwordx4 v32, s[16:19], s5 offen lds
  s_lshl_b32 s4, s24, 10
  s_add_u32 s4, s4, 86016
  s_mov_b32 m0, s4
  s_mul_i32 s5, s24, 5120
  s_add_u32 s5, s5, 430080
  s_add_u32 s5, s5, s44
  buffer_load_dwordx4 v32, s[16:19], s5 offen lds
  s_lshl_b32 s4, s24, 10
  s_add_u32 s4, s4, 90112
  s_mov_b32 m0, s4
  s_mul_i32 s5, s24, 5120
  s_add_u32 s5, s5, 450560
  s_add_u32 s5, s5, s44
  buffer_load_dwordx4 v32, s[16:19], s5 offen lds
  s_lshl_b32 s4, s24, 10
  s_add_u32 s4, s4, 94208
  s_mov_b32 m0, s4
  s_mul_i32 s5, s24, 5120
  s_add_u32 s5, s5, 471040
  s_add_u32 s5, s5, s44
  buffer_load_dwordx4 v32, s[16:19], s5 offen lds
  s_lshl_b32 s4, s24, 10
  s_add_u32 s4, s4, 98304
  s_mov_b32 m0, s4
  s_mul_i32 s5, s24, 5120
  s_add_u32 s5, s5, 491520
  s_add_u32 s5, s5, s44
  buffer_load_dwordx4 v32, s[16:19], s5 offen lds
  s_lshl_b32 s4, s24, 10
  s_add_u32 s4, s4, 102400
  s_mov_b32 m0, s4
  s_mul_i32 s5, s24, 5120
  s_add_u32 s5, s5, 512000
  s_add_u32 s5, s5, s44
  buffer_load_dwordx4 v32, s[16:19], s5 offen lds
  s_lshl_b32 s4, s24, 10
  s_add_u32 s4, s4, 106496
  s_mov_b32 m0, s4
  s_mul_i32 s5, s24, 5120
  s_add_u32 s5, s5, 532480
  s_add_u32 s5, s5, s44
  buffer_load_dwordx4 v32, s[16:19], s5 offen lds
  s_lshl_b32 s4, s24, 10
  s_add_u32 s4, s4, 110592
  s_mov_b32 m0, s4
  s_mul_i32 s5, s24, 5120
  s_add_u32 s5, s5, 552960
  s_add_u32 s5, s5, s44
  buffer_load_dwordx4 v32, s[16:19], s5 offen lds
  s_lshl_b32 s4, s24, 10
  s_add_u32 s4, s4, 114688
  s_mov_b32 m0, s4
  s_mul_i32 s5, s24, 5120
  s_add_u32 s5, s5, 573440
  s_add_u32 s5, s5, s44
  buffer_load_dwordx4 v32, s[16:19], s5 offen lds
  s_lshl_b32 s4, s24, 10
  s_add_u32 s4, s4, 118784
  s_mov_b32 m0, s4
  s_mul_i32 s5, s24, 5120
  s_add_u32 s5, s5, 593920
  s_add_u32 s5, s5, s44
  buffer_load_dwordx4 v32, s[16:19], s5 offen lds
  s_lshl_b32 s4, s24, 10
  s_add_u32 s4, s4, 122880
  s_mov_b32 m0, s4
  s_mul_i32 s5, s24, 5120
  s_add_u32 s5, s5, 614400
  s_add_u32 s5, s5, s44
  buffer_load_dwordx4 v32, s[16:19], s5 offen lds
  s_lshl_b32 s4, s24, 10
  s_add_u32 s4, s4, 126976
  s_mov_b32 m0, s4
  s_mul_i32 s5, s24, 5120
  s_add_u32 s5, s5, 634880
  s_add_u32 s5, s5, s44
  buffer_load_dwordx4 v32, s[16:19], s5 offen lds
  s_waitcnt vmcnt(16)
  s_barrier
  ds_read_b64_tr_b16 a[0:1], v36 offset:0
  ds_read_b64_tr_b16 a[2:3], v36 offset:4096
  ds_read_b64_tr_b16 a[4:5], v36 offset:32
  ds_read_b64_tr_b16 a[6:7], v36 offset:4128
  ds_read_b64_tr_b16 a[8:9], v36 offset:8192
  ds_read_b64_tr_b16 a[10:11], v36 offset:12288
  ds_read_b64_tr_b16 a[12:13], v36 offset:8224
  ds_read_b64_tr_b16 a[14:15], v36 offset:12320
  ds_read_b64_tr_b16 a[16:17], v36 offset:16384
  ds_read_b64_tr_b16 a[18:19], v36 offset:20480
  ds_read_b64_tr_b16 a[20:21], v36 offset:16416
  ds_read_b64_tr_b16 a[22:23], v36 offset:20512
  s_waitcnt lgkmcnt(0)
  ds_read_b64_tr_b16 a[24:25], v36 offset:24576
  ds_read_b64_tr_b16 a[26:27], v36 offset:28672
  ds_read_b64_tr_b16 a[28:29], v36 offset:24608
  ds_read_b64_tr_b16 a[30:31], v36 offset:28704
  ds_read_b64_tr_b16 a[32:33], v36 offset:32768
  ds_read_b64_tr_b16 a[34:35], v36 offset:36864
  ds_read_b64_tr_b16 a[36:37], v36 offset:32800
  ds_read_b64_tr_b16 a[38:39], v36 offset:36896
  ds_read_b64_tr_b16 a[40:41], v36 offset:40960
  ds_read_b64_tr_b16 a[42:43], v36 offset:45056
  ds_read_b64_tr_b16 a[44:45], v36 offset:40992
  ds_read_b64_tr_b16 a[46:47], v36 offset:45088
  s_waitcnt lgkmcnt(0)
  ds_read_b64_tr_b16 a[48:49], v36 offset:49152
  ds_read_b64_tr_b16 a[50:51], v36 offset:53248
  ds_read_b64_tr_b16 a[52:53], v36 offset:49184
  ds_read_b64_tr_b16 a[54:55], v36 offset:53280
  ds_read_b64_tr_b16 a[56:57], v36 offset:57344
  ds_read_b64_tr_b16 a[58:59], v36 offset:61440
  ds_read_b64_tr_b16 a[60:61], v36 offset:57376
  ds_read_b64_tr_b16 a[62:63], v36 offset:61472
  s_waitcnt lgkmcnt(0)
  s_barrier
  s_lshl_b32 s4, s24, 10
  s_add_u32 s4, s4, 0
  s_mov_b32 m0, s4
  s_mul_i32 s5, s24, 5120
  s_add_u32 s5, s5, 655360
  s_add_u32 s5, s5, s44
  buffer_load_dwordx4 v32, s[16:19], s5 offen lds
  s_lshl_b32 s4, s24, 10
  s_add_u32 s4, s4, 4096
  s_mov_b32 m0, s4
  s_mul_i32 s5, s24, 5120
  s_add_u32 s5, s5, 675840
  s_add_u32 s5, s5, s44
  buffer_load_dwordx4 v32, s[16:19], s5 offen lds
  s_lshl_b32 s4, s24, 10
  s_add_u32 s4, s4, 8192
  s_mov_b32 m0, s4
  s_mul_i32 s5, s24, 5120
  s_add_u32 s5, s5, 696320
  s_add_u32 s5, s5, s44
  buffer_load_dwordx4 v32, s[16:19], s5 offen lds
  s_lshl_b32 s4, s24, 10
  s_add_u32 s4, s4, 12288
  s_mov_b32 m0, s4
  s_mul_i32 s5, s24, 5120
  s_add_u32 s5, s5, 716800
  s_add_u32 s5, s5, s44
  buffer_load_dwordx4 v32, s[16:19], s5 offen lds
  s_lshl_b32 s4, s24, 10
  s_add_u32 s4, s4, 16384
  s_mov_b32 m0, s4
  s_mul_i32 s5, s24, 5120
  s_add_u32 s5, s5, 737280
  s_add_u32 s5, s5, s44
  buffer_load_dwordx4 v32, s[16:19], s5 offen lds
  s_lshl_b32 s4, s24, 10
  s_add_u32 s4, s4, 20480
  s_mov_b32 m0, s4
  s_mul_i32 s5, s24, 5120
  s_add_u32 s5, s5, 757760
  s_add_u32 s5, s5, s44
  buffer_load_dwordx4 v32, s[16:19], s5 offen lds
  s_lshl_b32 s4, s24, 10
  s_add_u32 s4, s4, 24576
  s_mov_b32 m0, s4
  s_mul_i32 s5, s24, 5120
  s_add_u32 s5, s5, 778240
  s_add_u32 s5, s5, s44
  buffer_load_dwordx4 v32, s[16:19], s5 offen lds
  s_lshl_b32 s4, s24, 10
  s_add_u32 s4, s4, 28672
  s_mov_b32 m0, s4
  s_mul_i32 s5, s24, 5120
  s_add_u32 s5, s5, 798720
  s_add_u32 s5, s5, s44
  buffer_load_dwordx4 v32, s[16:19], s5 offen lds
  s_lshl_b32 s4, s24, 10
  s_add_u32 s4, s4, 32768
  s_mov_b32 m0, s4
  s_mul_i32 s5, s24, 5120
  s_add_u32 s5, s5, 819200
  s_add_u32 s5, s5, s44
  buffer_load_dwordx4 v32, s[16:19], s5 offen lds
  s_lshl_b32 s4, s24, 10
  s_add_u32 s4, s4, 36864
  s_mov_b32 m0, s4
  s_mul_i32 s5, s24, 5120
  s_add_u32 s5, s5, 839680
  s_add_u32 s5, s5, s44
  buffer_load_dwordx4 v32, s[16:19], s5 offen lds
  s_lshl_b32 s4, s24, 10
  s_add_u32 s4, s4, 40960
  s_mov_b32 m0, s4
  s_mul_i32 s5, s24, 5120
  s_add_u32 s5, s5, 860160
  s_add_u32 s5, s5, s44
  buffer_load_dwordx4 v32, s[16:19], s5 offen lds
  s_lshl_b32 s4, s24, 10
  s_add_u32 s4, s4, 45056
  s_mov_b32 m0, s4
  s_mul_i32 s5, s24, 5120
  s_add_u32 s5, s5, 880640
  s_add_u32 s5, s5, s44
  buffer_load_dwordx4 v32, s[16:19], s5 offen lds
  s_lshl_b32 s4, s24, 10
  s_add_u32 s4, s4, 49152
  s_mov_b32 m0, s4
  s_mul_i32 s5, s24, 5120
  s_add_u32 s5, s5, 901120
  s_add_u32 s5, s5, s44
  buffer_load_dwordx4 v32, s[16:19], s5 offen lds
  s_lshl_b32 s4, s24, 10
  s_add_u32 s4, s4, 53248
  s_mov_b32 m0, s4
  s_mul_i32 s5, s24, 5120
  s_add_u32 s5, s5, 921600
  s_add_u32 s5, s5, s44
  buffer_load_dwordx4 v32, s[16:19], s5 offen lds
  s_lshl_b32 s4, s24, 10
  s_add_u32 s4, s4, 57344
  s_mov_b32 m0, s4
  s_mul_i32 s5, s24, 5120
  s_add_u32 s5, s5, 942080
  s_add_u32 s5, s5, s44
  buffer_load_dwordx4 v32, s[16:19], s5 offen lds
  s_lshl_b32 s4, s24, 10
  s_add_u32 s4, s4, 61440
  s_mov_b32 m0, s4
  s_mul_i32 s5, s24, 5120
  s_add_u32 s5, s5, 962560
  s_add_u32 s5, s5, s44
  buffer_load_dwordx4 v32, s[16:19], s5 offen lds
  s_waitcnt vmcnt(16)
  s_barrier
  v_add_u32 v28, 65536, v36
  ds_read_b64_tr_b16 a[64:65], v28 offset:0
  v_add_u32 v28, 65536, v36
  ds_read_b64_tr_b16 a[66:67], v28 offset:4096
  v_add_u32 v28, 65536, v36
  ds_read_b64_tr_b16 a[68:69], v28 offset:32
  v_add_u32 v28, 65536, v36
  ds_read_b64_tr_b16 a[70:71], v28 offset:4128
  v_add_u32 v28, 65536, v36
  ds_read_b64_tr_b16 a[72:73], v28 offset:8192
  v_add_u32 v28, 65536, v36
  ds_read_b64_tr_b16 a[74:75], v28 offset:12288
  v_add_u32 v28, 65536, v36
  ds_read_b64_tr_b16 a[76:77], v28 offset:8224
  v_add_u32 v28, 65536, v36
  ds_read_b64_tr_b16 a[78:79], v28 offset:12320
  v_add_u32 v28, 65536, v36
  ds_read_b64_tr_b16 a[80:81], v28 offset:16384
  v_add_u32 v28, 65536, v36
  ds_read_b64_tr_b16 a[82:83], v28 offset:20480
  v_add_u32 v28, 65536, v36
  ds_read_b64_tr_b16 a[84:85], v28 offset:16416
  v_add_u32 v28, 65536, v36
  ds_read_b64_tr_b16 a[86:87], v28 offset:20512
  s_waitcnt lgkmcnt(0)
  v_add_u32 v28, 65536, v36
  ds_read_b64_tr_b16 a[88:89], v28 offset:24576
  v_add_u32 v28, 65536, v36
  ds_read_b64_tr_b16 a[90:91], v28 offset:28672
  v_add_u32 v28, 65536, v36
  ds_read_b64_tr_b16 a[92:93], v28 offset:24608
  v_add_u32 v28, 65536, v36
  ds_read_b64_tr_b16 a[94:95], v28 offset:28704
  v_add_u32 v28, 65536, v36
  ds_read_b64_tr_b16 a[96:97], v28 offset:32768
  v_add_u32 v28, 65536, v36
  ds_read_b64_tr_b16 a[98:99], v28 offset:36864
  v_add_u32 v28, 65536, v36
  ds_read_b64_tr_b16 a[100:101], v28 offset:32800
  v_add_u32 v28, 65536, v36
  ds_read_b64_tr_b16 a[102:103], v28 offset:36896
  v_add_u32 v28, 65536, v36
  ds_read_b64_tr_b16 a[104:105], v28 offset:40960
  v_add_u32 v28, 65536, v36
  ds_read_b64_tr_b16 a[106:107], v28 offset:45056
  v_add_u32 v28, 65536, v36
  ds_read_b64_tr_b16 a[108:109], v28 offset:40992
  v_add_u32 v28, 65536, v36
  ds_read_b64_tr_b16 a[110:111], v28 offset:45088
  s_waitcnt lgkmcnt(0)
  v_add_u32 v28, 65536, v36
  ds_read_b64_tr_b16 a[112:113], v28 offset:49152
  v_add_u32 v28, 65536, v36
  ds_read_b64_tr_b16 a[114:115], v28 offset:53248
  v_add_u32 v28, 65536, v36
  ds_read_b64_tr_b16 a[116:117], v28 offset:49184
  v_add_u32 v28, 65536, v36
  ds_read_b64_tr_b16 a[118:119], v28 offset:53280
  v_add_u32 v28, 65536, v36
  ds_read_b64_tr_b16 a[120:121], v28 offset:57344
  v_add_u32 v28, 65536, v36
  ds_read_b64_tr_b16 a[122:123], v28 offset:61440
  v_add_u32 v28, 65536, v36
  ds_read_b64_tr_b16 a[124:125], v28 offset:57376
  v_add_u32 v28, 65536, v36
  ds_read_b64_tr_b16 a[126:127], v28 offset:61472
  s_waitcnt lgkmcnt(0)
  s_barrier
  s_lshl_b32 s4, s24, 10
  s_add_u32 s4, s4, 65536
  s_mov_b32 m0, s4
  s_mul_i32 s5, s24, 5120
  s_add_u32 s5, s5, 983040
  s_add_u32 s5, s5, s44
  buffer_load_dwordx4 v32, s[16:19], s5 offen lds
  s_lshl_b32 s4, s24, 10
  s_add_u32 s4, s4, 69632
  s_mov_b32 m0, s4
  s_mul_i32 s5, s24, 5120
  s_add_u32 s5, s5, 1003520
  s_add_u32 s5, s5, s44
  buffer_load_dwordx4 v32, s[16:19], s5 offen lds
  s_lshl_b32 s4, s24, 10
  s_add_u32 s4, s4, 73728
  s_mov_b32 m0, s4
  s_mul_i32 s5, s24, 5120
  s_add_u32 s5, s5, 1024000
  s_add_u32 s5, s5, s44
  buffer_load_dwordx4 v32, s[16:19], s5 offen lds
  s_lshl_b32 s4, s24, 10
  s_add_u32 s4, s4, 77824
  s_mov_b32 m0, s4
  s_mul_i32 s5, s24, 5120
  s_add_u32 s5, s5, 1044480
  s_add_u32 s5, s5, s44
  buffer_load_dwordx4 v32, s[16:19], s5 offen lds
  s_lshl_b32 s4, s24, 10
  s_add_u32 s4, s4, 81920
  s_mov_b32 m0, s4
  s_mul_i32 s5, s24, 5120
  s_add_u32 s5, s5, 1064960
  s_add_u32 s5, s5, s44
  buffer_load_dwordx4 v32, s[16:19], s5 offen lds
  s_lshl_b32 s4, s24, 10
  s_add_u32 s4, s4, 86016
  s_mov_b32 m0, s4
  s_mul_i32 s5, s24, 5120
  s_add_u32 s5, s5, 1085440
  s_add_u32 s5, s5, s44
  buffer_load_dwordx4 v32, s[16:19], s5 offen lds
  s_lshl_b32 s4, s24, 10
  s_add_u32 s4, s4, 90112
  s_mov_b32 m0, s4
  s_mul_i32 s5, s24, 5120
  s_add_u32 s5, s5, 1105920
  s_add_u32 s5, s5, s44
  buffer_load_dwordx4 v32, s[16:19], s5 offen lds
  s_lshl_b32 s4, s24, 10
  s_add_u32 s4, s4, 94208
  s_mov_b32 m0, s4
  s_mul_i32 s5, s24, 5120
  s_add_u32 s5, s5, 1126400
  s_add_u32 s5, s5, s44
  buffer_load_dwordx4 v32, s[16:19], s5 offen lds
  s_lshl_b32 s4, s24, 10
  s_add_u32 s4, s4, 98304
  s_mov_b32 m0, s4
  s_mul_i32 s5, s24, 5120
  s_add_u32 s5, s5, 1146880
  s_add_u32 s5, s5, s44
  buffer_load_dwordx4 v32, s[16:19], s5 offen lds
  s_lshl_b32 s4, s24, 10
  s_add_u32 s4, s4, 102400
  s_mov_b32 m0, s4
  s_mul_i32 s5, s24, 5120
  s_add_u32 s5, s5, 1167360
  s_add_u32 s5, s5, s44
  buffer_load_dwordx4 v32, s[16:19], s5 offen lds
  s_lshl_b32 s4, s24, 10
  s_add_u32 s4, s4, 106496
  s_mov_b32 m0, s4
  s_mul_i32 s5, s24, 5120
  s_add_u32 s5, s5, 1187840
  s_add_u32 s5, s5, s44
  buffer_load_dwordx4 v32, s[16:19], s5 offen lds
  s_lshl_b32 s4, s24, 10
  s_add_u32 s4, s4, 110592
  s_mov_b32 m0, s4
  s_mul_i32 s5, s24, 5120
  s_add_u32 s5, s5, 1208320
  s_add_u32 s5, s5, s44
  buffer_load_dwordx4 v32, s[16:19], s5 offen lds
  s_lshl_b32 s4, s24, 10
  s_add_u32 s4, s4, 114688
  s_mov_b32 m0, s4
  s_mul_i32 s5, s24, 5120
  s_add_u32 s5, s5, 1228800
  s_add_u32 s5, s5, s44
  buffer_load_dwordx4 v32, s[16:19], s5 offen lds
  s_lshl_b32 s4, s24, 10
  s_add_u32 s4, s4, 118784
  s_mov_b32 m0, s4
  s_mul_i32 s5, s24, 5120
  s_add_u32 s5, s5, 1249280
  s_add_u32 s5, s5, s44
  buffer_load_dwordx4 v32, s[16:19], s5 offen lds
  s_lshl_b32 s4, s24, 10
  s_add_u32 s4, s4, 122880
  s_mov_b32 m0, s4
  s_mul_i32 s5, s24, 5120
  s_add_u32 s5, s5, 1269760
  s_add_u32 s5, s5, s44
  buffer_load_dwordx4 v32, s[16:19], s5 offen lds
  s_lshl_b32 s4, s24, 10
  s_add_u32 s4, s4, 126976
  s_mov_b32 m0, s4
  s_mul_i32 s5, s24, 5120
  s_add_u32 s5, s5, 1290240
  s_add_u32 s5, s5, s44
  buffer_load_dwordx4 v32, s[16:19], s5 offen lds
  s_waitcnt vmcnt(16)
  s_barrier
  ds_read_b64_tr_b16 a[128:129], v36 offset:0
  ds_read_b64_tr_b16 a[130:131], v36 offset:4096
  ds_read_b64_tr_b16 a[132:133], v36 offset:32
  ds_read_b64_tr_b16 a[134:135], v36 offset:4128
  ds_read_b64_tr_b16 a[136:137], v36 offset:8192
  ds_read_b64_tr_b16 a[138:139], v36 offset:12288
  ds_read_b64_tr_b16 a[140:141], v36 offset:8224
  ds_read_b64_tr_b16 a[142:143], v36 offset:12320
  ds_read_b64_tr_b16 a[144:145], v36 offset:16384
  ds_read_b64_tr_b16 a[146:147], v36 offset:20480
  ds_read_b64_tr_b16 a[148:149], v36 offset:16416
  ds_read_b64_tr_b16 a[150:151], v36 offset:20512
  s_waitcnt lgkmcnt(0)
  ds_read_b64_tr_b16 a[152:153], v36 offset:24576
  ds_read_b64_tr_b16 a[154:155], v36 offset:28672
  ds_read_b64_tr_b16 a[156:157], v36 offset:24608
  ds_read_b64_tr_b16 a[158:159], v36 offset:28704
  ds_read_b64_tr_b16 a[160:161], v36 offset:32768
  ds_read_b64_tr_b16 a[162:163], v36 offset:36864
  ds_read_b64_tr_b16 a[164:165], v36 offset:32800
  ds_read_b64_tr_b16 a[166:167], v36 offset:36896
  ds_read_b64_tr_b16 a[168:169], v36 offset:40960
  ds_read_b64_tr_b16 a[170:171], v36 offset:45056
  ds_read_b64_tr_b16 a[172:173], v36 offset:40992
  ds_read_b64_tr_b16 a[174:175], v36 offset:45088
  s_waitcnt lgkmcnt(0)
  ds_read_b64_tr_b16 a[176:177], v36 offset:49152
  ds_read_b64_tr_b16 a[178:179], v36 offset:53248
  ds_read_b64_tr_b16 a[180:181], v36 offset:49184
  ds_read_b64_tr_b16 a[182:183], v36 offset:53280
  ds_read_b64_tr_b16 a[184:185], v36 offset:57344
  ds_read_b64_tr_b16 a[186:187], v36 offset:61440
  ds_read_b64_tr_b16 a[188:189], v36 offset:57376
  ds_read_b64_tr_b16 a[190:191], v36 offset:61472
  s_waitcnt lgkmcnt(0)
  s_barrier
  s_lshl_b32 s4, s24, 10
  s_add_u32 s4, s4, 0
  s_mov_b32 m0, s4
  s_mul_i32 s5, s24, 5120
  s_add_u32 s5, s5, 1310720
  s_add_u32 s5, s5, s44
  buffer_load_dwordx4 v32, s[16:19], s5 offen lds
  s_lshl_b32 s4, s24, 10
  s_add_u32 s4, s4, 4096
  s_mov_b32 m0, s4
  s_mul_i32 s5, s24, 5120
  s_add_u32 s5, s5, 1331200
  s_add_u32 s5, s5, s44
  buffer_load_dwordx4 v32, s[16:19], s5 offen lds
  s_lshl_b32 s4, s24, 10
  s_add_u32 s4, s4, 8192
  s_mov_b32 m0, s4
  s_mul_i32 s5, s24, 5120
  s_add_u32 s5, s5, 1351680
  s_add_u32 s5, s5, s44
  buffer_load_dwordx4 v32, s[16:19], s5 offen lds
  s_lshl_b32 s4, s24, 10
  s_add_u32 s4, s4, 12288
  s_mov_b32 m0, s4
  s_mul_i32 s5, s24, 5120
  s_add_u32 s5, s5, 1372160
  s_add_u32 s5, s5, s44
  buffer_load_dwordx4 v32, s[16:19], s5 offen lds
  s_lshl_b32 s4, s24, 10
  s_add_u32 s4, s4, 16384
  s_mov_b32 m0, s4
  s_mul_i32 s5, s24, 5120
  s_add_u32 s5, s5, 1392640
  s_add_u32 s5, s5, s44
  buffer_load_dwordx4 v32, s[16:19], s5 offen lds
  s_lshl_b32 s4, s24, 10
  s_add_u32 s4, s4, 20480
  s_mov_b32 m0, s4
  s_mul_i32 s5, s24, 5120
  s_add_u32 s5, s5, 1413120
  s_add_u32 s5, s5, s44
  buffer_load_dwordx4 v32, s[16:19], s5 offen lds
  s_lshl_b32 s4, s24, 10
  s_add_u32 s4, s4, 24576
  s_mov_b32 m0, s4
  s_mul_i32 s5, s24, 5120
  s_add_u32 s5, s5, 1433600
  s_add_u32 s5, s5, s44
  buffer_load_dwordx4 v32, s[16:19], s5 offen lds
  s_lshl_b32 s4, s24, 10
  s_add_u32 s4, s4, 28672
  s_mov_b32 m0, s4
  s_mul_i32 s5, s24, 5120
  s_add_u32 s5, s5, 1454080
  s_add_u32 s5, s5, s44
  buffer_load_dwordx4 v32, s[16:19], s5 offen lds
  s_lshl_b32 s4, s24, 10
  s_add_u32 s4, s4, 32768
  s_mov_b32 m0, s4
  s_mul_i32 s5, s24, 5120
  s_add_u32 s5, s5, 1474560
  s_add_u32 s5, s5, s44
  buffer_load_dwordx4 v32, s[16:19], s5 offen lds
  s_lshl_b32 s4, s24, 10
  s_add_u32 s4, s4, 36864
  s_mov_b32 m0, s4
  s_mul_i32 s5, s24, 5120
  s_add_u32 s5, s5, 1495040
  s_add_u32 s5, s5, s44
  buffer_load_dwordx4 v32, s[16:19], s5 offen lds
  s_lshl_b32 s4, s24, 10
  s_add_u32 s4, s4, 40960
  s_mov_b32 m0, s4
  s_mul_i32 s5, s24, 5120
  s_add_u32 s5, s5, 1515520
  s_add_u32 s5, s5, s44
  buffer_load_dwordx4 v32, s[16:19], s5 offen lds
  s_lshl_b32 s4, s24, 10
  s_add_u32 s4, s4, 45056
  s_mov_b32 m0, s4
  s_mul_i32 s5, s24, 5120
  s_add_u32 s5, s5, 1536000
  s_add_u32 s5, s5, s44
  buffer_load_dwordx4 v32, s[16:19], s5 offen lds
  s_lshl_b32 s4, s24, 10
  s_add_u32 s4, s4, 49152
  s_mov_b32 m0, s4
  s_mul_i32 s5, s24, 5120
  s_add_u32 s5, s5, 1556480
  s_add_u32 s5, s5, s44
  buffer_load_dwordx4 v32, s[16:19], s5 offen lds
  s_lshl_b32 s4, s24, 10
  s_add_u32 s4, s4, 53248
  s_mov_b32 m0, s4
  s_mul_i32 s5, s24, 5120
  s_add_u32 s5, s5, 1576960
  s_add_u32 s5, s5, s44
  buffer_load_dwordx4 v32, s[16:19], s5 offen lds
  s_lshl_b32 s4, s24, 10
  s_add_u32 s4, s4, 57344
  s_mov_b32 m0, s4
  s_mul_i32 s5, s24, 5120
  s_add_u32 s5, s5, 1597440
  s_add_u32 s5, s5, s44
  buffer_load_dwordx4 v32, s[16:19], s5 offen lds
  s_lshl_b32 s4, s24, 10
  s_add_u32 s4, s4, 61440
  s_mov_b32 m0, s4
  s_mul_i32 s5, s24, 5120
  s_add_u32 s5, s5, 1617920
  s_add_u32 s5, s5, s44
  buffer_load_dwordx4 v32, s[16:19], s5 offen lds
  s_waitcnt vmcnt(16)
  s_barrier
  v_add_u32 v28, 65536, v36
  ds_read_b64_tr_b16 a[192:193], v28 offset:0
  v_add_u32 v28, 65536, v36
  ds_read_b64_tr_b16 a[194:195], v28 offset:4096
  v_add_u32 v28, 65536, v36
  ds_read_b64_tr_b16 a[196:197], v28 offset:32
  v_add_u32 v28, 65536, v36
  ds_read_b64_tr_b16 a[198:199], v28 offset:4128
  v_add_u32 v28, 65536, v36
  ds_read_b64_tr_b16 a[200:201], v28 offset:8192
  v_add_u32 v28, 65536, v36
  ds_read_b64_tr_b16 a[202:203], v28 offset:12288
  v_add_u32 v28, 65536, v36
  ds_read_b64_tr_b16 a[204:205], v28 offset:8224
  v_add_u32 v28, 65536, v36
  ds_read_b64_tr_b16 a[206:207], v28 offset:12320
  v_add_u32 v28, 65536, v36
  ds_read_b64_tr_b16 a[208:209], v28 offset:16384
  v_add_u32 v28, 65536, v36
  ds_read_b64_tr_b16 a[210:211], v28 offset:20480
  v_add_u32 v28, 65536, v36
  ds_read_b64_tr_b16 a[212:213], v28 offset:16416
  v_add_u32 v28, 65536, v36
  ds_read_b64_tr_b16 a[214:215], v28 offset:20512
  s_waitcnt lgkmcnt(0)
  v_add_u32 v28, 65536, v36
  ds_read_b64_tr_b16 a[216:217], v28 offset:24576
  v_add_u32 v28, 65536, v36
  ds_read_b64_tr_b16 a[218:219], v28 offset:28672
  v_add_u32 v28, 65536, v36
  ds_read_b64_tr_b16 a[220:221], v28 offset:24608
  v_add_u32 v28, 65536, v36
  ds_read_b64_tr_b16 a[222:223], v28 offset:28704
  v_add_u32 v28, 65536, v36
  ds_read_b64_tr_b16 a[224:225], v28 offset:32768
  v_add_u32 v28, 65536, v36
  ds_read_b64_tr_b16 a[226:227], v28 offset:36864
  v_add_u32 v28, 65536, v36
  ds_read_b64_tr_b16 a[228:229], v28 offset:32800
  v_add_u32 v28, 65536, v36
  ds_read_b64_tr_b16 a[230:231], v28 offset:36896
  v_add_u32 v28, 65536, v36
  ds_read_b64_tr_b16 a[232:233], v28 offset:40960
  v_add_u32 v28, 65536, v36
  ds_read_b64_tr_b16 a[234:235], v28 offset:45056
  v_add_u32 v28, 65536, v36
  ds_read_b64_tr_b16 a[236:237], v28 offset:40992
  v_add_u32 v28, 65536, v36
  ds_read_b64_tr_b16 a[238:239], v28 offset:45088
  s_waitcnt lgkmcnt(0)
  v_add_u32 v28, 65536, v36
  ds_read_b64_tr_b16 a[240:241], v28 offset:49152
  v_add_u32 v28, 65536, v36
  ds_read_b64_tr_b16 a[242:243], v28 offset:53248
  v_add_u32 v28, 65536, v36
  ds_read_b64_tr_b16 a[244:245], v28 offset:49184
  v_add_u32 v28, 65536, v36
  ds_read_b64_tr_b16 a[246:247], v28 offset:53280
  v_add_u32 v28, 65536, v36
  ds_read_b64_tr_b16 a[248:249], v28 offset:57344
  v_add_u32 v28, 65536, v36
  ds_read_b64_tr_b16 a[250:251], v28 offset:61440
  v_add_u32 v28, 65536, v36
  ds_read_b64_tr_b16 a[252:253], v28 offset:57376
  v_add_u32 v28, 65536, v36
  ds_read_b64_tr_b16 a[254:255], v28 offset:61472
  s_waitcnt lgkmcnt(0)
  s_barrier
  s_lshl_b32 s4, s24, 10
  s_add_u32 s4, s4, 65536
  s_mov_b32 m0, s4
  s_mul_i32 s5, s24, 5120
  s_add_u32 s5, s5, 1638400
  s_add_u32 s5, s5, s44
  buffer_load_dwordx4 v32, s[16:19], s5 offen lds
  s_lshl_b32 s4, s24, 10
  s_add_u32 s4, s4, 69632
  s_mov_b32 m0, s4
  s_mul_i32 s5, s24, 5120
  s_add_u32 s5, s5, 1658880
  s_add_u32 s5, s5, s44
  buffer_load_dwordx4 v32, s[16:19], s5 offen lds
  s_lshl_b32 s4, s24, 10
  s_add_u32 s4, s4, 73728
  s_mov_b32 m0, s4
  s_mul_i32 s5, s24, 5120
  s_add_u32 s5, s5, 1679360
  s_add_u32 s5, s5, s44
  buffer_load_dwordx4 v32, s[16:19], s5 offen lds
  s_lshl_b32 s4, s24, 10
  s_add_u32 s4, s4, 77824
  s_mov_b32 m0, s4
  s_mul_i32 s5, s24, 5120
  s_add_u32 s5, s5, 1699840
  s_add_u32 s5, s5, s44
  buffer_load_dwordx4 v32, s[16:19], s5 offen lds
  s_lshl_b32 s4, s24, 10
  s_add_u32 s4, s4, 81920
  s_mov_b32 m0, s4
  s_mul_i32 s5, s24, 5120
  s_add_u32 s5, s5, 1720320
  s_add_u32 s5, s5, s44
  buffer_load_dwordx4 v32, s[16:19], s5 offen lds
  s_lshl_b32 s4, s24, 10
  s_add_u32 s4, s4, 86016
  s_mov_b32 m0, s4
  s_mul_i32 s5, s24, 5120
  s_add_u32 s5, s5, 1740800
  s_add_u32 s5, s5, s44
  buffer_load_dwordx4 v32, s[16:19], s5 offen lds
  s_lshl_b32 s4, s24, 10
  s_add_u32 s4, s4, 90112
  s_mov_b32 m0, s4
  s_mul_i32 s5, s24, 5120
  s_add_u32 s5, s5, 1761280
  s_add_u32 s5, s5, s44
  buffer_load_dwordx4 v32, s[16:19], s5 offen lds
  s_lshl_b32 s4, s24, 10
  s_add_u32 s4, s4, 94208
  s_mov_b32 m0, s4
  s_mul_i32 s5, s24, 5120
  s_add_u32 s5, s5, 1781760
  s_add_u32 s5, s5, s44
  buffer_load_dwordx4 v32, s[16:19], s5 offen lds
  s_lshl_b32 s4, s24, 10
  s_add_u32 s4, s4, 98304
  s_mov_b32 m0, s4
  s_mul_i32 s5, s24, 5120
  s_add_u32 s5, s5, 1802240
  s_add_u32 s5, s5, s44
  buffer_load_dwordx4 v32, s[16:19], s5 offen lds
  s_lshl_b32 s4, s24, 10
  s_add_u32 s4, s4, 102400
  s_mov_b32 m0, s4
  s_mul_i32 s5, s24, 5120
  s_add_u32 s5, s5, 1822720
  s_add_u32 s5, s5, s44
  buffer_load_dwordx4 v32, s[16:19], s5 offen lds
  s_lshl_b32 s4, s24, 10
  s_add_u32 s4, s4, 106496
  s_mov_b32 m0, s4
  s_mul_i32 s5, s24, 5120
  s_add_u32 s5, s5, 1843200
  s_add_u32 s5, s5, s44
  buffer_load_dwordx4 v32, s[16:19], s5 offen lds
  s_lshl_b32 s4, s24, 10
  s_add_u32 s4, s4, 110592
  s_mov_b32 m0, s4
  s_mul_i32 s5, s24, 5120
  s_add_u32 s5, s5, 1863680
  s_add_u32 s5, s5, s44
  buffer_load_dwordx4 v32, s[16:19], s5 offen lds
  s_lshl_b32 s4, s24, 10
  s_add_u32 s4, s4, 114688
  s_mov_b32 m0, s4
  s_mul_i32 s5, s24, 5120
  s_add_u32 s5, s5, 1884160
  s_add_u32 s5, s5, s44
  buffer_load_dwordx4 v32, s[16:19], s5 offen lds
  s_lshl_b32 s4, s24, 10
  s_add_u32 s4, s4, 118784
  s_mov_b32 m0, s4
  s_mul_i32 s5, s24, 5120
  s_add_u32 s5, s5, 1904640
  s_add_u32 s5, s5, s44
  buffer_load_dwordx4 v32, s[16:19], s5 offen lds
  s_lshl_b32 s4, s24, 10
  s_add_u32 s4, s4, 122880
  s_mov_b32 m0, s4
  s_mul_i32 s5, s24, 5120
  s_add_u32 s5, s5, 1925120
  s_add_u32 s5, s5, s44
  buffer_load_dwordx4 v32, s[16:19], s5 offen lds
  s_lshl_b32 s4, s24, 10
  s_add_u32 s4, s4, 126976
  s_mov_b32 m0, s4
  s_mul_i32 s5, s24, 5120
  s_add_u32 s5, s5, 1945600
  s_add_u32 s5, s5, s44
  buffer_load_dwordx4 v32, s[16:19], s5 offen lds
  s_waitcnt vmcnt(16)
  s_barrier
  ds_read_b64_tr_b16 v[128:129], v36 offset:0
  ds_read_b64_tr_b16 v[130:131], v36 offset:4096
  ds_read_b64_tr_b16 v[132:133], v36 offset:32
  ds_read_b64_tr_b16 v[134:135], v36 offset:4128
  ds_read_b64_tr_b16 v[136:137], v36 offset:8192
  ds_read_b64_tr_b16 v[138:139], v36 offset:12288
  ds_read_b64_tr_b16 v[140:141], v36 offset:8224
  ds_read_b64_tr_b16 v[142:143], v36 offset:12320
  ds_read_b64_tr_b16 v[144:145], v36 offset:16384
  ds_read_b64_tr_b16 v[146:147], v36 offset:20480
  ds_read_b64_tr_b16 v[148:149], v36 offset:16416
  ds_read_b64_tr_b16 v[150:151], v36 offset:20512
  s_waitcnt lgkmcnt(0)
  ds_read_b64_tr_b16 v[152:153], v36 offset:24576
  ds_read_b64_tr_b16 v[154:155], v36 offset:28672
  ds_read_b64_tr_b16 v[156:157], v36 offset:24608
  ds_read_b64_tr_b16 v[158:159], v36 offset:28704
  ds_read_b64_tr_b16 v[160:161], v36 offset:32768
  ds_read_b64_tr_b16 v[162:163], v36 offset:36864
  ds_read_b64_tr_b16 v[164:165], v36 offset:32800
  ds_read_b64_tr_b16 v[166:167], v36 offset:36896
  ds_read_b64_tr_b16 v[168:169], v36 offset:40960
  ds_read_b64_tr_b16 v[170:171], v36 offset:45056
  ds_read_b64_tr_b16 v[172:173], v36 offset:40992
  ds_read_b64_tr_b16 v[174:175], v36 offset:45088
  s_waitcnt lgkmcnt(0)
  ds_read_b64_tr_b16 v[176:177], v36 offset:49152
  ds_read_b64_tr_b16 v[178:179], v36 offset:53248
  ds_read_b64_tr_b16 v[180:181], v36 offset:49184
  ds_read_b64_tr_b16 v[182:183], v36 offset:53280
  ds_read_b64_tr_b16 v[184:185], v36 offset:57344
  ds_read_b64_tr_b16 v[186:187], v36 offset:61440
  ds_read_b64_tr_b16 v[188:189], v36 offset:57376
  ds_read_b64_tr_b16 v[190:191], v36 offset:61472
  s_waitcnt lgkmcnt(0)
  s_barrier
  s_waitcnt vmcnt(0)
  s_barrier
  v_add_u32 v28, 65536, v36
  ds_read_b64_tr_b16 v[192:193], v28 offset:0
  v_add_u32 v28, 65536, v36
  ds_read_b64_tr_b16 v[194:195], v28 offset:4096
  v_add_u32 v28, 65536, v36
  ds_read_b64_tr_b16 v[196:197], v28 offset:32
  v_add_u32 v28, 65536, v36
  ds_read_b64_tr_b16 v[198:199], v28 offset:4128
  v_add_u32 v28, 65536, v36
  ds_read_b64_tr_b16 v[200:201], v28 offset:8192
  v_add_u32 v28, 65536, v36
  ds_read_b64_tr_b16 v[202:203], v28 offset:12288
  v_add_u32 v28, 65536, v36
  ds_read_b64_tr_b16 v[204:205], v28 offset:8224
  v_add_u32 v28, 65536, v36
  ds_read_b64_tr_b16 v[206:207], v28 offset:12320
  v_add_u32 v28, 65536, v36
  ds_read_b64_tr_b16 v[208:209], v28 offset:16384
  v_add_u32 v28, 65536, v36
  ds_read_b64_tr_b16 v[210:211], v28 offset:20480
  v_add_u32 v28, 65536, v36
  ds_read_b64_tr_b16 v[212:213], v28 offset:16416
  v_add_u32 v28, 65536, v36
  ds_read_b64_tr_b16 v[214:215], v28 offset:20512
  s_waitcnt lgkmcnt(0)
  v_add_u32 v28, 65536, v36
  ds_read_b64_tr_b16 v[216:217], v28 offset:24576
  v_add_u32 v28, 65536, v36
  ds_read_b64_tr_b16 v[218:219], v28 offset:28672
  v_add_u32 v28, 65536, v36
  ds_read_b64_tr_b16 v[220:221], v28 offset:24608
  v_add_u32 v28, 65536, v36
  ds_read_b64_tr_b16 v[222:223], v28 offset:28704
  v_add_u32 v28, 65536, v36
  ds_read_b64_tr_b16 v[224:225], v28 offset:32768
  v_add_u32 v28, 65536, v36
  ds_read_b64_tr_b16 v[226:227], v28 offset:36864
  v_add_u32 v28, 65536, v36
  ds_read_b64_tr_b16 v[228:229], v28 offset:32800
  v_add_u32 v28, 65536, v36
  ds_read_b64_tr_b16 v[230:231], v28 offset:36896
  v_add_u32 v28, 65536, v36
  ds_read_b64_tr_b16 v[232:233], v28 offset:40960
  v_add_u32 v28, 65536, v36
  ds_read_b64_tr_b16 v[234:235], v28 offset:45056
  v_add_u32 v28, 65536, v36
  ds_read_b64_tr_b16 v[236:237], v28 offset:40992
  v_add_u32 v28, 65536, v36
  ds_read_b64_tr_b16 v[238:239], v28 offset:45088
  s_waitcnt lgkmcnt(0)
  v_add_u32 v28, 65536, v36
  ds_read_b64_tr_b16 v[240:241], v28 offset:49152
  v_add_u32 v28, 65536, v36
  ds_read_b64_tr_b16 v[242:243], v28 offset:53248
  v_add_u32 v28, 65536, v36
  ds_read_b64_tr_b16 v[244:245], v28 offset:49184
  v_add_u32 v28, 65536, v36
  ds_read_b64_tr_b16 v[246:247], v28 offset:53280
  v_add_u32 v28, 65536, v36
  ds_read_b64_tr_b16 v[248:249], v28 offset:57344
  v_add_u32 v28, 65536, v36
  ds_read_b64_tr_b16 v[250:251], v28 offset:61440
  v_add_u32 v28, 65536, v36
  ds_read_b64_tr_b16 v[252:253], v28 offset:57376
  v_add_u32 v28, 65536, v36
  ds_read_b64_tr_b16 v[254:255], v28 offset:61472
  s_waitcnt lgkmcnt(0)
  s_barrier
  s_cmp_eq_u32 s24, 0
  s_cbranch_scc0 L_wd_iwC
  s_mov_b32 s28, 131072
  s_mov_b32 s29, 2
  v_mov_b32 v18, 36
L_wn_iwC:
  buffer_load_dword v19, v18, s[12:15], 0 offen sc1
  s_waitcnt vmcnt(0)
  v_readfirstlane_b32 s3, v19
  s_sub_u32 s28, s28, 1
  s_cbranch_scc1 L_abort
  s_cmp_ge_u32 s3, 256
  s_cbranch_scc1 L_wd_iwC
  s_sleep 8
  s_branch L_wn_iwC
L_wd_iwC:
  s_barrier
  s_load_dwordx2 s[20:21], s[0:1], 0
  s_waitcnt lgkmcnt(0)
  s_and_b32 s21, s21, 0xffff
  s_mov_b32 s22, 2621440
  s_mov_b32 s23, 0x20000
  s_lshl_b32 s46, s37, 2
  s_add_u32 s46, s46, s24
  s_lshl_b32 s46, s46, 6
  v_mul_u32_u24 v25, 1280, v22
  v_lshlrev_b32 v28, 3, v21
  v_add_u32 v25, v25, v28
  s_lshl_b32 s4, s36, 9
  v_bfe_u32 v28, v0, 1, 2
  v_lshlrev_b32 v28, 7, v28
  v_and_b32 v29, 1, v0
  v_lshlrev_b32 v29, 3, v29
  v_add_u32 v28, v28, v29
  v_bfe_u32 v29, v0, 3, 1
  v_lshlrev_b32 v29, 2, v29
  v_add_u32 v28, v28, v29
  v_add_u32 v28, s4, v28
  v_add_u32 v23, 69632, v28
  s_mov_b32 s43, 0
  s_mul_i32 s38, s36, 49152
  s_mov_b32 s31, 0
  s_mov_b32 s33, 0
  s_mov_b32 s34, 0
L_C_top:
  s_lshr_b32 s57, s31, 1
  s_lshl_b32 s56, s57, 1
  s_sub_u32 s58, s56, 40
  s_cmp_lt_u32 s57, 40
  s_cselect_b32 s58, s57, s58
  s_add_u32 s56, s56, 41
  s_cmp_eq_u32 s53, 1
  s_cselect_b32 s58, s56, s58
  s_lshl_b32 s58, s58, 1
  s_and_b32 s57, s31, 1
  s_add_u32 s54, s58, s57
  s_cmp_eq_u32 s33, 1
  s_cbranch_scc1 L_C_pref
  s_mov_b32 s28, 131072
  s_mov_b32 s29, 60
L_C_poll:
  buffer_load_dword v28, v23, s[8:11], 0 offen sc1
  s_sub_u32 s28, s28, 1
  s_cbranch_scc1 L_abort
  s_waitcnt vmcnt(0)
  s_cmp_eq_u32 s34, 0
  s_cbranch_scc1 L_C_npa
  s_mov_b64 exec, 1
  v_mov_b32 v29, s34
  v_mov_b32 v30, 0
  buffer_store_dword v29, v30, s[8:11], s35 offen sc1
  s_mov_b64 exec, -1
  s_mov_b32 s34, 0
L_C_npa:
  s_lshr_b32 s57, s31, 1
  s_lshl_b32 s56, s57, 1
  s_sub_u32 s47, s56, 40
  s_cmp_lt_u32 s57, 40
  s_cselect_b32 s47, s57, s47
  s_add_u32 s56, s56, 41
  s_cmp_eq_u32 s53, 1
  s_cselect_b32 s47, s56, s47
  s_add_u32 s41, s47, 1
  s_and_b32 s47, s47, 1
  s_lshl_b32 s47, s47, 3
  s_lshl_b32 s42, 0xff, s47
  v_cmp_gt_u32 vcc, s41, v28
  s_and_b64 vcc, vcc, s[42:43]
  s_cmp_eq_u64 vcc, 0
  s_cbranch_scc0 L_C_poll
  s_lshr_b32 s57, s31, 1
  s_lshl_b32 s56, s57, 1
  s_sub_u32 s58, s56, 40
  s_cmp_lt_u32 s57, 40
  s_cselect_b32 s58, s57, s58
  s_add_u32 s56, s56, 41
  s_cmp_eq_u32 s53, 1
  s_cselect_b32 s58, s56, s58
  s_lshl_b32 s58, s58, 1
  s_and_b32 s57, s31, 1
  s_add_u32 s59, s58, s57
  s_mul_i32 s32, s59, 196608
  s_add_u32 s32, s32, s38
  s_add_u32 s32, s32, 108941312
  s_lshl_b32 s4, s24, 10
  s_add_u32 s32, s32, s4
  s_and_b32 s50, s31, 1
  s_mul_i32 s50, s50, 49152
  s_add_u32 s50, s50, s4
  s_add_u32 m0, s50, 0
  s_add_u32 s5, s32, 0
  buffer_load_dwordx4 v20, s[8:11], s5 offen sc1 lds
  s_add_u32 m0, s50, 4096
  s_add_u32 s5, s32, 4096
  buffer_load_dwordx4 v20, s[8:11], s5 offen sc1 lds
  s_add_u32 m0, s50, 8192
  s_add_u32 s5, s32, 8192
  buffer_load_dwordx4 v20, s[8:11], s5 offen sc1 lds
  s_add_u32 m0, s50, 12288
  s_add_u32 s5, s32, 12288
  buffer_load_dwordx4 v20, s[8:11], s5 offen sc1 lds
  s_add_u32 m0, s50, 16384
  s_add_u32 s5, s32, 16384
  buffer_load_dwordx4 v20, s[8:11], s5 offen sc1 lds
  s_add_u32 m0, s50, 20480
  s_add_u32 s5, s32, 20480
  buffer_load_dwordx4 v20, s[8:11], s5 offen sc1 lds
  s_add_u32 m0, s50, 24576
  s_add_u32 s5, s32, 24576
  buffer_load_dwordx4 v20, s[8:11], s5 offen sc1 lds
  s_add_u32 m0, s50, 28672
  s_add_u32 s5, s32, 28672
  buffer_load_dwordx4 v20, s[8:11], s5 offen sc1 lds
  s_add_u32 m0, s50, 32768
  s_add_u32 s5, s32, 32768
  buffer_load_dwordx4 v20, s[8:11], s5 offen sc1 lds
  s_add_u32 m0, s50, 36864
  s_add_u32 s5, s32, 36864
  buffer_load_dwordx4 v20, s[8:11], s5 offen sc1 lds
  s_add_u32 m0, s50, 40960
  s_add_u32 s5, s32, 40960
  buffer_load_dwordx4 v20, s[8:11], s5 offen sc1 lds
  s_add_u32 m0, s50, 45056
  s_add_u32 s5, s32, 45056
  buffer_load_dwordx4 v20, s[8:11], s5 offen sc1 lds
  s_mov_b32 s51, 1
  s_branch L_C_go
L_C_pref:
  s_waitcnt vmcnt(10)
  s_mov_b32 s51, 0
L_C_go:
  s_and_b32 s6, s31, 1
  s_mul_i32 s6, s6, 49152
  v_add_u32 v24, s6, v20
  s_mov_b32 s33, 0
  s_add_u32 s7, s31, 1
  s_cmp_ge_u32 s7, s52
  s_cbranch_scc1 L_C_cB
  s_lshr_b32 s57, s7, 1
  s_lshl_b32 s56, s57, 1
  s_sub_u32 s47, s56, 40
  s_cmp_lt_u32 s57, 40
  s_cselect_b32 s47, s57, s47
  s_add_u32 s56, s56, 41
  s_cmp_eq_u32 s53, 1
  s_cselect_b32 s47, s56, s47
  s_add_u32 s41, s47, 1
  s_and_b32 s47, s47, 1
  s_lshl_b32 s47, s47, 3
  s_lshl_b32 s42, 0xff, s47
  v_cmp_gt_u32 vcc, s41, v28
  s_and_b64 vcc, vcc, s[42:43]
  s_cmp_eq_u64 vcc, 0
  s_cbranch_scc0 L_C_cB
  s_mov_b32 s33, 1
  s_lshr_b32 s57, s7, 1
  s_lshl_b32 s56, s57, 1
  s_sub_u32 s58, s56, 40
  s_cmp_lt_u32 s57, 40
  s_cselect_b32 s58, s57, s58
  s_add_u32 s56, s56, 41
  s_cmp_eq_u32 s53, 1
  s_cselect_b32 s58, s56, s58
  s_lshl_b32 s58, s58, 1
  s_and_b32 s57, s7, 1
  s_add_u32 s59, s58, s57
  s_mul_i32 s32, s59, 196608
  s_add_u32 s32, s32, s38
  s_add_u32 s32, s32, 108941312
  s_lshl_b32 s4, s24, 10
  s_add_u32 s32, s32, s4
  s_and_b32 s50, s7, 1
  s_mul_i32 s50, s50, 49152
  s_add_u32 s50, s50, s4
  s_cmp_eq_u32 s51, 1
  s_cbranch_scc1 L_C_cAc
  s_mul_i32 s4, s54, 20480
  s_add_u32 s4, s4, s46
  buffer_load_dwordx2 v[92:93], v25, s[20:23], s4 offen
  buffer_load_dwordx2 v[94:95], v25, s[20:23], s4 offen offset:32
  s_waitcnt vmcnt(13)
  s_barrier
  ds_read_b128 v[72:75], v24 offset:0
  ds_read_b128 v[76:79], v24 offset:1024
  ds_read_b128 v[80:83], v24 offset:2048
  ds_read_b128 v[84:87], v24 offset:3072
  s_waitcnt lgkmcnt(3)
  v_mfma_f32_16x16x32_bf16 v[64:67], a[0:3], v[72:75], 0
  v_mfma_f32_16x16x32_bf16 v[68:71], a[4:7], v[72:75], 0
  ds_read_b128 v[72:75], v24 offset:4096
  s_waitcnt lgkmcnt(3)
  v_mfma_f32_16x16x32_bf16 v[64:67], a[8:11], v[76:79], v[64:67]
  s_add_u32 m0, s50, 0
  s_add_u32 s5, s32, 0
  buffer_load_dwordx4 v20, s[8:11], s5 offen sc1 lds
  v_mfma_f32_16x16x32_bf16 v[68:71], a[12:15], v[76:79], v[68:71]
  ds_read_b128 v[76:79], v24 offset:5120
  s_waitcnt lgkmcnt(3)
  v_mfma_f32_16x16x32_bf16 v[64:67], a[16:19], v[80:83], v[64:67]
  v_mfma_f32_16x16x32_bf16 v[68:71], a[20:23], v[80:83], v[68:71]
  ds_read_b128 v[80:83], v24 offset:6144
  s_waitcnt lgkmcnt(3)
  v_mfma_f32_16x16x32_bf16 v[64:67], a[24:27], v[84:87], v[64:67]
  v_mfma_f32_16x16x32_bf16 v[68:71], a[28:31], v[84:87], v[68:71]
  ds_read_b128 v[84:87], v24 offset:7168
  s_waitcnt lgkmcnt(3)
  v_mfma_f32_16x16x32_bf16 v[64:67], a[32:35], v[72:75], v[64:67]
  v_mfma_f32_16x16x32_bf16 v[68:71], a[36:39], v[72:75], v[68:71]
  ds_read_b128 v[72:75], v24 offset:8192
  s_waitcnt lgkmcnt(3)
  v_mfma_f32_16x16x32_bf16 v[64:67], a[40:43], v[76:79], v[64:67]
  s_add_u32 m0, s50, 4096
  s_add_u32 s5, s32, 4096
  buffer_load_dwordx4 v20, s[8:11], s5 offen sc1 lds
  v_mfma_f32_16x16x32_bf16 v[68:71], a[44:47], v[76:79], v[68:71]
  ds_read_b128 v[76:79], v24 offset:9216
  s_waitcnt lgkmcnt(3)
  v_mfma_f32_16x16x32_bf16 v[64:67], a[48:51], v[80:83], v[64:67]
  v_mfma_f32_16x16x32_bf16 v[68:71], a[52:55], v[80:83], v[68:71]
  ds_read_b128 v[80:83], v24 offset:10240
  s_waitcnt lgkmcnt(3)
  v_mfma_f32_16x16x32_bf16 v[64:67], a[56:59], v[84:87], v[64:67]
  v_mfma_f32_16x16x32_bf16 v[68:71], a[60:63], v[84:87], v[68:71]
  ds_read_b128 v[84:87], v24 offset:11264
  s_waitcnt lgkmcnt(3)
  v_mfma_f32_16x16x32_bf16 v[64:67], a[64:67], v[72:75], v[64:67]
  v_mfma_f32_16x16x32_bf16 v[68:71], a[68:71], v[72:75], v[68:71]
  ds_read_b128 v[72:75], v24 offset:12288
  s_waitcnt lgkmcnt(3)
  v_mfma_f32_16x16x32_bf16 v[64:67], a[72:75], v[76:79], v[64:67]
  s_add_u32 m0, s50, 8192
  s_add_u32 s5, s32, 8192
  buffer_load_dwordx4 v20, s[8:11], s5 offen sc1 lds
  v_mfma_f32_16x16x32_bf16 v[68:71], a[76:79], v[76:79], v[68:71]
  ds_read_b128 v[76:79], v24 offset:13312
  s_waitcnt lgkmcnt(3)
  v_mfma_f32_16x16x32_bf16 v[64:67], a[80:83], v[80:83], v[64:67]
  v_mfma_f32_16x16x32_bf16 v[68:71], a[84:87], v[80:83], v[68:71]
  ds_read_b128 v[80:83], v24 offset:14336
  s_waitcnt lgkmcnt(3)
  v_mfma_f32_16x16x32_bf16 v[64:67], a[88:91], v[84:87], v[64:67]
  v_mfma_f32_16x16x32_bf16 v[68:71], a[92:95], v[84:87], v[68:71]
  ds_read_b128 v[84:87], v24 offset:15360
  s_waitcnt lgkmcnt(3)
  v_mfma_f32_16x16x32_bf16 v[64:67], a[96:99], v[72:75], v[64:67]
  v_mfma_f32_16x16x32_bf16 v[68:71], a[100:103], v[72:75], v[68:71]
  s_waitcnt vmcnt(11)
  s_barrier
  ds_read_b128 v[72:75], v24 offset:16384
  s_waitcnt lgkmcnt(3)
  v_mfma_f32_16x16x32_bf16 v[64:67], a[104:107], v[76:79], v[64:67]
  s_add_u32 m0, s50, 12288
  s_add_u32 s5, s32, 12288
  buffer_load_dwordx4 v20, s[8:11], s5 offen sc1 lds
  v_mfma_f32_16x16x32_bf16 v[68:71], a[108:111], v[76:79], v[68:71]
  ds_read_b128 v[76:79], v24 offset:17408
  s_waitcnt lgkmcnt(3)
  v_mfma_f32_16x16x32_bf16 v[64:67], a[112:115], v[80:83], v[64:67]
  v_mfma_f32_16x16x32_bf16 v[68:71], a[116:119], v[80:83], v[68:71]
  ds_read_b128 v[80:83], v24 offset:18432
  s_waitcnt lgkmcnt(3)
  v_mfma_f32_16x16x32_bf16 v[64:67], a[120:123], v[84:87], v[64:67]
  v_mfma_f32_16x16x32_bf16 v[68:71], a[124:127], v[84:87], v[68:71]
  ds_read_b128 v[84:87], v24 offset:19456
  s_waitcnt lgkmcnt(3)
  v_mfma_f32_16x16x32_bf16 v[64:67], a[128:131], v[72:75], v[64:67]
  buffer_load_dword v28, v23, s[8:11], 0 offen sc1
  v_mfma_f32_16x16x32_bf16 v[68:71], a[132:135], v[72:75], v[68:71]
  ds_read_b128 v[72:75], v24 offset:20480
  s_waitcnt lgkmcnt(3)
  v_mfma_f32_16x16x32_bf16 v[64:67], a[136:139], v[76:79], v[64:67]
  s_add_u32 m0, s50, 16384
  s_add_u32 s5, s32, 16384
  buffer_load_dwordx4 v20, s[8:11], s5 offen sc1 lds
  v_mfma_f32_16x16x32_bf16 v[68:71], a[140:143], v[76:79], v[68:71]
  ds_read_b128 v[76:79], v24 offset:21504
  s_waitcnt lgkmcnt(3)
  v_mfma_f32_16x16x32_bf16 v[64:67], a[144:147], v[80:83], v[64:67]
  v_mfma_f32_16x16x32_bf16 v[68:71], a[148:151], v[80:83], v[68:71]
  ds_read_b128 v[80:83], v24 offset:22528
  s_waitcnt lgkmcnt(3)
  v_mfma_f32_16x16x32_bf16 v[64:67], a[152:155], v[84:87], v[64:67]
  v_mfma_f32_16x16x32_bf16 v[68:71], a[156:159], v[84:87], v[68:71]
  ds_read_b128 v[84:87], v24 offset:23552
  s_waitcnt lgkmcnt(3)
  v_mfma_f32_16x16x32_bf16 v[64:67], a[160:163], v[72:75], v[64:67]
  v_mfma_f32_16x16x32_bf16 v[68:71], a[164:167], v[72:75], v[68:71]
  ds_read_b128 v[72:75], v24 offset:24576
  s_waitcnt lgkmcnt(3)
  v_mfma_f32_16x16x32_bf16 v[64:67], a[168:171], v[76:79], v[64:67]
  s_add_u32 m0, s50, 20480
  s_add_u32 s5, s32, 20480
  buffer_load_dwordx4 v20, s[8:11], s5 offen sc1 lds
  v_mfma_f32_16x16x32_bf16 v[68:71], a[172:175], v[76:79], v[68:71]
  ds_read_b128 v[76:79], v24 offset:25600
  s_waitcnt lgkmcnt(3)
  v_mfma_f32_16x16x32_bf16 v[64:67], a[176:179], v[80:83], v[64:67]
  v_mfma_f32_16x16x32_bf16 v[68:71], a[180:183], v[80:83], v[68:71]
  ds_read_b128 v[80:83], v24 offset:26624
  s_waitcnt lgkmcnt(3)
  v_mfma_f32_16x16x32_bf16 v[64:67], a[184:187], v[84:87], v[64:67]
  v_mfma_f32_16x16x32_bf16 v[68:71], a[188:191], v[84:87], v[68:71]
  ds_read_b128 v[84:87], v24 offset:27648
  s_waitcnt lgkmcnt(3)
  v_mfma_f32_16x16x32_bf16 v[64:67], a[192:195], v[72:75], v[64:67]
  v_mfma_f32_16x16x32_bf16 v[68:71], a[196:199], v[72:75], v[68:71]
  ds_read_b128 v[72:75], v24 offset:28672
  s_waitcnt lgkmcnt(3)
  v_mfma_f32_16x16x32_bf16 v[64:67], a[200:203], v[76:79], v[64:67]
  s_add_u32 m0, s50, 24576
  s_add_u32 s5, s32, 24576
  buffer_load_dwordx4 v20, s[8:11], s5 offen sc1 lds
  v_mfma_f32_16x16x32_bf16 v[68:71], a[204:207], v[76:79], v[68:71]
  ds_read_b128 v[76:79], v24 offset:29696
  s_waitcnt lgkmcnt(3)
  v_mfma_f32_16x16x32_bf16 v[64:67], a[208:211], v[80:83], v[64:67]
  v_mfma_f32_16x16x32_bf16 v[68:71], a[212:215], v[80:83], v[68:71]
  ds_read_b128 v[80:83], v24 offset:30720
  s_waitcnt lgkmcnt(3)
  v_mfma_f32_16x16x32_bf16 v[64:67], a[216:219], v[84:87], v[64:67]
  v_mfma_f32_16x16x32_bf16 v[68:71], a[220:223], v[84:87], v[68:71]
  ds_read_b128 v[84:87], v24 offset:31744
  s_waitcnt lgkmcnt(3)
  v_mfma_f32_16x16x32_bf16 v[64:67], a[224:227], v[72:75], v[64:67]
  v_mfma_f32_16x16x32_bf16 v[68:71], a[228:231], v[72:75], v[68:71]
  s_waitcnt vmcnt(12)
  s_barrier
  ds_read_b128 v[72:75], v24 offset:32768
  s_waitcnt lgkmcnt(3)
  v_mfma_f32_16x16x32_bf16 v[64:67], a[232:235], v[76:79], v[64:67]
  s_add_u32 m0, s50, 28672
  s_add_u32 s5, s32, 28672
  buffer_load_dwordx4 v20, s[8:11], s5 offen sc1 lds
  v_mfma_f32_16x16x32_bf16 v[68:71], a[236:239], v[76:79], v[68:71]
  ds_read_b128 v[76:79], v24 offset:33792
  s_waitcnt lgkmcnt(3)
  v_mfma_f32_16x16x32_bf16 v[64:67], a[240:243], v[80:83], v[64:67]
  v_mfma_f32_16x16x32_bf16 v[68:71], a[244:247], v[80:83], v[68:71]
  ds_read_b128 v[80:83], v24 offset:34816
  s_waitcnt lgkmcnt(3)
  v_mfma_f32_16x16x32_bf16 v[64:67], a[248:251], v[84:87], v[64:67]
  v_mfma_f32_16x16x32_bf16 v[68:71], a[252:255], v[84:87], v[68:71]
  ds_read_b128 v[84:87], v24 offset:35840
  s_waitcnt lgkmcnt(3)
  v_mfma_f32_16x16x32_bf16 v[64:67], v[128:131], v[72:75], v[64:67]
  v_mfma_f32_16x16x32_bf16 v[68:71], v[132:135], v[72:75], v[68:71]
  ds_read_b128 v[72:75], v24 offset:36864
  s_waitcnt lgkmcnt(3)
  v_mfma_f32_16x16x32_bf16 v[64:67], v[136:139], v[76:79], v[64:67]
  s_add_u32 m0, s50, 32768
  s_add_u32 s5, s32, 32768
  buffer_load_dwordx4 v20, s[8:11], s5 offen sc1 lds
  v_mfma_f32_16x16x32_bf16 v[68:71], v[140:143], v[76:79], v[68:71]
  ds_read_b128 v[76:79], v24 offset:37888
  s_waitcnt lgkmcnt(3)
  v_mfma_f32_16x16x32_bf16 v[64:67], v[144:147], v[80:83], v[64:67]
  v_mfma_f32_16x16x32_bf16 v[68:71], v[148:151], v[80:83], v[68:71]
  ds_read_b128 v[80:83], v24 offset:38912
  s_waitcnt lgkmcnt(3)
  v_mfma_f32_16x16x32_bf16 v[64:67], v[152:155], v[84:87], v[64:67]
  v_mfma_f32_16x16x32_bf16 v[68:71], v[156:159], v[84:87], v[68:71]
  ds_read_b128 v[84:87], v24 offset:39936
  s_waitcnt lgkmcnt(3)
  v_mfma_f32_16x16x32_bf16 v[64:67], v[160:163], v[72:75], v[64:67]
  v_mfma_f32_16x16x32_bf16 v[68:71], v[164:167], v[72:75], v[68:71]
  ds_read_b128 v[72:75], v24 offset:40960
  s_waitcnt lgkmcnt(3)
  v_mfma_f32_16x16x32_bf16 v[64:67], v[168:171], v[76:79], v[64:67]
  s_add_u32 m0, s50, 36864
  s_add_u32 s5, s32, 36864
  buffer_load_dwordx4 v20, s[8:11], s5 offen sc1 lds
  v_mfma_f32_16x16x32_bf16 v[68:71], v[172:175], v[76:79], v[68:71]
  ds_read_b128 v[76:79], v24 offset:41984
  s_waitcnt lgkmcnt(3)
  v_mfma_f32_16x16x32_bf16 v[64:67], v[176:179], v[80:83], v[64:67]
  v_mfma_f32_16x16x32_bf16 v[68:71], v[180:183], v[80:83], v[68:71]
  ds_read_b128 v[80:83], v24 offset:43008
  s_waitcnt lgkmcnt(3)
  v_mfma_f32_16x16x32_bf16 v[64:67], v[184:187], v[84:87], v[64:67]
  v_mfma_f32_16x16x32_bf16 v[68:71], v[188:191], v[84:87], v[68:71]
  ds_read_b128 v[84:87], v24 offset:44032
  s_waitcnt lgkmcnt(3)
  v_mfma_f32_16x16x32_bf16 v[64:67], v[192:195], v[72:75], v[64:67]
  v_mfma_f32_16x16x32_bf16 v[68:71], v[196:199], v[72:75], v[68:71]
  ds_read_b128 v[72:75], v24 offset:45056
  s_waitcnt lgkmcnt(3)
  v_mfma_f32_16x16x32_bf16 v[64:67], v[200:203], v[76:79], v[64:67]
  s_add_u32 m0, s50, 40960
  s_add_u32 s5, s32, 40960
  buffer_load_dwordx4 v20, s[8:11], s5 offen sc1 lds
  v_mfma_f32_16x16x32_bf16 v[68:71], v[204:207], v[76:79], v[68:71]
  ds_read_b128 v[76:79], v24 offset:46080
  s_waitcnt lgkmcnt(3)
  v_mfma_f32_16x16x32_bf16 v[64:67], v[208:211], v[80:83], v[64:67]
  v_mfma_f32_16x16x32_bf16 v[68:71], v[212:215], v[80:83], v[68:71]
  ds_read_b128 v[80:83], v24 offset:47104
  s_waitcnt lgkmcnt(3)
  v_mfma_f32_16x16x32_bf16 v[64:67], v[216:219], v[84:87], v[64:67]
  v_mfma_f32_16x16x32_bf16 v[68:71], v[220:223], v[84:87], v[68:71]
  ds_read_b128 v[84:87], v24 offset:48128
  s_waitcnt lgkmcnt(3)
  v_mfma_f32_16x16x32_bf16 v[64:67], v[224:227], v[72:75], v[64:67]
  v_mfma_f32_16x16x32_bf16 v[68:71], v[228:231], v[72:75], v[68:71]
  s_waitcnt lgkmcnt(2)
  v_mfma_f32_16x16x32_bf16 v[64:67], v[232:235], v[76:79], v[64:67]
  s_add_u32 m0, s50, 45056
  s_add_u32 s5, s32, 45056
  buffer_load_dwordx4 v20, s[8:11], s5 offen sc1 lds
  v_mfma_f32_16x16x32_bf16 v[68:71], v[236:239], v[76:79], v[68:71]
  s_waitcnt lgkmcnt(1)
  v_mfma_f32_16x16x32_bf16 v[64:67], v[240:243], v[80:83], v[64:67]
  v_mfma_f32_16x16x32_bf16 v[68:71], v[244:247], v[80:83], v[68:71]
  s_waitcnt lgkmcnt(0)
  v_mfma_f32_16x16x32_bf16 v[64:67], v[248:251], v[84:87], v[64:67]
  v_mfma_f32_16x16x32_bf16 v[68:71], v[252:255], v[84:87], v[68:71]
  s_waitcnt vmcnt(13)
  s_branch L_C_ep
L_C_cAc:
  s_mul_i32 s4, s54, 20480
  s_add_u32 s4, s4, s46
  buffer_load_dwordx2 v[92:93], v25, s[20:23], s4 offen
  buffer_load_dwordx2 v[94:95], v25, s[20:23], s4 offen offset:32
  s_waitcnt vmcnt(10)
  s_barrier
  ds_read_b128 v[72:75], v24 offset:0
  ds_read_b128 v[76:79], v24 offset:1024
  ds_read_b128 v[80:83], v24 offset:2048
  ds_read_b128 v[84:87], v24 offset:3072
  s_waitcnt lgkmcnt(3)
  v_mfma_f32_16x16x32_bf16 v[64:67], a[0:3], v[72:75], 0
  v_mfma_f32_16x16x32_bf16 v[68:71], a[4:7], v[72:75], 0
  ds_read_b128 v[72:75], v24 offset:4096
  s_waitcnt lgkmcnt(3)
  v_mfma_f32_16x16x32_bf16 v[64:67], a[8:11], v[76:79], v[64:67]
  s_add_u32 m0, s50, 0
  s_add_u32 s5, s32, 0
  buffer_load_dwordx4 v20, s[8:11], s5 offen sc1 lds
  v_mfma_f32_16x16x32_bf16 v[68:71], a[12:15], v[76:79], v[68:71]
  ds_read_b128 v[76:79], v24 offset:5120
  s_waitcnt lgkmcnt(3)
  v_mfma_f32_16x16x32_bf16 v[64:67], a[16:19], v[80:83], v[64:67]
  v_mfma_f32_16x16x32_bf16 v[68:71], a[20:23], v[80:83], v[68:71]
  ds_read_b128 v[80:83], v24 offset:6144
  s_waitcnt lgkmcnt(3)
  v_mfma_f32_16x16x32_bf16 v[64:67], a[24:27], v[84:87], v[64:67]
  v_mfma_f32_16x16x32_bf16 v[68:71], a[28:31], v[84:87], v[68:71]
  ds_read_b128 v[84:87], v24 offset:7168
  s_waitcnt lgkmcnt(3)
  v_mfma_f32_16x16x32_bf16 v[64:67], a[32:35], v[72:75], v[64:67]
  v_mfma_f32_16x16x32_bf16 v[68:71], a[36:39], v[72:75], v[68:71]
  ds_read_b128 v[72:75], v24 offset:8192
  s_waitcnt lgkmcnt(3)
  v_mfma_f32_16x16x32_bf16 v[64:67], a[40:43], v[76:79], v[64:67]
  s_add_u32 m0, s50, 4096
  s_add_u32 s5, s32, 4096
  buffer_load_dwordx4 v20, s[8:11], s5 offen sc1 lds
  v_mfma_f32_16x16x32_bf16 v[68:71], a[44:47], v[76:79], v[68:71]
  ds_read_b128 v[76:79], v24 offset:9216
  s_waitcnt lgkmcnt(3)
  v_mfma_f32_16x16x32_bf16 v[64:67], a[48:51], v[80:83], v[64:67]
  v_mfma_f32_16x16x32_bf16 v[68:71], a[52:55], v[80:83], v[68:71]
  ds_read_b128 v[80:83], v24 offset:10240
  s_waitcnt lgkmcnt(3)
  v_mfma_f32_16x16x32_bf16 v[64:67], a[56:59], v[84:87], v[64:67]
  v_mfma_f32_16x16x32_bf16 v[68:71], a[60:63], v[84:87], v[68:71]
  ds_read_b128 v[84:87], v24 offset:11264
  s_waitcnt lgkmcnt(3)
  v_mfma_f32_16x16x32_bf16 v[64:67], a[64:67], v[72:75], v[64:67]
  v_mfma_f32_16x16x32_bf16 v[68:71], a[68:71], v[72:75], v[68:71]
  ds_read_b128 v[72:75], v24 offset:12288
  s_waitcnt lgkmcnt(3)
  v_mfma_f32_16x16x32_bf16 v[64:67], a[72:75], v[76:79], v[64:67]
  s_add_u32 m0, s50, 8192
  s_add_u32 s5, s32, 8192
  buffer_load_dwordx4 v20, s[8:11], s5 offen sc1 lds
  v_mfma_f32_16x16x32_bf16 v[68:71], a[76:79], v[76:79], v[68:71]
  ds_read_b128 v[76:79], v24 offset:13312
  s_waitcnt lgkmcnt(3)
  v_mfma_f32_16x16x32_bf16 v[64:67], a[80:83], v[80:83], v[64:67]
  v_mfma_f32_16x16x32_bf16 v[68:71], a[84:87], v[80:83], v[68:71]
  ds_read_b128 v[80:83], v24 offset:14336
  s_waitcnt lgkmcnt(3)
  v_mfma_f32_16x16x32_bf16 v[64:67], a[88:91], v[84:87], v[64:67]
  v_mfma_f32_16x16x32_bf16 v[68:71], a[92:95], v[84:87], v[68:71]
  ds_read_b128 v[84:87], v24 offset:15360
  s_waitcnt lgkmcnt(3)
  v_mfma_f32_16x16x32_bf16 v[64:67], a[96:99], v[72:75], v[64:67]
  v_mfma_f32_16x16x32_bf16 v[68:71], a[100:103], v[72:75], v[68:71]
  s_waitcnt vmcnt(9)
  s_barrier
  ds_read_b128 v[72:75], v24 offset:16384
  s_waitcnt lgkmcnt(3)
  v_mfma_f32_16x16x32_bf16 v[64:67], a[104:107], v[76:79], v[64:67]
  s_add_u32 m0, s50, 12288
  s_add_u32 s5, s32, 12288
  buffer_load_dwordx4 v20, s[8:11], s5 offen sc1 lds
  v_mfma_f32_16x16x32_bf16 v[68:71], a[108:111], v[76:79], v[68:71]
  ds_read_b128 v[76:79], v24 offset:17408
  s_waitcnt lgkmcnt(3)
  v_mfma_f32_16x16x32_bf16 v[64:67], a[112:115], v[80:83], v[64:67]
  v_mfma_f32_16x16x32_bf16 v[68:71], a[116:119], v[80:83], v[68:71]
  ds_read_b128 v[80:83], v24 offset:18432
  s_waitcnt lgkmcnt(3)
  v_mfma_f32_16x16x32_bf16 v[64:67], a[120:123], v[84:87], v[64:67]
  v_mfma_f32_16x16x32_bf16 v[68:71], a[124:127], v[84:87], v[68:71]
  ds_read_b128 v[84:87], v24 offset:19456
  s_waitcnt lgkmcnt(3)
  v_mfma_f32_16x16x32_bf16 v[64:67], a[128:131], v[72:75], v[64:67]
  buffer_load_dword v28, v23, s[8:11], 0 offen sc1
  v_mfma_f32_16x16x32_bf16 v[68:71], a[132:135], v[72:75], v[68:71]
  ds_read_b128 v[72:75], v24 offset:20480
  s_waitcnt lgkmcnt(3)
  v_mfma_f32_16x16x32_bf16 v[64:67], a[136:139], v[76:79], v[64:67]
  s_add_u32 m0, s50, 16384
  s_add_u32 s5, s32, 16384
  buffer_load_dwordx4 v20, s[8:11], s5 offen sc1 lds
  v_mfma_f32_16x16x32_bf16 v[68:71], a[140:143], v[76:79], v[68:71]
  ds_read_b128 v[76:79], v24 offset:21504
  s_waitcnt lgkmcnt(3)
  v_mfma_f32_16x16x32_bf16 v[64:67], a[144:147], v[80:83], v[64:67]
  v_mfma_f32_16x16x32_bf16 v[68:71], a[148:151], v[80:83], v[68:71]
  ds_read_b128 v[80:83], v24 offset:22528
  s_waitcnt lgkmcnt(3)
  v_mfma_f32_16x16x32_bf16 v[64:67], a[152:155], v[84:87], v[64:67]
  v_mfma_f32_16x16x32_bf16 v[68:71], a[156:159], v[84:87], v[68:71]
  ds_read_b128 v[84:87], v24 offset:23552
  s_waitcnt lgkmcnt(3)
  v_mfma_f32_16x16x32_bf16 v[64:67], a[160:163], v[72:75], v[64:67]
  v_mfma_f32_16x16x32_bf16 v[68:71], a[164:167], v[72:75], v[68:71]
  ds_read_b128 v[72:75], v24 offset:24576
  s_waitcnt lgkmcnt(3)
  v_mfma_f32_16x16x32_bf16 v[64:67], a[168:171], v[76:79], v[64:67]
  s_add_u32 m0, s50, 20480
  s_add_u32 s5, s32, 20480
  buffer_load_dwordx4 v20, s[8:11], s5 offen sc1 lds
  v_mfma_f32_16x16x32_bf16 v[68:71], a[172:175], v[76:79], v[68:71]
  ds_read_b128 v[76:79], v24 offset:25600
  s_waitcnt lgkmcnt(3)
  v_mfma_f32_16x16x32_bf16 v[64:67], a[176:179], v[80:83], v[64:67]
  v_mfma_f32_16x16x32_bf16 v[68:71], a[180:183], v[80:83], v[68:71]
  ds_read_b128 v[80:83], v24 offset:26624
  s_waitcnt lgkmcnt(3)
  v_mfma_f32_16x16x32_bf16 v[64:67], a[184:187], v[84:87], v[64:67]
  v_mfma_f32_16x16x32_bf16 v[68:71], a[188:191], v[84:87], v[68:71]
  ds_read_b128 v[84:87], v24 offset:27648
  s_waitcnt lgkmcnt(3)
  v_mfma_f32_16x16x32_bf16 v[64:67], a[192:195], v[72:75], v[64:67]
  v_mfma_f32_16x16x32_bf16 v[68:71], a[196:199], v[72:75], v[68:71]
  ds_read_b128 v[72:75], v24 offset:28672
  s_waitcnt lgkmcnt(3)
  v_mfma_f32_16x16x32_bf16 v[64:67], a[200:203], v[76:79], v[64:67]
  s_add_u32 m0, s50, 24576
  s_add_u32 s5, s32, 24576
  buffer_load_dwordx4 v20, s[8:11], s5 offen sc1 lds
  v_mfma_f32_16x16x32_bf16 v[68:71], a[204:207], v[76:79], v[68:71]
  ds_read_b128 v[76:79], v24 offset:29696
  s_waitcnt lgkmcnt(3)
  v_mfma_f32_16x16x32_bf16 v[64:67], a[208:211], v[80:83], v[64:67]
  v_mfma_f32_16x16x32_bf16 v[68:71], a[212:215], v[80:83], v[68:71]
  ds_read_b128 v[80:83], v24 offset:30720
  s_waitcnt lgkmcnt(3)
  v_mfma_f32_16x16x32_bf16 v[64:67], a[216:219], v[84:87], v[64:67]
  v_mfma_f32_16x16x32_bf16 v[68:71], a[220:223], v[84:87], v[68:71]
  ds_read_b128 v[84:87], v24 offset:31744
  s_waitcnt lgkmcnt(3)
  v_mfma_f32_16x16x32_bf16 v[64:67], a[224:227], v[72:75], v[64:67]
  v_mfma_f32_16x16x32_bf16 v[68:71], a[228:231], v[72:75], v[68:71]
  s_waitcnt vmcnt(10)
  s_barrier
  ds_read_b128 v[72:75], v24 offset:32768
  s_waitcnt lgkmcnt(3)
  v_mfma_f32_16x16x32_bf16 v[64:67], a[232:235], v[76:79], v[64:67]
  s_add_u32 m0, s50, 28672
  s_add_u32 s5, s32, 28672
  buffer_load_dwordx4 v20, s[8:11], s5 offen sc1 lds
  v_mfma_f32_16x16x32_bf16 v[68:71], a[236:239], v[76:79], v[68:71]
  ds_read_b128 v[76:79], v24 offset:33792
  s_waitcnt lgkmcnt(3)
  v_mfma_f32_16x16x32_bf16 v[64:67], a[240:243], v[80:83], v[64:67]
  v_mfma_f32_16x16x32_bf16 v[68:71], a[244:247], v[80:83], v[68:71]
  ds_read_b128 v[80:83], v24 offset:34816
  s_waitcnt lgkmcnt(3)
  v_mfma_f32_16x16x32_bf16 v[64:67], a[248:251], v[84:87], v[64:67]
  v_mfma_f32_16x16x32_bf16 v[68:71], a[252:255], v[84:87], v[68:71]
  ds_read_b128 v[84:87], v24 offset:35840
  s_waitcnt lgkmcnt(3)
  v_mfma_f32_16x16x32_bf16 v[64:67], v[128:131], v[72:75], v[64:67]
  v_mfma_f32_16x16x32_bf16 v[68:71], v[132:135], v[72:75], v[68:71]
  ds_read_b128 v[72:75], v24 offset:36864
  s_waitcnt lgkmcnt(3)
  v_mfma_f32_16x16x32_bf16 v[64:67], v[136:139], v[76:79], v[64:67]
  s_add_u32 m0, s50, 32768
  s_add_u32 s5, s32, 32768
  buffer_load_dwordx4 v20, s[8:11], s5 offen sc1 lds
  v_mfma_f32_16x16x32_bf16 v[68:71], v[140:143], v[76:79], v[68:71]
  ds_read_b128 v[76:79], v24 offset:37888
  s_waitcnt lgkmcnt(3)
  v_mfma_f32_16x16x32_bf16 v[64:67], v[144:147], v[80:83], v[64:67]
  v_mfma_f32_16x16x32_bf16 v[68:71], v[148:151], v[80:83], v[68:71]
  ds_read_b128 v[80:83], v24 offset:38912
  s_waitcnt lgkmcnt(3)
  v_mfma_f32_16x16x32_bf16 v[64:67], v[152:155], v[84:87], v[64:67]
  v_mfma_f32_16x16x32_bf16 v[68:71], v[156:159], v[84:87], v[68:71]
  ds_read_b128 v[84:87], v24 offset:39936
  s_waitcnt lgkmcnt(3)
  v_mfma_f32_16x16x32_bf16 v[64:67], v[160:163], v[72:75], v[64:67]
  v_mfma_f32_16x16x32_bf16 v[68:71], v[164:167], v[72:75], v[68:71]
  ds_read_b128 v[72:75], v24 offset:40960
  s_waitcnt lgkmcnt(3)
  v_mfma_f32_16x16x32_bf16 v[64:67], v[168:171], v[76:79], v[64:67]
  s_add_u32 m0, s50, 36864
  s_add_u32 s5, s32, 36864
  buffer_load_dwordx4 v20, s[8:11], s5 offen sc1 lds
  v_mfma_f32_16x16x32_bf16 v[68:71], v[172:175], v[76:79], v[68:71]
  ds_read_b128 v[76:79], v24 offset:41984
  s_waitcnt lgkmcnt(3)
  v_mfma_f32_16x16x32_bf16 v[64:67], v[176:179], v[80:83], v[64:67]
  v_mfma_f32_16x16x32_bf16 v[68:71], v[180:183], v[80:83], v[68:71]
  ds_read_b128 v[80:83], v24 offset:43008
  s_waitcnt lgkmcnt(3)
  v_mfma_f32_16x16x32_bf16 v[64:67], v[184:187], v[84:87], v[64:67]
  v_mfma_f32_16x16x32_bf16 v[68:71], v[188:191], v[84:87], v[68:71]
  ds_read_b128 v[84:87], v24 offset:44032
  s_waitcnt lgkmcnt(3)
  v_mfma_f32_16x16x32_bf16 v[64:67], v[192:195], v[72:75], v[64:67]
  v_mfma_f32_16x16x32_bf16 v[68:71], v[196:199], v[72:75], v[68:71]
  ds_read_b128 v[72:75], v24 offset:45056
  s_waitcnt lgkmcnt(3)
  v_mfma_f32_16x16x32_bf16 v[64:67], v[200:203], v[76:79], v[64:67]
  s_add_u32 m0, s50, 40960
  s_add_u32 s5, s32, 40960
  buffer_load_dwordx4 v20, s[8:11], s5 offen sc1 lds
  v_mfma_f32_16x16x32_bf16 v[68:71], v[204:207], v[76:79], v[68:71]
  ds_read_b128 v[76:79], v24 offset:46080
  s_waitcnt lgkmcnt(3)
  v_mfma_f32_16x16x32_bf16 v[64:67], v[208:211], v[80:83], v[64:67]
  v_mfma_f32_16x16x32_bf16 v[68:71], v[212:215], v[80:83], v[68:71]
  ds_read_b128 v[80:83], v24 offset:47104
  s_waitcnt lgkmcnt(3)
  v_mfma_f32_16x16x32_bf16 v[64:67], v[216:219], v[84:87], v[64:67]
  v_mfma_f32_16x16x32_bf16 v[68:71], v[220:223], v[84:87], v[68:71]
  ds_read_b128 v[84:87], v24 offset:48128
  s_waitcnt lgkmcnt(3)
  v_mfma_f32_16x16x32_bf16 v[64:67], v[224:227], v[72:75], v[64:67]
  v_mfma_f32_16x16x32_bf16 v[68:71], v[228:231], v[72:75], v[68:71]
  s_waitcnt lgkmcnt(2)
  v_mfma_f32_16x16x32_bf16 v[64:67], v[232:235], v[76:79], v[64:67]
  s_add_u32 m0, s50, 45056
  s_add_u32 s5, s32, 45056
  buffer_load_dwordx4 v20, s[8:11], s5 offen sc1 lds
  v_mfma_f32_16x16x32_bf16 v[68:71], v[236:239], v[76:79], v[68:71]
  s_waitcnt lgkmcnt(1)
  v_mfma_f32_16x16x32_bf16 v[64:67], v[240:243], v[80:83], v[64:67]
  v_mfma_f32_16x16x32_bf16 v[68:71], v[244:247], v[80:83], v[68:71]
  s_waitcnt lgkmcnt(0)
  v_mfma_f32_16x16x32_bf16 v[64:67], v[248:251], v[84:87], v[64:67]
  v_mfma_f32_16x16x32_bf16 v[68:71], v[252:255], v[84:87], v[68:71]
  s_waitcnt vmcnt(13)
  s_branch L_C_ep
L_C_cB:
  s_cmp_eq_u32 s51, 1
  s_cbranch_scc1 L_C_cBc
  s_mul_i32 s4, s54, 20480
  s_add_u32 s4, s4, s46
  buffer_load_dwordx2 v[92:93], v25, s[20:23], s4 offen
  buffer_load_dwordx2 v[94:95], v25, s[20:23], s4 offen offset:32
  s_waitcnt vmcnt(13)
  s_barrier
  ds_read_b128 v[72:75], v24 offset:0
  ds_read_b128 v[76:79], v24 offset:1024
  ds_read_b128 v[80:83], v24 offset:2048
  ds_read_b128 v[84:87], v24 offset:3072
  s_waitcnt lgkmcnt(3)
  v_mfma_f32_16x16x32_bf16 v[64:67], a[0:3], v[72:75], 0
  v_mfma_f32_16x16x32_bf16 v[68:71], a[4:7], v[72:75], 0
  ds_read_b128 v[72:75], v24 offset:4096
  s_waitcnt lgkmcnt(3)
  v_mfma_f32_16x16x32_bf16 v[64:67], a[8:11], v[76:79], v[64:67]
  v_mfma_f32_16x16x32_bf16 v[68:71], a[12:15], v[76:79], v[68:71]
  ds_read_b128 v[76:79], v24 offset:5120
  s_waitcnt lgkmcnt(3)
  v_mfma_f32_16x16x32_bf16 v[64:67], a[16:19], v[80:83], v[64:67]
  v_mfma_f32_16x16x32_bf16 v[68:71], a[20:23], v[80:83], v[68:71]
  ds_read_b128 v[80:83], v24 offset:6144
  s_waitcnt lgkmcnt(3)
  v_mfma_f32_16x16x32_bf16 v[64:67], a[24:27], v[84:87], v[64:67]
  v_mfma_f32_16x16x32_bf16 v[68:71], a[28:31], v[84:87], v[68:71]
  ds_read_b128 v[84:87], v24 offset:7168
  s_waitcnt lgkmcnt(3)
  v_mfma_f32_16x16x32_bf16 v[64:67], a[32:35], v[72:75], v[64:67]
  v_mfma_f32_16x16x32_bf16 v[68:71], a[36:39], v[72:75], v[68:71]
  ds_read_b128 v[72:75], v24 offset:8192
  s_waitcnt lgkmcnt(3)
  v_mfma_f32_16x16x32_bf16 v[64:67], a[40:43], v[76:79], v[64:67]
  v_mfma_f32_16x16x32_bf16 v[68:71], a[44:47], v[76:79], v[68:71]
  ds_read_b128 v[76:79], v24 offset:9216
  s_waitcnt lgkmcnt(3)
  v_mfma_f32_16x16x32_bf16 v[64:67], a[48:51], v[80:83], v[64:67]
  v_mfma_f32_16x16x32_bf16 v[68:71], a[52:55], v[80:83], v[68:71]
  ds_read_b128 v[80:83], v24 offset:10240
  s_waitcnt lgkmcnt(3)
  v_mfma_f32_16x16x32_bf16 v[64:67], a[56:59], v[84:87], v[64:67]
  v_mfma_f32_16x16x32_bf16 v[68:71], a[60:63], v[84:87], v[68:71]
  ds_read_b128 v[84:87], v24 offset:11264
  s_waitcnt lgkmcnt(3)
  v_mfma_f32_16x16x32_bf16 v[64:67], a[64:67], v[72:75], v[64:67]
  v_mfma_f32_16x16x32_bf16 v[68:71], a[68:71], v[72:75], v[68:71]
  ds_read_b128 v[72:75], v24 offset:12288
  s_waitcnt lgkmcnt(3)
  v_mfma_f32_16x16x32_bf16 v[64:67], a[72:75], v[76:79], v[64:67]
  v_mfma_f32_16x16x32_bf16 v[68:71], a[76:79], v[76:79], v[68:71]
  ds_read_b128 v[76:79], v24 offset:13312
  s_waitcnt lgkmcnt(3)
  v_mfma_f32_16x16x32_bf16 v[64:67], a[80:83], v[80:83], v[64:67]
  v_mfma_f32_16x16x32_bf16 v[68:71], a[84:87], v[80:83], v[68:71]
  ds_read_b128 v[80:83], v24 offset:14336
  s_waitcnt lgkmcnt(3)
  v_mfma_f32_16x16x32_bf16 v[64:67], a[88:91], v[84:87], v[64:67]
  v_mfma_f32_16x16x32_bf16 v[68:71], a[92:95], v[84:87], v[68:71]
  ds_read_b128 v[84:87], v24 offset:15360
  s_waitcnt lgkmcnt(3)
  v_mfma_f32_16x16x32_bf16 v[64:67], a[96:99], v[72:75], v[64:67]
  v_mfma_f32_16x16x32_bf16 v[68:71], a[100:103], v[72:75], v[68:71]
  s_waitcnt vmcnt(8)
  s_barrier
  ds_read_b128 v[72:75], v24 offset:16384
  s_waitcnt lgkmcnt(3)
  v_mfma_f32_16x16x32_bf16 v[64:67], a[104:107], v[76:79], v[64:67]
  v_mfma_f32_16x16x32_bf16 v[68:71], a[108:111], v[76:79], v[68:71]
  ds_read_b128 v[76:79], v24 offset:17408
  s_waitcnt lgkmcnt(3)
  v_mfma_f32_16x16x32_bf16 v[64:67], a[112:115], v[80:83], v[64:67]
  v_mfma_f32_16x16x32_bf16 v[68:71], a[116:119], v[80:83], v[68:71]
  ds_read_b128 v[80:83], v24 offset:18432
  s_waitcnt lgkmcnt(3)
  v_mfma_f32_16x16x32_bf16 v[64:67], a[120:123], v[84:87], v[64:67]
  v_mfma_f32_16x16x32_bf16 v[68:71], a[124:127], v[84:87], v[68:71]
  ds_read_b128 v[84:87], v24 offset:19456
  s_waitcnt lgkmcnt(3)
  v_mfma_f32_16x16x32_bf16 v[64:67], a[128:131], v[72:75], v[64:67]
  buffer_load_dword v28, v23, s[8:11], 0 offen sc1
  v_mfma_f32_16x16x32_bf16 v[68:71], a[132:135], v[72:75], v[68:71]
  ds_read_b128 v[72:75], v24 offset:20480
  s_waitcnt lgkmcnt(3)
  v_mfma_f32_16x16x32_bf16 v[64:67], a[136:139], v[76:79], v[64:67]
  v_mfma_f32_16x16x32_bf16 v[68:71], a[140:143], v[76:79], v[68:71]
  ds_read_b128 v[76:79], v24 offset:21504
  s_waitcnt lgkmcnt(3)
  v_mfma_f32_16x16x32_bf16 v[64:67], a[144:147], v[80:83], v[64:67]
  v_mfma_f32_16x16x32_bf16 v[68:71], a[148:151], v[80:83], v[68:71]
  ds_read_b128 v[80:83], v24 offset:22528
  s_waitcnt lgkmcnt(3)
  v_mfma_f32_16x16x32_bf16 v[64:67], a[152:155], v[84:87], v[64:67]
  v_mfma_f32_16x16x32_bf16 v[68:71], a[156:159], v[84:87], v[68:71]
  ds_read_b128 v[84:87], v24 offset:23552
  s_waitcnt lgkmcnt(3)
  v_mfma_f32_16x16x32_bf16 v[64:67], a[160:163], v[72:75], v[64:67]
  v_mfma_f32_16x16x32_bf16 v[68:71], a[164:167], v[72:75], v[68:71]
  ds_read_b128 v[72:75], v24 offset:24576
  s_waitcnt lgkmcnt(3)
  v_mfma_f32_16x16x32_bf16 v[64:67], a[168:171], v[76:79], v[64:67]
  v_mfma_f32_16x16x32_bf16 v[68:71], a[172:175], v[76:79], v[68:71]
  ds_read_b128 v[76:79], v24 offset:25600
  s_waitcnt lgkmcnt(3)
  v_mfma_f32_16x16x32_bf16 v[64:67], a[176:179], v[80:83], v[64:67]
  v_mfma_f32_16x16x32_bf16 v[68:71], a[180:183], v[80:83], v[68:71]
  ds_read_b128 v[80:83], v24 offset:26624
  s_waitcnt lgkmcnt(3)
  v_mfma_f32_16x16x32_bf16 v[64:67], a[184:187], v[84:87], v[64:67]
  v_mfma_f32_16x16x32_bf16 v[68:71], a[188:191], v[84:87], v[68:71]
  ds_read_b128 v[84:87], v24 offset:27648
  s_waitcnt lgkmcnt(3)
  v_mfma_f32_16x16x32_bf16 v[64:67], a[192:195], v[72:75], v[64:67]
  v_mfma_f32_16x16x32_bf16 v[68:71], a[196:199], v[72:75], v[68:71]
  ds_read_b128 v[72:75], v24 offset:28672
  s_waitcnt lgkmcnt(3)
  v_mfma_f32_16x16x32_bf16 v[64:67], a[200:203], v[76:79], v[64:67]
  v_mfma_f32_16x16x32_bf16 v[68:71], a[204:207], v[76:79], v[68:71]
  ds_read_b128 v[76:79], v24 offset:29696
  s_waitcnt lgkmcnt(3)
  v_mfma_f32_16x16x32_bf16 v[64:67], a[208:211], v[80:83], v[64:67]
  v_mfma_f32_16x16x32_bf16 v[68:71], a[212:215], v[80:83], v[68:71]
  ds_read_b128 v[80:83], v24 offset:30720
  s_waitcnt lgkmcnt(3)
  v_mfma_f32_16x16x32_bf16 v[64:67], a[216:219], v[84:87], v[64:67]
  v_mfma_f32_16x16x32_bf16 v[68:71], a[220:223], v[84:87], v[68:71]
  ds_read_b128 v[84:87], v24 offset:31744
  s_waitcnt lgkmcnt(3)
  v_mfma_f32_16x16x32_bf16 v[64:67], a[224:227], v[72:75], v[64:67]
  v_mfma_f32_16x16x32_bf16 v[68:71], a[228:231], v[72:75], v[68:71]
  s_waitcnt vmcnt(5)
  s_barrier
  ds_read_b128 v[72:75], v24 offset:32768
  s_waitcnt lgkmcnt(3)
  v_mfma_f32_16x16x32_bf16 v[64:67], a[232:235], v[76:79], v[64:67]
  v_mfma_f32_16x16x32_bf16 v[68:71], a[236:239], v[76:79], v[68:71]
  ds_read_b128 v[76:79], v24 offset:33792
  s_waitcnt lgkmcnt(3)
  v_mfma_f32_16x16x32_bf16 v[64:67], a[240:243], v[80:83], v[64:67]
  v_mfma_f32_16x16x32_bf16 v[68:71], a[244:247], v[80:83], v[68:71]
  ds_read_b128 v[80:83], v24 offset:34816
  s_waitcnt lgkmcnt(3)
  v_mfma_f32_16x16x32_bf16 v[64:67], a[248:251], v[84:87], v[64:67]
  v_mfma_f32_16x16x32_bf16 v[68:71], a[252:255], v[84:87], v[68:71]
  ds_read_b128 v[84:87], v24 offset:35840
  s_waitcnt lgkmcnt(3)
  v_mfma_f32_16x16x32_bf16 v[64:67], v[128:131], v[72:75], v[64:67]
  v_mfma_f32_16x16x32_bf16 v[68:71], v[132:135], v[72:75], v[68:71]
  ds_read_b128 v[72:75], v24 offset:36864
  s_waitcnt lgkmcnt(3)
  v_mfma_f32_16x16x32_bf16 v[64:67], v[136:139], v[76:79], v[64:67]
  v_mfma_f32_16x16x32_bf16 v[68:71], v[140:143], v[76:79], v[68:71]
  ds_read_b128 v[76:79], v24 offset:37888
  s_waitcnt lgkmcnt(3)
  v_mfma_f32_16x16x32_bf16 v[64:67], v[144:147], v[80:83], v[64:67]
  v_mfma_f32_16x16x32_bf16 v[68:71], v[148:151], v[80:83], v[68:71]
  ds_read_b128 v[80:83], v24 offset:38912
  s_waitcnt lgkmcnt(3)
  v_mfma_f32_16x16x32_bf16 v[64:67], v[152:155], v[84:87], v[64:67]
  v_mfma_f32_16x16x32_bf16 v[68:71], v[156:159], v[84:87], v[68:71]
  ds_read_b128 v[84:87], v24 offset:39936
  s_waitcnt lgkmcnt(3)
  v_mfma_f32_16x16x32_bf16 v[64:67], v[160:163], v[72:75], v[64:67]
  v_mfma_f32_16x16x32_bf16 v[68:71], v[164:167], v[72:75], v[68:71]
  ds_read_b128 v[72:75], v24 offset:40960
  s_waitcnt lgkmcnt(3)
  v_mfma_f32_16x16x32_bf16 v[64:67], v[168:171], v[76:79], v[64:67]
  v_mfma_f32_16x16x32_bf16 v[68:71], v[172:175], v[76:79], v[68:71]
  ds_read_b128 v[76:79], v24 offset:41984
  s_waitcnt lgkmcnt(3)
  v_mfma_f32_16x16x32_bf16 v[64:67], v[176:179], v[80:83], v[64:67]
  v_mfma_f32_16x16x32_bf16 v[68:71], v[180:183], v[80:83], v[68:71]
  ds_read_b128 v[80:83], v24 offset:43008
  s_waitcnt lgkmcnt(3)
  v_mfma_f32_16x16x32_bf16 v[64:67], v[184:187], v[84:87], v[64:67]
  v_mfma_f32_16x16x32_bf16 v[68:71], v[188:191], v[84:87], v[68:71]
  ds_read_b128 v[84:87], v24 offset:44032
  s_waitcnt lgkmcnt(3)
  v_mfma_f32_16x16x32_bf16 v[64:67], v[192:195], v[72:75], v[64:67]
  v_mfma_f32_16x16x32_bf16 v[68:71], v[196:199], v[72:75], v[68:71]
  ds_read_b128 v[72:75], v24 offset:45056
  s_waitcnt lgkmcnt(3)
  v_mfma_f32_16x16x32_bf16 v[64:67], v[200:203], v[76:79], v[64:67]
  v_mfma_f32_16x16x32_bf16 v[68:71], v[204:207], v[76:79], v[68:71]
  ds_read_b128 v[76:79], v24 offset:46080
  s_waitcnt lgkmcnt(3)
  v_mfma_f32_16x16x32_bf16 v[64:67], v[208:211], v[80:83], v[64:67]
  v_mfma_f32_16x16x32_bf16 v[68:71], v[212:215], v[80:83], v[68:71]
  ds_read_b128 v[80:83], v24 offset:47104
  s_waitcnt lgkmcnt(3)
  v_mfma_f32_16x16x32_bf16 v[64:67], v[216:219], v[84:87], v[64:67]
  v_mfma_f32_16x16x32_bf16 v[68:71], v[220:223], v[84:87], v[68:71]
  ds_read_b128 v[84:87], v24 offset:48128
  s_waitcnt lgkmcnt(3)
  v_mfma_f32_16x16x32_bf16 v[64:67], v[224:227], v[72:75], v[64:67]
  v_mfma_f32_16x16x32_bf16 v[68:71], v[228:231], v[72:75], v[68:71]
  s_waitcnt lgkmcnt(2)
  v_mfma_f32_16x16x32_bf16 v[64:67], v[232:235], v[76:79], v[64:67]
  v_mfma_f32_16x16x32_bf16 v[68:71], v[236:239], v[76:79], v[68:71]
  s_waitcnt lgkmcnt(1)
  v_mfma_f32_16x16x32_bf16 v[64:67], v[240:243], v[80:83], v[64:67]
  v_mfma_f32_16x16x32_bf16 v[68:71], v[244:247], v[80:83], v[68:71]
  s_waitcnt lgkmcnt(0)
  v_mfma_f32_16x16x32_bf16 v[64:67], v[248:251], v[84:87], v[64:67]
  v_mfma_f32_16x16x32_bf16 v[68:71], v[252:255], v[84:87], v[68:71]
  s_waitcnt vmcnt(1)
  s_branch L_C_ep
L_C_cBc:
  s_mul_i32 s4, s54, 20480
  s_add_u32 s4, s4, s46
  buffer_load_dwordx2 v[92:93], v25, s[20:23], s4 offen
  buffer_load_dwordx2 v[94:95], v25, s[20:23], s4 offen offset:32
  s_waitcnt vmcnt(10)
  s_barrier
  ds_read_b128 v[72:75], v24 offset:0
  ds_read_b128 v[76:79], v24 offset:1024
  ds_read_b128 v[80:83], v24 offset:2048
  ds_read_b128 v[84:87], v24 offset:3072
  s_waitcnt lgkmcnt(3)
  v_mfma_f32_16x16x32_bf16 v[64:67], a[0:3], v[72:75], 0
  v_mfma_f32_16x16x32_bf16 v[68:71], a[4:7], v[72:75], 0
  ds_read_b128 v[72:75], v24 offset:4096
  s_waitcnt lgkmcnt(3)
  v_mfma_f32_16x16x32_bf16 v[64:67], a[8:11], v[76:79], v[64:67]
  v_mfma_f32_16x16x32_bf16 v[68:71], a[12:15], v[76:79], v[68:71]
  ds_read_b128 v[76:79], v24 offset:5120
  s_waitcnt lgkmcnt(3)
  v_mfma_f32_16x16x32_bf16 v[64:67], a[16:19], v[80:83], v[64:67]
  v_mfma_f32_16x16x32_bf16 v[68:71], a[20:23], v[80:83], v[68:71]
  ds_read_b128 v[80:83], v24 offset:6144
  s_waitcnt lgkmcnt(3)
  v_mfma_f32_16x16x32_bf16 v[64:67], a[24:27], v[84:87], v[64:67]
  v_mfma_f32_16x16x32_bf16 v[68:71], a[28:31], v[84:87], v[68:71]
  ds_read_b128 v[84:87], v24 offset:7168
  s_waitcnt lgkmcnt(3)
  v_mfma_f32_16x16x32_bf16 v[64:67], a[32:35], v[72:75], v[64:67]
  v_mfma_f32_16x16x32_bf16 v[68:71], a[36:39], v[72:75], v[68:71]
  ds_read_b128 v[72:75], v24 offset:8192
  s_waitcnt lgkmcnt(3)
  v_mfma_f32_16x16x32_bf16 v[64:67], a[40:43], v[76:79], v[64:67]
  v_mfma_f32_16x16x32_bf16 v[68:71], a[44:47], v[76:79], v[68:71]
  ds_read_b128 v[76:79], v24 offset:9216
  s_waitcnt lgkmcnt(3)
  v_mfma_f32_16x16x32_bf16 v[64:67], a[48:51], v[80:83], v[64:67]
  v_mfma_f32_16x16x32_bf16 v[68:71], a[52:55], v[80:83], v[68:71]
  ds_read_b128 v[80:83], v24 offset:10240
  s_waitcnt lgkmcnt(3)
  v_mfma_f32_16x16x32_bf16 v[64:67], a[56:59], v[84:87], v[64:67]
  v_mfma_f32_16x16x32_bf16 v[68:71], a[60:63], v[84:87], v[68:71]
  ds_read_b128 v[84:87], v24 offset:11264
  s_waitcnt lgkmcnt(3)
  v_mfma_f32_16x16x32_bf16 v[64:67], a[64:67], v[72:75], v[64:67]
  v_mfma_f32_16x16x32_bf16 v[68:71], a[68:71], v[72:75], v[68:71]
  ds_read_b128 v[72:75], v24 offset:12288
  s_waitcnt lgkmcnt(3)
  v_mfma_f32_16x16x32_bf16 v[64:67], a[72:75], v[76:79], v[64:67]
  v_mfma_f32_16x16x32_bf16 v[68:71], a[76:79], v[76:79], v[68:71]
  ds_read_b128 v[76:79], v24 offset:13312
  s_waitcnt lgkmcnt(3)
  v_mfma_f32_16x16x32_bf16 v[64:67], a[80:83], v[80:83], v[64:67]
  v_mfma_f32_16x16x32_bf16 v[68:71], a[84:87], v[80:83], v[68:71]
  ds_read_b128 v[80:83], v24 offset:14336
  s_waitcnt lgkmcnt(3)
  v_mfma_f32_16x16x32_bf16 v[64:67], a[88:91], v[84:87], v[64:67]
  v_mfma_f32_16x16x32_bf16 v[68:71], a[92:95], v[84:87], v[68:71]
  ds_read_b128 v[84:87], v24 offset:15360
  s_waitcnt lgkmcnt(3)
  v_mfma_f32_16x16x32_bf16 v[64:67], a[96:99], v[72:75], v[64:67]
  v_mfma_f32_16x16x32_bf16 v[68:71], a[100:103], v[72:75], v[68:71]
  s_waitcnt vmcnt(6)
  s_barrier
  ds_read_b128 v[72:75], v24 offset:16384
  s_waitcnt lgkmcnt(3)
  v_mfma_f32_16x16x32_bf16 v[64:67], a[104:107], v[76:79], v[64:67]
  v_mfma_f32_16x16x32_bf16 v[68:71], a[108:111], v[76:79], v[68:71]
  ds_read_b128 v[76:79], v24 offset:17408
  s_waitcnt lgkmcnt(3)
  v_mfma_f32_16x16x32_bf16 v[64:67], a[112:115], v[80:83], v[64:67]
  v_mfma_f32_16x16x32_bf16 v[68:71], a[116:119], v[80:83], v[68:71]
  ds_read_b128 v[80:83], v24 offset:18432
  s_waitcnt lgkmcnt(3)
  v_mfma_f32_16x16x32_bf16 v[64:67], a[120:123], v[84:87], v[64:67]
  v_mfma_f32_16x16x32_bf16 v[68:71], a[124:127], v[84:87], v[68:71]
  ds_read_b128 v[84:87], v24 offset:19456
  s_waitcnt lgkmcnt(3)
  v_mfma_f32_16x16x32_bf16 v[64:67], a[128:131], v[72:75], v[64:67]
  buffer_load_dword v28, v23, s[8:11], 0 offen sc1
  v_mfma_f32_16x16x32_bf16 v[68:71], a[132:135], v[72:75], v[68:71]
  ds_read_b128 v[72:75], v24 offset:20480
  s_waitcnt lgkmcnt(3)
  v_mfma_f32_16x16x32_bf16 v[64:67], a[136:139], v[76:79], v[64:67]
  v_mfma_f32_16x16x32_bf16 v[68:71], a[140:143], v[76:79], v[68:71]
  ds_read_b128 v[76:79], v24 offset:21504
  s_waitcnt lgkmcnt(3)
  v_mfma_f32_16x16x32_bf16 v[64:67], a[144:147], v[80:83], v[64:67]
  v_mfma_f32_16x16x32_bf16 v[68:71], a[148:151], v[80:83], v[68:71]
  ds_read_b128 v[80:83], v24 offset:22528
  s_waitcnt lgkmcnt(3)
  v_mfma_f32_16x16x32_bf16 v[64:67], a[152:155], v[84:87], v[64:67]
  v_mfma_f32_16x16x32_bf16 v[68:71], a[156:159], v[84:87], v[68:71]
  ds_read_b128 v[84:87], v24 offset:23552
  s_waitcnt lgkmcnt(3)
  v_mfma_f32_16x16x32_bf16 v[64:67], a[160:163], v[72:75], v[64:67]
  v_mfma_f32_16x16x32_bf16 v[68:71], a[164:167], v[72:75], v[68:71]
  ds_read_b128 v[72:75], v24 offset:24576
  s_waitcnt lgkmcnt(3)
  v_mfma_f32_16x16x32_bf16 v[64:67], a[168:171], v[76:79], v[64:67]
  v_mfma_f32_16x16x32_bf16 v[68:71], a[172:175], v[76:79], v[68:71]
  ds_read_b128 v[76:79], v24 offset:25600
  s_waitcnt lgkmcnt(3)
  v_mfma_f32_16x16x32_bf16 v[64:67], a[176:179], v[80:83], v[64:67]
  v_mfma_f32_16x16x32_bf16 v[68:71], a[180:183], v[80:83], v[68:71]
  ds_read_b128 v[80:83], v24 offset:26624
  s_waitcnt lgkmcnt(3)
  v_mfma_f32_16x16x32_bf16 v[64:67], a[184:187], v[84:87], v[64:67]
  v_mfma_f32_16x16x32_bf16 v[68:71], a[188:191], v[84:87], v[68:71]
  ds_read_b128 v[84:87], v24 offset:27648
  s_waitcnt lgkmcnt(3)
  v_mfma_f32_16x16x32_bf16 v[64:67], a[192:195], v[72:75], v[64:67]
  v_mfma_f32_16x16x32_bf16 v[68:71], a[196:199], v[72:75], v[68:71]
  ds_read_b128 v[72:75], v24 offset:28672
  s_waitcnt lgkmcnt(3)
  v_mfma_f32_16x16x32_bf16 v[64:67], a[200:203], v[76:79], v[64:67]
  v_mfma_f32_16x16x32_bf16 v[68:71], a[204:207], v[76:79], v[68:71]
  ds_read_b128 v[76:79], v24 offset:29696
  s_waitcnt lgkmcnt(3)
  v_mfma_f32_16x16x32_bf16 v[64:67], a[208:211], v[80:83], v[64:67]
  v_mfma_f32_16x16x32_bf16 v[68:71], a[212:215], v[80:83], v[68:71]
  ds_read_b128 v[80:83], v24 offset:30720
  s_waitcnt lgkmcnt(3)
  v_mfma_f32_16x16x32_bf16 v[64:67], a[216:219], v[84:87], v[64:67]
  v_mfma_f32_16x16x32_bf16 v[68:71], a[220:223], v[84:87], v[68:71]
  ds_read_b128 v[84:87], v24 offset:31744
  s_waitcnt lgkmcnt(3)
  v_mfma_f32_16x16x32_bf16 v[64:67], a[224:227], v[72:75], v[64:67]
  v_mfma_f32_16x16x32_bf16 v[68:71], a[228:231], v[72:75], v[68:71]
  s_waitcnt vmcnt(3)
  s_barrier
  ds_read_b128 v[72:75], v24 offset:32768
  s_waitcnt lgkmcnt(3)
  v_mfma_f32_16x16x32_bf16 v[64:67], a[232:235], v[76:79], v[64:67]
  v_mfma_f32_16x16x32_bf16 v[68:71], a[236:239], v[76:79], v[68:71]
  ds_read_b128 v[76:79], v24 offset:33792
  s_waitcnt lgkmcnt(3)
  v_mfma_f32_16x16x32_bf16 v[64:67], a[240:243], v[80:83], v[64:67]
  v_mfma_f32_16x16x32_bf16 v[68:71], a[244:247], v[80:83], v[68:71]
  ds_read_b128 v[80:83], v24 offset:34816
  s_waitcnt lgkmcnt(3)
  v_mfma_f32_16x16x32_bf16 v[64:67], a[248:251], v[84:87], v[64:67]
  v_mfma_f32_16x16x32_bf16 v[68:71], a[252:255], v[84:87], v[68:71]
  ds_read_b128 v[84:87], v24 offset:35840
  s_waitcnt lgkmcnt(3)
  v_mfma_f32_16x16x32_bf16 v[64:67], v[128:131], v[72:75], v[64:67]
  v_mfma_f32_16x16x32_bf16 v[68:71], v[132:135], v[72:75], v[68:71]
  ds_read_b128 v[72:75], v24 offset:36864
  s_waitcnt lgkmcnt(3)
  v_mfma_f32_16x16x32_bf16 v[64:67], v[136:139], v[76:79], v[64:67]
  v_mfma_f32_16x16x32_bf16 v[68:71], v[140:143], v[76:79], v[68:71]
  ds_read_b128 v[76:79], v24 offset:37888
  s_waitcnt lgkmcnt(3)
  v_mfma_f32_16x16x32_bf16 v[64:67], v[144:147], v[80:83], v[64:67]
  v_mfma_f32_16x16x32_bf16 v[68:71], v[148:151], v[80:83], v[68:71]
  ds_read_b128 v[80:83], v24 offset:38912
  s_waitcnt lgkmcnt(3)
  v_mfma_f32_16x16x32_bf16 v[64:67], v[152:155], v[84:87], v[64:67]
  v_mfma_f32_16x16x32_bf16 v[68:71], v[156:159], v[84:87], v[68:71]
  ds_read_b128 v[84:87], v24 offset:39936
  s_waitcnt lgkmcnt(3)
  v_mfma_f32_16x16x32_bf16 v[64:67], v[160:163], v[72:75], v[64:67]
  v_mfma_f32_16x16x32_bf16 v[68:71], v[164:167], v[72:75], v[68:71]
  ds_read_b128 v[72:75], v24 offset:40960
  s_waitcnt lgkmcnt(3)
  v_mfma_f32_16x16x32_bf16 v[64:67], v[168:171], v[76:79], v[64:67]
  v_mfma_f32_16x16x32_bf16 v[68:71], v[172:175], v[76:79], v[68:71]
  ds_read_b128 v[76:79], v24 offset:41984
  s_waitcnt lgkmcnt(3)
  v_mfma_f32_16x16x32_bf16 v[64:67], v[176:179], v[80:83], v[64:67]
  v_mfma_f32_16x16x32_bf16 v[68:71], v[180:183], v[80:83], v[68:71]
  ds_read_b128 v[80:83], v24 offset:43008
  s_waitcnt lgkmcnt(3)
  v_mfma_f32_16x16x32_bf16 v[64:67], v[184:187], v[84:87], v[64:67]
  v_mfma_f32_16x16x32_bf16 v[68:71], v[188:191], v[84:87], v[68:71]
  ds_read_b128 v[84:87], v24 offset:44032
  s_waitcnt lgkmcnt(3)
  v_mfma_f32_16x16x32_bf16 v[64:67], v[192:195], v[72:75], v[64:67]
  v_mfma_f32_16x16x32_bf16 v[68:71], v[196:199], v[72:75], v[68:71]
  ds_read_b128 v[72:75], v24 offset:45056
  s_waitcnt lgkmcnt(3)
  v_mfma_f32_16x16x32_bf16 v[64:67], v[200:203], v[76:79], v[64:67]
  v_mfma_f32_16x16x32_bf16 v[68:71], v[204:207], v[76:79], v[68:71]
  ds_read_b128 v[76:79], v24 offset:46080
  s_waitcnt lgkmcnt(3)
  v_mfma_f32_16x16x32_bf16 v[64:67], v[208:211], v[80:83], v[64:67]
  v_mfma_f32_16x16x32_bf16 v[68:71], v[212:215], v[80:83], v[68:71]
  ds_read_b128 v[80:83], v24 offset:47104
  s_waitcnt lgkmcnt(3)
  v_mfma_f32_16x16x32_bf16 v[64:67], v[216:219], v[84:87], v[64:67]
  v_mfma_f32_16x16x32_bf16 v[68:71], v[220:223], v[84:87], v[68:71]
  ds_read_b128 v[84:87], v24 offset:48128
  s_waitcnt lgkmcnt(3)
  v_mfma_f32_16x16x32_bf16 v[64:67], v[224:227], v[72:75], v[64:67]
  v_mfma_f32_16x16x32_bf16 v[68:71], v[228:231], v[72:75], v[68:71]
  s_waitcnt lgkmcnt(2)
  v_mfma_f32_16x16x32_bf16 v[64:67], v[232:235], v[76:79], v[64:67]
  v_mfma_f32_16x16x32_bf16 v[68:71], v[236:239], v[76:79], v[68:71]
  s_waitcnt lgkmcnt(1)
  v_mfma_f32_16x16x32_bf16 v[64:67], v[240:243], v[80:83], v[64:67]
  v_mfma_f32_16x16x32_bf16 v[68:71], v[244:247], v[80:83], v[68:71]
  s_waitcnt lgkmcnt(0)
  v_mfma_f32_16x16x32_bf16 v[64:67], v[248:251], v[84:87], v[64:67]
  v_mfma_f32_16x16x32_bf16 v[68:71], v[252:255], v[84:87], v[68:71]
  s_waitcnt vmcnt(1)
L_C_ep:
  s_mov_b64 exec, 1
  v_mov_b32 v29, s31
  v_mov_b32 v30, 0
  buffer_store_dword v29, v30, s[8:11], s35 offen sc1
  s_mov_b64 exec, -1
  s_mul_i32 s4, s54, 81920
  s_mul_i32 s5, s36, 20480
  s_add_u32 s4, s4, s5
  s_lshl_b32 s5, s37, 2
  s_add_u32 s5, s5, s24
  s_lshl_b32 s5, s5, 10
  s_add_u32 s4, s4, s5
  s_add_u32 s4, s4, 134107136
  s_cmp_eq_u32 s36, 0
  s_cbranch_scc0 L_C_nox
  v_lshlrev_b32 v96, 16, v92
  v_and_b32 v97, 0xffff0000, v92
  v_add_f32 v64, v64, v96
  v_add_f32 v65, v65, v97
  v_lshlrev_b32 v96, 16, v93
  v_and_b32 v97, 0xffff0000, v93
  v_add_f32 v66, v66, v96
  v_add_f32 v67, v67, v97
  v_lshlrev_b32 v96, 16, v94
  v_and_b32 v97, 0xffff0000, v94
  v_add_f32 v68, v68, v96
  v_add_f32 v69, v69, v97
  v_lshlrev_b32 v96, 16, v95
  v_and_b32 v97, 0xffff0000, v95
  v_add_f32 v70, v70, v96
  v_add_f32 v71, v71, v97
L_C_nox:
  v_cvt_pk_bf16_f32 v88, v64, v65
  v_cvt_pk_bf16_f32 v89, v66, v67
  v_cvt_pk_bf16_f32 v90, v68, v69
  v_cvt_pk_bf16_f32 v91, v70, v71
  buffer_store_dwordx4 v[88:91], v20, s[8:11], s4 offen sc1
  s_add_u32 s31, s31, 1
  s_mov_b32 s34, s31
  s_cmp_lt_u32 s31, s52
  s_cbranch_scc1 L_C_top
  s_waitcnt vmcnt(0)
  s_cmp_eq_u32 s34, 0
  s_cbranch_scc1 L_C_npc
  s_mov_b64 exec, 1
  v_mov_b32 v29, s34
  v_mov_b32 v30, 0
  buffer_store_dword v29, v30, s[8:11], s35 offen sc1
  s_mov_b64 exec, -1
  s_mov_b32 s34, 0
L_C_npc:
  s_waitcnt vmcnt(0)
  s_branch L_exit
L_roleD:
  s_sub_u32 s55, s30, 108
  s_mov_b32 s53, 0
L_D_par:
  s_mov_b32 s36, s55
  s_lshl_b32 s37, s36, 2
  s_add_u32 s37, s37, s24
  s_lshl_b32 s4, s36, 7
  s_lshl_b32 s5, s24, 2
  s_add_u32 s4, s4, s5
  s_mul_i32 s5, s53, 1536
  s_add_u32 s4, s4, s5
  s_add_u32 s35, s4, 94208
  s_mov_b32 s52, 52
  s_cmp_eq_u32 s53, 1
  s_cmov_b32 s52, 12
  s_cmp_eq_u32 s53, 1
  s_cbranch_scc1 L_D_second
  s_mov_b64 exec, 1
  v_mov_b32 v28, 0
  v_mov_b32 v29, 0
  buffer_store_dword v28, v29, s[8:11], s35 offen sc1
  s_mov_b64 exec, -1
  s_load_dwordx2 s[20:21], s[0:1], 0
  s_waitcnt lgkmcnt(0)
  s_and_b32 s21, s21, 0xffff
  s_mov_b32 s22, 2621440
  s_mov_b32 s23, 0x20000
  s_lshl_b32 s4, s30, 4
  s_mul_i32 s4, s4, 1280
  s_mul_i32 s5, s24, 320
  s_add_u32 s4, s4, s5
  v_mul_u32_u24 v28, 1280, v22
  v_lshlrev_b32 v29, 4, v21
  v_add_u32 v28, v28, v29
  buffer_load_dwordx4 v[40:43], v28, s[20:23], s4 offen offset:0
  buffer_load_dwordx4 v[44:47], v28, s[20:23], s4 offen offset:64
  buffer_load_dwordx4 v[48:51], v28, s[20:23], s4 offen offset:128
  buffer_load_dwordx4 v[52:55], v28, s[20:23], s4 offen offset:192
  buffer_load_dwordx4 v[56:59], v28, s[20:23], s4 offen offset:256
  s_waitcnt vmcnt(0)
  v_lshlrev_b32 v64, 16, v40
  v_and_b32 v65, 0xffff0000, v40
  v_lshlrev_b32 v66, 16, v41
  v_and_b32 v67, 0xffff0000, v41
  v_lshlrev_b32 v68, 16, v42
  v_and_b32 v69, 0xffff0000, v42
  v_lshlrev_b32 v70, 16, v43
  v_and_b32 v71, 0xffff0000, v43
  v_lshlrev_b32 v72, 16, v44
  v_and_b32 v73, 0xffff0000, v44
  v_lshlrev_b32 v74, 16, v45
  v_and_b32 v75, 0xffff0000, v45
  v_lshlrev_b32 v76, 16, v46
  v_and_b32 v77, 0xffff0000, v46
  v_lshlrev_b32 v78, 16, v47
  v_and_b32 v79, 0xffff0000, v47
  v_lshlrev_b32 v80, 16, v48
  v_and_b32 v81, 0xffff0000, v48
  v_lshlrev_b32 v82, 16, v49
  v_and_b32 v83, 0xffff0000, v49
  v_lshlrev_b32 v84, 16, v50
  v_and_b32 v85, 0xffff0000, v50
  v_lshlrev_b32 v86, 16, v51
  v_and_b32 v87, 0xffff0000, v51
  v_lshlrev_b32 v88, 16, v52
  v_and_b32 v89, 0xffff0000, v52
  v_lshlrev_b32 v90, 16, v53
  v_and_b32 v91, 0xffff0000, v53
  v_lshlrev_b32 v92, 16, v54
  v_and_b32 v93, 0xffff0000, v54
  v_lshlrev_b32 v94, 16, v55
  v_and_b32 v95, 0xffff0000, v55
  v_lshlrev_b32 v96, 16, v56
  v_and_b32 v97, 0xffff0000, v56
  v_lshlrev_b32 v98, 16, v57
  v_and_b32 v99, 0xffff0000, v57
  v_lshlrev_b32 v100, 16, v58
  v_and_b32 v101, 0xffff0000, v58
  v_lshlrev_b32 v102, 16, v59
  v_and_b32 v103, 0xffff0000, v59
  s_mov_b32 s47, 131072
  v_pk_add_f32 v[104:105], v[64:65], v[66:67]
  v_pk_mul_f32 v[106:107], v[64:65], v[64:65]
  v_pk_fma_f32 v[106:107], v[66:67], v[66:67], v[106:107]
  v_pk_add_f32 v[104:105], v[104:105], v[68:69]
  v_pk_fma_f32 v[106:107], v[68:69], v[68:69], v[106:107]
  v_pk_add_f32 v[104:105], v[104:105], v[70:71]
  v_pk_fma_f32 v[106:107], v[70:71], v[70:71], v[106:107]
  v_pk_add_f32 v[104:105], v[104:105], v[72:73]
  v_pk_fma_f32 v[106:107], v[72:73], v[72:73], v[106:107]
  v_pk_add_f32 v[104:105], v[104:105], v[74:75]
  v_pk_fma_f32 v[106:107], v[74:75], v[74:75], v[106:107]
  v_pk_add_f32 v[104:105], v[104:105], v[76:77]
  v_pk_fma_f32 v[106:107], v[76:77], v[76:77], v[106:107]
  v_pk_add_f32 v[104:105], v[104:105], v[78:79]
  v_pk_fma_f32 v[106:107], v[78:79], v[78:79], v[106:107]
  v_pk_add_f32 v[104:105], v[104:105], v[80:81]
  v_pk_fma_f32 v[106:107], v[80:81], v[80:81], v[106:107]
  v_pk_add_f32 v[104:105], v[104:105], v[82:83]
  v_pk_fma_f32 v[106:107], v[82:83], v[82:83], v[106:107]
  v_pk_add_f32 v[104:105], v[104:105], v[84:85]
  v_pk_fma_f32 v[106:107], v[84:85], v[84:85], v[106:107]
  v_pk_add_f32 v[104:105], v[104:105], v[86:87]
  v_pk_fma_f32 v[106:107], v[86:87], v[86:87], v[106:107]
  v_pk_add_f32 v[104:105], v[104:105], v[88:89]
  v_pk_fma_f32 v[106:107], v[88:89], v[88:89], v[106:107]
  v_pk_add_f32 v[104:105], v[104:105], v[90:91]
  v_pk_fma_f32 v[106:107], v[90:91], v[90:91], v[106:107]
  v_pk_add_f32 v[104:105], v[104:105], v[92:93]
  v_pk_fma_f32 v[106:107], v[92:93], v[92:93], v[106:107]
  v_pk_add_f32 v[104:105], v[104:105], v[94:95]
  v_pk_fma_f32 v[106:107], v[94:95], v[94:95], v[106:107]
  v_pk_add_f32 v[104:105], v[104:105], v[96:97]
  v_pk_fma_f32 v[106:107], v[96:97], v[96:97], v[106:107]
  v_pk_add_f32 v[104:105], v[104:105], v[98:99]
  v_pk_fma_f32 v[106:107], v[98:99], v[98:99], v[106:107]
  v_pk_add_f32 v[104:105], v[104:105], v[100:101]
  v_pk_fma_f32 v[106:107], v[100:101], v[100:101], v[106:107]
  v_pk_add_f32 v[104:105], v[104:105], v[102:103]
  v_pk_fma_f32 v[106:107], v[102:103], v[102:103], v[106:107]
  v_add_f32 v104, v104, v105
  v_add_f32 v105, v106, v107
  v_mov_b32 v108, v104
  v_mov_b32 v109, v105
  s_nop 0
  v_permlane16_swap_b32 v104, v108
  v_permlane16_swap_b32 v105, v109
  v_pk_add_f32 v[104:105], v[104:105], v[108:109]
  v_mov_b32 v108, v104
  v_mov_b32 v109, v105
  s_nop 0
  v_permlane32_swap_b32 v104, v108
  v_permlane32_swap_b32 v105, v109
  v_pk_add_f32 v[104:105], v[104:105], v[108:109]
  v_lshlrev_b32 v108, 3, v22
  v_add_u32 v108, s47, v108
  s_lshl_b32 s4, s24, 7
  v_add_u32 v109, s4, v108
  ds_write_b64 v109, v[104:105]
  s_waitcnt lgkmcnt(0)
  s_barrier
  ds_read_b64 v[104:105], v108
  ds_read_b64 v[106:107], v108 offset:128
  ds_read_b64 v[110:111], v108 offset:256
  ds_read_b64 v[112:113], v108 offset:384
  s_waitcnt lgkmcnt(2)
  v_pk_add_f32 v[104:105], v[104:105], v[106:107]
  s_waitcnt lgkmcnt(0)
  v_pk_add_f32 v[106:107], v[110:111], v[112:113]
  v_pk_add_f32 v[104:105], v[104:105], v[106:107]
  v_mul_f32 v104, 986500301, v104
  v_mul_f32 v106, v104, v104
  v_mov_b32 v107, 925353388
  v_fmac_f32 v107, 986500301, v105
  v_sub_f32 v107, v107, v106
  v_max_f32 v107, 925353388, v107
  v_rsq_f32 v106, v107
  s_nop 0
  v_mul_f32 v104, v104, v106
  v_pk_fma_f32 v[64:65], v[64:65], v[106:107], v[104:105] op_sel_hi:[1,0,0] neg_lo:[0,0,1] neg_hi:[0,0,1]
  v_pk_fma_f32 v[66:67], v[66:67], v[106:107], v[104:105] op_sel_hi:[1,0,0] neg_lo:[0,0,1] neg_hi:[0,0,1]
  v_pk_fma_f32 v[68:69], v[68:69], v[106:107], v[104:105] op_sel_hi:[1,0,0] neg_lo:[0,0,1] neg_hi:[0,0,1]
  v_pk_fma_f32 v[70:71], v[70:71], v[106:107], v[104:105] op_sel_hi:[1,0,0] neg_lo:[0,0,1] neg_hi:[0,0,1]
  v_pk_fma_f32 v[72:73], v[72:73], v[106:107], v[104:105] op_sel_hi:[1,0,0] neg_lo:[0,0,1] neg_hi:[0,0,1]
  v_pk_fma_f32 v[74:75], v[74:75], v[106:107], v[104:105] op_sel_hi:[1,0,0] neg_lo:[0,0,1] neg_hi:[0,0,1]
  v_pk_fma_f32 v[76:77], v[76:77], v[106:107], v[104:105] op_sel_hi:[1,0,0] neg_lo:[0,0,1] neg_hi:[0,0,1]
  v_pk_fma_f32 v[78:79], v[78:79], v[106:107], v[104:105] op_sel_hi:[1,0,0] neg_lo:[0,0,1] neg_hi:[0,0,1]
  v_pk_fma_f32 v[80:81], v[80:81], v[106:107], v[104:105] op_sel_hi:[1,0,0] neg_lo:[0,0,1] neg_hi:[0,0,1]
  v_pk_fma_f32 v[82:83], v[82:83], v[106:107], v[104:105] op_sel_hi:[1,0,0] neg_lo:[0,0,1] neg_hi:[0,0,1]
  v_pk_fma_f32 v[84:85], v[84:85], v[106:107], v[104:105] op_sel_hi:[1,0,0] neg_lo:[0,0,1] neg_hi:[0,0,1]
  v_pk_fma_f32 v[86:87], v[86:87], v[106:107], v[104:105] op_sel_hi:[1,0,0] neg_lo:[0,0,1] neg_hi:[0,0,1]
  v_pk_fma_f32 v[88:89], v[88:89], v[106:107], v[104:105] op_sel_hi:[1,0,0] neg_lo:[0,0,1] neg_hi:[0,0,1]
  v_pk_fma_f32 v[90:91], v[90:91], v[106:107], v[104:105] op_sel_hi:[1,0,0] neg_lo:[0,0,1] neg_hi:[0,0,1]
  v_pk_fma_f32 v[92:93], v[92:93], v[106:107], v[104:105] op_sel_hi:[1,0,0] neg_lo:[0,0,1] neg_hi:[0,0,1]
  v_pk_fma_f32 v[94:95], v[94:95], v[106:107], v[104:105] op_sel_hi:[1,0,0] neg_lo:[0,0,1] neg_hi:[0,0,1]
  v_pk_fma_f32 v[96:97], v[96:97], v[106:107], v[104:105] op_sel_hi:[1,0,0] neg_lo:[0,0,1] neg_hi:[0,0,1]
  v_pk_fma_f32 v[98:99], v[98:99], v[106:107], v[104:105] op_sel_hi:[1,0,0] neg_lo:[0,0,1] neg_hi:[0,0,1]
  v_pk_fma_f32 v[100:101], v[100:101], v[106:107], v[104:105] op_sel_hi:[1,0,0] neg_lo:[0,0,1] neg_hi:[0,0,1]
  v_pk_fma_f32 v[102:103], v[102:103], v[106:107], v[104:105] op_sel_hi:[1,0,0] neg_lo:[0,0,1] neg_hi:[0,0,1]
  v_cvt_pk_bf16_f32 v40, v64, v65
  v_cvt_pk_bf16_f32 v41, v66, v67
  v_cvt_pk_bf16_f32 v42, v68, v69
  v_cvt_pk_bf16_f32 v43, v70, v71
  v_cvt_pk_bf16_f32 v44, v72, v73
  v_cvt_pk_bf16_f32 v45, v74, v75
  v_cvt_pk_bf16_f32 v46, v76, v77
  v_cvt_pk_bf16_f32 v47, v78, v79
  v_cvt_pk_bf16_f32 v48, v80, v81
  v_cvt_pk_bf16_f32 v49, v82, v83
  v_cvt_pk_bf16_f32 v50, v84, v85
  v_cvt_pk_bf16_f32 v51, v86, v87
  v_cvt_pk_bf16_f32 v52, v88, v89
  v_cvt_pk_bf16_f32 v53, v90, v91
  v_cvt_pk_bf16_f32 v54, v92, v93
  v_cvt_pk_bf16_f32 v55, v94, v95
  v_cvt_pk_bf16_f32 v56, v96, v97
  v_cvt_pk_bf16_f32 v57, v98, v99
  v_cvt_pk_bf16_f32 v58, v100, v101
  v_cvt_pk_bf16_f32 v59, v102, v103
  s_lshr_b32 s4, s30, 1
  s_mul_i32 s4, s4, 40960
  s_and_b32 s5, s30, 1
  s_lshl_b32 s5, s5, 10
  s_add_u32 s4, s4, s5
  s_mul_i32 s5, s24, 10240
  s_add_u32 s4, s4, s5
  s_add_u32 s4, s4, 5656576
  s_add_u32 s5, s4, 0
  buffer_store_dwordx4 v[40:43], v20, s[8:11], s5 offen sc1
  s_add_u32 s5, s4, 2048
  buffer_store_dwordx4 v[44:47], v20, s[8:11], s5 offen sc1
  s_add_u32 s5, s4, 4096
  buffer_store_dwordx4 v[48:51], v20, s[8:11], s5 offen sc1
  s_add_u32 s5, s4, 6144
  buffer_store_dwordx4 v[52:55], v20, s[8:11], s5 offen sc1
  s_add_u32 s5, s4, 8192
  buffer_store_dwordx4 v[56:59], v20, s[8:11], s5 offen sc1
  s_waitcnt vmcnt(0)
  s_barrier
  s_cmp_eq_u32 s24, 0
  s_cbranch_scc0 L_ia_D
  s_mov_b64 exec, 1
  v_mov_b32 v1, 36
  v_mov_b32 v2, 1
  buffer_atomic_add v2, v1, s[12:15], 0 offen
  s_mov_b64 exec, -1
L_ia_D:
L_D_second:
  s_load_dwordx2 s[16:17], s[0:1], 64
  s_waitcnt lgkmcnt(0)
  s_and_b32 s17, s17, 0xffff
  s_mov_b32 s18, 1966080
  s_mov_b32 s19, 0x20000
  s_load_dwordx2 s[20:21], s[0:1], 72
  s_waitcnt lgkmcnt(0)
  s_and_b32 s21, s21, 0xffff
  s_mov_b32 s22, 1966080
  s_mov_b32 s23, 0x20000
  s_lshl_b32 s44, s36, 8
  s_lshl_b32 s45, s24, 6
  v_lshrrev_b32 v28, 4, v0
  v_and_b32 v29, 15, v0
  v_mul_u32_u24 v32, 3072, v28
  v_lshlrev_b32 v29, 4, v29
  v_add_u32 v32, v32, v29
  v_bfe_u32 v28, v0, 2, 2
  v_and_b32 v29, 3, v0
  v_mul_u32_u24 v30, 4, v21
  v_add_u32 v30, v30, v28
  v_mul_u32_u24 v30, 256, v30
  v_lshlrev_b32 v29, 3, v29
  v_add_u32 v30, v30, v29
  v_add_u32 v30, s45, v30
  v_mov_b32 v36, v30
  v_lshrrev_b32 v28, 4, v0
  v_and_b32 v29, 15, v0
  v_mul_u32_u24 v33, 3072, v28
  v_lshlrev_b32 v29, 4, v29
  v_add_u32 v33, v33, v29
  v_bfe_u32 v28, v0, 2, 2
  v_and_b32 v29, 3, v0
  v_mul_u32_u24 v30, 4, v21
  v_add_u32 v30, v30, v28
  v_mul_u32_u24 v30, 256, v30
  v_lshlrev_b32 v29, 3, v29
  v_add_u32 v30, v30, v29
  v_add_u32 v30, s45, v30
  v_mov_b32 v37, v30
  s_lshl_b32 s4, s24, 10
  s_add_u32 s4, s4, 0
  s_mov_b32 m0, s4
  s_mul_i32 s5, s24, 12288
  s_add_u32 s5, s5, 0
  s_add_u32 s5, s5, s44
  buffer_load_dwordx4 v32, s[16:19], s5 offen lds
  s_lshl_b32 s4, s24, 10
  s_add_u32 s4, s4, 4096
  s_mov_b32 m0, s4
  s_mul_i32 s5, s24, 12288
  s_add_u32 s5, s5, 49152
  s_add_u32 s5, s5, s44
  buffer_load_dwordx4 v32, s[16:19], s5 offen lds
  s_lshl_b32 s4, s24, 10
  s_add_u32 s4, s4, 8192
  s_mov_b32 m0, s4
  s_mul_i32 s5, s24, 12288
  s_add_u32 s5, s5, 98304
  s_add_u32 s5, s5, s44
  buffer_load_dwordx4 v32, s[16:19], s5 offen lds
  s_lshl_b32 s4, s24, 10
  s_add_u32 s4, s4, 12288
  s_mov_b32 m0, s4
  s_mul_i32 s5, s24, 12288
  s_add_u32 s5, s5, 147456
  s_add_u32 s5, s5, s44
  buffer_load_dwordx4 v32, s[16:19], s5 offen lds
  s_lshl_b32 s4, s24, 10
  s_add_u32 s4, s4, 16384
  s_mov_b32 m0, s4
  s_mul_i32 s5, s24, 12288
  s_add_u32 s5, s5, 196608
  s_add_u32 s5, s5, s44
  buffer_load_dwordx4 v32, s[16:19], s5 offen lds
  s_lshl_b32 s4, s24, 10
  s_add_u32 s4, s4, 20480
  s_mov_b32 m0, s4
  s_mul_i32 s5, s24, 12288
  s_add_u32 s5, s5, 245760
  s_add_u32 s5, s5, s44
  buffer_load_dwordx4 v32, s[16:19], s5 offen lds
  s_lshl_b32 s4, s24, 10
  s_add_u32 s4, s4, 24576
  s_mov_b32 m0, s4
  s_mul_i32 s5, s24, 12288
  s_add_u32 s5, s5, 294912
  s_add_u32 s5, s5, s44
  buffer_load_dwordx4 v32, s[16:19], s5 offen lds
  s_lshl_b32 s4, s24, 10
  s_add_u32 s4, s4, 28672
  s_mov_b32 m0, s4
  s_mul_i32 s5, s24, 12288
  s_add_u32 s5, s5, 344064
  s_add_u32 s5, s5, s44
  buffer_load_dwordx4 v32, s[16:19], s5 offen lds
  s_lshl_b32 s4, s24, 10
  s_add_u32 s4, s4, 32768
  s_mov_b32 m0, s4
  s_mul_i32 s5, s24, 12288
  s_add_u32 s5, s5, 0
  s_add_u32 s5, s5, s44
  buffer_load_dwordx4 v33, s[20:23], s5 offen lds
  s_lshl_b32 s4, s24, 10
  s_add_u32 s4, s4, 36864
  s_mov_b32 m0, s4
  s_mul_i32 s5, s24, 12288
  s_add_u32 s5, s5, 49152
  s_add_u32 s5, s5, s44
  buffer_load_dwordx4 v33, s[20:23], s5 offen lds
  s_lshl_b32 s4, s24, 10
  s_add_u32 s4, s4, 40960
  s_mov_b32 m0, s4
  s_mul_i32 s5, s24, 12288
  s_add_u32 s5, s5, 98304
  s_add_u32 s5, s5, s44
  buffer_load_dwordx4 v33, s[20:23], s5 offen lds
  s_lshl_b32 s4, s24, 10
  s_add_u32 s4, s4, 45056
  s_mov_b32 m0, s4
  s_mul_i32 s5, s24, 12288
  s_add_u32 s5, s5, 147456
  s_add_u32 s5, s5, s44
  buffer_load_dwordx4 v33, s[20:23], s5 offen lds
  s_lshl_b32 s4, s24, 10
  s_add_u32 s4, s4, 49152
  s_mov_b32 m0, s4
  s_mul_i32 s5, s24, 12288
  s_add_u32 s5, s5, 196608
  s_add_u32 s5, s5, s44
  buffer_load_dwordx4 v33, s[20:23], s5 offen lds
  s_lshl_b32 s4, s24, 10
  s_add_u32 s4, s4, 53248
  s_mov_b32 m0, s4
  s_mul_i32 s5, s24, 12288
  s_add_u32 s5, s5, 245760
  s_add_u32 s5, s5, s44
  buffer_load_dwordx4 v33, s[20:23], s5 offen lds
  s_lshl_b32 s4, s24, 10
  s_add_u32 s4, s4, 57344
  s_mov_b32 m0, s4
  s_mul_i32 s5, s24, 12288
  s_add_u32 s5, s5, 294912
  s_add_u32 s5, s5, s44
  buffer_load_dwordx4 v33, s[20:23], s5 offen lds
  s_lshl_b32 s4, s24, 10
  s_add_u32 s4, s4, 61440
  s_mov_b32 m0, s4
  s_mul_i32 s5, s24, 12288
  s_add_u32 s5, s5, 344064
  s_add_u32 s5, s5, s44
  buffer_load_dwordx4 v33, s[20:23], s5 offen lds
  s_lshl_b32 s4, s24, 10
  s_add_u32 s4, s4, 65536
  s_mov_b32 m0, s4
  s_mul_i32 s5, s24, 12288
  s_add_u32 s5, s5, 393216
  s_add_u32 s5, s5, s44
  buffer_load_dwordx4 v32, s[16:19], s5 offen lds
  s_lshl_b32 s4, s24, 10
  s_add_u32 s4, s4, 69632
  s_mov_b32 m0, s4
  s_mul_i32 s5, s24, 12288
  s_add_u32 s5, s5, 442368
  s_add_u32 s5, s5, s44
  buffer_load_dwordx4 v32, s[16:19], s5 offen lds
  s_lshl_b32 s4, s24, 10
  s_add_u32 s4, s4, 73728
  s_mov_b32 m0, s4
  s_mul_i32 s5, s24, 12288
  s_add_u32 s5, s5, 491520
  s_add_u32 s5, s5, s44
  buffer_load_dwordx4 v32, s[16:19], s5 offen lds
  s_lshl_b32 s4, s24, 10
  s_add_u32 s4, s4, 77824
  s_mov_b32 m0, s4
  s_mul_i32 s5, s24, 12288
  s_add_u32 s5, s5, 540672
  s_add_u32 s5, s5, s44
  buffer_load_dwordx4 v32, s[16:19], s5 offen lds
  s_lshl_b32 s4, s24, 10
  s_add_u32 s4, s4, 81920
  s_mov_b32 m0, s4
  s_mul_i32 s5, s24, 12288
  s_add_u32 s5, s5, 589824
  s_add_u32 s5, s5, s44
  buffer_load_dwordx4 v32, s[16:19], s5 offen lds
  s_lshl_b32 s4, s24, 10
  s_add_u32 s4, s4, 86016
  s_mov_b32 m0, s4
  s_mul_i32 s5, s24, 12288
  s_add_u32 s5, s5, 638976
  s_add_u32 s5, s5, s44
  buffer_load_dwordx4 v32, s[16:19], s5 offen lds
  s_lshl_b32 s4, s24, 10
  s_add_u32 s4, s4, 90112
  s_mov_b32 m0, s4
  s_mul_i32 s5, s24, 12288
  s_add_u32 s5, s5, 688128
  s_add_u32 s5, s5, s44
  buffer_load_dwordx4 v32, s[16:19], s5 offen lds
  s_lshl_b32 s4, s24, 10
  s_add_u32 s4, s4, 94208
  s_mov_b32 m0, s4
  s_mul_i32 s5, s24, 12288
  s_add_u32 s5, s5, 737280
  s_add_u32 s5, s5, s44
  buffer_load_dwordx4 v32, s[16:19], s5 offen lds
  s_lshl_b32 s4, s24, 10
  s_add_u32 s4, s4, 98304
  s_mov_b32 m0, s4
  s_mul_i32 s5, s24, 12288
  s_add_u32 s5, s5, 393216
  s_add_u32 s5, s5, s44
  buffer_load_dwordx4 v33, s[20:23], s5 offen lds
  s_lshl_b32 s4, s24, 10
  s_add_u32 s4, s4, 102400
  s_mov_b32 m0, s4
  s_mul_i32 s5, s24, 12288
  s_add_u32 s5, s5, 442368
  s_add_u32 s5, s5, s44
  buffer_load_dwordx4 v33, s[20:23], s5 offen lds
  s_lshl_b32 s4, s24, 10
  s_add_u32 s4, s4, 106496
  s_mov_b32 m0, s4
  s_mul_i32 s5, s24, 12288
  s_add_u32 s5, s5, 491520
  s_add_u32 s5, s5, s44
  buffer_load_dwordx4 v33, s[20:23], s5 offen lds
  s_lshl_b32 s4, s24, 10
  s_add_u32 s4, s4, 110592
  s_mov_b32 m0, s4
  s_mul_i32 s5, s24, 12288
  s_add_u32 s5, s5, 540672
  s_add_u32 s5, s5, s44
  buffer_load_dwordx4 v33, s[20:23], s5 offen lds
  s_lshl_b32 s4, s24, 10
  s_add_u32 s4, s4, 114688
  s_mov_b32 m0, s4
  s_mul_i32 s5, s24, 12288
  s_add_u32 s5, s5, 589824
  s_add_u32 s5, s5, s44
  buffer_load_dwordx4 v33, s[20:23], s5 offen lds
  s_lshl_b32 s4, s24, 10
  s_add_u32 s4, s4, 118784
  s_mov_b32 m0, s4
  s_mul_i32 s5, s24, 12288
  s_add_u32 s5, s5, 638976
  s_add_u32 s5, s5, s44
  buffer_load_dwordx4 v33, s[20:23], s5 offen lds
  s_lshl_b32 s4, s24, 10
  s_add_u32 s4, s4, 122880
  s_mov_b32 m0, s4
  s_mul_i32 s5, s24, 12288
  s_add_u32 s5, s5, 688128
  s_add_u32 s5, s5, s44
  buffer_load_dwordx4 v33, s[20:23], s5 offen lds
  s_lshl_b32 s4, s24, 10
  s_add_u32 s4, s4, 126976
  s_mov_b32 m0, s4
  s_mul_i32 s5, s24, 12288
  s_add_u32 s5, s5, 737280
  s_add_u32 s5, s5, s44
  buffer_load_dwordx4 v33, s[20:23], s5 offen lds
  s_waitcnt vmcnt(16)
  s_barrier
  ds_read_b64_tr_b16 a[0:1], v36 offset:0
  ds_read_b64_tr_b16 a[2:3], v36 offset:4096
  ds_read_b64_tr_b16 a[4:5], v36 offset:32
  ds_read_b64_tr_b16 a[6:7], v36 offset:4128
  ds_read_b64_tr_b16 a[8:9], v37 offset:32768
  ds_read_b64_tr_b16 a[10:11], v37 offset:36864
  ds_read_b64_tr_b16 a[12:13], v37 offset:32800
  ds_read_b64_tr_b16 a[14:15], v37 offset:36896
  ds_read_b64_tr_b16 a[16:17], v36 offset:8192
  ds_read_b64_tr_b16 a[18:19], v36 offset:12288
  ds_read_b64_tr_b16 a[20:21], v36 offset:8224
  ds_read_b64_tr_b16 a[22:23], v36 offset:12320
  s_waitcnt lgkmcnt(0)
  ds_read_b64_tr_b16 a[24:25], v37 offset:40960
  ds_read_b64_tr_b16 a[26:27], v37 offset:45056
  ds_read_b64_tr_b16 a[28:29], v37 offset:40992
  ds_read_b64_tr_b16 a[30:31], v37 offset:45088
  ds_read_b64_tr_b16 a[32:33], v36 offset:16384
  ds_read_b64_tr_b16 a[34:35], v36 offset:20480
  ds_read_b64_tr_b16 a[36:37], v36 offset:16416
  ds_read_b64_tr_b16 a[38:39], v36 offset:20512
  ds_read_b64_tr_b16 a[40:41], v37 offset:49152
  ds_read_b64_tr_b16 a[42:43], v37 offset:53248
  ds_read_b64_tr_b16 a[44:45], v37 offset:49184
  ds_read_b64_tr_b16 a[46:47], v37 offset:53280
  s_waitcnt lgkmcnt(0)
  ds_read_b64_tr_b16 a[48:49], v36 offset:24576
  ds_read_b64_tr_b16 a[50:51], v36 offset:28672
  ds_read_b64_tr_b16 a[52:53], v36 offset:24608
  ds_read_b64_tr_b16 a[54:55], v36 offset:28704
  ds_read_b64_tr_b16 a[56:57], v37 offset:57344
  ds_read_b64_tr_b16 a[58:59], v37 offset:61440
  ds_read_b64_tr_b16 a[60:61], v37 offset:57376
  ds_read_b64_tr_b16 a[62:63], v37 offset:61472
  s_waitcnt lgkmcnt(0)
  s_barrier
  s_lshl_b32 s4, s24, 10
  s_add_u32 s4, s4, 0
  s_mov_b32 m0, s4
  s_mul_i32 s5, s24, 12288
  s_add_u32 s5, s5, 786432
  s_add_u32 s5, s5, s44
  buffer_load_dwordx4 v32, s[16:19], s5 offen lds
  s_lshl_b32 s4, s24, 10
  s_add_u32 s4, s4, 4096
  s_mov_b32 m0, s4
  s_mul_i32 s5, s24, 12288
  s_add_u32 s5, s5, 835584
  s_add_u32 s5, s5, s44
  buffer_load_dwordx4 v32, s[16:19], s5 offen lds
  s_lshl_b32 s4, s24, 10
  s_add_u32 s4, s4, 8192
  s_mov_b32 m0, s4
  s_mul_i32 s5, s24, 12288
  s_add_u32 s5, s5, 884736
  s_add_u32 s5, s5, s44
  buffer_load_dwordx4 v32, s[16:19], s5 offen lds
  s_lshl_b32 s4, s24, 10
  s_add_u32 s4, s4, 12288
  s_mov_b32 m0, s4
  s_mul_i32 s5, s24, 12288
  s_add_u32 s5, s5, 933888
  s_add_u32 s5, s5, s44
  buffer_load_dwordx4 v32, s[16:19], s5 offen lds
  s_lshl_b32 s4, s24, 10
  s_add_u32 s4, s4, 16384
  s_mov_b32 m0, s4
  s_mul_i32 s5, s24, 12288
  s_add_u32 s5, s5, 983040
  s_add_u32 s5, s5, s44
  buffer_load_dwordx4 v32, s[16:19], s5 offen lds
  s_lshl_b32 s4, s24, 10
  s_add_u32 s4, s4, 20480
  s_mov_b32 m0, s4
  s_mul_i32 s5, s24, 12288
  s_add_u32 s5, s5, 1032192
  s_add_u32 s5, s5, s44
  buffer_load_dwordx4 v32, s[16:19], s5 offen lds
  s_lshl_b32 s4, s24, 10
  s_add_u32 s4, s4, 24576
  s_mov_b32 m0, s4
  s_mul_i32 s5, s24, 12288
  s_add_u32 s5, s5, 1081344
  s_add_u32 s5, s5, s44
  buffer_load_dwordx4 v32, s[16:19], s5 offen lds
  s_lshl_b32 s4, s24, 10
  s_add_u32 s4, s4, 28672
  s_mov_b32 m0, s4
  s_mul_i32 s5, s24, 12288
  s_add_u32 s5, s5, 1130496
  s_add_u32 s5, s5, s44
  buffer_load_dwordx4 v32, s[16:19], s5 offen lds
  s_lshl_b32 s4, s24, 10
  s_add_u32 s4, s4, 32768
  s_mov_b32 m0, s4
  s_mul_i32 s5, s24, 12288
  s_add_u32 s5, s5, 786432
  s_add_u32 s5, s5, s44
  buffer_load_dwordx4 v33, s[20:23], s5 offen lds
  s_lshl_b32 s4, s24, 10
  s_add_u32 s4, s4, 36864
  s_mov_b32 m0, s4
  s_mul_i32 s5, s24, 12288
  s_add_u32 s5, s5, 835584
  s_add_u32 s5, s5, s44
  buffer_load_dwordx4 v33, s[20:23], s5 offen lds
  s_lshl_b32 s4, s24, 10
  s_add_u32 s4, s4, 40960
  s_mov_b32 m0, s4
  s_mul_i32 s5, s24, 12288
  s_add_u32 s5, s5, 884736
  s_add_u32 s5, s5, s44
  buffer_load_dwordx4 v33, s[20:23], s5 offen lds
  s_lshl_b32 s4, s24, 10
  s_add_u32 s4, s4, 45056
  s_mov_b32 m0, s4
  s_mul_i32 s5, s24, 12288
  s_add_u32 s5, s5, 933888
  s_add_u32 s5, s5, s44
  buffer_load_dwordx4 v33, s[20:23], s5 offen lds
  s_lshl_b32 s4, s24, 10
  s_add_u32 s4, s4, 49152
  s_mov_b32 m0, s4
  s_mul_i32 s5, s24, 12288
  s_add_u32 s5, s5, 983040
  s_add_u32 s5, s5, s44
  buffer_load_dwordx4 v33, s[20:23], s5 offen lds
  s_lshl_b32 s4, s24, 10
  s_add_u32 s4, s4, 53248
  s_mov_b32 m0, s4
  s_mul_i32 s5, s24, 12288
  s_add_u32 s5, s5, 1032192
  s_add_u32 s5, s5, s44
  buffer_load_dwordx4 v33, s[20:23], s5 offen lds
  s_lshl_b32 s4, s24, 10
  s_add_u32 s4, s4, 57344
  s_mov_b32 m0, s4
  s_mul_i32 s5, s24, 12288
  s_add_u32 s5, s5, 1081344
  s_add_u32 s5, s5, s44
  buffer_load_dwordx4 v33, s[20:23], s5 offen lds
  s_lshl_b32 s4, s24, 10
  s_add_u32 s4, s4, 61440
  s_mov_b32 m0, s4
  s_mul_i32 s5, s24, 12288
  s_add_u32 s5, s5, 1130496
  s_add_u32 s5, s5, s44
  buffer_load_dwordx4 v33, s[20:23], s5 offen lds
  s_waitcnt vmcnt(16)
  s_barrier
  v_add_u32 v28, 65536, v36
  ds_read_b64_tr_b16 a[64:65], v28 offset:0
  v_add_u32 v28, 65536, v36
  ds_read_b64_tr_b16 a[66:67], v28 offset:4096
  v_add_u32 v28, 65536, v36
  ds_read_b64_tr_b16 a[68:69], v28 offset:32
  v_add_u32 v28, 65536, v36
  ds_read_b64_tr_b16 a[70:71], v28 offset:4128
  v_add_u32 v28, 65536, v37
  ds_read_b64_tr_b16 a[72:73], v28 offset:32768
  v_add_u32 v28, 65536, v37
  ds_read_b64_tr_b16 a[74:75], v28 offset:36864
  v_add_u32 v28, 65536, v37
  ds_read_b64_tr_b16 a[76:77], v28 offset:32800
  v_add_u32 v28, 65536, v37
  ds_read_b64_tr_b16 a[78:79], v28 offset:36896
  v_add_u32 v28, 65536, v36
  ds_read_b64_tr_b16 a[80:81], v28 offset:8192
  v_add_u32 v28, 65536, v36
  ds_read_b64_tr_b16 a[82:83], v28 offset:12288
  v_add_u32 v28, 65536, v36
  ds_read_b64_tr_b16 a[84:85], v28 offset:8224
  v_add_u32 v28, 65536, v36
  ds_read_b64_tr_b16 a[86:87], v28 offset:12320
  s_waitcnt lgkmcnt(0)
  v_add_u32 v28, 65536, v37
  ds_read_b64_tr_b16 a[88:89], v28 offset:40960
  v_add_u32 v28, 65536, v37
  ds_read_b64_tr_b16 a[90:91], v28 offset:45056
  v_add_u32 v28, 65536, v37
  ds_read_b64_tr_b16 a[92:93], v28 offset:40992
  v_add_u32 v28, 65536, v37
  ds_read_b64_tr_b16 a[94:95], v28 offset:45088
  v_add_u32 v28, 65536, v36
  ds_read_b64_tr_b16 a[96:97], v28 offset:16384
  v_add_u32 v28, 65536, v36
  ds_read_b64_tr_b16 a[98:99], v28 offset:20480
  v_add_u32 v28, 65536, v36
  ds_read_b64_tr_b16 a[100:101], v28 offset:16416
  v_add_u32 v28, 65536, v36
  ds_read_b64_tr_b16 a[102:103], v28 offset:20512
  v_add_u32 v28, 65536, v37
  ds_read_b64_tr_b16 a[104:105], v28 offset:49152
  v_add_u32 v28, 65536, v37
  ds_read_b64_tr_b16 a[106:107], v28 offset:53248
  v_add_u32 v28, 65536, v37
  ds_read_b64_tr_b16 a[108:109], v28 offset:49184
  v_add_u32 v28, 65536, v37
  ds_read_b64_tr_b16 a[110:111], v28 offset:53280
  s_waitcnt lgkmcnt(0)
  v_add_u32 v28, 65536, v36
  ds_read_b64_tr_b16 a[112:113], v28 offset:24576
  v_add_u32 v28, 65536, v36
  ds_read_b64_tr_b16 a[114:115], v28 offset:28672
  v_add_u32 v28, 65536, v36
  ds_read_b64_tr_b16 a[116:117], v28 offset:24608
  v_add_u32 v28, 65536, v36
  ds_read_b64_tr_b16 a[118:119], v28 offset:28704
  v_add_u32 v28, 65536, v37
  ds_read_b64_tr_b16 a[120:121], v28 offset:57344
  v_add_u32 v28, 65536, v37
  ds_read_b64_tr_b16 a[122:123], v28 offset:61440
  v_add_u32 v28, 65536, v37
  ds_read_b64_tr_b16 a[124:125], v28 offset:57376
  v_add_u32 v28, 65536, v37
  ds_read_b64_tr_b16 a[126:127], v28 offset:61472
  s_waitcnt lgkmcnt(0)
  s_barrier
  s_lshl_b32 s4, s24, 10
  s_add_u32 s4, s4, 65536
  s_mov_b32 m0, s4
  s_mul_i32 s5, s24, 12288
  s_add_u32 s5, s5, 1179648
  s_add_u32 s5, s5, s44
  buffer_load_dwordx4 v32, s[16:19], s5 offen lds
  s_lshl_b32 s4, s24, 10
  s_add_u32 s4, s4, 69632
  s_mov_b32 m0, s4
  s_mul_i32 s5, s24, 12288
  s_add_u32 s5, s5, 1228800
  s_add_u32 s5, s5, s44
  buffer_load_dwordx4 v32, s[16:19], s5 offen lds
  s_lshl_b32 s4, s24, 10
  s_add_u32 s4, s4, 73728
  s_mov_b32 m0, s4
  s_mul_i32 s5, s24, 12288
  s_add_u32 s5, s5, 1277952
  s_add_u32 s5, s5, s44
  buffer_load_dwordx4 v32, s[16:19], s5 offen lds
  s_lshl_b32 s4, s24, 10
  s_add_u32 s4, s4, 77824
  s_mov_b32 m0, s4
  s_mul_i32 s5, s24, 12288
  s_add_u32 s5, s5, 1327104
  s_add_u32 s5, s5, s44
  buffer_load_dwordx4 v32, s[16:19], s5 offen lds
  s_lshl_b32 s4, s24, 10
  s_add_u32 s4, s4, 81920
  s_mov_b32 m0, s4
  s_mul_i32 s5, s24, 12288
  s_add_u32 s5, s5, 1376256
  s_add_u32 s5, s5, s44
  buffer_load_dwordx4 v32, s[16:19], s5 offen lds
  s_lshl_b32 s4, s24, 10
  s_add_u32 s4, s4, 86016
  s_mov_b32 m0, s4
  s_mul_i32 s5, s24, 12288
  s_add_u32 s5, s5, 1425408
  s_add_u32 s5, s5, s44
  buffer_load_dwordx4 v32, s[16:19], s5 offen lds
  s_lshl_b32 s4, s24, 10
  s_add_u32 s4, s4, 90112
  s_mov_b32 m0, s4
  s_mul_i32 s5, s24, 12288
  s_add_u32 s5, s5, 1474560
  s_add_u32 s5, s5, s44
  buffer_load_dwordx4 v32, s[16:19], s5 offen lds
  s_lshl_b32 s4, s24, 10
  s_add_u32 s4, s4, 94208
  s_mov_b32 m0, s4
  s_mul_i32 s5, s24, 12288
  s_add_u32 s5, s5, 1523712
  s_add_u32 s5, s5, s44
  buffer_load_dwordx4 v32, s[16:19], s5 offen lds
  s_lshl_b32 s4, s24, 10
  s_add_u32 s4, s4, 98304
  s_mov_b32 m0, s4
  s_mul_i32 s5, s24, 12288
  s_add_u32 s5, s5, 1179648
  s_add_u32 s5, s5, s44
  buffer_load_dwordx4 v33, s[20:23], s5 offen lds
  s_lshl_b32 s4, s24, 10
  s_add_u32 s4, s4, 102400
  s_mov_b32 m0, s4
  s_mul_i32 s5, s24, 12288
  s_add_u32 s5, s5, 1228800
  s_add_u32 s5, s5, s44
  buffer_load_dwordx4 v33, s[20:23], s5 offen lds
  s_lshl_b32 s4, s24, 10
  s_add_u32 s4, s4, 106496
  s_mov_b32 m0, s4
  s_mul_i32 s5, s24, 12288
  s_add_u32 s5, s5, 1277952
  s_add_u32 s5, s5, s44
  buffer_load_dwordx4 v33, s[20:23], s5 offen lds
  s_lshl_b32 s4, s24, 10
  s_add_u32 s4, s4, 110592
  s_mov_b32 m0, s4
  s_mul_i32 s5, s24, 12288
  s_add_u32 s5, s5, 1327104
  s_add_u32 s5, s5, s44
  buffer_load_dwordx4 v33, s[20:23], s5 offen lds
  s_lshl_b32 s4, s24, 10
  s_add_u32 s4, s4, 114688
  s_mov_b32 m0, s4
  s_mul_i32 s5, s24, 12288
  s_add_u32 s5, s5, 1376256
  s_add_u32 s5, s5, s44
  buffer_load_dwordx4 v33, s[20:23], s5 offen lds
  s_lshl_b32 s4, s24, 10
  s_add_u32 s4, s4, 118784
  s_mov_b32 m0, s4
  s_mul_i32 s5, s24, 12288
  s_add_u32 s5, s5, 1425408
  s_add_u32 s5, s5, s44
  buffer_load_dwordx4 v33, s[20:23], s5 offen lds
  s_lshl_b32 s4, s24, 10
  s_add_u32 s4, s4, 122880
  s_mov_b32 m0, s4
  s_mul_i32 s5, s24, 12288
  s_add_u32 s5, s5, 1474560
  s_add_u32 s5, s5, s44
  buffer_load_dwordx4 v33, s[20:23], s5 offen lds
  s_lshl_b32 s4, s24, 10
  s_add_u32 s4, s4, 126976
  s_mov_b32 m0, s4
  s_mul_i32 s5, s24, 12288
  s_add_u32 s5, s5, 1523712
  s_add_u32 s5, s5, s44
  buffer_load_dwordx4 v33, s[20:23], s5 offen lds
  s_waitcnt vmcnt(16)
  s_barrier
  ds_read_b64_tr_b16 a[128:129], v36 offset:0
  ds_read_b64_tr_b16 a[130:131], v36 offset:4096
  ds_read_b64_tr_b16 a[132:133], v36 offset:32
  ds_read_b64_tr_b16 a[134:135], v36 offset:4128
  ds_read_b64_tr_b16 a[136:137], v37 offset:32768
  ds_read_b64_tr_b16 a[138:139], v37 offset:36864
  ds_read_b64_tr_b16 a[140:141], v37 offset:32800
  ds_read_b64_tr_b16 a[142:143], v37 offset:36896
  ds_read_b64_tr_b16 a[144:145], v36 offset:8192
  ds_read_b64_tr_b16 a[146:147], v36 offset:12288
  ds_read_b64_tr_b16 a[148:149], v36 offset:8224
  ds_read_b64_tr_b16 a[150:151], v36 offset:12320
  s_waitcnt lgkmcnt(0)
  ds_read_b64_tr_b16 a[152:153], v37 offset:40960
  ds_read_b64_tr_b16 a[154:155], v37 offset:45056
  ds_read_b64_tr_b16 a[156:157], v37 offset:40992
  ds_read_b64_tr_b16 a[158:159], v37 offset:45088
  ds_read_b64_tr_b16 a[160:161], v36 offset:16384
  ds_read_b64_tr_b16 a[162:163], v36 offset:20480
  ds_read_b64_tr_b16 a[164:165], v36 offset:16416
  ds_read_b64_tr_b16 a[166:167], v36 offset:20512
  ds_read_b64_tr_b16 a[168:169], v37 offset:49152
  ds_read_b64_tr_b16 a[170:171], v37 offset:53248
  ds_read_b64_tr_b16 a[172:173], v37 offset:49184
  ds_read_b64_tr_b16 a[174:175], v37 offset:53280
  s_waitcnt lgkmcnt(0)
  ds_read_b64_tr_b16 a[176:177], v36 offset:24576
  ds_read_b64_tr_b16 a[178:179], v36 offset:28672
  ds_read_b64_tr_b16 a[180:181], v36 offset:24608
  ds_read_b64_tr_b16 a[182:183], v36 offset:28704
  ds_read_b64_tr_b16 a[184:185], v37 offset:57344
  ds_read_b64_tr_b16 a[186:187], v37 offset:61440
  ds_read_b64_tr_b16 a[188:189], v37 offset:57376
  ds_read_b64_tr_b16 a[190:191], v37 offset:61472
  s_waitcnt lgkmcnt(0)
  s_barrier
  s_lshl_b32 s4, s24, 10
  s_add_u32 s4, s4, 0
  s_mov_b32 m0, s4
  s_mul_i32 s5, s24, 12288
  s_add_u32 s5, s5, 1572864
  s_add_u32 s5, s5, s44
  buffer_load_dwordx4 v32, s[16:19], s5 offen lds
  s_lshl_b32 s4, s24, 10
  s_add_u32 s4, s4, 4096
  s_mov_b32 m0, s4
  s_mul_i32 s5, s24, 12288
  s_add_u32 s5, s5, 1622016
  s_add_u32 s5, s5, s44
  buffer_load_dwordx4 v32, s[16:19], s5 offen lds
  s_lshl_b32 s4, s24, 10
  s_add_u32 s4, s4, 8192
  s_mov_b32 m0, s4
  s_mul_i32 s5, s24, 12288
  s_add_u32 s5, s5, 1671168
  s_add_u32 s5, s5, s44
  buffer_load_dwordx4 v32, s[16:19], s5 offen lds
  s_lshl_b32 s4, s24, 10
  s_add_u32 s4, s4, 12288
  s_mov_b32 m0, s4
  s_mul_i32 s5, s24, 12288
  s_add_u32 s5, s5, 1720320
  s_add_u32 s5, s5, s44
  buffer_load_dwordx4 v32, s[16:19], s5 offen lds
  s_lshl_b32 s4, s24, 10
  s_add_u32 s4, s4, 16384
  s_mov_b32 m0, s4
  s_mul_i32 s5, s24, 12288
  s_add_u32 s5, s5, 1769472
  s_add_u32 s5, s5, s44
  buffer_load_dwordx4 v32, s[16:19], s5 offen lds
  s_lshl_b32 s4, s24, 10
  s_add_u32 s4, s4, 20480
  s_mov_b32 m0, s4
  s_mul_i32 s5, s24, 12288
  s_add_u32 s5, s5, 1818624
  s_add_u32 s5, s5, s44
  buffer_load_dwordx4 v32, s[16:19], s5 offen lds
  s_lshl_b32 s4, s24, 10
  s_add_u32 s4, s4, 24576
  s_mov_b32 m0, s4
  s_mul_i32 s5, s24, 12288
  s_add_u32 s5, s5, 1867776
  s_add_u32 s5, s5, s44
  buffer_load_dwordx4 v32, s[16:19], s5 offen lds
  s_lshl_b32 s4, s24, 10
  s_add_u32 s4, s4, 28672
  s_mov_b32 m0, s4
  s_mul_i32 s5, s24, 12288
  s_add_u32 s5, s5, 1916928
  s_add_u32 s5, s5, s44
  buffer_load_dwordx4 v32, s[16:19], s5 offen lds
  s_lshl_b32 s4, s24, 10
  s_add_u32 s4, s4, 32768
  s_mov_b32 m0, s4
  s_mul_i32 s5, s24, 12288
  s_add_u32 s5, s5, 1572864
  s_add_u32 s5, s5, s44
  buffer_load_dwordx4 v33, s[20:23], s5 offen lds
  s_lshl_b32 s4, s24, 10
  s_add_u32 s4, s4, 36864
  s_mov_b32 m0, s4
  s_mul_i32 s5, s24, 12288
  s_add_u32 s5, s5, 1622016
  s_add_u32 s5, s5, s44
  buffer_load_dwordx4 v33, s[20:23], s5 offen lds
  s_lshl_b32 s4, s24, 10
  s_add_u32 s4, s4, 40960
  s_mov_b32 m0, s4
  s_mul_i32 s5, s24, 12288
  s_add_u32 s5, s5, 1671168
  s_add_u32 s5, s5, s44
  buffer_load_dwordx4 v33, s[20:23], s5 offen lds
  s_lshl_b32 s4, s24, 10
  s_add_u32 s4, s4, 45056
  s_mov_b32 m0, s4
  s_mul_i32 s5, s24, 12288
  s_add_u32 s5, s5, 1720320
  s_add_u32 s5, s5, s44
  buffer_load_dwordx4 v33, s[20:23], s5 offen lds
  s_lshl_b32 s4, s24, 10
  s_add_u32 s4, s4, 49152
  s_mov_b32 m0, s4
  s_mul_i32 s5, s24, 12288
  s_add_u32 s5, s5, 1769472
  s_add_u32 s5, s5, s44
  buffer_load_dwordx4 v33, s[20:23], s5 offen lds
  s_lshl_b32 s4, s24, 10
  s_add_u32 s4, s4, 53248
  s_mov_b32 m0, s4
  s_mul_i32 s5, s24, 12288
  s_add_u32 s5, s5, 1818624
  s_add_u32 s5, s5, s44
  buffer_load_dwordx4 v33, s[20:23], s5 offen lds
  s_lshl_b32 s4, s24, 10
  s_add_u32 s4, s4, 57344
  s_mov_b32 m0, s4
  s_mul_i32 s5, s24, 12288
  s_add_u32 s5, s5, 1867776
  s_add_u32 s5, s5, s44
  buffer_load_dwordx4 v33, s[20:23], s5 offen lds
  s_lshl_b32 s4, s24, 10
  s_add_u32 s4, s4, 61440
  s_mov_b32 m0, s4
  s_mul_i32 s5, s24, 12288
  s_add_u32 s5, s5, 1916928
  s_add_u32 s5, s5, s44
  buffer_load_dwordx4 v33, s[20:23], s5 offen lds
  s_waitcnt vmcnt(16)
  s_barrier
  v_add_u32 v28, 65536, v36
  ds_read_b64_tr_b16 a[192:193], v28 offset:0
  v_add_u32 v28, 65536, v36
  ds_read_b64_tr_b16 a[194:195], v28 offset:4096
  v_add_u32 v28, 65536, v36
  ds_read_b64_tr_b16 a[196:197], v28 offset:32
  v_add_u32 v28, 65536, v36
  ds_read_b64_tr_b16 a[198:199], v28 offset:4128
  v_add_u32 v28, 65536, v37
  ds_read_b64_tr_b16 a[200:201], v28 offset:32768
  v_add_u32 v28, 65536, v37
  ds_read_b64_tr_b16 a[202:203], v28 offset:36864
  v_add_u32 v28, 65536, v37
  ds_read_b64_tr_b16 a[204:205], v28 offset:32800
  v_add_u32 v28, 65536, v37
  ds_read_b64_tr_b16 a[206:207], v28 offset:36896
  v_add_u32 v28, 65536, v36
  ds_read_b64_tr_b16 a[208:209], v28 offset:8192
  v_add_u32 v28, 65536, v36
  ds_read_b64_tr_b16 a[210:211], v28 offset:12288
  v_add_u32 v28, 65536, v36
  ds_read_b64_tr_b16 a[212:213], v28 offset:8224
  v_add_u32 v28, 65536, v36
  ds_read_b64_tr_b16 a[214:215], v28 offset:12320
  s_waitcnt lgkmcnt(0)
  v_add_u32 v28, 65536, v37
  ds_read_b64_tr_b16 a[216:217], v28 offset:40960
  v_add_u32 v28, 65536, v37
  ds_read_b64_tr_b16 a[218:219], v28 offset:45056
  v_add_u32 v28, 65536, v37
  ds_read_b64_tr_b16 a[220:221], v28 offset:40992
  v_add_u32 v28, 65536, v37
  ds_read_b64_tr_b16 a[222:223], v28 offset:45088
  v_add_u32 v28, 65536, v36
  ds_read_b64_tr_b16 a[224:225], v28 offset:16384
  v_add_u32 v28, 65536, v36
  ds_read_b64_tr_b16 a[226:227], v28 offset:20480
  v_add_u32 v28, 65536, v36
  ds_read_b64_tr_b16 a[228:229], v28 offset:16416
  v_add_u32 v28, 65536, v36
  ds_read_b64_tr_b16 a[230:231], v28 offset:20512
  v_add_u32 v28, 65536, v37
  ds_read_b64_tr_b16 a[232:233], v28 offset:49152
  v_add_u32 v28, 65536, v37
  ds_read_b64_tr_b16 a[234:235], v28 offset:53248
  v_add_u32 v28, 65536, v37
  ds_read_b64_tr_b16 a[236:237], v28 offset:49184
  v_add_u32 v28, 65536, v37
  ds_read_b64_tr_b16 a[238:239], v28 offset:53280
  s_waitcnt lgkmcnt(0)
  v_add_u32 v28, 65536, v36
  ds_read_b64_tr_b16 a[240:241], v28 offset:24576
  v_add_u32 v28, 65536, v36
  ds_read_b64_tr_b16 a[242:243], v28 offset:28672
  v_add_u32 v28, 65536, v36
  ds_read_b64_tr_b16 a[244:245], v28 offset:24608
  v_add_u32 v28, 65536, v36
  ds_read_b64_tr_b16 a[246:247], v28 offset:28704
  v_add_u32 v28, 65536, v37
  ds_read_b64_tr_b16 a[248:249], v28 offset:57344
  v_add_u32 v28, 65536, v37
  ds_read_b64_tr_b16 a[250:251], v28 offset:61440
  v_add_u32 v28, 65536, v37
  ds_read_b64_tr_b16 a[252:253], v28 offset:57376
  v_add_u32 v28, 65536, v37
  ds_read_b64_tr_b16 a[254:255], v28 offset:61472
  s_waitcnt lgkmcnt(0)
  s_barrier
  s_waitcnt vmcnt(0)
  s_barrier
  ds_read_b64_tr_b16 v[192:193], v36 offset:0
  ds_read_b64_tr_b16 v[194:195], v36 offset:4096
  ds_read_b64_tr_b16 v[196:197], v36 offset:32
  ds_read_b64_tr_b16 v[198:199], v36 offset:4128
  ds_read_b64_tr_b16 v[200:201], v37 offset:32768
  ds_read_b64_tr_b16 v[202:203], v37 offset:36864
  ds_read_b64_tr_b16 v[204:205], v37 offset:32800
  ds_read_b64_tr_b16 v[206:207], v37 offset:36896
  ds_read_b64_tr_b16 v[208:209], v36 offset:8192
  ds_read_b64_tr_b16 v[210:211], v36 offset:12288
  ds_read_b64_tr_b16 v[212:213], v36 offset:8224
  ds_read_b64_tr_b16 v[214:215], v36 offset:12320
  s_waitcnt lgkmcnt(0)
  ds_read_b64_tr_b16 v[216:217], v37 offset:40960
  ds_read_b64_tr_b16 v[218:219], v37 offset:45056
  ds_read_b64_tr_b16 v[220:221], v37 offset:40992
  ds_read_b64_tr_b16 v[222:223], v37 offset:45088
  ds_read_b64_tr_b16 v[224:225], v36 offset:16384
  ds_read_b64_tr_b16 v[226:227], v36 offset:20480
  ds_read_b64_tr_b16 v[228:229], v36 offset:16416
  ds_read_b64_tr_b16 v[230:231], v36 offset:20512
  ds_read_b64_tr_b16 v[232:233], v37 offset:49152
  ds_read_b64_tr_b16 v[234:235], v37 offset:53248
  ds_read_b64_tr_b16 v[236:237], v37 offset:49184
  ds_read_b64_tr_b16 v[238:239], v37 offset:53280
  s_waitcnt lgkmcnt(0)
  ds_read_b64_tr_b16 v[240:241], v36 offset:24576
  ds_read_b64_tr_b16 v[242:243], v36 offset:28672
  ds_read_b64_tr_b16 v[244:245], v36 offset:24608
  ds_read_b64_tr_b16 v[246:247], v36 offset:28704
  ds_read_b64_tr_b16 v[248:249], v37 offset:57344
  ds_read_b64_tr_b16 v[250:251], v37 offset:61440
  ds_read_b64_tr_b16 v[252:253], v37 offset:57376
  ds_read_b64_tr_b16 v[254:255], v37 offset:61472
  s_waitcnt lgkmcnt(0)
  s_barrier
  s_cmp_eq_u32 s24, 0
  s_cbranch_scc0 L_wd_iwD
  s_mov_b32 s28, 131072
  s_mov_b32 s29, 2
  v_mov_b32 v18, 36
L_wn_iwD:
  buffer_load_dword v19, v18, s[12:15], 0 offen sc1
  s_waitcnt vmcnt(0)
  v_readfirstlane_b32 s3, v19
  s_sub_u32 s28, s28, 1
  s_cbranch_scc1 L_abort
  s_cmp_ge_u32 s3, 256
  s_cbranch_scc1 L_wd_iwD
  s_sleep 8
  s_branch L_wn_iwD
L_wd_iwD:
  s_barrier
  v_min_u32 v28, 11, v0
  v_lshrrev_b32 v26, 2, v28
  v_and_b32 v28, 3, v28
  v_lshlrev_b32 v28, 2, v28
  v_lshlrev_b32 v29, 7, v26
  v_add_u32 v28, v28, v29
  v_add_u32 v23, 90112, v28
  s_mul_i32 s4, s53, 384
  v_add_u32 v23, s4, v23
  s_mov_b64 s[42:43], 0xfff
  s_mov_b32 s31, 0
  s_mov_b32 s33, 0
  s_mov_b32 s34, 0
L_D_top:
  s_lshl_b32 s56, s31, 1
  s_sub_u32 s54, s56, 40
  s_cmp_lt_u32 s31, 40
  s_cselect_b32 s54, s31, s54
  s_add_u32 s56, s56, 41
  s_cmp_eq_u32 s53, 1
  s_cselect_b32 s54, s56, s54
  s_cmp_eq_u32 s33, 1
  s_cbranch_scc1 L_D_pref
  s_mov_b32 s28, 131072
  s_mov_b32 s29, 60
L_D_poll:
  buffer_load_dword v28, v23, s[8:11], 0 offen sc1
  s_sub_u32 s28, s28, 1
  s_cbranch_scc1 L_abort
  s_waitcnt vmcnt(0)
  s_cmp_eq_u32 s34, 0
  s_cbranch_scc1 L_D_npa
  s_mov_b64 exec, 1
  v_mov_b32 v29, s34
  v_mov_b32 v30, 0
  buffer_store_dword v29, v30, s[8:11], s35 offen sc1
  s_mov_b64 exec, -1
  s_mov_b32 s34, 0
L_D_npa:
  s_mul_hi_u32 s48, s31, 1431655766
  s_mul_i32 s48, s48, 3
  s_sub_u32 s48, s31, s48
  s_add_u32 s48, s48, 3
  v_sub_u32 v27, s48, v26
  v_subrev_u32 v29, 3, v27
  v_min_u32 v27, v27, v29
  s_add_u32 s47, s31, 1
  v_sub_u32 v27, s47, v27
  v_max_i32 v27, 0, v27
  v_cmp_gt_u32 vcc, v27, v28
  s_and_b64 vcc, vcc, s[42:43]
  s_cmp_eq_u64 vcc, 0
  s_cbranch_scc0 L_D_poll
  s_lshl_b32 s56, s31, 1
  s_sub_u32 s59, s56, 40
  s_cmp_lt_u32 s31, 40
  s_cselect_b32 s59, s31, s59
  s_add_u32 s56, s56, 41
  s_cmp_eq_u32 s53, 1
  s_cselect_b32 s59, s56, s59
  s_mul_i32 s32, s59, 40960
  s_add_u32 s32, s32, 147214336
  s_lshl_b32 s4, s24, 10
  s_add_u32 s32, s32, s4
  s_and_b32 s50, s31, 1
  s_mul_i32 s50, s50, 40960
  s_add_u32 s50, s50, s4
  s_add_u32 m0, s50, 0
  s_add_u32 s5, s32, 0
  buffer_load_dwordx4 v20, s[8:11], s5 offen sc1 lds
  s_add_u32 m0, s50, 4096
  s_add_u32 s5, s32, 4096
  buffer_load_dwordx4 v20, s[8:11], s5 offen sc1 lds
  s_add_u32 m0, s50, 8192
  s_add_u32 s5, s32, 8192
  buffer_load_dwordx4 v20, s[8:11], s5 offen sc1 lds
  s_add_u32 m0, s50, 12288
  s_add_u32 s5, s32, 12288
  buffer_load_dwordx4 v20, s[8:11], s5 offen sc1 lds
  s_add_u32 m0, s50, 16384
  s_add_u32 s5, s32, 16384
  buffer_load_dwordx4 v20, s[8:11], s5 offen sc1 lds
  s_add_u32 m0, s50, 20480
  s_add_u32 s5, s32, 20480
  buffer_load_dwordx4 v20, s[8:11], s5 offen sc1 lds
  s_add_u32 m0, s50, 24576
  s_add_u32 s5, s32, 24576
  buffer_load_dwordx4 v20, s[8:11], s5 offen sc1 lds
  s_add_u32 m0, s50, 28672
  s_add_u32 s5, s32, 28672
  buffer_load_dwordx4 v20, s[8:11], s5 offen sc1 lds
  s_add_u32 m0, s50, 32768
  s_add_u32 s5, s32, 32768
  buffer_load_dwordx4 v20, s[8:11], s5 offen sc1 lds
  s_add_u32 m0, s50, 36864
  s_add_u32 s5, s32, 36864
  buffer_load_dwordx4 v20, s[8:11], s5 offen sc1 lds
  s_mov_b32 s51, 1
  s_branch L_D_go
L_D_pref:
  s_waitcnt vmcnt(10)
  s_mov_b32 s51, 0
L_D_go:
  s_and_b32 s6, s31, 1
  s_mul_i32 s6, s6, 40960
  v_add_u32 v24, s6, v20
  s_mov_b32 s33, 0
  s_add_u32 s7, s31, 1
  s_cmp_ge_u32 s7, s52
  s_cbranch_scc1 L_D_cB
  s_mul_hi_u32 s48, s7, 1431655766
  s_mul_i32 s48, s48, 3
  s_sub_u32 s48, s7, s48
  s_add_u32 s48, s48, 3
  v_sub_u32 v27, s48, v26
  v_subrev_u32 v29, 3, v27
  v_min_u32 v27, v27, v29
  s_add_u32 s47, s7, 1
  v_sub_u32 v27, s47, v27
  v_max_i32 v27, 0, v27
  v_cmp_gt_u32 vcc, v27, v28
  s_and_b64 vcc, vcc, s[42:43]
  s_cmp_eq_u64 vcc, 0
  s_cbranch_scc0 L_D_cB
  s_mov_b32 s33, 1
  s_lshl_b32 s56, s7, 1
  s_sub_u32 s59, s56, 40
  s_cmp_lt_u32 s7, 40
  s_cselect_b32 s59, s7, s59
  s_add_u32 s56, s56, 41
  s_cmp_eq_u32 s53, 1
  s_cselect_b32 s59, s56, s59
  s_mul_i32 s32, s59, 40960
  s_add_u32 s32, s32, 147214336
  s_lshl_b32 s4, s24, 10
  s_add_u32 s32, s32, s4
  s_and_b32 s50, s7, 1
  s_mul_i32 s50, s50, 40960
  s_add_u32 s50, s50, s4
  s_cmp_eq_u32 s51, 1
  s_cbranch_scc1 L_D_cAc
  s_waitcnt vmcnt(11)
  s_barrier
  ds_read_b128 v[160:163], v24 offset:0
  ds_read_b128 v[164:167], v24 offset:1024
  ds_read_b128 v[168:171], v24 offset:2048
  ds_read_b128 v[172:175], v24 offset:3072
  s_waitcnt lgkmcnt(2)
  v_mfma_f32_16x16x32_bf16 v[128:131], a[0:3], v[160:163], 0
  v_mfma_f32_16x16x32_bf16 v[132:135], a[4:7], v[160:163], 0
  v_mfma_f32_16x16x32_bf16 v[136:139], a[8:11], v[160:163], 0
  v_mfma_f32_16x16x32_bf16 v[140:143], a[12:15], v[160:163], 0
  v_mfma_f32_16x16x32_bf16 v[144:147], a[0:3], v[164:167], 0
  v_mfma_f32_16x16x32_bf16 v[148:151], a[4:7], v[164:167], 0
  v_mfma_f32_16x16x32_bf16 v[152:155], a[8:11], v[164:167], 0
  v_mfma_f32_16x16x32_bf16 v[156:159], a[12:15], v[164:167], 0
  ds_read_b128 v[160:163], v24 offset:4096
  ds_read_b128 v[164:167], v24 offset:5120
  s_waitcnt lgkmcnt(2)
  v_mfma_f32_16x16x32_bf16 v[128:131], a[16:19], v[168:171], v[128:131]
  s_add_u32 m0, s50, 0
  s_add_u32 s5, s32, 0
  buffer_load_dwordx4 v20, s[8:11], s5 offen sc1 lds
  v_mfma_f32_16x16x32_bf16 v[132:135], a[20:23], v[168:171], v[132:135]
  v_mfma_f32_16x16x32_bf16 v[136:139], a[24:27], v[168:171], v[136:139]
  v_mfma_f32_16x16x32_bf16 v[140:143], a[28:31], v[168:171], v[140:143]
  v_mfma_f32_16x16x32_bf16 v[144:147], a[16:19], v[172:175], v[144:147]
  v_mfma_f32_16x16x32_bf16 v[148:151], a[20:23], v[172:175], v[148:151]
  v_mfma_f32_16x16x32_bf16 v[152:155], a[24:27], v[172:175], v[152:155]
  v_mfma_f32_16x16x32_bf16 v[156:159], a[28:31], v[172:175], v[156:159]
  ds_read_b128 v[168:171], v24 offset:6144
  ds_read_b128 v[172:175], v24 offset:7168
  s_waitcnt lgkmcnt(2)
  v_mfma_f32_16x16x32_bf16 v[128:131], a[32:35], v[160:163], v[128:131]
  v_mfma_f32_16x16x32_bf16 v[132:135], a[36:39], v[160:163], v[132:135]
  v_mfma_f32_16x16x32_bf16 v[136:139], a[40:43], v[160:163], v[136:139]
  v_mfma_f32_16x16x32_bf16 v[140:143], a[44:47], v[160:163], v[140:143]
  v_mfma_f32_16x16x32_bf16 v[144:147], a[32:35], v[164:167], v[144:147]
  v_mfma_f32_16x16x32_bf16 v[148:151], a[36:39], v[164:167], v[148:151]
  v_mfma_f32_16x16x32_bf16 v[152:155], a[40:43], v[164:167], v[152:155]
  v_mfma_f32_16x16x32_bf16 v[156:159], a[44:47], v[164:167], v[156:159]
  ds_read_b128 v[160:163], v24 offset:8192
  ds_read_b128 v[164:167], v24 offset:9216
  s_waitcnt lgkmcnt(2)
  v_mfma_f32_16x16x32_bf16 v[128:131], a[48:51], v[168:171], v[128:131]
  s_add_u32 m0, s50, 4096
  s_add_u32 s5, s32, 4096
  buffer_load_dwordx4 v20, s[8:11], s5 offen sc1 lds
  v_mfma_f32_16x16x32_bf16 v[132:135], a[52:55], v[168:171], v[132:135]
  v_mfma_f32_16x16x32_bf16 v[136:139], a[56:59], v[168:171], v[136:139]
  v_mfma_f32_16x16x32_bf16 v[140:143], a[60:63], v[168:171], v[140:143]
  v_mfma_f32_16x16x32_bf16 v[144:147], a[48:51], v[172:175], v[144:147]
  v_mfma_f32_16x16x32_bf16 v[148:151], a[52:55], v[172:175], v[148:151]
  v_mfma_f32_16x16x32_bf16 v[152:155], a[56:59], v[172:175], v[152:155]
  v_mfma_f32_16x16x32_bf16 v[156:159], a[60:63], v[172:175], v[156:159]
  ds_read_b128 v[168:171], v24 offset:10240
  ds_read_b128 v[172:175], v24 offset:11264
  s_waitcnt lgkmcnt(2)
  v_mfma_f32_16x16x32_bf16 v[128:131], a[64:67], v[160:163], v[128:131]
  v_mfma_f32_16x16x32_bf16 v[132:135], a[68:71], v[160:163], v[132:135]
  v_mfma_f32_16x16x32_bf16 v[136:139], a[72:75], v[160:163], v[136:139]
  v_mfma_f32_16x16x32_bf16 v[140:143], a[76:79], v[160:163], v[140:143]
  v_mfma_f32_16x16x32_bf16 v[144:147], a[64:67], v[164:167], v[144:147]
  v_mfma_f32_16x16x32_bf16 v[148:151], a[68:71], v[164:167], v[148:151]
  v_mfma_f32_16x16x32_bf16 v[152:155], a[72:75], v[164:167], v[152:155]
  v_mfma_f32_16x16x32_bf16 v[156:159], a[76:79], v[164:167], v[156:159]
  s_waitcnt vmcnt(9)
  s_barrier
  ds_read_b128 v[160:163], v24 offset:12288
  ds_read_b128 v[164:167], v24 offset:13312
  s_waitcnt lgkmcnt(2)
  v_mfma_f32_16x16x32_bf16 v[128:131], a[80:83], v[168:171], v[128:131]
  s_add_u32 m0, s50, 8192
  s_add_u32 s5, s32, 8192
  buffer_load_dwordx4 v20, s[8:11], s5 offen sc1 lds
  v_mfma_f32_16x16x32_bf16 v[132:135], a[84:87], v[168:171], v[132:135]
  v_mfma_f32_16x16x32_bf16 v[136:139], a[88:91], v[168:171], v[136:139]
  v_mfma_f32_16x16x32_bf16 v[140:143], a[92:95], v[168:171], v[140:143]
  v_mfma_f32_16x16x32_bf16 v[144:147], a[80:83], v[172:175], v[144:147]
  v_mfma_f32_16x16x32_bf16 v[148:151], a[84:87], v[172:175], v[148:151]
  v_mfma_f32_16x16x32_bf16 v[152:155], a[88:91], v[172:175], v[152:155]
  v_mfma_f32_16x16x32_bf16 v[156:159], a[92:95], v[172:175], v[156:159]
  ds_read_b128 v[168:171], v24 offset:14336
  ds_read_b128 v[172:175], v24 offset:15360
  s_waitcnt lgkmcnt(2)
  v_mfma_f32_16x16x32_bf16 v[128:131], a[96:99], v[160:163], v[128:131]
  buffer_load_dword v28, v23, s[8:11], 0 offen sc1
  v_mfma_f32_16x16x32_bf16 v[132:135], a[100:103], v[160:163], v[132:135]
  v_mfma_f32_16x16x32_bf16 v[136:139], a[104:107], v[160:163], v[136:139]
  v_mfma_f32_16x16x32_bf16 v[140:143], a[108:111], v[160:163], v[140:143]
  v_mfma_f32_16x16x32_bf16 v[144:147], a[96:99], v[164:167], v[144:147]
  v_mfma_f32_16x16x32_bf16 v[148:151], a[100:103], v[164:167], v[148:151]
  v_mfma_f32_16x16x32_bf16 v[152:155], a[104:107], v[164:167], v[152:155]
  v_mfma_f32_16x16x32_bf16 v[156:159], a[108:111], v[164:167], v[156:159]
  ds_read_b128 v[160:163], v24 offset:16384
  ds_read_b128 v[164:167], v24 offset:17408
  s_waitcnt lgkmcnt(2)
  v_mfma_f32_16x16x32_bf16 v[128:131], a[112:115], v[168:171], v[128:131]
  s_add_u32 m0, s50, 12288
  s_add_u32 s5, s32, 12288
  buffer_load_dwordx4 v20, s[8:11], s5 offen sc1 lds
  v_mfma_f32_16x16x32_bf16 v[132:135], a[116:119], v[168:171], v[132:135]
  v_mfma_f32_16x16x32_bf16 v[136:139], a[120:123], v[168:171], v[136:139]
  v_mfma_f32_16x16x32_bf16 v[140:143], a[124:127], v[168:171], v[140:143]
  v_mfma_f32_16x16x32_bf16 v[144:147], a[112:115], v[172:175], v[144:147]
  v_mfma_f32_16x16x32_bf16 v[148:151], a[116:119], v[172:175], v[148:151]
  v_mfma_f32_16x16x32_bf16 v[152:155], a[120:123], v[172:175], v[152:155]
  v_mfma_f32_16x16x32_bf16 v[156:159], a[124:127], v[172:175], v[156:159]
  ds_read_b128 v[168:171], v24 offset:18432
  ds_read_b128 v[172:175], v24 offset:19456
  s_waitcnt lgkmcnt(2)
  v_mfma_f32_16x16x32_bf16 v[128:131], a[128:131], v[160:163], v[128:131]
  v_mfma_f32_16x16x32_bf16 v[132:135], a[132:135], v[160:163], v[132:135]
  v_mfma_f32_16x16x32_bf16 v[136:139], a[136:139], v[160:163], v[136:139]
  v_mfma_f32_16x16x32_bf16 v[140:143], a[140:143], v[160:163], v[140:143]
  v_mfma_f32_16x16x32_bf16 v[144:147], a[128:131], v[164:167], v[144:147]
  v_mfma_f32_16x16x32_bf16 v[148:151], a[132:135], v[164:167], v[148:151]
  v_mfma_f32_16x16x32_bf16 v[152:155], a[136:139], v[164:167], v[152:155]
  v_mfma_f32_16x16x32_bf16 v[156:159], a[140:143], v[164:167], v[156:159]
  ds_read_b128 v[160:163], v24 offset:20480
  ds_read_b128 v[164:167], v24 offset:21504
  s_waitcnt lgkmcnt(2)
  v_mfma_f32_16x16x32_bf16 v[128:131], a[144:147], v[168:171], v[128:131]
  s_add_u32 m0, s50, 16384
  s_add_u32 s5, s32, 16384
  buffer_load_dwordx4 v20, s[8:11], s5 offen sc1 lds
  v_mfma_f32_16x16x32_bf16 v[132:135], a[148:151], v[168:171], v[132:135]
  v_mfma_f32_16x16x32_bf16 v[136:139], a[152:155], v[168:171], v[136:139]
  v_mfma_f32_16x16x32_bf16 v[140:143], a[156:159], v[168:171], v[140:143]
  v_mfma_f32_16x16x32_bf16 v[144:147], a[144:147], v[172:175], v[144:147]
  v_mfma_f32_16x16x32_bf16 v[148:151], a[148:151], v[172:175], v[148:151]
  v_mfma_f32_16x16x32_bf16 v[152:155], a[152:155], v[172:175], v[152:155]
  v_mfma_f32_16x16x32_bf16 v[156:159], a[156:159], v[172:175], v[156:159]
  ds_read_b128 v[168:171], v24 offset:22528
  ds_read_b128 v[172:175], v24 offset:23552
  s_waitcnt lgkmcnt(2)
  v_mfma_f32_16x16x32_bf16 v[128:131], a[160:163], v[160:163], v[128:131]
  v_mfma_f32_16x16x32_bf16 v[132:135], a[164:167], v[160:163], v[132:135]
  v_mfma_f32_16x16x32_bf16 v[136:139], a[168:171], v[160:163], v[136:139]
  v_mfma_f32_16x16x32_bf16 v[140:143], a[172:175], v[160:163], v[140:143]
  v_mfma_f32_16x16x32_bf16 v[144:147], a[160:163], v[164:167], v[144:147]
  v_mfma_f32_16x16x32_bf16 v[148:151], a[164:167], v[164:167], v[148:151]
  v_mfma_f32_16x16x32_bf16 v[152:155], a[168:171], v[164:167], v[152:155]
  v_mfma_f32_16x16x32_bf16 v[156:159], a[172:175], v[164:167], v[156:159]
  s_waitcnt vmcnt(9)
  s_barrier
  ds_read_b128 v[160:163], v24 offset:24576
  ds_read_b128 v[164:167], v24 offset:25600
  s_waitcnt lgkmcnt(2)
  v_mfma_f32_16x16x32_bf16 v[128:131], a[176:179], v[168:171], v[128:131]
  s_add_u32 m0, s50, 20480
  s_add_u32 s5, s32, 20480
  buffer_load_dwordx4 v20, s[8:11], s5 offen sc1 lds
  v_mfma_f32_16x16x32_bf16 v[132:135], a[180:183], v[168:171], v[132:135]
  v_mfma_f32_16x16x32_bf16 v[136:139], a[184:187], v[168:171], v[136:139]
  v_mfma_f32_16x16x32_bf16 v[140:143], a[188:191], v[168:171], v[140:143]
  v_mfma_f32_16x16x32_bf16 v[144:147], a[176:179], v[172:175], v[144:147]
  v_mfma_f32_16x16x32_bf16 v[148:151], a[180:183], v[172:175], v[148:151]
  v_mfma_f32_16x16x32_bf16 v[152:155], a[184:187], v[172:175], v[152:155]
  v_mfma_f32_16x16x32_bf16 v[156:159], a[188:191], v[172:175], v[156:159]
  ds_read_b128 v[168:171], v24 offset:26624
  ds_read_b128 v[172:175], v24 offset:27648
  s_waitcnt lgkmcnt(2)
  v_mfma_f32_16x16x32_bf16 v[128:131], a[192:195], v[160:163], v[128:131]
  v_mfma_f32_16x16x32_bf16 v[132:135], a[196:199], v[160:163], v[132:135]
  v_mfma_f32_16x16x32_bf16 v[136:139], a[200:203], v[160:163], v[136:139]
  v_mfma_f32_16x16x32_bf16 v[140:143], a[204:207], v[160:163], v[140:143]
  v_mfma_f32_16x16x32_bf16 v[144:147], a[192:195], v[164:167], v[144:147]
  v_mfma_f32_16x16x32_bf16 v[148:151], a[196:199], v[164:167], v[148:151]
  v_mfma_f32_16x16x32_bf16 v[152:155], a[200:203], v[164:167], v[152:155]
  v_mfma_f32_16x16x32_bf16 v[156:159], a[204:207], v[164:167], v[156:159]
  ds_read_b128 v[160:163], v24 offset:28672
  ds_read_b128 v[164:167], v24 offset:29696
  s_waitcnt lgkmcnt(2)
  v_mfma_f32_16x16x32_bf16 v[128:131], a[208:211], v[168:171], v[128:131]
  s_add_u32 m0, s50, 24576
  s_add_u32 s5, s32, 24576
  buffer_load_dwordx4 v20, s[8:11], s5 offen sc1 lds
  v_mfma_f32_16x16x32_bf16 v[132:135], a[212:215], v[168:171], v[132:135]
  v_mfma_f32_16x16x32_bf16 v[136:139], a[216:219], v[168:171], v[136:139]
  v_mfma_f32_16x16x32_bf16 v[140:143], a[220:223], v[168:171], v[140:143]
  v_mfma_f32_16x16x32_bf16 v[144:147], a[208:211], v[172:175], v[144:147]
  v_mfma_f32_16x16x32_bf16 v[148:151], a[212:215], v[172:175], v[148:151]
  v_mfma_f32_16x16x32_bf16 v[152:155], a[216:219], v[172:175], v[152:155]
  v_mfma_f32_16x16x32_bf16 v[156:159], a[220:223], v[172:175], v[156:159]
  ds_read_b128 v[168:171], v24 offset:30720
  ds_read_b128 v[172:175], v24 offset:31744
  s_waitcnt lgkmcnt(2)
  v_mfma_f32_16x16x32_bf16 v[128:131], a[224:227], v[160:163], v[128:131]
  v_mfma_f32_16x16x32_bf16 v[132:135], a[228:231], v[160:163], v[132:135]
  v_mfma_f32_16x16x32_bf16 v[136:139], a[232:235], v[160:163], v[136:139]
  v_mfma_f32_16x16x32_bf16 v[140:143], a[236:239], v[160:163], v[140:143]
  v_mfma_f32_16x16x32_bf16 v[144:147], a[224:227], v[164:167], v[144:147]
  v_mfma_f32_16x16x32_bf16 v[148:151], a[228:231], v[164:167], v[148:151]
  v_mfma_f32_16x16x32_bf16 v[152:155], a[232:235], v[164:167], v[152:155]
  v_mfma_f32_16x16x32_bf16 v[156:159], a[236:239], v[164:167], v[156:159]
  ds_read_b128 v[160:163], v24 offset:32768
  ds_read_b128 v[164:167], v24 offset:33792
  s_waitcnt lgkmcnt(2)
  v_mfma_f32_16x16x32_bf16 v[128:131], a[240:243], v[168:171], v[128:131]
  s_add_u32 m0, s50, 28672
  s_add_u32 s5, s32, 28672
  buffer_load_dwordx4 v20, s[8:11], s5 offen sc1 lds
  v_mfma_f32_16x16x32_bf16 v[132:135], a[244:247], v[168:171], v[132:135]
  v_mfma_f32_16x16x32_bf16 v[136:139], a[248:251], v[168:171], v[136:139]
  v_mfma_f32_16x16x32_bf16 v[140:143], a[252:255], v[168:171], v[140:143]
  v_mfma_f32_16x16x32_bf16 v[144:147], a[240:243], v[172:175], v[144:147]
  v_mfma_f32_16x16x32_bf16 v[148:151], a[244:247], v[172:175], v[148:151]
  v_mfma_f32_16x16x32_bf16 v[152:155], a[248:251], v[172:175], v[152:155]
  v_mfma_f32_16x16x32_bf16 v[156:159], a[252:255], v[172:175], v[156:159]
  ds_read_b128 v[168:171], v24 offset:34816
  ds_read_b128 v[172:175], v24 offset:35840
  s_waitcnt lgkmcnt(2)
  v_mfma_f32_16x16x32_bf16 v[128:131], v[192:195], v[160:163], v[128:131]
  v_mfma_f32_16x16x32_bf16 v[132:135], v[196:199], v[160:163], v[132:135]
  v_mfma_f32_16x16x32_bf16 v[136:139], v[200:203], v[160:163], v[136:139]
  v_mfma_f32_16x16x32_bf16 v[140:143], v[204:207], v[160:163], v[140:143]
  v_mfma_f32_16x16x32_bf16 v[144:147], v[192:195], v[164:167], v[144:147]
  v_mfma_f32_16x16x32_bf16 v[148:151], v[196:199], v[164:167], v[148:151]
  v_mfma_f32_16x16x32_bf16 v[152:155], v[200:203], v[164:167], v[152:155]
  v_mfma_f32_16x16x32_bf16 v[156:159], v[204:207], v[164:167], v[156:159]
  ds_read_b128 v[160:163], v24 offset:36864
  ds_read_b128 v[164:167], v24 offset:37888
  s_waitcnt lgkmcnt(2)
  v_mfma_f32_16x16x32_bf16 v[128:131], v[208:211], v[168:171], v[128:131]
  s_add_u32 m0, s50, 32768
  s_add_u32 s5, s32, 32768
  buffer_load_dwordx4 v20, s[8:11], s5 offen sc1 lds
  v_mfma_f32_16x16x32_bf16 v[132:135], v[212:215], v[168:171], v[132:135]
  v_mfma_f32_16x16x32_bf16 v[136:139], v[216:219], v[168:171], v[136:139]
  v_mfma_f32_16x16x32_bf16 v[140:143], v[220:223], v[168:171], v[140:143]
  v_mfma_f32_16x16x32_bf16 v[144:147], v[208:211], v[172:175], v[144:147]
  v_mfma_f32_16x16x32_bf16 v[148:151], v[212:215], v[172:175], v[148:151]
  v_mfma_f32_16x16x32_bf16 v[152:155], v[216:219], v[172:175], v[152:155]
  v_mfma_f32_16x16x32_bf16 v[156:159], v[220:223], v[172:175], v[156:159]
  ds_read_b128 v[168:171], v24 offset:38912
  ds_read_b128 v[172:175], v24 offset:39936
  s_waitcnt lgkmcnt(2)
  v_mfma_f32_16x16x32_bf16 v[128:131], v[224:227], v[160:163], v[128:131]
  v_mfma_f32_16x16x32_bf16 v[132:135], v[228:231], v[160:163], v[132:135]
  v_mfma_f32_16x16x32_bf16 v[136:139], v[232:235], v[160:163], v[136:139]
  v_mfma_f32_16x16x32_bf16 v[140:143], v[236:239], v[160:163], v[140:143]
  v_mfma_f32_16x16x32_bf16 v[144:147], v[224:227], v[164:167], v[144:147]
  v_mfma_f32_16x16x32_bf16 v[148:151], v[228:231], v[164:167], v[148:151]
  v_mfma_f32_16x16x32_bf16 v[152:155], v[232:235], v[164:167], v[152:155]
  v_mfma_f32_16x16x32_bf16 v[156:159], v[236:239], v[164:167], v[156:159]
  s_waitcnt lgkmcnt(0)
  v_mfma_f32_16x16x32_bf16 v[128:131], v[240:243], v[168:171], v[128:131]
  s_add_u32 m0, s50, 36864
  s_add_u32 s5, s32, 36864
  buffer_load_dwordx4 v20, s[8:11], s5 offen sc1 lds
  v_mfma_f32_16x16x32_bf16 v[132:135], v[244:247], v[168:171], v[132:135]
  v_mfma_f32_16x16x32_bf16 v[136:139], v[248:251], v[168:171], v[136:139]
  v_mfma_f32_16x16x32_bf16 v[140:143], v[252:255], v[168:171], v[140:143]
  v_mfma_f32_16x16x32_bf16 v[144:147], v[240:243], v[172:175], v[144:147]
  v_mfma_f32_16x16x32_bf16 v[148:151], v[244:247], v[172:175], v[148:151]
  v_mfma_f32_16x16x32_bf16 v[152:155], v[248:251], v[172:175], v[152:155]
  v_mfma_f32_16x16x32_bf16 v[156:159], v[252:255], v[172:175], v[156:159]
  s_waitcnt vmcnt(11)
  s_branch L_D_ep
L_D_cAc:
  s_waitcnt vmcnt(7)
  s_barrier
  ds_read_b128 v[160:163], v24 offset:0
  ds_read_b128 v[164:167], v24 offset:1024
  ds_read_b128 v[168:171], v24 offset:2048
  ds_read_b128 v[172:175], v24 offset:3072
  s_waitcnt lgkmcnt(2)
  v_mfma_f32_16x16x32_bf16 v[128:131], a[0:3], v[160:163], 0
  v_mfma_f32_16x16x32_bf16 v[132:135], a[4:7], v[160:163], 0
  v_mfma_f32_16x16x32_bf16 v[136:139], a[8:11], v[160:163], 0
  v_mfma_f32_16x16x32_bf16 v[140:143], a[12:15], v[160:163], 0
  v_mfma_f32_16x16x32_bf16 v[144:147], a[0:3], v[164:167], 0
  v_mfma_f32_16x16x32_bf16 v[148:151], a[4:7], v[164:167], 0
  v_mfma_f32_16x16x32_bf16 v[152:155], a[8:11], v[164:167], 0
  v_mfma_f32_16x16x32_bf16 v[156:159], a[12:15], v[164:167], 0
  ds_read_b128 v[160:163], v24 offset:4096
  ds_read_b128 v[164:167], v24 offset:5120
  s_waitcnt lgkmcnt(2)
  v_mfma_f32_16x16x32_bf16 v[128:131], a[16:19], v[168:171], v[128:131]
  s_add_u32 m0, s50, 0
  s_add_u32 s5, s32, 0
  buffer_load_dwordx4 v20, s[8:11], s5 offen sc1 lds
  v_mfma_f32_16x16x32_bf16 v[132:135], a[20:23], v[168:171], v[132:135]
  v_mfma_f32_16x16x32_bf16 v[136:139], a[24:27], v[168:171], v[136:139]
  v_mfma_f32_16x16x32_bf16 v[140:143], a[28:31], v[168:171], v[140:143]
  v_mfma_f32_16x16x32_bf16 v[144:147], a[16:19], v[172:175], v[144:147]
  v_mfma_f32_16x16x32_bf16 v[148:151], a[20:23], v[172:175], v[148:151]
  v_mfma_f32_16x16x32_bf16 v[152:155], a[24:27], v[172:175], v[152:155]
  v_mfma_f32_16x16x32_bf16 v[156:159], a[28:31], v[172:175], v[156:159]
  ds_read_b128 v[168:171], v24 offset:6144
  ds_read_b128 v[172:175], v24 offset:7168
  s_waitcnt lgkmcnt(2)
  v_mfma_f32_16x16x32_bf16 v[128:131], a[32:35], v[160:163], v[128:131]
  v_mfma_f32_16x16x32_bf16 v[132:135], a[36:39], v[160:163], v[132:135]
  v_mfma_f32_16x16x32_bf16 v[136:139], a[40:43], v[160:163], v[136:139]
  v_mfma_f32_16x16x32_bf16 v[140:143], a[44:47], v[160:163], v[140:143]
  v_mfma_f32_16x16x32_bf16 v[144:147], a[32:35], v[164:167], v[144:147]
  v_mfma_f32_16x16x32_bf16 v[148:151], a[36:39], v[164:167], v[148:151]
  v_mfma_f32_16x16x32_bf16 v[152:155], a[40:43], v[164:167], v[152:155]
  v_mfma_f32_16x16x32_bf16 v[156:159], a[44:47], v[164:167], v[156:159]
  ds_read_b128 v[160:163], v24 offset:8192
  ds_read_b128 v[164:167], v24 offset:9216
  s_waitcnt lgkmcnt(2)
  v_mfma_f32_16x16x32_bf16 v[128:131], a[48:51], v[168:171], v[128:131]
  s_add_u32 m0, s50, 4096
  s_add_u32 s5, s32, 4096
  buffer_load_dwordx4 v20, s[8:11], s5 offen sc1 lds
  v_mfma_f32_16x16x32_bf16 v[132:135], a[52:55], v[168:171], v[132:135]
  v_mfma_f32_16x16x32_bf16 v[136:139], a[56:59], v[168:171], v[136:139]
  v_mfma_f32_16x16x32_bf16 v[140:143], a[60:63], v[168:171], v[140:143]
  v_mfma_f32_16x16x32_bf16 v[144:147], a[48:51], v[172:175], v[144:147]
  v_mfma_f32_16x16x32_bf16 v[148:151], a[52:55], v[172:175], v[148:151]
  v_mfma_f32_16x16x32_bf16 v[152:155], a[56:59], v[172:175], v[152:155]
  v_mfma_f32_16x16x32_bf16 v[156:159], a[60:63], v[172:175], v[156:159]
  ds_read_b128 v[168:171], v24 offset:10240
  ds_read_b128 v[172:175], v24 offset:11264
  s_waitcnt lgkmcnt(2)
  v_mfma_f32_16x16x32_bf16 v[128:131], a[64:67], v[160:163], v[128:131]
  v_mfma_f32_16x16x32_bf16 v[132:135], a[68:71], v[160:163], v[132:135]
  v_mfma_f32_16x16x32_bf16 v[136:139], a[72:75], v[160:163], v[136:139]
  v_mfma_f32_16x16x32_bf16 v[140:143], a[76:79], v[160:163], v[140:143]
  v_mfma_f32_16x16x32_bf16 v[144:147], a[64:67], v[164:167], v[144:147]
  v_mfma_f32_16x16x32_bf16 v[148:151], a[68:71], v[164:167], v[148:151]
  v_mfma_f32_16x16x32_bf16 v[152:155], a[72:75], v[164:167], v[152:155]
  v_mfma_f32_16x16x32_bf16 v[156:159], a[76:79], v[164:167], v[156:159]
  s_waitcnt vmcnt(6)
  s_barrier
  ds_read_b128 v[160:163], v24 offset:12288
  ds_read_b128 v[164:167], v24 offset:13312
  s_waitcnt lgkmcnt(2)
  v_mfma_f32_16x16x32_bf16 v[128:131], a[80:83], v[168:171], v[128:131]
  s_add_u32 m0, s50, 8192
  s_add_u32 s5, s32, 8192
  buffer_load_dwordx4 v20, s[8:11], s5 offen sc1 lds
  v_mfma_f32_16x16x32_bf16 v[132:135], a[84:87], v[168:171], v[132:135]
  v_mfma_f32_16x16x32_bf16 v[136:139], a[88:91], v[168:171], v[136:139]
  v_mfma_f32_16x16x32_bf16 v[140:143], a[92:95], v[168:171], v[140:143]
  v_mfma_f32_16x16x32_bf16 v[144:147], a[80:83], v[172:175], v[144:147]
  v_mfma_f32_16x16x32_bf16 v[148:151], a[84:87], v[172:175], v[148:151]
  v_mfma_f32_16x16x32_bf16 v[152:155], a[88:91], v[172:175], v[152:155]
  v_mfma_f32_16x16x32_bf16 v[156:159], a[92:95], v[172:175], v[156:159]
  ds_read_b128 v[168:171], v24 offset:14336
  ds_read_b128 v[172:175], v24 offset:15360
  s_waitcnt lgkmcnt(2)
  v_mfma_f32_16x16x32_bf16 v[128:131], a[96:99], v[160:163], v[128:131]
  buffer_load_dword v28, v23, s[8:11], 0 offen sc1
  v_mfma_f32_16x16x32_bf16 v[132:135], a[100:103], v[160:163], v[132:135]
  v_mfma_f32_16x16x32_bf16 v[136:139], a[104:107], v[160:163], v[136:139]
  v_mfma_f32_16x16x32_bf16 v[140:143], a[108:111], v[160:163], v[140:143]
  v_mfma_f32_16x16x32_bf16 v[144:147], a[96:99], v[164:167], v[144:147]
  v_mfma_f32_16x16x32_bf16 v[148:151], a[100:103], v[164:167], v[148:151]
  v_mfma_f32_16x16x32_bf16 v[152:155], a[104:107], v[164:167], v[152:155]
  v_mfma_f32_16x16x32_bf16 v[156:159], a[108:111], v[164:167], v[156:159]
  ds_read_b128 v[160:163], v24 offset:16384
  ds_read_b128 v[164:167], v24 offset:17408
  s_waitcnt lgkmcnt(2)
  v_mfma_f32_16x16x32_bf16 v[128:131], a[112:115], v[168:171], v[128:131]
  s_add_u32 m0, s50, 12288
  s_add_u32 s5, s32, 12288
  buffer_load_dwordx4 v20, s[8:11], s5 offen sc1 lds
  v_mfma_f32_16x16x32_bf16 v[132:135], a[116:119], v[168:171], v[132:135]
  v_mfma_f32_16x16x32_bf16 v[136:139], a[120:123], v[168:171], v[136:139]
  v_mfma_f32_16x16x32_bf16 v[140:143], a[124:127], v[168:171], v[140:143]
  v_mfma_f32_16x16x32_bf16 v[144:147], a[112:115], v[172:175], v[144:147]
  v_mfma_f32_16x16x32_bf16 v[148:151], a[116:119], v[172:175], v[148:151]
  v_mfma_f32_16x16x32_bf16 v[152:155], a[120:123], v[172:175], v[152:155]
  v_mfma_f32_16x16x32_bf16 v[156:159], a[124:127], v[172:175], v[156:159]
  ds_read_b128 v[168:171], v24 offset:18432
  ds_read_b128 v[172:175], v24 offset:19456
  s_waitcnt lgkmcnt(2)
  v_mfma_f32_16x16x32_bf16 v[128:131], a[128:131], v[160:163], v[128:131]
  v_mfma_f32_16x16x32_bf16 v[132:135], a[132:135], v[160:163], v[132:135]
  v_mfma_f32_16x16x32_bf16 v[136:139], a[136:139], v[160:163], v[136:139]
  v_mfma_f32_16x16x32_bf16 v[140:143], a[140:143], v[160:163], v[140:143]
  v_mfma_f32_16x16x32_bf16 v[144:147], a[128:131], v[164:167], v[144:147]
  v_mfma_f32_16x16x32_bf16 v[148:151], a[132:135], v[164:167], v[148:151]
  v_mfma_f32_16x16x32_bf16 v[152:155], a[136:139], v[164:167], v[152:155]
  v_mfma_f32_16x16x32_bf16 v[156:159], a[140:143], v[164:167], v[156:159]
  ds_read_b128 v[160:163], v24 offset:20480
  ds_read_b128 v[164:167], v24 offset:21504
  s_waitcnt lgkmcnt(2)
  v_mfma_f32_16x16x32_bf16 v[128:131], a[144:147], v[168:171], v[128:131]
  s_add_u32 m0, s50, 16384
  s_add_u32 s5, s32, 16384
  buffer_load_dwordx4 v20, s[8:11], s5 offen sc1 lds
  v_mfma_f32_16x16x32_bf16 v[132:135], a[148:151], v[168:171], v[132:135]
  v_mfma_f32_16x16x32_bf16 v[136:139], a[152:155], v[168:171], v[136:139]
  v_mfma_f32_16x16x32_bf16 v[140:143], a[156:159], v[168:171], v[140:143]
  v_mfma_f32_16x16x32_bf16 v[144:147], a[144:147], v[172:175], v[144:147]
  v_mfma_f32_16x16x32_bf16 v[148:151], a[148:151], v[172:175], v[148:151]
  v_mfma_f32_16x16x32_bf16 v[152:155], a[152:155], v[172:175], v[152:155]
  v_mfma_f32_16x16x32_bf16 v[156:159], a[156:159], v[172:175], v[156:159]
  ds_read_b128 v[168:171], v24 offset:22528
  ds_read_b128 v[172:175], v24 offset:23552
  s_waitcnt lgkmcnt(2)
  v_mfma_f32_16x16x32_bf16 v[128:131], a[160:163], v[160:163], v[128:131]
  v_mfma_f32_16x16x32_bf16 v[132:135], a[164:167], v[160:163], v[132:135]
  v_mfma_f32_16x16x32_bf16 v[136:139], a[168:171], v[160:163], v[136:139]
  v_mfma_f32_16x16x32_bf16 v[140:143], a[172:175], v[160:163], v[140:143]
  v_mfma_f32_16x16x32_bf16 v[144:147], a[160:163], v[164:167], v[144:147]
  v_mfma_f32_16x16x32_bf16 v[148:151], a[164:167], v[164:167], v[148:151]
  v_mfma_f32_16x16x32_bf16 v[152:155], a[168:171], v[164:167], v[152:155]
  v_mfma_f32_16x16x32_bf16 v[156:159], a[172:175], v[164:167], v[156:159]
  s_waitcnt vmcnt(6)
  s_barrier
  ds_read_b128 v[160:163], v24 offset:24576
  ds_read_b128 v[164:167], v24 offset:25600
  s_waitcnt lgkmcnt(2)
  v_mfma_f32_16x16x32_bf16 v[128:131], a[176:179], v[168:171], v[128:131]
  s_add_u32 m0, s50, 20480
  s_add_u32 s5, s32, 20480
  buffer_load_dwordx4 v20, s[8:11], s5 offen sc1 lds
  v_mfma_f32_16x16x32_bf16 v[132:135], a[180:183], v[168:171], v[132:135]
  v_mfma_f32_16x16x32_bf16 v[136:139], a[184:187], v[168:171], v[136:139]
  v_mfma_f32_16x16x32_bf16 v[140:143], a[188:191], v[168:171], v[140:143]
  v_mfma_f32_16x16x32_bf16 v[144:147], a[176:179], v[172:175], v[144:147]
  v_mfma_f32_16x16x32_bf16 v[148:151], a[180:183], v[172:175], v[148:151]
  v_mfma_f32_16x16x32_bf16 v[152:155], a[184:187], v[172:175], v[152:155]
  v_mfma_f32_16x16x32_bf16 v[156:159], a[188:191], v[172:175], v[156:159]
  ds_read_b128 v[168:171], v24 offset:26624
  ds_read_b128 v[172:175], v24 offset:27648
  s_waitcnt lgkmcnt(2)
  v_mfma_f32_16x16x32_bf16 v[128:131], a[192:195], v[160:163], v[128:131]
  v_mfma_f32_16x16x32_bf16 v[132:135], a[196:199], v[160:163], v[132:135]
  v_mfma_f32_16x16x32_bf16 v[136:139], a[200:203], v[160:163], v[136:139]
  v_mfma_f32_16x16x32_bf16 v[140:143], a[204:207], v[160:163], v[140:143]
  v_mfma_f32_16x16x32_bf16 v[144:147], a[192:195], v[164:167], v[144:147]
  v_mfma_f32_16x16x32_bf16 v[148:151], a[196:199], v[164:167], v[148:151]
  v_mfma_f32_16x16x32_bf16 v[152:155], a[200:203], v[164:167], v[152:155]
  v_mfma_f32_16x16x32_bf16 v[156:159], a[204:207], v[164:167], v[156:159]
  ds_read_b128 v[160:163], v24 offset:28672
  ds_read_b128 v[164:167], v24 offset:29696
  s_waitcnt lgkmcnt(2)
  v_mfma_f32_16x16x32_bf16 v[128:131], a[208:211], v[168:171], v[128:131]
  s_add_u32 m0, s50, 24576
  s_add_u32 s5, s32, 24576
  buffer_load_dwordx4 v20, s[8:11], s5 offen sc1 lds
  v_mfma_f32_16x16x32_bf16 v[132:135], a[212:215], v[168:171], v[132:135]
  v_mfma_f32_16x16x32_bf16 v[136:139], a[216:219], v[168:171], v[136:139]
  v_mfma_f32_16x16x32_bf16 v[140:143], a[220:223], v[168:171], v[140:143]
  v_mfma_f32_16x16x32_bf16 v[144:147], a[208:211], v[172:175], v[144:147]
  v_mfma_f32_16x16x32_bf16 v[148:151], a[212:215], v[172:175], v[148:151]
  v_mfma_f32_16x16x32_bf16 v[152:155], a[216:219], v[172:175], v[152:155]
  v_mfma_f32_16x16x32_bf16 v[156:159], a[220:223], v[172:175], v[156:159]
  ds_read_b128 v[168:171], v24 offset:30720
  ds_read_b128 v[172:175], v24 offset:31744
  s_waitcnt lgkmcnt(2)
  v_mfma_f32_16x16x32_bf16 v[128:131], a[224:227], v[160:163], v[128:131]
  v_mfma_f32_16x16x32_bf16 v[132:135], a[228:231], v[160:163], v[132:135]
  v_mfma_f32_16x16x32_bf16 v[136:139], a[232:235], v[160:163], v[136:139]
  v_mfma_f32_16x16x32_bf16 v[140:143], a[236:239], v[160:163], v[140:143]
  v_mfma_f32_16x16x32_bf16 v[144:147], a[224:227], v[164:167], v[144:147]
  v_mfma_f32_16x16x32_bf16 v[148:151], a[228:231], v[164:167], v[148:151]
  v_mfma_f32_16x16x32_bf16 v[152:155], a[232:235], v[164:167], v[152:155]
  v_mfma_f32_16x16x32_bf16 v[156:159], a[236:239], v[164:167], v[156:159]
  ds_read_b128 v[160:163], v24 offset:32768
  ds_read_b128 v[164:167], v24 offset:33792
  s_waitcnt lgkmcnt(2)
  v_mfma_f32_16x16x32_bf16 v[128:131], a[240:243], v[168:171], v[128:131]
  s_add_u32 m0, s50, 28672
  s_add_u32 s5, s32, 28672
  buffer_load_dwordx4 v20, s[8:11], s5 offen sc1 lds
  v_mfma_f32_16x16x32_bf16 v[132:135], a[244:247], v[168:171], v[132:135]
  v_mfma_f32_16x16x32_bf16 v[136:139], a[248:251], v[168:171], v[136:139]
  v_mfma_f32_16x16x32_bf16 v[140:143], a[252:255], v[168:171], v[140:143]
  v_mfma_f32_16x16x32_bf16 v[144:147], a[240:243], v[172:175], v[144:147]
  v_mfma_f32_16x16x32_bf16 v[148:151], a[244:247], v[172:175], v[148:151]
  v_mfma_f32_16x16x32_bf16 v[152:155], a[248:251], v[172:175], v[152:155]
  v_mfma_f32_16x16x32_bf16 v[156:159], a[252:255], v[172:175], v[156:159]
  ds_read_b128 v[168:171], v24 offset:34816
  ds_read_b128 v[172:175], v24 offset:35840
  s_waitcnt lgkmcnt(2)
  v_mfma_f32_16x16x32_bf16 v[128:131], v[192:195], v[160:163], v[128:131]
  v_mfma_f32_16x16x32_bf16 v[132:135], v[196:199], v[160:163], v[132:135]
  v_mfma_f32_16x16x32_bf16 v[136:139], v[200:203], v[160:163], v[136:139]
  v_mfma_f32_16x16x32_bf16 v[140:143], v[204:207], v[160:163], v[140:143]
  v_mfma_f32_16x16x32_bf16 v[144:147], v[192:195], v[164:167], v[144:147]
  v_mfma_f32_16x16x32_bf16 v[148:151], v[196:199], v[164:167], v[148:151]
  v_mfma_f32_16x16x32_bf16 v[152:155], v[200:203], v[164:167], v[152:155]
  v_mfma_f32_16x16x32_bf16 v[156:159], v[204:207], v[164:167], v[156:159]
  ds_read_b128 v[160:163], v24 offset:36864
  ds_read_b128 v[164:167], v24 offset:37888
  s_waitcnt lgkmcnt(2)
  v_mfma_f32_16x16x32_bf16 v[128:131], v[208:211], v[168:171], v[128:131]
  s_add_u32 m0, s50, 32768
  s_add_u32 s5, s32, 32768
  buffer_load_dwordx4 v20, s[8:11], s5 offen sc1 lds
  v_mfma_f32_16x16x32_bf16 v[132:135], v[212:215], v[168:171], v[132:135]
  v_mfma_f32_16x16x32_bf16 v[136:139], v[216:219], v[168:171], v[136:139]
  v_mfma_f32_16x16x32_bf16 v[140:143], v[220:223], v[168:171], v[140:143]
  v_mfma_f32_16x16x32_bf16 v[144:147], v[208:211], v[172:175], v[144:147]
  v_mfma_f32_16x16x32_bf16 v[148:151], v[212:215], v[172:175], v[148:151]
  v_mfma_f32_16x16x32_bf16 v[152:155], v[216:219], v[172:175], v[152:155]
  v_mfma_f32_16x16x32_bf16 v[156:159], v[220:223], v[172:175], v[156:159]
  ds_read_b128 v[168:171], v24 offset:38912
  ds_read_b128 v[172:175], v24 offset:39936
  s_waitcnt lgkmcnt(2)
  v_mfma_f32_16x16x32_bf16 v[128:131], v[224:227], v[160:163], v[128:131]
  v_mfma_f32_16x16x32_bf16 v[132:135], v[228:231], v[160:163], v[132:135]
  v_mfma_f32_16x16x32_bf16 v[136:139], v[232:235], v[160:163], v[136:139]
  v_mfma_f32_16x16x32_bf16 v[140:143], v[236:239], v[160:163], v[140:143]
  v_mfma_f32_16x16x32_bf16 v[144:147], v[224:227], v[164:167], v[144:147]
  v_mfma_f32_16x16x32_bf16 v[148:151], v[228:231], v[164:167], v[148:151]
  v_mfma_f32_16x16x32_bf16 v[152:155], v[232:235], v[164:167], v[152:155]
  v_mfma_f32_16x16x32_bf16 v[156:159], v[236:239], v[164:167], v[156:159]
  s_waitcnt lgkmcnt(0)
  v_mfma_f32_16x16x32_bf16 v[128:131], v[240:243], v[168:171], v[128:131]
  s_add_u32 m0, s50, 36864
  s_add_u32 s5, s32, 36864
  buffer_load_dwordx4 v20, s[8:11], s5 offen sc1 lds
  v_mfma_f32_16x16x32_bf16 v[132:135], v[244:247], v[168:171], v[132:135]
  v_mfma_f32_16x16x32_bf16 v[136:139], v[248:251], v[168:171], v[136:139]
  v_mfma_f32_16x16x32_bf16 v[140:143], v[252:255], v[168:171], v[140:143]
  v_mfma_f32_16x16x32_bf16 v[144:147], v[240:243], v[172:175], v[144:147]
  v_mfma_f32_16x16x32_bf16 v[148:151], v[244:247], v[172:175], v[148:151]
  v_mfma_f32_16x16x32_bf16 v[152:155], v[248:251], v[172:175], v[152:155]
  v_mfma_f32_16x16x32_bf16 v[156:159], v[252:255], v[172:175], v[156:159]
  s_waitcnt vmcnt(11)
  s_branch L_D_ep
L_D_cB:
  s_cmp_eq_u32 s51, 1
  s_cbranch_scc1 L_D_cBc
  s_waitcnt vmcnt(11)
  s_barrier
  ds_read_b128 v[160:163], v24 offset:0
  ds_read_b128 v[164:167], v24 offset:1024
  ds_read_b128 v[168:171], v24 offset:2048
  ds_read_b128 v[172:175], v24 offset:3072
  s_waitcnt lgkmcnt(2)
  v_mfma_f32_16x16x32_bf16 v[128:131], a[0:3], v[160:163], 0
  v_mfma_f32_16x16x32_bf16 v[132:135], a[4:7], v[160:163], 0
  v_mfma_f32_16x16x32_bf16 v[136:139], a[8:11], v[160:163], 0
  v_mfma_f32_16x16x32_bf16 v[140:143], a[12:15], v[160:163], 0
  v_mfma_f32_16x16x32_bf16 v[144:147], a[0:3], v[164:167], 0
  v_mfma_f32_16x16x32_bf16 v[148:151], a[4:7], v[164:167], 0
  v_mfma_f32_16x16x32_bf16 v[152:155], a[8:11], v[164:167], 0
  v_mfma_f32_16x16x32_bf16 v[156:159], a[12:15], v[164:167], 0
  ds_read_b128 v[160:163], v24 offset:4096
  ds_read_b128 v[164:167], v24 offset:5120
  s_waitcnt lgkmcnt(2)
  v_mfma_f32_16x16x32_bf16 v[128:131], a[16:19], v[168:171], v[128:131]
  v_mfma_f32_16x16x32_bf16 v[132:135], a[20:23], v[168:171], v[132:135]
  v_mfma_f32_16x16x32_bf16 v[136:139], a[24:27], v[168:171], v[136:139]
  v_mfma_f32_16x16x32_bf16 v[140:143], a[28:31], v[168:171], v[140:143]
  v_mfma_f32_16x16x32_bf16 v[144:147], a[16:19], v[172:175], v[144:147]
  v_mfma_f32_16x16x32_bf16 v[148:151], a[20:23], v[172:175], v[148:151]
  v_mfma_f32_16x16x32_bf16 v[152:155], a[24:27], v[172:175], v[152:155]
  v_mfma_f32_16x16x32_bf16 v[156:159], a[28:31], v[172:175], v[156:159]
  ds_read_b128 v[168:171], v24 offset:6144
  ds_read_b128 v[172:175], v24 offset:7168
  s_waitcnt lgkmcnt(2)
  v_mfma_f32_16x16x32_bf16 v[128:131], a[32:35], v[160:163], v[128:131]
  v_mfma_f32_16x16x32_bf16 v[132:135], a[36:39], v[160:163], v[132:135]
  v_mfma_f32_16x16x32_bf16 v[136:139], a[40:43], v[160:163], v[136:139]
  v_mfma_f32_16x16x32_bf16 v[140:143], a[44:47], v[160:163], v[140:143]
  v_mfma_f32_16x16x32_bf16 v[144:147], a[32:35], v[164:167], v[144:147]
  v_mfma_f32_16x16x32_bf16 v[148:151], a[36:39], v[164:167], v[148:151]
  v_mfma_f32_16x16x32_bf16 v[152:155], a[40:43], v[164:167], v[152:155]
  v_mfma_f32_16x16x32_bf16 v[156:159], a[44:47], v[164:167], v[156:159]
  ds_read_b128 v[160:163], v24 offset:8192
  ds_read_b128 v[164:167], v24 offset:9216
  s_waitcnt lgkmcnt(2)
  v_mfma_f32_16x16x32_bf16 v[128:131], a[48:51], v[168:171], v[128:131]
  v_mfma_f32_16x16x32_bf16 v[132:135], a[52:55], v[168:171], v[132:135]
  v_mfma_f32_16x16x32_bf16 v[136:139], a[56:59], v[168:171], v[136:139]
  v_mfma_f32_16x16x32_bf16 v[140:143], a[60:63], v[168:171], v[140:143]
  v_mfma_f32_16x16x32_bf16 v[144:147], a[48:51], v[172:175], v[144:147]
  v_mfma_f32_16x16x32_bf16 v[148:151], a[52:55], v[172:175], v[148:151]
  v_mfma_f32_16x16x32_bf16 v[152:155], a[56:59], v[172:175], v[152:155]
  v_mfma_f32_16x16x32_bf16 v[156:159], a[60:63], v[172:175], v[156:159]
  ds_read_b128 v[168:171], v24 offset:10240
  ds_read_b128 v[172:175], v24 offset:11264
  s_waitcnt lgkmcnt(2)
  v_mfma_f32_16x16x32_bf16 v[128:131], a[64:67], v[160:163], v[128:131]
  v_mfma_f32_16x16x32_bf16 v[132:135], a[68:71], v[160:163], v[132:135]
  v_mfma_f32_16x16x32_bf16 v[136:139], a[72:75], v[160:163], v[136:139]
  v_mfma_f32_16x16x32_bf16 v[140:143], a[76:79], v[160:163], v[140:143]
  v_mfma_f32_16x16x32_bf16 v[144:147], a[64:67], v[164:167], v[144:147]
  v_mfma_f32_16x16x32_bf16 v[148:151], a[68:71], v[164:167], v[148:151]
  v_mfma_f32_16x16x32_bf16 v[152:155], a[72:75], v[164:167], v[152:155]
  v_mfma_f32_16x16x32_bf16 v[156:159], a[76:79], v[164:167], v[156:159]
  s_waitcnt vmcnt(7)
  s_barrier
  ds_read_b128 v[160:163], v24 offset:12288
  ds_read_b128 v[164:167], v24 offset:13312
  s_waitcnt lgkmcnt(2)
  v_mfma_f32_16x16x32_bf16 v[128:131], a[80:83], v[168:171], v[128:131]
  v_mfma_f32_16x16x32_bf16 v[132:135], a[84:87], v[168:171], v[132:135]
  v_mfma_f32_16x16x32_bf16 v[136:139], a[88:91], v[168:171], v[136:139]
  v_mfma_f32_16x16x32_bf16 v[140:143], a[92:95], v[168:171], v[140:143]
  v_mfma_f32_16x16x32_bf16 v[144:147], a[80:83], v[172:175], v[144:147]
  v_mfma_f32_16x16x32_bf16 v[148:151], a[84:87], v[172:175], v[148:151]
  v_mfma_f32_16x16x32_bf16 v[152:155], a[88:91], v[172:175], v[152:155]
  v_mfma_f32_16x16x32_bf16 v[156:159], a[92:95], v[172:175], v[156:159]
  ds_read_b128 v[168:171], v24 offset:14336
  ds_read_b128 v[172:175], v24 offset:15360
  s_waitcnt lgkmcnt(2)
  v_mfma_f32_16x16x32_bf16 v[128:131], a[96:99], v[160:163], v[128:131]
  buffer_load_dword v28, v23, s[8:11], 0 offen sc1
  v_mfma_f32_16x16x32_bf16 v[132:135], a[100:103], v[160:163], v[132:135]
  v_mfma_f32_16x16x32_bf16 v[136:139], a[104:107], v[160:163], v[136:139]
  v_mfma_f32_16x16x32_bf16 v[140:143], a[108:111], v[160:163], v[140:143]
  v_mfma_f32_16x16x32_bf16 v[144:147], a[96:99], v[164:167], v[144:147]
  v_mfma_f32_16x16x32_bf16 v[148:151], a[100:103], v[164:167], v[148:151]
  v_mfma_f32_16x16x32_bf16 v[152:155], a[104:107], v[164:167], v[152:155]
  v_mfma_f32_16x16x32_bf16 v[156:159], a[108:111], v[164:167], v[156:159]
  ds_read_b128 v[160:163], v24 offset:16384
  ds_read_b128 v[164:167], v24 offset:17408
  s_waitcnt lgkmcnt(2)
  v_mfma_f32_16x16x32_bf16 v[128:131], a[112:115], v[168:171], v[128:131]
  v_mfma_f32_16x16x32_bf16 v[132:135], a[116:119], v[168:171], v[132:135]
  v_mfma_f32_16x16x32_bf16 v[136:139], a[120:123], v[168:171], v[136:139]
  v_mfma_f32_16x16x32_bf16 v[140:143], a[124:127], v[168:171], v[140:143]
  v_mfma_f32_16x16x32_bf16 v[144:147], a[112:115], v[172:175], v[144:147]
  v_mfma_f32_16x16x32_bf16 v[148:151], a[116:119], v[172:175], v[148:151]
  v_mfma_f32_16x16x32_bf16 v[152:155], a[120:123], v[172:175], v[152:155]
  v_mfma_f32_16x16x32_bf16 v[156:159], a[124:127], v[172:175], v[156:159]
  ds_read_b128 v[168:171], v24 offset:18432
  ds_read_b128 v[172:175], v24 offset:19456
  s_waitcnt lgkmcnt(2)
  v_mfma_f32_16x16x32_bf16 v[128:131], a[128:131], v[160:163], v[128:131]
  v_mfma_f32_16x16x32_bf16 v[132:135], a[132:135], v[160:163], v[132:135]
  v_mfma_f32_16x16x32_bf16 v[136:139], a[136:139], v[160:163], v[136:139]
  v_mfma_f32_16x16x32_bf16 v[140:143], a[140:143], v[160:163], v[140:143]
  v_mfma_f32_16x16x32_bf16 v[144:147], a[128:131], v[164:167], v[144:147]
  v_mfma_f32_16x16x32_bf16 v[148:151], a[132:135], v[164:167], v[148:151]
  v_mfma_f32_16x16x32_bf16 v[152:155], a[136:139], v[164:167], v[152:155]
  v_mfma_f32_16x16x32_bf16 v[156:159], a[140:143], v[164:167], v[156:159]
  ds_read_b128 v[160:163], v24 offset:20480
  ds_read_b128 v[164:167], v24 offset:21504
  s_waitcnt lgkmcnt(2)
  v_mfma_f32_16x16x32_bf16 v[128:131], a[144:147], v[168:171], v[128:131]
  v_mfma_f32_16x16x32_bf16 v[132:135], a[148:151], v[168:171], v[132:135]
  v_mfma_f32_16x16x32_bf16 v[136:139], a[152:155], v[168:171], v[136:139]
  v_mfma_f32_16x16x32_bf16 v[140:143], a[156:159], v[168:171], v[140:143]
  v_mfma_f32_16x16x32_bf16 v[144:147], a[144:147], v[172:175], v[144:147]
  v_mfma_f32_16x16x32_bf16 v[148:151], a[148:151], v[172:175], v[148:151]
  v_mfma_f32_16x16x32_bf16 v[152:155], a[152:155], v[172:175], v[152:155]
  v_mfma_f32_16x16x32_bf16 v[156:159], a[156:159], v[172:175], v[156:159]
  ds_read_b128 v[168:171], v24 offset:22528
  ds_read_b128 v[172:175], v24 offset:23552
  s_waitcnt lgkmcnt(2)
  v_mfma_f32_16x16x32_bf16 v[128:131], a[160:163], v[160:163], v[128:131]
  v_mfma_f32_16x16x32_bf16 v[132:135], a[164:167], v[160:163], v[132:135]
  v_mfma_f32_16x16x32_bf16 v[136:139], a[168:171], v[160:163], v[136:139]
  v_mfma_f32_16x16x32_bf16 v[140:143], a[172:175], v[160:163], v[140:143]
  v_mfma_f32_16x16x32_bf16 v[144:147], a[160:163], v[164:167], v[144:147]
  v_mfma_f32_16x16x32_bf16 v[148:151], a[164:167], v[164:167], v[148:151]
  v_mfma_f32_16x16x32_bf16 v[152:155], a[168:171], v[164:167], v[152:155]
  v_mfma_f32_16x16x32_bf16 v[156:159], a[172:175], v[164:167], v[156:159]
  s_waitcnt vmcnt(4)
  s_barrier
  ds_read_b128 v[160:163], v24 offset:24576
  ds_read_b128 v[164:167], v24 offset:25600
  s_waitcnt lgkmcnt(2)
  v_mfma_f32_16x16x32_bf16 v[128:131], a[176:179], v[168:171], v[128:131]
  v_mfma_f32_16x16x32_bf16 v[132:135], a[180:183], v[168:171], v[132:135]
  v_mfma_f32_16x16x32_bf16 v[136:139], a[184:187], v[168:171], v[136:139]
  v_mfma_f32_16x16x32_bf16 v[140:143], a[188:191], v[168:171], v[140:143]
  v_mfma_f32_16x16x32_bf16 v[144:147], a[176:179], v[172:175], v[144:147]
  v_mfma_f32_16x16x32_bf16 v[148:151], a[180:183], v[172:175], v[148:151]
  v_mfma_f32_16x16x32_bf16 v[152:155], a[184:187], v[172:175], v[152:155]
  v_mfma_f32_16x16x32_bf16 v[156:159], a[188:191], v[172:175], v[156:159]
  ds_read_b128 v[168:171], v24 offset:26624
  ds_read_b128 v[172:175], v24 offset:27648
  s_waitcnt lgkmcnt(2)
  v_mfma_f32_16x16x32_bf16 v[128:131], a[192:195], v[160:163], v[128:131]
  v_mfma_f32_16x16x32_bf16 v[132:135], a[196:199], v[160:163], v[132:135]
  v_mfma_f32_16x16x32_bf16 v[136:139], a[200:203], v[160:163], v[136:139]
  v_mfma_f32_16x16x32_bf16 v[140:143], a[204:207], v[160:163], v[140:143]
  v_mfma_f32_16x16x32_bf16 v[144:147], a[192:195], v[164:167], v[144:147]
  v_mfma_f32_16x16x32_bf16 v[148:151], a[196:199], v[164:167], v[148:151]
  v_mfma_f32_16x16x32_bf16 v[152:155], a[200:203], v[164:167], v[152:155]
  v_mfma_f32_16x16x32_bf16 v[156:159], a[204:207], v[164:167], v[156:159]
  ds_read_b128 v[160:163], v24 offset:28672
  ds_read_b128 v[164:167], v24 offset:29696
  s_waitcnt lgkmcnt(2)
  v_mfma_f32_16x16x32_bf16 v[128:131], a[208:211], v[168:171], v[128:131]
  v_mfma_f32_16x16x32_bf16 v[132:135], a[212:215], v[168:171], v[132:135]
  v_mfma_f32_16x16x32_bf16 v[136:139], a[216:219], v[168:171], v[136:139]
  v_mfma_f32_16x16x32_bf16 v[140:143], a[220:223], v[168:171], v[140:143]
  v_mfma_f32_16x16x32_bf16 v[144:147], a[208:211], v[172:175], v[144:147]
  v_mfma_f32_16x16x32_bf16 v[148:151], a[212:215], v[172:175], v[148:151]
  v_mfma_f32_16x16x32_bf16 v[152:155], a[216:219], v[172:175], v[152:155]
  v_mfma_f32_16x16x32_bf16 v[156:159], a[220:223], v[172:175], v[156:159]
  ds_read_b128 v[168:171], v24 offset:30720
  ds_read_b128 v[172:175], v24 offset:31744
  s_waitcnt lgkmcnt(2)
  v_mfma_f32_16x16x32_bf16 v[128:131], a[224:227], v[160:163], v[128:131]
  v_mfma_f32_16x16x32_bf16 v[132:135], a[228:231], v[160:163], v[132:135]
  v_mfma_f32_16x16x32_bf16 v[136:139], a[232:235], v[160:163], v[136:139]
  v_mfma_f32_16x16x32_bf16 v[140:143], a[236:239], v[160:163], v[140:143]
  v_mfma_f32_16x16x32_bf16 v[144:147], a[224:227], v[164:167], v[144:147]
  v_mfma_f32_16x16x32_bf16 v[148:151], a[228:231], v[164:167], v[148:151]
  v_mfma_f32_16x16x32_bf16 v[152:155], a[232:235], v[164:167], v[152:155]
  v_mfma_f32_16x16x32_bf16 v[156:159], a[236:239], v[164:167], v[156:159]
  ds_read_b128 v[160:163], v24 offset:32768
  ds_read_b128 v[164:167], v24 offset:33792
  s_waitcnt lgkmcnt(2)
  v_mfma_f32_16x16x32_bf16 v[128:131], a[240:243], v[168:171], v[128:131]
  v_mfma_f32_16x16x32_bf16 v[132:135], a[244:247], v[168:171], v[132:135]
  v_mfma_f32_16x16x32_bf16 v[136:139], a[248:251], v[168:171], v[136:139]
  v_mfma_f32_16x16x32_bf16 v[140:143], a[252:255], v[168:171], v[140:143]
  v_mfma_f32_16x16x32_bf16 v[144:147], a[240:243], v[172:175], v[144:147]
  v_mfma_f32_16x16x32_bf16 v[148:151], a[244:247], v[172:175], v[148:151]
  v_mfma_f32_16x16x32_bf16 v[152:155], a[248:251], v[172:175], v[152:155]
  v_mfma_f32_16x16x32_bf16 v[156:159], a[252:255], v[172:175], v[156:159]
  ds_read_b128 v[168:171], v24 offset:34816
  ds_read_b128 v[172:175], v24 offset:35840
  s_waitcnt lgkmcnt(2)
  v_mfma_f32_16x16x32_bf16 v[128:131], v[192:195], v[160:163], v[128:131]
  v_mfma_f32_16x16x32_bf16 v[132:135], v[196:199], v[160:163], v[132:135]
  v_mfma_f32_16x16x32_bf16 v[136:139], v[200:203], v[160:163], v[136:139]
  v_mfma_f32_16x16x32_bf16 v[140:143], v[204:207], v[160:163], v[140:143]
  v_mfma_f32_16x16x32_bf16 v[144:147], v[192:195], v[164:167], v[144:147]
  v_mfma_f32_16x16x32_bf16 v[148:151], v[196:199], v[164:167], v[148:151]
  v_mfma_f32_16x16x32_bf16 v[152:155], v[200:203], v[164:167], v[152:155]
  v_mfma_f32_16x16x32_bf16 v[156:159], v[204:207], v[164:167], v[156:159]
  ds_read_b128 v[160:163], v24 offset:36864
  ds_read_b128 v[164:167], v24 offset:37888
  s_waitcnt lgkmcnt(2)
  v_mfma_f32_16x16x32_bf16 v[128:131], v[208:211], v[168:171], v[128:131]
  v_mfma_f32_16x16x32_bf16 v[132:135], v[212:215], v[168:171], v[132:135]
  v_mfma_f32_16x16x32_bf16 v[136:139], v[216:219], v[168:171], v[136:139]
  v_mfma_f32_16x16x32_bf16 v[140:143], v[220:223], v[168:171], v[140:143]
  v_mfma_f32_16x16x32_bf16 v[144:147], v[208:211], v[172:175], v[144:147]
  v_mfma_f32_16x16x32_bf16 v[148:151], v[212:215], v[172:175], v[148:151]
  v_mfma_f32_16x16x32_bf16 v[152:155], v[216:219], v[172:175], v[152:155]
  v_mfma_f32_16x16x32_bf16 v[156:159], v[220:223], v[172:175], v[156:159]
  ds_read_b128 v[168:171], v24 offset:38912
  ds_read_b128 v[172:175], v24 offset:39936
  s_waitcnt lgkmcnt(2)
  v_mfma_f32_16x16x32_bf16 v[128:131], v[224:227], v[160:163], v[128:131]
  v_mfma_f32_16x16x32_bf16 v[132:135], v[228:231], v[160:163], v[132:135]
  v_mfma_f32_16x16x32_bf16 v[136:139], v[232:235], v[160:163], v[136:139]
  v_mfma_f32_16x16x32_bf16 v[140:143], v[236:239], v[160:163], v[140:143]
  v_mfma_f32_16x16x32_bf16 v[144:147], v[224:227], v[164:167], v[144:147]
  v_mfma_f32_16x16x32_bf16 v[148:151], v[228:231], v[164:167], v[148:151]
  v_mfma_f32_16x16x32_bf16 v[152:155], v[232:235], v[164:167], v[152:155]
  v_mfma_f32_16x16x32_bf16 v[156:159], v[236:239], v[164:167], v[156:159]
  s_waitcnt lgkmcnt(0)
  v_mfma_f32_16x16x32_bf16 v[128:131], v[240:243], v[168:171], v[128:131]
  v_mfma_f32_16x16x32_bf16 v[132:135], v[244:247], v[168:171], v[132:135]
  v_mfma_f32_16x16x32_bf16 v[136:139], v[248:251], v[168:171], v[136:139]
  v_mfma_f32_16x16x32_bf16 v[140:143], v[252:255], v[168:171], v[140:143]
  v_mfma_f32_16x16x32_bf16 v[144:147], v[240:243], v[172:175], v[144:147]
  v_mfma_f32_16x16x32_bf16 v[148:151], v[244:247], v[172:175], v[148:151]
  v_mfma_f32_16x16x32_bf16 v[152:155], v[248:251], v[172:175], v[152:155]
  v_mfma_f32_16x16x32_bf16 v[156:159], v[252:255], v[172:175], v[156:159]
  s_waitcnt vmcnt(1)
  s_branch L_D_ep
L_D_cBc:
  s_waitcnt vmcnt(7)
  s_barrier
  ds_read_b128 v[160:163], v24 offset:0
  ds_read_b128 v[164:167], v24 offset:1024
  ds_read_b128 v[168:171], v24 offset:2048
  ds_read_b128 v[172:175], v24 offset:3072
  s_waitcnt lgkmcnt(2)
  v_mfma_f32_16x16x32_bf16 v[128:131], a[0:3], v[160:163], 0
  v_mfma_f32_16x16x32_bf16 v[132:135], a[4:7], v[160:163], 0
  v_mfma_f32_16x16x32_bf16 v[136:139], a[8:11], v[160:163], 0
  v_mfma_f32_16x16x32_bf16 v[140:143], a[12:15], v[160:163], 0
  v_mfma_f32_16x16x32_bf16 v[144:147], a[0:3], v[164:167], 0
  v_mfma_f32_16x16x32_bf16 v[148:151], a[4:7], v[164:167], 0
  v_mfma_f32_16x16x32_bf16 v[152:155], a[8:11], v[164:167], 0
  v_mfma_f32_16x16x32_bf16 v[156:159], a[12:15], v[164:167], 0
  ds_read_b128 v[160:163], v24 offset:4096
  ds_read_b128 v[164:167], v24 offset:5120
  s_waitcnt lgkmcnt(2)
  v_mfma_f32_16x16x32_bf16 v[128:131], a[16:19], v[168:171], v[128:131]
  v_mfma_f32_16x16x32_bf16 v[132:135], a[20:23], v[168:171], v[132:135]
  v_mfma_f32_16x16x32_bf16 v[136:139], a[24:27], v[168:171], v[136:139]
  v_mfma_f32_16x16x32_bf16 v[140:143], a[28:31], v[168:171], v[140:143]
  v_mfma_f32_16x16x32_bf16 v[144:147], a[16:19], v[172:175], v[144:147]
  v_mfma_f32_16x16x32_bf16 v[148:151], a[20:23], v[172:175], v[148:151]
  v_mfma_f32_16x16x32_bf16 v[152:155], a[24:27], v[172:175], v[152:155]
  v_mfma_f32_16x16x32_bf16 v[156:159], a[28:31], v[172:175], v[156:159]
  ds_read_b128 v[168:171], v24 offset:6144
  ds_read_b128 v[172:175], v24 offset:7168
  s_waitcnt lgkmcnt(2)
  v_mfma_f32_16x16x32_bf16 v[128:131], a[32:35], v[160:163], v[128:131]
  v_mfma_f32_16x16x32_bf16 v[132:135], a[36:39], v[160:163], v[132:135]
  v_mfma_f32_16x16x32_bf16 v[136:139], a[40:43], v[160:163], v[136:139]
  v_mfma_f32_16x16x32_bf16 v[140:143], a[44:47], v[160:163], v[140:143]
  v_mfma_f32_16x16x32_bf16 v[144:147], a[32:35], v[164:167], v[144:147]
  v_mfma_f32_16x16x32_bf16 v[148:151], a[36:39], v[164:167], v[148:151]
  v_mfma_f32_16x16x32_bf16 v[152:155], a[40:43], v[164:167], v[152:155]
  v_mfma_f32_16x16x32_bf16 v[156:159], a[44:47], v[164:167], v[156:159]
  ds_read_b128 v[160:163], v24 offset:8192
  ds_read_b128 v[164:167], v24 offset:9216
  s_waitcnt lgkmcnt(2)
  v_mfma_f32_16x16x32_bf16 v[128:131], a[48:51], v[168:171], v[128:131]
  v_mfma_f32_16x16x32_bf16 v[132:135], a[52:55], v[168:171], v[132:135]
  v_mfma_f32_16x16x32_bf16 v[136:139], a[56:59], v[168:171], v[136:139]
  v_mfma_f32_16x16x32_bf16 v[140:143], a[60:63], v[168:171], v[140:143]
  v_mfma_f32_16x16x32_bf16 v[144:147], a[48:51], v[172:175], v[144:147]
  v_mfma_f32_16x16x32_bf16 v[148:151], a[52:55], v[172:175], v[148:151]
  v_mfma_f32_16x16x32_bf16 v[152:155], a[56:59], v[172:175], v[152:155]
  v_mfma_f32_16x16x32_bf16 v[156:159], a[60:63], v[172:175], v[156:159]
  ds_read_b128 v[168:171], v24 offset:10240
  ds_read_b128 v[172:175], v24 offset:11264
  s_waitcnt lgkmcnt(2)
  v_mfma_f32_16x16x32_bf16 v[128:131], a[64:67], v[160:163], v[128:131]
  v_mfma_f32_16x16x32_bf16 v[132:135], a[68:71], v[160:163], v[132:135]
  v_mfma_f32_16x16x32_bf16 v[136:139], a[72:75], v[160:163], v[136:139]
  v_mfma_f32_16x16x32_bf16 v[140:143], a[76:79], v[160:163], v[140:143]
  v_mfma_f32_16x16x32_bf16 v[144:147], a[64:67], v[164:167], v[144:147]
  v_mfma_f32_16x16x32_bf16 v[148:151], a[68:71], v[164:167], v[148:151]
  v_mfma_f32_16x16x32_bf16 v[152:155], a[72:75], v[164:167], v[152:155]
  v_mfma_f32_16x16x32_bf16 v[156:159], a[76:79], v[164:167], v[156:159]
  s_waitcnt vmcnt(4)
  s_barrier
  ds_read_b128 v[160:163], v24 offset:12288
  ds_read_b128 v[164:167], v24 offset:13312
  s_waitcnt lgkmcnt(2)
  v_mfma_f32_16x16x32_bf16 v[128:131], a[80:83], v[168:171], v[128:131]
  v_mfma_f32_16x16x32_bf16 v[132:135], a[84:87], v[168:171], v[132:135]
  v_mfma_f32_16x16x32_bf16 v[136:139], a[88:91], v[168:171], v[136:139]
  v_mfma_f32_16x16x32_bf16 v[140:143], a[92:95], v[168:171], v[140:143]
  v_mfma_f32_16x16x32_bf16 v[144:147], a[80:83], v[172:175], v[144:147]
  v_mfma_f32_16x16x32_bf16 v[148:151], a[84:87], v[172:175], v[148:151]
  v_mfma_f32_16x16x32_bf16 v[152:155], a[88:91], v[172:175], v[152:155]
  v_mfma_f32_16x16x32_bf16 v[156:159], a[92:95], v[172:175], v[156:159]
  ds_read_b128 v[168:171], v24 offset:14336
  ds_read_b128 v[172:175], v24 offset:15360
  s_waitcnt lgkmcnt(2)
  v_mfma_f32_16x16x32_bf16 v[128:131], a[96:99], v[160:163], v[128:131]
  buffer_load_dword v28, v23, s[8:11], 0 offen sc1
  v_mfma_f32_16x16x32_bf16 v[132:135], a[100:103], v[160:163], v[132:135]
  v_mfma_f32_16x16x32_bf16 v[136:139], a[104:107], v[160:163], v[136:139]
  v_mfma_f32_16x16x32_bf16 v[140:143], a[108:111], v[160:163], v[140:143]
  v_mfma_f32_16x16x32_bf16 v[144:147], a[96:99], v[164:167], v[144:147]
  v_mfma_f32_16x16x32_bf16 v[148:151], a[100:103], v[164:167], v[148:151]
  v_mfma_f32_16x16x32_bf16 v[152:155], a[104:107], v[164:167], v[152:155]
  v_mfma_f32_16x16x32_bf16 v[156:159], a[108:111], v[164:167], v[156:159]
  ds_read_b128 v[160:163], v24 offset:16384
  ds_read_b128 v[164:167], v24 offset:17408
  s_waitcnt lgkmcnt(2)
  v_mfma_f32_16x16x32_bf16 v[128:131], a[112:115], v[168:171], v[128:131]
  v_mfma_f32_16x16x32_bf16 v[132:135], a[116:119], v[168:171], v[132:135]
  v_mfma_f32_16x16x32_bf16 v[136:139], a[120:123], v[168:171], v[136:139]
  v_mfma_f32_16x16x32_bf16 v[140:143], a[124:127], v[168:171], v[140:143]
  v_mfma_f32_16x16x32_bf16 v[144:147], a[112:115], v[172:175], v[144:147]
  v_mfma_f32_16x16x32_bf16 v[148:151], a[116:119], v[172:175], v[148:151]
  v_mfma_f32_16x16x32_bf16 v[152:155], a[120:123], v[172:175], v[152:155]
  v_mfma_f32_16x16x32_bf16 v[156:159], a[124:127], v[172:175], v[156:159]
  ds_read_b128 v[168:171], v24 offset:18432
  ds_read_b128 v[172:175], v24 offset:19456
  s_waitcnt lgkmcnt(2)
  v_mfma_f32_16x16x32_bf16 v[128:131], a[128:131], v[160:163], v[128:131]
  v_mfma_f32_16x16x32_bf16 v[132:135], a[132:135], v[160:163], v[132:135]
  v_mfma_f32_16x16x32_bf16 v[136:139], a[136:139], v[160:163], v[136:139]
  v_mfma_f32_16x16x32_bf16 v[140:143], a[140:143], v[160:163], v[140:143]
  v_mfma_f32_16x16x32_bf16 v[144:147], a[128:131], v[164:167], v[144:147]
  v_mfma_f32_16x16x32_bf16 v[148:151], a[132:135], v[164:167], v[148:151]
  v_mfma_f32_16x16x32_bf16 v[152:155], a[136:139], v[164:167], v[152:155]
  v_mfma_f32_16x16x32_bf16 v[156:159], a[140:143], v[164:167], v[156:159]
  ds_read_b128 v[160:163], v24 offset:20480
  ds_read_b128 v[164:167], v24 offset:21504
  s_waitcnt lgkmcnt(2)
  v_mfma_f32_16x16x32_bf16 v[128:131], a[144:147], v[168:171], v[128:131]
  v_mfma_f32_16x16x32_bf16 v[132:135], a[148:151], v[168:171], v[132:135]
  v_mfma_f32_16x16x32_bf16 v[136:139], a[152:155], v[168:171], v[136:139]
  v_mfma_f32_16x16x32_bf16 v[140:143], a[156:159], v[168:171], v[140:143]
  v_mfma_f32_16x16x32_bf16 v[144:147], a[144:147], v[172:175], v[144:147]
  v_mfma_f32_16x16x32_bf16 v[148:151], a[148:151], v[172:175], v[148:151]
  v_mfma_f32_16x16x32_bf16 v[152:155], a[152:155], v[172:175], v[152:155]
  v_mfma_f32_16x16x32_bf16 v[156:159], a[156:159], v[172:175], v[156:159]
  ds_read_b128 v[168:171], v24 offset:22528
  ds_read_b128 v[172:175], v24 offset:23552
  s_waitcnt lgkmcnt(2)
  v_mfma_f32_16x16x32_bf16 v[128:131], a[160:163], v[160:163], v[128:131]
  v_mfma_f32_16x16x32_bf16 v[132:135], a[164:167], v[160:163], v[132:135]
  v_mfma_f32_16x16x32_bf16 v[136:139], a[168:171], v[160:163], v[136:139]
  v_mfma_f32_16x16x32_bf16 v[140:143], a[172:175], v[160:163], v[140:143]
  v_mfma_f32_16x16x32_bf16 v[144:147], a[160:163], v[164:167], v[144:147]
  v_mfma_f32_16x16x32_bf16 v[148:151], a[164:167], v[164:167], v[148:151]
  v_mfma_f32_16x16x32_bf16 v[152:155], a[168:171], v[164:167], v[152:155]
  v_mfma_f32_16x16x32_bf16 v[156:159], a[172:175], v[164:167], v[156:159]
  s_waitcnt vmcnt(1)
  s_barrier
  ds_read_b128 v[160:163], v24 offset:24576
  ds_read_b128 v[164:167], v24 offset:25600
  s_waitcnt lgkmcnt(2)
  v_mfma_f32_16x16x32_bf16 v[128:131], a[176:179], v[168:171], v[128:131]
  v_mfma_f32_16x16x32_bf16 v[132:135], a[180:183], v[168:171], v[132:135]
  v_mfma_f32_16x16x32_bf16 v[136:139], a[184:187], v[168:171], v[136:139]
  v_mfma_f32_16x16x32_bf16 v[140:143], a[188:191], v[168:171], v[140:143]
  v_mfma_f32_16x16x32_bf16 v[144:147], a[176:179], v[172:175], v[144:147]
  v_mfma_f32_16x16x32_bf16 v[148:151], a[180:183], v[172:175], v[148:151]
  v_mfma_f32_16x16x32_bf16 v[152:155], a[184:187], v[172:175], v[152:155]
  v_mfma_f32_16x16x32_bf16 v[156:159], a[188:191], v[172:175], v[156:159]
  ds_read_b128 v[168:171], v24 offset:26624
  ds_read_b128 v[172:175], v24 offset:27648
  s_waitcnt lgkmcnt(2)
  v_mfma_f32_16x16x32_bf16 v[128:131], a[192:195], v[160:163], v[128:131]
  v_mfma_f32_16x16x32_bf16 v[132:135], a[196:199], v[160:163], v[132:135]
  v_mfma_f32_16x16x32_bf16 v[136:139], a[200:203], v[160:163], v[136:139]
  v_mfma_f32_16x16x32_bf16 v[140:143], a[204:207], v[160:163], v[140:143]
  v_mfma_f32_16x16x32_bf16 v[144:147], a[192:195], v[164:167], v[144:147]
  v_mfma_f32_16x16x32_bf16 v[148:151], a[196:199], v[164:167], v[148:151]
  v_mfma_f32_16x16x32_bf16 v[152:155], a[200:203], v[164:167], v[152:155]
  v_mfma_f32_16x16x32_bf16 v[156:159], a[204:207], v[164:167], v[156:159]
  ds_read_b128 v[160:163], v24 offset:28672
  ds_read_b128 v[164:167], v24 offset:29696
  s_waitcnt lgkmcnt(2)
  v_mfma_f32_16x16x32_bf16 v[128:131], a[208:211], v[168:171], v[128:131]
  v_mfma_f32_16x16x32_bf16 v[132:135], a[212:215], v[168:171], v[132:135]
  v_mfma_f32_16x16x32_bf16 v[136:139], a[216:219], v[168:171], v[136:139]
  v_mfma_f32_16x16x32_bf16 v[140:143], a[220:223], v[168:171], v[140:143]
  v_mfma_f32_16x16x32_bf16 v[144:147], a[208:211], v[172:175], v[144:147]
  v_mfma_f32_16x16x32_bf16 v[148:151], a[212:215], v[172:175], v[148:151]
  v_mfma_f32_16x16x32_bf16 v[152:155], a[216:219], v[172:175], v[152:155]
  v_mfma_f32_16x16x32_bf16 v[156:159], a[220:223], v[172:175], v[156:159]
  ds_read_b128 v[168:171], v24 offset:30720
  ds_read_b128 v[172:175], v24 offset:31744
  s_waitcnt lgkmcnt(2)
  v_mfma_f32_16x16x32_bf16 v[128:131], a[224:227], v[160:163], v[128:131]
  v_mfma_f32_16x16x32_bf16 v[132:135], a[228:231], v[160:163], v[132:135]
  v_mfma_f32_16x16x32_bf16 v[136:139], a[232:235], v[160:163], v[136:139]
  v_mfma_f32_16x16x32_bf16 v[140:143], a[236:239], v[160:163], v[140:143]
  v_mfma_f32_16x16x32_bf16 v[144:147], a[224:227], v[164:167], v[144:147]
  v_mfma_f32_16x16x32_bf16 v[148:151], a[228:231], v[164:167], v[148:151]
  v_mfma_f32_16x16x32_bf16 v[152:155], a[232:235], v[164:167], v[152:155]
  v_mfma_f32_16x16x32_bf16 v[156:159], a[236:239], v[164:167], v[156:159]
  ds_read_b128 v[160:163], v24 offset:32768
  ds_read_b128 v[164:167], v24 offset:33792
  s_waitcnt lgkmcnt(2)
  v_mfma_f32_16x16x32_bf16 v[128:131], a[240:243], v[168:171], v[128:131]
  v_mfma_f32_16x16x32_bf16 v[132:135], a[244:247], v[168:171], v[132:135]
  v_mfma_f32_16x16x32_bf16 v[136:139], a[248:251], v[168:171], v[136:139]
  v_mfma_f32_16x16x32_bf16 v[140:143], a[252:255], v[168:171], v[140:143]
  v_mfma_f32_16x16x32_bf16 v[144:147], a[240:243], v[172:175], v[144:147]
  v_mfma_f32_16x16x32_bf16 v[148:151], a[244:247], v[172:175], v[148:151]
  v_mfma_f32_16x16x32_bf16 v[152:155], a[248:251], v[172:175], v[152:155]
  v_mfma_f32_16x16x32_bf16 v[156:159], a[252:255], v[172:175], v[156:159]
  ds_read_b128 v[168:171], v24 offset:34816
  ds_read_b128 v[172:175], v24 offset:35840
  s_waitcnt lgkmcnt(2)
  v_mfma_f32_16x16x32_bf16 v[128:131], v[192:195], v[160:163], v[128:131]
  v_mfma_f32_16x16x32_bf16 v[132:135], v[196:199], v[160:163], v[132:135]
  v_mfma_f32_16x16x32_bf16 v[136:139], v[200:203], v[160:163], v[136:139]
  v_mfma_f32_16x16x32_bf16 v[140:143], v[204:207], v[160:163], v[140:143]
  v_mfma_f32_16x16x32_bf16 v[144:147], v[192:195], v[164:167], v[144:147]
  v_mfma_f32_16x16x32_bf16 v[148:151], v[196:199], v[164:167], v[148:151]
  v_mfma_f32_16x16x32_bf16 v[152:155], v[200:203], v[164:167], v[152:155]
  v_mfma_f32_16x16x32_bf16 v[156:159], v[204:207], v[164:167], v[156:159]
  ds_read_b128 v[160:163], v24 offset:36864
  ds_read_b128 v[164:167], v24 offset:37888
  s_waitcnt lgkmcnt(2)
  v_mfma_f32_16x16x32_bf16 v[128:131], v[208:211], v[168:171], v[128:131]
  v_mfma_f32_16x16x32_bf16 v[132:135], v[212:215], v[168:171], v[132:135]
  v_mfma_f32_16x16x32_bf16 v[136:139], v[216:219], v[168:171], v[136:139]
  v_mfma_f32_16x16x32_bf16 v[140:143], v[220:223], v[168:171], v[140:143]
  v_mfma_f32_16x16x32_bf16 v[144:147], v[208:211], v[172:175], v[144:147]
  v_mfma_f32_16x16x32_bf16 v[148:151], v[212:215], v[172:175], v[148:151]
  v_mfma_f32_16x16x32_bf16 v[152:155], v[216:219], v[172:175], v[152:155]
  v_mfma_f32_16x16x32_bf16 v[156:159], v[220:223], v[172:175], v[156:159]
  ds_read_b128 v[168:171], v24 offset:38912
  ds_read_b128 v[172:175], v24 offset:39936
  s_waitcnt lgkmcnt(2)
  v_mfma_f32_16x16x32_bf16 v[128:131], v[224:227], v[160:163], v[128:131]
  v_mfma_f32_16x16x32_bf16 v[132:135], v[228:231], v[160:163], v[132:135]
  v_mfma_f32_16x16x32_bf16 v[136:139], v[232:235], v[160:163], v[136:139]
  v_mfma_f32_16x16x32_bf16 v[140:143], v[236:239], v[160:163], v[140:143]
  v_mfma_f32_16x16x32_bf16 v[144:147], v[224:227], v[164:167], v[144:147]
  v_mfma_f32_16x16x32_bf16 v[148:151], v[228:231], v[164:167], v[148:151]
  v_mfma_f32_16x16x32_bf16 v[152:155], v[232:235], v[164:167], v[152:155]
  v_mfma_f32_16x16x32_bf16 v[156:159], v[236:239], v[164:167], v[156:159]
  s_waitcnt lgkmcnt(0)
  v_mfma_f32_16x16x32_bf16 v[128:131], v[240:243], v[168:171], v[128:131]
  v_mfma_f32_16x16x32_bf16 v[132:135], v[244:247], v[168:171], v[132:135]
  v_mfma_f32_16x16x32_bf16 v[136:139], v[248:251], v[168:171], v[136:139]
  v_mfma_f32_16x16x32_bf16 v[140:143], v[252:255], v[168:171], v[140:143]
  v_mfma_f32_16x16x32_bf16 v[144:147], v[240:243], v[172:175], v[144:147]
  v_mfma_f32_16x16x32_bf16 v[148:151], v[244:247], v[172:175], v[148:151]
  v_mfma_f32_16x16x32_bf16 v[152:155], v[248:251], v[172:175], v[152:155]
  v_mfma_f32_16x16x32_bf16 v[156:159], v[252:255], v[172:175], v[156:159]
  s_waitcnt vmcnt(1)
L_D_ep:
  s_mov_b64 exec, 1
  v_mov_b32 v29, s31
  v_mov_b32 v30, 0
  buffer_store_dword v29, v30, s[8:11], s35 offen sc1
  s_mov_b64 exec, -1
  s_mul_i32 s4, s54, 98304
  s_lshl_b32 s5, s37, 10
  s_add_u32 s4, s4, s5
  s_add_u32 s4, s4, 149835776
  s_mov_b32 s46, 3216550459
  v_mul_f32 v176, s46, v128
  v_mul_f32 v177, s46, v129
  v_mul_f32 v178, s46, v130
  v_mul_f32 v179, s46, v131
  v_mul_f32 v180, s46, v132
  v_mul_f32 v181, s46, v133
  v_mul_f32 v182, s46, v134
  v_mul_f32 v183, s46, v135
  v_exp_f32 v176, v176
  v_exp_f32 v177, v177
  v_exp_f32 v178, v178
  v_exp_f32 v179, v179
  v_exp_f32 v180, v180
  v_exp_f32 v181, v181
  v_exp_f32 v182, v182
  v_exp_f32 v183, v183
  v_add_f32 v176, 1.0, v176
  v_add_f32 v177, 1.0, v177
  v_add_f32 v178, 1.0, v178
  v_add_f32 v179, 1.0, v179
  v_add_f32 v180, 1.0, v180
  v_add_f32 v181, 1.0, v181
  v_add_f32 v182, 1.0, v182
  v_add_f32 v183, 1.0, v183
  v_rcp_f32 v176, v176
  v_rcp_f32 v177, v177
  v_rcp_f32 v178, v178
  v_rcp_f32 v179, v179
  v_rcp_f32 v180, v180
  v_rcp_f32 v181, v181
  v_rcp_f32 v182, v182
  v_rcp_f32 v183, v183
  v_mul_f32 v128, v128, v136
  v_mul_f32 v129, v129, v137
  v_mul_f32 v130, v130, v138
  v_mul_f32 v131, v131, v139
  v_mul_f32 v132, v132, v140
  v_mul_f32 v133, v133, v141
  v_mul_f32 v134, v134, v142
  v_mul_f32 v135, v135, v143
  v_mul_f32 v128, v128, v176
  v_mul_f32 v129, v129, v177
  v_mul_f32 v130, v130, v178
  v_mul_f32 v131, v131, v179
  v_mul_f32 v132, v132, v180
  v_mul_f32 v133, v133, v181
  v_mul_f32 v134, v134, v182
  v_mul_f32 v135, v135, v183
  v_cvt_pk_bf16_f32 v184, v128, v129
  v_cvt_pk_bf16_f32 v185, v130, v131
  v_cvt_pk_bf16_f32 v186, v132, v133
  v_cvt_pk_bf16_f32 v187, v134, v135
  s_add_u32 s5, s4, 0
  buffer_store_dwordx4 v[184:187], v20, s[8:11], s5 offen sc1
  v_mul_f32 v176, s46, v144
  v_mul_f32 v177, s46, v145
  v_mul_f32 v178, s46, v146
  v_mul_f32 v179, s46, v147
  v_mul_f32 v180, s46, v148
  v_mul_f32 v181, s46, v149
  v_mul_f32 v182, s46, v150
  v_mul_f32 v183, s46, v151
  v_exp_f32 v176, v176
  v_exp_f32 v177, v177
  v_exp_f32 v178, v178
  v_exp_f32 v179, v179
  v_exp_f32 v180, v180
  v_exp_f32 v181, v181
  v_exp_f32 v182, v182
  v_exp_f32 v183, v183
  v_add_f32 v176, 1.0, v176
  v_add_f32 v177, 1.0, v177
  v_add_f32 v178, 1.0, v178
  v_add_f32 v179, 1.0, v179
  v_add_f32 v180, 1.0, v180
  v_add_f32 v181, 1.0, v181
  v_add_f32 v182, 1.0, v182
  v_add_f32 v183, 1.0, v183
  v_rcp_f32 v176, v176
  v_rcp_f32 v177, v177
  v_rcp_f32 v178, v178
  v_rcp_f32 v179, v179
  v_rcp_f32 v180, v180
  v_rcp_f32 v181, v181
  v_rcp_f32 v182, v182
  v_rcp_f32 v183, v183
  v_mul_f32 v144, v144, v152
  v_mul_f32 v145, v145, v153
  v_mul_f32 v146, v146, v154
  v_mul_f32 v147, v147, v155
  v_mul_f32 v148, v148, v156
  v_mul_f32 v149, v149, v157
  v_mul_f32 v150, v150, v158
  v_mul_f32 v151, v151, v159
  v_mul_f32 v144, v144, v176
  v_mul_f32 v145, v145, v177
  v_mul_f32 v146, v146, v178
  v_mul_f32 v147, v147, v179
  v_mul_f32 v148, v148, v180
  v_mul_f32 v149, v149, v181
  v_mul_f32 v150, v150, v182
  v_mul_f32 v151, v151, v183
  v_cvt_pk_bf16_f32 v188, v144, v145
  v_cvt_pk_bf16_f32 v189, v146, v147
  v_cvt_pk_bf16_f32 v190, v148, v149
  v_cvt_pk_bf16_f32 v191, v150, v151
  s_add_u32 s5, s4, 49152
  buffer_store_dwordx4 v[188:191], v20, s[8:11], s5 offen sc1
  s_add_u32 s31, s31, 1
  s_mov_b32 s34, s31
  s_cmp_lt_u32 s31, s52
  s_cbranch_scc1 L_D_top
  s_waitcnt vmcnt(0)
  s_cmp_eq_u32 s34, 0
  s_cbranch_scc1 L_D_npc
  s_mov_b64 exec, 1
  v_mov_b32 v29, s34
  v_mov_b32 v30, 0
  buffer_store_dword v29, v30, s[8:11], s35 offen sc1
  s_mov_b64 exec, -1
  s_mov_b32 s34, 0
L_D_npc:
  s_waitcnt vmcnt(0)
  s_branch L_exit
L_roleE:
  s_sub_u32 s55, s30, 120
  s_mov_b32 s53, 0
L_E_par:
  s_mov_b32 s37, s55
  s_mov_b32 s52, 104
  s_cmp_eq_u32 s53, 1
  s_cmov_b32 s52, 24
  s_cmp_eq_u32 s53, 1
  s_cbranch_scc1 L_E_second
  s_load_dwordx2 s[20:21], s[0:1], 0
  s_waitcnt lgkmcnt(0)
  s_and_b32 s21, s21, 0xffff
  s_mov_b32 s22, 2621440
  s_mov_b32 s23, 0x20000
  s_lshl_b32 s4, s30, 4
  s_mul_i32 s4, s4, 1280
  s_mul_i32 s5, s24, 320
  s_add_u32 s4, s4, s5
  v_mul_u32_u24 v28, 1280, v22
  v_lshlrev_b32 v29, 4, v21
  v_add_u32 v28, v28, v29
  buffer_load_dwordx4 v[40:43], v28, s[20:23], s4 offen offset:0
  buffer_load_dwordx4 v[44:47], v28, s[20:23], s4 offen offset:64
  buffer_load_dwordx4 v[48:51], v28, s[20:23], s4 offen offset:128
  buffer_load_dwordx4 v[52:55], v28, s[20:23], s4 offen offset:192
  buffer_load_dwordx4 v[56:59], v28, s[20:23], s4 offen offset:256
  s_waitcnt vmcnt(0)
  v_lshlrev_b32 v64, 16, v40
  v_and_b32 v65, 0xffff0000, v40
  v_lshlrev_b32 v66, 16, v41
  v_and_b32 v67, 0xffff0000, v41
  v_lshlrev_b32 v68, 16, v42
  v_and_b32 v69, 0xffff0000, v42
  v_lshlrev_b32 v70, 16, v43
  v_and_b32 v71, 0xffff0000, v43
  v_lshlrev_b32 v72, 16, v44
  v_and_b32 v73, 0xffff0000, v44
  v_lshlrev_b32 v74, 16, v45
  v_and_b32 v75, 0xffff0000, v45
  v_lshlrev_b32 v76, 16, v46
  v_and_b32 v77, 0xffff0000, v46
  v_lshlrev_b32 v78, 16, v47
  v_and_b32 v79, 0xffff0000, v47
  v_lshlrev_b32 v80, 16, v48
  v_and_b32 v81, 0xffff0000, v48
  v_lshlrev_b32 v82, 16, v49
  v_and_b32 v83, 0xffff0000, v49
  v_lshlrev_b32 v84, 16, v50
  v_and_b32 v85, 0xffff0000, v50
  v_lshlrev_b32 v86, 16, v51
  v_and_b32 v87, 0xffff0000, v51
  v_lshlrev_b32 v88, 16, v52
  v_and_b32 v89, 0xffff0000, v52
  v_lshlrev_b32 v90, 16, v53
  v_and_b32 v91, 0xffff0000, v53
  v_lshlrev_b32 v92, 16, v54
  v_and_b32 v93, 0xffff0000, v54
  v_lshlrev_b32 v94, 16, v55
  v_and_b32 v95, 0xffff0000, v55
  v_lshlrev_b32 v96, 16, v56
  v_and_b32 v97, 0xffff0000, v56
  v_lshlrev_b32 v98, 16, v57
  v_and_b32 v99, 0xffff0000, v57
  v_lshlrev_b32 v100, 16, v58
  v_and_b32 v101, 0xffff0000, v58
  v_lshlrev_b32 v102, 16, v59
  v_and_b32 v103, 0xffff0000, v59
  s_mov_b32 s47, 131072
  v_pk_add_f32 v[104:105], v[64:65], v[66:67]
  v_pk_mul_f32 v[106:107], v[64:65], v[64:65]
  v_pk_fma_f32 v[106:107], v[66:67], v[66:67], v[106:107]
  v_pk_add_f32 v[104:105], v[104:105], v[68:69]
  v_pk_fma_f32 v[106:107], v[68:69], v[68:69], v[106:107]
  v_pk_add_f32 v[104:105], v[104:105], v[70:71]
  v_pk_fma_f32 v[106:107], v[70:71], v[70:71], v[106:107]
  v_pk_add_f32 v[104:105], v[104:105], v[72:73]
  v_pk_fma_f32 v[106:107], v[72:73], v[72:73], v[106:107]
  v_pk_add_f32 v[104:105], v[104:105], v[74:75]
  v_pk_fma_f32 v[106:107], v[74:75], v[74:75], v[106:107]
  v_pk_add_f32 v[104:105], v[104:105], v[76:77]
  v_pk_fma_f32 v[106:107], v[76:77], v[76:77], v[106:107]
  v_pk_add_f32 v[104:105], v[104:105], v[78:79]
  v_pk_fma_f32 v[106:107], v[78:79], v[78:79], v[106:107]
  v_pk_add_f32 v[104:105], v[104:105], v[80:81]
  v_pk_fma_f32 v[106:107], v[80:81], v[80:81], v[106:107]
  v_pk_add_f32 v[104:105], v[104:105], v[82:83]
  v_pk_fma_f32 v[106:107], v[82:83], v[82:83], v[106:107]
  v_pk_add_f32 v[104:105], v[104:105], v[84:85]
  v_pk_fma_f32 v[106:107], v[84:85], v[84:85], v[106:107]
  v_pk_add_f32 v[104:105], v[104:105], v[86:87]
  v_pk_fma_f32 v[106:107], v[86:87], v[86:87], v[106:107]
  v_pk_add_f32 v[104:105], v[104:105], v[88:89]
  v_pk_fma_f32 v[106:107], v[88:89], v[88:89], v[106:107]
  v_pk_add_f32 v[104:105], v[104:105], v[90:91]
  v_pk_fma_f32 v[106:107], v[90:91], v[90:91], v[106:107]
  v_pk_add_f32 v[104:105], v[104:105], v[92:93]
  v_pk_fma_f32 v[106:107], v[92:93], v[92:93], v[106:107]
  v_pk_add_f32 v[104:105], v[104:105], v[94:95]
  v_pk_fma_f32 v[106:107], v[94:95], v[94:95], v[106:107]
  v_pk_add_f32 v[104:105], v[104:105], v[96:97]
  v_pk_fma_f32 v[106:107], v[96:97], v[96:97], v[106:107]
  v_pk_add_f32 v[104:105], v[104:105], v[98:99]
  v_pk_fma_f32 v[106:107], v[98:99], v[98:99], v[106:107]
  v_pk_add_f32 v[104:105], v[104:105], v[100:101]
  v_pk_fma_f32 v[106:107], v[100:101], v[100:101], v[106:107]
  v_pk_add_f32 v[104:105], v[104:105], v[102:103]
  v_pk_fma_f32 v[106:107], v[102:103], v[102:103], v[106:107]
  v_add_f32 v104, v104, v105
  v_add_f32 v105, v106, v107
  v_mov_b32 v108, v104
  v_mov_b32 v109, v105
  s_nop 0
  v_permlane16_swap_b32 v104, v108
  v_permlane16_swap_b32 v105, v109
  v_pk_add_f32 v[104:105], v[104:105], v[108:109]
  v_mov_b32 v108, v104
  v_mov_b32 v109, v105
  s_nop 0
  v_permlane32_swap_b32 v104, v108
  v_permlane32_swap_b32 v105, v109
  v_pk_add_f32 v[104:105], v[104:105], v[108:109]
  v_lshlrev_b32 v108, 3, v22
  v_add_u32 v108, s47, v108
  s_lshl_b32 s4, s24, 7
  v_add_u32 v109, s4, v108
  ds_write_b64 v109, v[104:105]
  s_waitcnt lgkmcnt(0)
  s_barrier
  ds_read_b64 v[104:105], v108
  ds_read_b64 v[106:107], v108 offset:128
  ds_read_b64 v[110:111], v108 offset:256
  ds_read_b64 v[112:113], v108 offset:384
  s_waitcnt lgkmcnt(2)
  v_pk_add_f32 v[104:105], v[104:105], v[106:107]
  s_waitcnt lgkmcnt(0)
  v_pk_add_f32 v[106:107], v[110:111], v[112:113]
  v_pk_add_f32 v[104:105], v[104:105], v[106:107]
  v_mul_f32 v104, 986500301, v104
  v_mul_f32 v106, v104, v104
  v_mov_b32 v107, 925353388
  v_fmac_f32 v107, 986500301, v105
  v_sub_f32 v107, v107, v106
  v_max_f32 v107, 925353388, v107
  v_rsq_f32 v106, v107
  s_nop 0
  v_mul_f32 v104, v104, v106
  v_pk_fma_f32 v[64:65], v[64:65], v[106:107], v[104:105] op_sel_hi:[1,0,0] neg_lo:[0,0,1] neg_hi:[0,0,1]
  v_pk_fma_f32 v[66:67], v[66:67], v[106:107], v[104:105] op_sel_hi:[1,0,0] neg_lo:[0,0,1] neg_hi:[0,0,1]
  v_pk_fma_f32 v[68:69], v[68:69], v[106:107], v[104:105] op_sel_hi:[1,0,0] neg_lo:[0,0,1] neg_hi:[0,0,1]
  v_pk_fma_f32 v[70:71], v[70:71], v[106:107], v[104:105] op_sel_hi:[1,0,0] neg_lo:[0,0,1] neg_hi:[0,0,1]
  v_pk_fma_f32 v[72:73], v[72:73], v[106:107], v[104:105] op_sel_hi:[1,0,0] neg_lo:[0,0,1] neg_hi:[0,0,1]
  v_pk_fma_f32 v[74:75], v[74:75], v[106:107], v[104:105] op_sel_hi:[1,0,0] neg_lo:[0,0,1] neg_hi:[0,0,1]
  v_pk_fma_f32 v[76:77], v[76:77], v[106:107], v[104:105] op_sel_hi:[1,0,0] neg_lo:[0,0,1] neg_hi:[0,0,1]
  v_pk_fma_f32 v[78:79], v[78:79], v[106:107], v[104:105] op_sel_hi:[1,0,0] neg_lo:[0,0,1] neg_hi:[0,0,1]
  v_pk_fma_f32 v[80:81], v[80:81], v[106:107], v[104:105] op_sel_hi:[1,0,0] neg_lo:[0,0,1] neg_hi:[0,0,1]
  v_pk_fma_f32 v[82:83], v[82:83], v[106:107], v[104:105] op_sel_hi:[1,0,0] neg_lo:[0,0,1] neg_hi:[0,0,1]
  v_pk_fma_f32 v[84:85], v[84:85], v[106:107], v[104:105] op_sel_hi:[1,0,0] neg_lo:[0,0,1] neg_hi:[0,0,1]
  v_pk_fma_f32 v[86:87], v[86:87], v[106:107], v[104:105] op_sel_hi:[1,0,0] neg_lo:[0,0,1] neg_hi:[0,0,1]
  v_pk_fma_f32 v[88:89], v[88:89], v[106:107], v[104:105] op_sel_hi:[1,0,0] neg_lo:[0,0,1] neg_hi:[0,0,1]
  v_pk_fma_f32 v[90:91], v[90:91], v[106:107], v[104:105] op_sel_hi:[1,0,0] neg_lo:[0,0,1] neg_hi:[0,0,1]
  v_pk_fma_f32 v[92:93], v[92:93], v[106:107], v[104:105] op_sel_hi:[1,0,0] neg_lo:[0,0,1] neg_hi:[0,0,1]
  v_pk_fma_f32 v[94:95], v[94:95], v[106:107], v[104:105] op_sel_hi:[1,0,0] neg_lo:[0,0,1] neg_hi:[0,0,1]
  v_pk_fma_f32 v[96:97], v[96:97], v[106:107], v[104:105] op_sel_hi:[1,0,0] neg_lo:[0,0,1] neg_hi:[0,0,1]
  v_pk_fma_f32 v[98:99], v[98:99], v[106:107], v[104:105] op_sel_hi:[1,0,0] neg_lo:[0,0,1] neg_hi:[0,0,1]
  v_pk_fma_f32 v[100:101], v[100:101], v[106:107], v[104:105] op_sel_hi:[1,0,0] neg_lo:[0,0,1] neg_hi:[0,0,1]
  v_pk_fma_f32 v[102:103], v[102:103], v[106:107], v[104:105] op_sel_hi:[1,0,0] neg_lo:[0,0,1] neg_hi:[0,0,1]
  v_cvt_pk_bf16_f32 v40, v64, v65
  v_cvt_pk_bf16_f32 v41, v66, v67
  v_cvt_pk_bf16_f32 v42, v68, v69
  v_cvt_pk_bf16_f32 v43, v70, v71
  v_cvt_pk_bf16_f32 v44, v72, v73
  v_cvt_pk_bf16_f32 v45, v74, v75
  v_cvt_pk_bf16_f32 v46, v76, v77
  v_cvt_pk_bf16_f32 v47, v78, v79
  v_cvt_pk_bf16_f32 v48, v80, v81
  v_cvt_pk_bf16_f32 v49, v82, v83
  v_cvt_pk_bf16_f32 v50, v84, v85
  v_cvt_pk_bf16_f32 v51, v86, v87
  v_cvt_pk_bf16_f32 v52, v88, v89
  v_cvt_pk_bf16_f32 v53, v90, v91
  v_cvt_pk_bf16_f32 v54, v92, v93
  v_cvt_pk_bf16_f32 v55, v94, v95
  v_cvt_pk_bf16_f32 v56, v96, v97
  v_cvt_pk_bf16_f32 v57, v98, v99
  v_cvt_pk_bf16_f32 v58, v100, v101
  v_cvt_pk_bf16_f32 v59, v102, v103
  s_lshr_b32 s4, s30, 1
  s_mul_i32 s4, s4, 40960
  s_and_b32 s5, s30, 1
  s_lshl_b32 s5, s5, 10
  s_add_u32 s4, s4, s5
  s_mul_i32 s5, s24, 10240
  s_add_u32 s4, s4, s5
  s_add_u32 s4, s4, 5656576
  s_add_u32 s5, s4, 0
  buffer_store_dwordx4 v[40:43], v20, s[8:11], s5 offen sc1
  s_add_u32 s5, s4, 2048
  buffer_store_dwordx4 v[44:47], v20, s[8:11], s5 offen sc1
  s_add_u32 s5, s4, 4096
  buffer_store_dwordx4 v[48:51], v20, s[8:11], s5 offen sc1
  s_add_u32 s5, s4, 6144
  buffer_store_dwordx4 v[52:55], v20, s[8:11], s5 offen sc1
  s_add_u32 s5, s4, 8192
  buffer_store_dwordx4 v[56:59], v20, s[8:11], s5 offen sc1
  s_waitcnt vmcnt(0)
  s_barrier
  s_cmp_eq_u32 s24, 0
  s_cbranch_scc0 L_ia_E
  s_mov_b64 exec, 1
  v_mov_b32 v1, 36
  v_mov_b32 v2, 1
  buffer_atomic_add v2, v1, s[12:15], 0 offen
  s_mov_b64 exec, -1
L_ia_E:
L_E_second:
  s_load_dwordx2 s[16:17], s[0:1], 80
  s_waitcnt lgkmcnt(0)
  s_and_b32 s17, s17, 0xffff
  s_mov_b32 s18, 1966080
  s_mov_b32 s19, 0x20000
  s_lshl_b32 s44, s37, 8
  s_lshl_b32 s45, s24, 6
  v_lshrrev_b32 v28, 4, v0
  v_and_b32 v29, 15, v0
  v_mul_u32_u24 v32, 1280, v28
  v_lshlrev_b32 v29, 4, v29
  v_add_u32 v32, v32, v29
  v_bfe_u32 v28, v0, 2, 2
  v_and_b32 v29, 3, v0
  v_mul_u32_u24 v30, 4, v21
  v_add_u32 v30, v30, v28
  v_mul_u32_u24 v30, 256, v30
  v_lshlrev_b32 v29, 3, v29
  v_add_u32 v30, v30, v29
  v_add_u32 v30, s45, v30
  v_mov_b32 v36, v30
  s_lshl_b32 s4, s24, 10
  s_add_u32 s4, s4, 0
  s_mov_b32 m0, s4
  s_mul_i32 s5, s24, 5120
  s_add_u32 s5, s5, 0
  s_add_u32 s5, s5, s44
  buffer_load_dwordx4 v32, s[16:19], s5 offen lds
  s_lshl_b32 s4, s24, 10
  s_add_u32 s4, s4, 4096
  s_mov_b32 m0, s4
  s_mul_i32 s5, s24, 5120
  s_add_u32 s5, s5, 20480
  s_add_u32 s5, s5, s44
  buffer_load_dwordx4 v32, s[16:19], s5 offen lds
  s_lshl_b32 s4, s24, 10
  s_add_u32 s4, s4, 8192
  s_mov_b32 m0, s4
  s_mul_i32 s5, s24, 5120
  s_add_u32 s5, s5, 40960
  s_add_u32 s5, s5, s44
  buffer_load_dwordx4 v32, s[16:19], s5 offen lds
  s_lshl_b32 s4, s24, 10
  s_add_u32 s4, s4, 12288
  s_mov_b32 m0, s4
  s_mul_i32 s5, s24, 5120
  s_add_u32 s5, s5, 61440
  s_add_u32 s5, s5, s44
  buffer_load_dwordx4 v32, s[16:19], s5 offen lds
  s_lshl_b32 s4, s24, 10
  s_add_u32 s4, s4, 16384
  s_mov_b32 m0, s4
  s_mul_i32 s5, s24, 5120
  s_add_u32 s5, s5, 81920
  s_add_u32 s5, s5, s44
  buffer_load_dwordx4 v32, s[16:19], s5 offen lds
  s_lshl_b32 s4, s24, 10
  s_add_u32 s4, s4, 20480
  s_mov_b32 m0, s4
  s_mul_i32 s5, s24, 5120
  s_add_u32 s5, s5, 102400
  s_add_u32 s5, s5, s44
  buffer_load_dwordx4 v32, s[16:19], s5 offen lds
  s_lshl_b32 s4, s24, 10
  s_add_u32 s4, s4, 24576
  s_mov_b32 m0, s4
  s_mul_i32 s5, s24, 5120
  s_add_u32 s5, s5, 122880
  s_add_u32 s5, s5, s44
  buffer_load_dwordx4 v32, s[16:19], s5 offen lds
  s_lshl_b32 s4, s24, 10
  s_add_u32 s4, s4, 28672
  s_mov_b32 m0, s4
  s_mul_i32 s5, s24, 5120
  s_add_u32 s5, s5, 143360
  s_add_u32 s5, s5, s44
  buffer_load_dwordx4 v32, s[16:19], s5 offen lds
  s_lshl_b32 s4, s24, 10
  s_add_u32 s4, s4, 32768
  s_mov_b32 m0, s4
  s_mul_i32 s5, s24, 5120
  s_add_u32 s5, s5, 163840
  s_add_u32 s5, s5, s44
  buffer_load_dwordx4 v32, s[16:19], s5 offen lds
  s_lshl_b32 s4, s24, 10
  s_add_u32 s4, s4, 36864
  s_mov_b32 m0, s4
  s_mul_i32 s5, s24, 5120
  s_add_u32 s5, s5, 184320
  s_add_u32 s5, s5, s44
  buffer_load_dwordx4 v32, s[16:19], s5 offen lds
  s_lshl_b32 s4, s24, 10
  s_add_u32 s4, s4, 40960
  s_mov_b32 m0, s4
  s_mul_i32 s5, s24, 5120
  s_add_u32 s5, s5, 204800
  s_add_u32 s5, s5, s44
  buffer_load_dwordx4 v32, s[16:19], s5 offen lds
  s_lshl_b32 s4, s24, 10
  s_add_u32 s4, s4, 45056
  s_mov_b32 m0, s4
  s_mul_i32 s5, s24, 5120
  s_add_u32 s5, s5, 225280
  s_add_u32 s5, s5, s44
  buffer_load_dwordx4 v32, s[16:19], s5 offen lds
  s_lshl_b32 s4, s24, 10
  s_add_u32 s4, s4, 49152
  s_mov_b32 m0, s4
  s_mul_i32 s5, s24, 5120
  s_add_u32 s5, s5, 245760
  s_add_u32 s5, s5, s44
  buffer_load_dwordx4 v32, s[16:19], s5 offen lds
  s_lshl_b32 s4, s24, 10
  s_add_u32 s4, s4, 53248
  s_mov_b32 m0, s4
  s_mul_i32 s5, s24, 5120
  s_add_u32 s5, s5, 266240
  s_add_u32 s5, s5, s44
  buffer_load_dwordx4 v32, s[16:19], s5 offen lds
  s_lshl_b32 s4, s24, 10
  s_add_u32 s4, s4, 57344
  s_mov_b32 m0, s4
  s_mul_i32 s5, s24, 5120
  s_add_u32 s5, s5, 286720
  s_add_u32 s5, s5, s44
  buffer_load_dwordx4 v32, s[16:19], s5 offen lds
  s_lshl_b32 s4, s24, 10
  s_add_u32 s4, s4, 61440
  s_mov_b32 m0, s4
  s_mul_i32 s5, s24, 5120
  s_add_u32 s5, s5, 307200
  s_add_u32 s5, s5, s44
  buffer_load_dwordx4 v32, s[16:19], s5 offen lds
  s_lshl_b32 s4, s24, 10
  s_add_u32 s4, s4, 65536
  s_mov_b32 m0, s4
  s_mul_i32 s5, s24, 5120
  s_add_u32 s5, s5, 327680
  s_add_u32 s5, s5, s44
  buffer_load_dwordx4 v32, s[16:19], s5 offen lds
  s_lshl_b32 s4, s24, 10
  s_add_u32 s4, s4, 69632
  s_mov_b32 m0, s4
  s_mul_i32 s5, s24, 5120
  s_add_u32 s5, s5, 348160
  s_add_u32 s5, s5, s44
  buffer_load_dwordx4 v32, s[16:19], s5 offen lds
  s_lshl_b32 s4, s24, 10
  s_add_u32 s4, s4, 73728
  s_mov_b32 m0, s4
  s_mul_i32 s5, s24, 5120
  s_add_u32 s5, s5, 368640
  s_add_u32 s5, s5, s44
  buffer_load_dwordx4 v32, s[16:19], s5 offen lds
  s_lshl_b32 s4, s24, 10
  s_add_u32 s4, s4, 77824
  s_mov_b32 m0, s4
  s_mul_i32 s5, s24, 5120
  s_add_u32 s5, s5, 389120
  s_add_u32 s5, s5, s44
  buffer_load_dwordx4 v32, s[16:19], s5 offen lds
  s_lshl_b32 s4, s24, 10
  s_add_u32 s4, s4, 81920
  s_mov_b32 m0, s4
  s_mul_i32 s5, s24, 5120
  s_add_u32 s5, s5, 409600
  s_add_u32 s5, s5, s44
  buffer_load_dwordx4 v32, s[16:19], s5 offen lds
  s_lshl_b32 s4, s24, 10
  s_add_u32 s4, s4, 86016
  s_mov_b32 m0, s4
  s_mul_i32 s5, s24, 5120
  s_add_u32 s5, s5, 430080
  s_add_u32 s5, s5, s44
  buffer_load_dwordx4 v32, s[16:19], s5 offen lds
  s_lshl_b32 s4, s24, 10
  s_add_u32 s4, s4, 90112
  s_mov_b32 m0, s4
  s_mul_i32 s5, s24, 5120
  s_add_u32 s5, s5, 450560
  s_add_u32 s5, s5, s44
  buffer_load_dwordx4 v32, s[16:19], s5 offen lds
  s_lshl_b32 s4, s24, 10
  s_add_u32 s4, s4, 94208
  s_mov_b32 m0, s4
  s_mul_i32 s5, s24, 5120
  s_add_u32 s5, s5, 471040
  s_add_u32 s5, s5, s44
  buffer_load_dwordx4 v32, s[16:19], s5 offen lds
  s_lshl_b32 s4, s24, 10
  s_add_u32 s4, s4, 98304
  s_mov_b32 m0, s4
  s_mul_i32 s5, s24, 5120
  s_add_u32 s5, s5, 491520
  s_add_u32 s5, s5, s44
  buffer_load_dwordx4 v32, s[16:19], s5 offen lds
  s_lshl_b32 s4, s24, 10
  s_add_u32 s4, s4, 102400
  s_mov_b32 m0, s4
  s_mul_i32 s5, s24, 5120
  s_add_u32 s5, s5, 512000
  s_add_u32 s5, s5, s44
  buffer_load_dwordx4 v32, s[16:19], s5 offen lds
  s_lshl_b32 s4, s24, 10
  s_add_u32 s4, s4, 106496
  s_mov_b32 m0, s4
  s_mul_i32 s5, s24, 5120
  s_add_u32 s5, s5, 532480
  s_add_u32 s5, s5, s44
  buffer_load_dwordx4 v32, s[16:19], s5 offen lds
  s_lshl_b32 s4, s24, 10
  s_add_u32 s4, s4, 110592
  s_mov_b32 m0, s4
  s_mul_i32 s5, s24, 5120
  s_add_u32 s5, s5, 552960
  s_add_u32 s5, s5, s44
  buffer_load_dwordx4 v32, s[16:19], s5 offen lds
  s_lshl_b32 s4, s24, 10
  s_add_u32 s4, s4, 114688
  s_mov_b32 m0, s4
  s_mul_i32 s5, s24, 5120
  s_add_u32 s5, s5, 573440
  s_add_u32 s5, s5, s44
  buffer_load_dwordx4 v32, s[16:19], s5 offen lds
  s_lshl_b32 s4, s24, 10
  s_add_u32 s4, s4, 118784
  s_mov_b32 m0, s4
  s_mul_i32 s5, s24, 5120
  s_add_u32 s5, s5, 593920
  s_add_u32 s5, s5, s44
  buffer_load_dwordx4 v32, s[16:19], s5 offen lds
  s_lshl_b32 s4, s24, 10
  s_add_u32 s4, s4, 122880
  s_mov_b32 m0, s4
  s_mul_i32 s5, s24, 5120
  s_add_u32 s5, s5, 614400
  s_add_u32 s5, s5, s44
  buffer_load_dwordx4 v32, s[16:19], s5 offen lds
  s_lshl_b32 s4, s24, 10
  s_add_u32 s4, s4, 126976
  s_mov_b32 m0, s4
  s_mul_i32 s5, s24, 5120
  s_add_u32 s5, s5, 634880
  s_add_u32 s5, s5, s44
  buffer_load_dwordx4 v32, s[16:19], s5 offen lds
  s_waitcnt vmcnt(16)
  s_barrier
  ds_read_b64_tr_b16 a[0:1], v36 offset:0
  ds_read_b64_tr_b16 a[2:3], v36 offset:4096
  ds_read_b64_tr_b16 a[4:5], v36 offset:32
  ds_read_b64_tr_b16 a[6:7], v36 offset:4128
  ds_read_b64_tr_b16 a[8:9], v36 offset:8192
  ds_read_b64_tr_b16 a[10:11], v36 offset:12288
  ds_read_b64_tr_b16 a[12:13], v36 offset:8224
  ds_read_b64_tr_b16 a[14:15], v36 offset:12320
  ds_read_b64_tr_b16 a[16:17], v36 offset:16384
  ds_read_b64_tr_b16 a[18:19], v36 offset:20480
  ds_read_b64_tr_b16 a[20:21], v36 offset:16416
  ds_read_b64_tr_b16 a[22:23], v36 offset:20512
  s_waitcnt lgkmcnt(0)
  ds_read_b64_tr_b16 a[24:25], v36 offset:24576
  ds_read_b64_tr_b16 a[26:27], v36 offset:28672
  ds_read_b64_tr_b16 a[28:29], v36 offset:24608
  ds_read_b64_tr_b16 a[30:31], v36 offset:28704
  ds_read_b64_tr_b16 a[32:33], v36 offset:32768
  ds_read_b64_tr_b16 a[34:35], v36 offset:36864
  ds_read_b64_tr_b16 a[36:37], v36 offset:32800
  ds_read_b64_tr_b16 a[38:39], v36 offset:36896
  ds_read_b64_tr_b16 a[40:41], v36 offset:40960
  ds_read_b64_tr_b16 a[42:43], v36 offset:45056
  ds_read_b64_tr_b16 a[44:45], v36 offset:40992
  ds_read_b64_tr_b16 a[46:47], v36 offset:45088
  s_waitcnt lgkmcnt(0)
  ds_read_b64_tr_b16 a[48:49], v36 offset:49152
  ds_read_b64_tr_b16 a[50:51], v36 offset:53248
  ds_read_b64_tr_b16 a[52:53], v36 offset:49184
  ds_read_b64_tr_b16 a[54:55], v36 offset:53280
  ds_read_b64_tr_b16 a[56:57], v36 offset:57344
  ds_read_b64_tr_b16 a[58:59], v36 offset:61440
  ds_read_b64_tr_b16 a[60:61], v36 offset:57376
  ds_read_b64_tr_b16 a[62:63], v36 offset:61472
  s_waitcnt lgkmcnt(0)
  s_barrier
  s_lshl_b32 s4, s24, 10
  s_add_u32 s4, s4, 0
  s_mov_b32 m0, s4
  s_mul_i32 s5, s24, 5120
  s_add_u32 s5, s5, 655360
  s_add_u32 s5, s5, s44
  buffer_load_dwordx4 v32, s[16:19], s5 offen lds
  s_lshl_b32 s4, s24, 10
  s_add_u32 s4, s4, 4096
  s_mov_b32 m0, s4
  s_mul_i32 s5, s24, 5120
  s_add_u32 s5, s5, 675840
  s_add_u32 s5, s5, s44
  buffer_load_dwordx4 v32, s[16:19], s5 offen lds
  s_lshl_b32 s4, s24, 10
  s_add_u32 s4, s4, 8192
  s_mov_b32 m0, s4
  s_mul_i32 s5, s24, 5120
  s_add_u32 s5, s5, 696320
  s_add_u32 s5, s5, s44
  buffer_load_dwordx4 v32, s[16:19], s5 offen lds
  s_lshl_b32 s4, s24, 10
  s_add_u32 s4, s4, 12288
  s_mov_b32 m0, s4
  s_mul_i32 s5, s24, 5120
  s_add_u32 s5, s5, 716800
  s_add_u32 s5, s5, s44
  buffer_load_dwordx4 v32, s[16:19], s5 offen lds
  s_lshl_b32 s4, s24, 10
  s_add_u32 s4, s4, 16384
  s_mov_b32 m0, s4
  s_mul_i32 s5, s24, 5120
  s_add_u32 s5, s5, 737280
  s_add_u32 s5, s5, s44
  buffer_load_dwordx4 v32, s[16:19], s5 offen lds
  s_lshl_b32 s4, s24, 10
  s_add_u32 s4, s4, 20480
  s_mov_b32 m0, s4
  s_mul_i32 s5, s24, 5120
  s_add_u32 s5, s5, 757760
  s_add_u32 s5, s5, s44
  buffer_load_dwordx4 v32, s[16:19], s5 offen lds
  s_lshl_b32 s4, s24, 10
  s_add_u32 s4, s4, 24576
  s_mov_b32 m0, s4
  s_mul_i32 s5, s24, 5120
  s_add_u32 s5, s5, 778240
  s_add_u32 s5, s5, s44
  buffer_load_dwordx4 v32, s[16:19], s5 offen lds
  s_lshl_b32 s4, s24, 10
  s_add_u32 s4, s4, 28672
  s_mov_b32 m0, s4
  s_mul_i32 s5, s24, 5120
  s_add_u32 s5, s5, 798720
  s_add_u32 s5, s5, s44
  buffer_load_dwordx4 v32, s[16:19], s5 offen lds
  s_lshl_b32 s4, s24, 10
  s_add_u32 s4, s4, 32768
  s_mov_b32 m0, s4
  s_mul_i32 s5, s24, 5120
  s_add_u32 s5, s5, 819200
  s_add_u32 s5, s5, s44
  buffer_load_dwordx4 v32, s[16:19], s5 offen lds
  s_lshl_b32 s4, s24, 10
  s_add_u32 s4, s4, 36864
  s_mov_b32 m0, s4
  s_mul_i32 s5, s24, 5120
  s_add_u32 s5, s5, 839680
  s_add_u32 s5, s5, s44
  buffer_load_dwordx4 v32, s[16:19], s5 offen lds
  s_lshl_b32 s4, s24, 10
  s_add_u32 s4, s4, 40960
  s_mov_b32 m0, s4
  s_mul_i32 s5, s24, 5120
  s_add_u32 s5, s5, 860160
  s_add_u32 s5, s5, s44
  buffer_load_dwordx4 v32, s[16:19], s5 offen lds
  s_lshl_b32 s4, s24, 10
  s_add_u32 s4, s4, 45056
  s_mov_b32 m0, s4
  s_mul_i32 s5, s24, 5120
  s_add_u32 s5, s5, 880640
  s_add_u32 s5, s5, s44
  buffer_load_dwordx4 v32, s[16:19], s5 offen lds
  s_lshl_b32 s4, s24, 10
  s_add_u32 s4, s4, 49152
  s_mov_b32 m0, s4
  s_mul_i32 s5, s24, 5120
  s_add_u32 s5, s5, 901120
  s_add_u32 s5, s5, s44
  buffer_load_dwordx4 v32, s[16:19], s5 offen lds
  s_lshl_b32 s4, s24, 10
  s_add_u32 s4, s4, 53248
  s_mov_b32 m0, s4
  s_mul_i32 s5, s24, 5120
  s_add_u32 s5, s5, 921600
  s_add_u32 s5, s5, s44
  buffer_load_dwordx4 v32, s[16:19], s5 offen lds
  s_lshl_b32 s4, s24, 10
  s_add_u32 s4, s4, 57344
  s_mov_b32 m0, s4
  s_mul_i32 s5, s24, 5120
  s_add_u32 s5, s5, 942080
  s_add_u32 s5, s5, s44
  buffer_load_dwordx4 v32, s[16:19], s5 offen lds
  s_lshl_b32 s4, s24, 10
  s_add_u32 s4, s4, 61440
  s_mov_b32 m0, s4
  s_mul_i32 s5, s24, 5120
  s_add_u32 s5, s5, 962560
  s_add_u32 s5, s5, s44
  buffer_load_dwordx4 v32, s[16:19], s5 offen lds
  s_waitcnt vmcnt(16)
  s_barrier
  v_add_u32 v28, 65536, v36
  ds_read_b64_tr_b16 a[64:65], v28 offset:0
  v_add_u32 v28, 65536, v36
  ds_read_b64_tr_b16 a[66:67], v28 offset:4096
  v_add_u32 v28, 65536, v36
  ds_read_b64_tr_b16 a[68:69], v28 offset:32
  v_add_u32 v28, 65536, v36
  ds_read_b64_tr_b16 a[70:71], v28 offset:4128
  v_add_u32 v28, 65536, v36
  ds_read_b64_tr_b16 a[72:73], v28 offset:8192
  v_add_u32 v28, 65536, v36
  ds_read_b64_tr_b16 a[74:75], v28 offset:12288
  v_add_u32 v28, 65536, v36
  ds_read_b64_tr_b16 a[76:77], v28 offset:8224
  v_add_u32 v28, 65536, v36
  ds_read_b64_tr_b16 a[78:79], v28 offset:12320
  v_add_u32 v28, 65536, v36
  ds_read_b64_tr_b16 a[80:81], v28 offset:16384
  v_add_u32 v28, 65536, v36
  ds_read_b64_tr_b16 a[82:83], v28 offset:20480
  v_add_u32 v28, 65536, v36
  ds_read_b64_tr_b16 a[84:85], v28 offset:16416
  v_add_u32 v28, 65536, v36
  ds_read_b64_tr_b16 a[86:87], v28 offset:20512
  s_waitcnt lgkmcnt(0)
  v_add_u32 v28, 65536, v36
  ds_read_b64_tr_b16 a[88:89], v28 offset:24576
  v_add_u32 v28, 65536, v36
  ds_read_b64_tr_b16 a[90:91], v28 offset:28672
  v_add_u32 v28, 65536, v36
  ds_read_b64_tr_b16 a[92:93], v28 offset:24608
  v_add_u32 v28, 65536, v36
  ds_read_b64_tr_b16 a[94:95], v28 offset:28704
  v_add_u32 v28, 65536, v36
  ds_read_b64_tr_b16 a[96:97], v28 offset:32768
  v_add_u32 v28, 65536, v36
  ds_read_b64_tr_b16 a[98:99], v28 offset:36864
  v_add_u32 v28, 65536, v36
  ds_read_b64_tr_b16 a[100:101], v28 offset:32800
  v_add_u32 v28, 65536, v36
  ds_read_b64_tr_b16 a[102:103], v28 offset:36896
  v_add_u32 v28, 65536, v36
  ds_read_b64_tr_b16 a[104:105], v28 offset:40960
  v_add_u32 v28, 65536, v36
  ds_read_b64_tr_b16 a[106:107], v28 offset:45056
  v_add_u32 v28, 65536, v36
  ds_read_b64_tr_b16 a[108:109], v28 offset:40992
  v_add_u32 v28, 65536, v36
  ds_read_b64_tr_b16 a[110:111], v28 offset:45088
  s_waitcnt lgkmcnt(0)
  v_add_u32 v28, 65536, v36
  ds_read_b64_tr_b16 a[112:113], v28 offset:49152
  v_add_u32 v28, 65536, v36
  ds_read_b64_tr_b16 a[114:115], v28 offset:53248
  v_add_u32 v28, 65536, v36
  ds_read_b64_tr_b16 a[116:117], v28 offset:49184
  v_add_u32 v28, 65536, v36
  ds_read_b64_tr_b16 a[118:119], v28 offset:53280
  v_add_u32 v28, 65536, v36
  ds_read_b64_tr_b16 a[120:121], v28 offset:57344
  v_add_u32 v28, 65536, v36
  ds_read_b64_tr_b16 a[122:123], v28 offset:61440
  v_add_u32 v28, 65536, v36
  ds_read_b64_tr_b16 a[124:125], v28 offset:57376
  v_add_u32 v28, 65536, v36
  ds_read_b64_tr_b16 a[126:127], v28 offset:61472
  s_waitcnt lgkmcnt(0)
  s_barrier
  s_lshl_b32 s4, s24, 10
  s_add_u32 s4, s4, 65536
  s_mov_b32 m0, s4
  s_mul_i32 s5, s24, 5120
  s_add_u32 s5, s5, 983040
  s_add_u32 s5, s5, s44
  buffer_load_dwordx4 v32, s[16:19], s5 offen lds
  s_lshl_b32 s4, s24, 10
  s_add_u32 s4, s4, 69632
  s_mov_b32 m0, s4
  s_mul_i32 s5, s24, 5120
  s_add_u32 s5, s5, 1003520
  s_add_u32 s5, s5, s44
  buffer_load_dwordx4 v32, s[16:19], s5 offen lds
  s_lshl_b32 s4, s24, 10
  s_add_u32 s4, s4, 73728
  s_mov_b32 m0, s4
  s_mul_i32 s5, s24, 5120
  s_add_u32 s5, s5, 1024000
  s_add_u32 s5, s5, s44
  buffer_load_dwordx4 v32, s[16:19], s5 offen lds
  s_lshl_b32 s4, s24, 10
  s_add_u32 s4, s4, 77824
  s_mov_b32 m0, s4
  s_mul_i32 s5, s24, 5120
  s_add_u32 s5, s5, 1044480
  s_add_u32 s5, s5, s44
  buffer_load_dwordx4 v32, s[16:19], s5 offen lds
  s_lshl_b32 s4, s24, 10
  s_add_u32 s4, s4, 81920
  s_mov_b32 m0, s4
  s_mul_i32 s5, s24, 5120
  s_add_u32 s5, s5, 1064960
  s_add_u32 s5, s5, s44
  buffer_load_dwordx4 v32, s[16:19], s5 offen lds
  s_lshl_b32 s4, s24, 10
  s_add_u32 s4, s4, 86016
  s_mov_b32 m0, s4
  s_mul_i32 s5, s24, 5120
  s_add_u32 s5, s5, 1085440
  s_add_u32 s5, s5, s44
  buffer_load_dwordx4 v32, s[16:19], s5 offen lds
  s_lshl_b32 s4, s24, 10
  s_add_u32 s4, s4, 90112
  s_mov_b32 m0, s4
  s_mul_i32 s5, s24, 5120
  s_add_u32 s5, s5, 1105920
  s_add_u32 s5, s5, s44
  buffer_load_dwordx4 v32, s[16:19], s5 offen lds
  s_lshl_b32 s4, s24, 10
  s_add_u32 s4, s4, 94208
  s_mov_b32 m0, s4
  s_mul_i32 s5, s24, 5120
  s_add_u32 s5, s5, 1126400
  s_add_u32 s5, s5, s44
  buffer_load_dwordx4 v32, s[16:19], s5 offen lds
  s_lshl_b32 s4, s24, 10
  s_add_u32 s4, s4, 98304
  s_mov_b32 m0, s4
  s_mul_i32 s5, s24, 5120
  s_add_u32 s5, s5, 1146880
  s_add_u32 s5, s5, s44
  buffer_load_dwordx4 v32, s[16:19], s5 offen lds
  s_lshl_b32 s4, s24, 10
  s_add_u32 s4, s4, 102400
  s_mov_b32 m0, s4
  s_mul_i32 s5, s24, 5120
  s_add_u32 s5, s5, 1167360
  s_add_u32 s5, s5, s44
  buffer_load_dwordx4 v32, s[16:19], s5 offen lds
  s_lshl_b32 s4, s24, 10
  s_add_u32 s4, s4, 106496
  s_mov_b32 m0, s4
  s_mul_i32 s5, s24, 5120
  s_add_u32 s5, s5, 1187840
  s_add_u32 s5, s5, s44
  buffer_load_dwordx4 v32, s[16:19], s5 offen lds
  s_lshl_b32 s4, s24, 10
  s_add_u32 s4, s4, 110592
  s_mov_b32 m0, s4
  s_mul_i32 s5, s24, 5120
  s_add_u32 s5, s5, 1208320
  s_add_u32 s5, s5, s44
  buffer_load_dwordx4 v32, s[16:19], s5 offen lds
  s_lshl_b32 s4, s24, 10
  s_add_u32 s4, s4, 114688
  s_mov_b32 m0, s4
  s_mul_i32 s5, s24, 5120
  s_add_u32 s5, s5, 1228800
  s_add_u32 s5, s5, s44
  buffer_load_dwordx4 v32, s[16:19], s5 offen lds
  s_lshl_b32 s4, s24, 10
  s_add_u32 s4, s4, 118784
  s_mov_b32 m0, s4
  s_mul_i32 s5, s24, 5120
  s_add_u32 s5, s5, 1249280
  s_add_u32 s5, s5, s44
  buffer_load_dwordx4 v32, s[16:19], s5 offen lds
  s_lshl_b32 s4, s24, 10
  s_add_u32 s4, s4, 122880
  s_mov_b32 m0, s4
  s_mul_i32 s5, s24, 5120
  s_add_u32 s5, s5, 1269760
  s_add_u32 s5, s5, s44
  buffer_load_dwordx4 v32, s[16:19], s5 offen lds
  s_lshl_b32 s4, s24, 10
  s_add_u32 s4, s4, 126976
  s_mov_b32 m0, s4
  s_mul_i32 s5, s24, 5120
  s_add_u32 s5, s5, 1290240
  s_add_u32 s5, s5, s44
  buffer_load_dwordx4 v32, s[16:19], s5 offen lds
  s_waitcnt vmcnt(16)
  s_barrier
  ds_read_b64_tr_b16 a[128:129], v36 offset:0
  ds_read_b64_tr_b16 a[130:131], v36 offset:4096
  ds_read_b64_tr_b16 a[132:133], v36 offset:32
  ds_read_b64_tr_b16 a[134:135], v36 offset:4128
  ds_read_b64_tr_b16 a[136:137], v36 offset:8192
  ds_read_b64_tr_b16 a[138:139], v36 offset:12288
  ds_read_b64_tr_b16 a[140:141], v36 offset:8224
  ds_read_b64_tr_b16 a[142:143], v36 offset:12320
  ds_read_b64_tr_b16 a[144:145], v36 offset:16384
  ds_read_b64_tr_b16 a[146:147], v36 offset:20480
  ds_read_b64_tr_b16 a[148:149], v36 offset:16416
  ds_read_b64_tr_b16 a[150:151], v36 offset:20512
  s_waitcnt lgkmcnt(0)
  ds_read_b64_tr_b16 a[152:153], v36 offset:24576
  ds_read_b64_tr_b16 a[154:155], v36 offset:28672
  ds_read_b64_tr_b16 a[156:157], v36 offset:24608
  ds_read_b64_tr_b16 a[158:159], v36 offset:28704
  ds_read_b64_tr_b16 a[160:161], v36 offset:32768
  ds_read_b64_tr_b16 a[162:163], v36 offset:36864
  ds_read_b64_tr_b16 a[164:165], v36 offset:32800
  ds_read_b64_tr_b16 a[166:167], v36 offset:36896
  ds_read_b64_tr_b16 a[168:169], v36 offset:40960
  ds_read_b64_tr_b16 a[170:171], v36 offset:45056
  ds_read_b64_tr_b16 a[172:173], v36 offset:40992
  ds_read_b64_tr_b16 a[174:175], v36 offset:45088
  s_waitcnt lgkmcnt(0)
  ds_read_b64_tr_b16 a[176:177], v36 offset:49152
  ds_read_b64_tr_b16 a[178:179], v36 offset:53248
  ds_read_b64_tr_b16 a[180:181], v36 offset:49184
  ds_read_b64_tr_b16 a[182:183], v36 offset:53280
  ds_read_b64_tr_b16 a[184:185], v36 offset:57344
  ds_read_b64_tr_b16 a[186:187], v36 offset:61440
  ds_read_b64_tr_b16 a[188:189], v36 offset:57376
  ds_read_b64_tr_b16 a[190:191], v36 offset:61472
  s_waitcnt lgkmcnt(0)
  s_barrier
  s_lshl_b32 s4, s24, 10
  s_add_u32 s4, s4, 0
  s_mov_b32 m0, s4
  s_mul_i32 s5, s24, 5120
  s_add_u32 s5, s5, 1310720
  s_add_u32 s5, s5, s44
  buffer_load_dwordx4 v32, s[16:19], s5 offen lds
  s_lshl_b32 s4, s24, 10
  s_add_u32 s4, s4, 4096
  s_mov_b32 m0, s4
  s_mul_i32 s5, s24, 5120
  s_add_u32 s5, s5, 1331200
  s_add_u32 s5, s5, s44
  buffer_load_dwordx4 v32, s[16:19], s5 offen lds
  s_lshl_b32 s4, s24, 10
  s_add_u32 s4, s4, 8192
  s_mov_b32 m0, s4
  s_mul_i32 s5, s24, 5120
  s_add_u32 s5, s5, 1351680
  s_add_u32 s5, s5, s44
  buffer_load_dwordx4 v32, s[16:19], s5 offen lds
  s_lshl_b32 s4, s24, 10
  s_add_u32 s4, s4, 12288
  s_mov_b32 m0, s4
  s_mul_i32 s5, s24, 5120
  s_add_u32 s5, s5, 1372160
  s_add_u32 s5, s5, s44
  buffer_load_dwordx4 v32, s[16:19], s5 offen lds
  s_lshl_b32 s4, s24, 10
  s_add_u32 s4, s4, 16384
  s_mov_b32 m0, s4
  s_mul_i32 s5, s24, 5120
  s_add_u32 s5, s5, 1392640
  s_add_u32 s5, s5, s44
  buffer_load_dwordx4 v32, s[16:19], s5 offen lds
  s_lshl_b32 s4, s24, 10
  s_add_u32 s4, s4, 20480
  s_mov_b32 m0, s4
  s_mul_i32 s5, s24, 5120
  s_add_u32 s5, s5, 1413120
  s_add_u32 s5, s5, s44
  buffer_load_dwordx4 v32, s[16:19], s5 offen lds
  s_lshl_b32 s4, s24, 10
  s_add_u32 s4, s4, 24576
  s_mov_b32 m0, s4
  s_mul_i32 s5, s24, 5120
  s_add_u32 s5, s5, 1433600
  s_add_u32 s5, s5, s44
  buffer_load_dwordx4 v32, s[16:19], s5 offen lds
  s_lshl_b32 s4, s24, 10
  s_add_u32 s4, s4, 28672
  s_mov_b32 m0, s4
  s_mul_i32 s5, s24, 5120
  s_add_u32 s5, s5, 1454080
  s_add_u32 s5, s5, s44
  buffer_load_dwordx4 v32, s[16:19], s5 offen lds
  s_lshl_b32 s4, s24, 10
  s_add_u32 s4, s4, 32768
  s_mov_b32 m0, s4
  s_mul_i32 s5, s24, 5120
  s_add_u32 s5, s5, 1474560
  s_add_u32 s5, s5, s44
  buffer_load_dwordx4 v32, s[16:19], s5 offen lds
  s_lshl_b32 s4, s24, 10
  s_add_u32 s4, s4, 36864
  s_mov_b32 m0, s4
  s_mul_i32 s5, s24, 5120
  s_add_u32 s5, s5, 1495040
  s_add_u32 s5, s5, s44
  buffer_load_dwordx4 v32, s[16:19], s5 offen lds
  s_lshl_b32 s4, s24, 10
  s_add_u32 s4, s4, 40960
  s_mov_b32 m0, s4
  s_mul_i32 s5, s24, 5120
  s_add_u32 s5, s5, 1515520
  s_add_u32 s5, s5, s44
  buffer_load_dwordx4 v32, s[16:19], s5 offen lds
  s_lshl_b32 s4, s24, 10
  s_add_u32 s4, s4, 45056
  s_mov_b32 m0, s4
  s_mul_i32 s5, s24, 5120
  s_add_u32 s5, s5, 1536000
  s_add_u32 s5, s5, s44
  buffer_load_dwordx4 v32, s[16:19], s5 offen lds
  s_lshl_b32 s4, s24, 10
  s_add_u32 s4, s4, 49152
  s_mov_b32 m0, s4
  s_mul_i32 s5, s24, 5120
  s_add_u32 s5, s5, 1556480
  s_add_u32 s5, s5, s44
  buffer_load_dwordx4 v32, s[16:19], s5 offen lds
  s_lshl_b32 s4, s24, 10
  s_add_u32 s4, s4, 53248
  s_mov_b32 m0, s4
  s_mul_i32 s5, s24, 5120
  s_add_u32 s5, s5, 1576960
  s_add_u32 s5, s5, s44
  buffer_load_dwordx4 v32, s[16:19], s5 offen lds
  s_lshl_b32 s4, s24, 10
  s_add_u32 s4, s4, 57344
  s_mov_b32 m0, s4
  s_mul_i32 s5, s24, 5120
  s_add_u32 s5, s5, 1597440
  s_add_u32 s5, s5, s44
  buffer_load_dwordx4 v32, s[16:19], s5 offen lds
  s_lshl_b32 s4, s24, 10
  s_add_u32 s4, s4, 61440
  s_mov_b32 m0, s4
  s_mul_i32 s5, s24, 5120
  s_add_u32 s5, s5, 1617920
  s_add_u32 s5, s5, s44
  buffer_load_dwordx4 v32, s[16:19], s5 offen lds
  s_waitcnt vmcnt(16)
  s_barrier
  v_add_u32 v28, 65536, v36
  ds_read_b64_tr_b16 a[192:193], v28 offset:0
  v_add_u32 v28, 65536, v36
  ds_read_b64_tr_b16 a[194:195], v28 offset:4096
  v_add_u32 v28, 65536, v36
  ds_read_b64_tr_b16 a[196:197], v28 offset:32
  v_add_u32 v28, 65536, v36
  ds_read_b64_tr_b16 a[198:199], v28 offset:4128
  v_add_u32 v28, 65536, v36
  ds_read_b64_tr_b16 a[200:201], v28 offset:8192
  v_add_u32 v28, 65536, v36
  ds_read_b64_tr_b16 a[202:203], v28 offset:12288
  v_add_u32 v28, 65536, v36
  ds_read_b64_tr_b16 a[204:205], v28 offset:8224
  v_add_u32 v28, 65536, v36
  ds_read_b64_tr_b16 a[206:207], v28 offset:12320
  v_add_u32 v28, 65536, v36
  ds_read_b64_tr_b16 a[208:209], v28 offset:16384
  v_add_u32 v28, 65536, v36
  ds_read_b64_tr_b16 a[210:211], v28 offset:20480
  v_add_u32 v28, 65536, v36
  ds_read_b64_tr_b16 a[212:213], v28 offset:16416
  v_add_u32 v28, 65536, v36
  ds_read_b64_tr_b16 a[214:215], v28 offset:20512
  s_waitcnt lgkmcnt(0)
  v_add_u32 v28, 65536, v36
  ds_read_b64_tr_b16 a[216:217], v28 offset:24576
  v_add_u32 v28, 65536, v36
  ds_read_b64_tr_b16 a[218:219], v28 offset:28672
  v_add_u32 v28, 65536, v36
  ds_read_b64_tr_b16 a[220:221], v28 offset:24608
  v_add_u32 v28, 65536, v36
  ds_read_b64_tr_b16 a[222:223], v28 offset:28704
  v_add_u32 v28, 65536, v36
  ds_read_b64_tr_b16 a[224:225], v28 offset:32768
  v_add_u32 v28, 65536, v36
  ds_read_b64_tr_b16 a[226:227], v28 offset:36864
  v_add_u32 v28, 65536, v36
  ds_read_b64_tr_b16 a[228:229], v28 offset:32800
  v_add_u32 v28, 65536, v36
  ds_read_b64_tr_b16 a[230:231], v28 offset:36896
  v_add_u32 v28, 65536, v36
  ds_read_b64_tr_b16 a[232:233], v28 offset:40960
  v_add_u32 v28, 65536, v36
  ds_read_b64_tr_b16 a[234:235], v28 offset:45056
  v_add_u32 v28, 65536, v36
  ds_read_b64_tr_b16 a[236:237], v28 offset:40992
  v_add_u32 v28, 65536, v36
  ds_read_b64_tr_b16 a[238:239], v28 offset:45088
  s_waitcnt lgkmcnt(0)
  v_add_u32 v28, 65536, v36
  ds_read_b64_tr_b16 a[240:241], v28 offset:49152
  v_add_u32 v28, 65536, v36
  ds_read_b64_tr_b16 a[242:243], v28 offset:53248
  v_add_u32 v28, 65536, v36
  ds_read_b64_tr_b16 a[244:245], v28 offset:49184
  v_add_u32 v28, 65536, v36
  ds_read_b64_tr_b16 a[246:247], v28 offset:53280
  v_add_u32 v28, 65536, v36
  ds_read_b64_tr_b16 a[248:249], v28 offset:57344
  v_add_u32 v28, 65536, v36
  ds_read_b64_tr_b16 a[250:251], v28 offset:61440
  v_add_u32 v28, 65536, v36
  ds_read_b64_tr_b16 a[252:253], v28 offset:57376
  v_add_u32 v28, 65536, v36
  ds_read_b64_tr_b16 a[254:255], v28 offset:61472
  s_waitcnt lgkmcnt(0)
  s_barrier
  s_lshl_b32 s4, s24, 10
  s_add_u32 s4, s4, 65536
  s_mov_b32 m0, s4
  s_mul_i32 s5, s24, 5120
  s_add_u32 s5, s5, 1638400
  s_add_u32 s5, s5, s44
  buffer_load_dwordx4 v32, s[16:19], s5 offen lds
  s_lshl_b32 s4, s24, 10
  s_add_u32 s4, s4, 69632
  s_mov_b32 m0, s4
  s_mul_i32 s5, s24, 5120
  s_add_u32 s5, s5, 1658880
  s_add_u32 s5, s5, s44
  buffer_load_dwordx4 v32, s[16:19], s5 offen lds
  s_lshl_b32 s4, s24, 10
  s_add_u32 s4, s4, 73728
  s_mov_b32 m0, s4
  s_mul_i32 s5, s24, 5120
  s_add_u32 s5, s5, 1679360
  s_add_u32 s5, s5, s44
  buffer_load_dwordx4 v32, s[16:19], s5 offen lds
  s_lshl_b32 s4, s24, 10
  s_add_u32 s4, s4, 77824
  s_mov_b32 m0, s4
  s_mul_i32 s5, s24, 5120
  s_add_u32 s5, s5, 1699840
  s_add_u32 s5, s5, s44
  buffer_load_dwordx4 v32, s[16:19], s5 offen lds
  s_lshl_b32 s4, s24, 10
  s_add_u32 s4, s4, 81920
  s_mov_b32 m0, s4
  s_mul_i32 s5, s24, 5120
  s_add_u32 s5, s5, 1720320
  s_add_u32 s5, s5, s44
  buffer_load_dwordx4 v32, s[16:19], s5 offen lds
  s_lshl_b32 s4, s24, 10
  s_add_u32 s4, s4, 86016
  s_mov_b32 m0, s4
  s_mul_i32 s5, s24, 5120
  s_add_u32 s5, s5, 1740800
  s_add_u32 s5, s5, s44
  buffer_load_dwordx4 v32, s[16:19], s5 offen lds
  s_lshl_b32 s4, s24, 10
  s_add_u32 s4, s4, 90112
  s_mov_b32 m0, s4
  s_mul_i32 s5, s24, 5120
  s_add_u32 s5, s5, 1761280
  s_add_u32 s5, s5, s44
  buffer_load_dwordx4 v32, s[16:19], s5 offen lds
  s_lshl_b32 s4, s24, 10
  s_add_u32 s4, s4, 94208
  s_mov_b32 m0, s4
  s_mul_i32 s5, s24, 5120
  s_add_u32 s5, s5, 1781760
  s_add_u32 s5, s5, s44
  buffer_load_dwordx4 v32, s[16:19], s5 offen lds
  s_lshl_b32 s4, s24, 10
  s_add_u32 s4, s4, 98304
  s_mov_b32 m0, s4
  s_mul_i32 s5, s24, 5120
  s_add_u32 s5, s5, 1802240
  s_add_u32 s5, s5, s44
  buffer_load_dwordx4 v32, s[16:19], s5 offen lds
  s_lshl_b32 s4, s24, 10
  s_add_u32 s4, s4, 102400
  s_mov_b32 m0, s4
  s_mul_i32 s5, s24, 5120
  s_add_u32 s5, s5, 1822720
  s_add_u32 s5, s5, s44
  buffer_load_dwordx4 v32, s[16:19], s5 offen lds
  s_lshl_b32 s4, s24, 10
  s_add_u32 s4, s4, 106496
  s_mov_b32 m0, s4
  s_mul_i32 s5, s24, 5120
  s_add_u32 s5, s5, 1843200
  s_add_u32 s5, s5, s44
  buffer_load_dwordx4 v32, s[16:19], s5 offen lds
  s_lshl_b32 s4, s24, 10
  s_add_u32 s4, s4, 110592
  s_mov_b32 m0, s4
  s_mul_i32 s5, s24, 5120
  s_add_u32 s5, s5, 1863680
  s_add_u32 s5, s5, s44
  buffer_load_dwordx4 v32, s[16:19], s5 offen lds
  s_lshl_b32 s4, s24, 10
  s_add_u32 s4, s4, 114688
  s_mov_b32 m0, s4
  s_mul_i32 s5, s24, 5120
  s_add_u32 s5, s5, 1884160
  s_add_u32 s5, s5, s44
  buffer_load_dwordx4 v32, s[16:19], s5 offen lds
  s_lshl_b32 s4, s24, 10
  s_add_u32 s4, s4, 118784
  s_mov_b32 m0, s4
  s_mul_i32 s5, s24, 5120
  s_add_u32 s5, s5, 1904640
  s_add_u32 s5, s5, s44
  buffer_load_dwordx4 v32, s[16:19], s5 offen lds
  s_lshl_b32 s4, s24, 10
  s_add_u32 s4, s4, 122880
  s_mov_b32 m0, s4
  s_mul_i32 s5, s24, 5120
  s_add_u32 s5, s5, 1925120
  s_add_u32 s5, s5, s44
  buffer_load_dwordx4 v32, s[16:19], s5 offen lds
  s_lshl_b32 s4, s24, 10
  s_add_u32 s4, s4, 126976
  s_mov_b32 m0, s4
  s_mul_i32 s5, s24, 5120
  s_add_u32 s5, s5, 1945600
  s_add_u32 s5, s5, s44
  buffer_load_dwordx4 v32, s[16:19], s5 offen lds
  s_waitcnt vmcnt(16)
  s_barrier
  ds_read_b64_tr_b16 v[128:129], v36 offset:0
  ds_read_b64_tr_b16 v[130:131], v36 offset:4096
  ds_read_b64_tr_b16 v[132:133], v36 offset:32
  ds_read_b64_tr_b16 v[134:135], v36 offset:4128
  ds_read_b64_tr_b16 v[136:137], v36 offset:8192
  ds_read_b64_tr_b16 v[138:139], v36 offset:12288
  ds_read_b64_tr_b16 v[140:141], v36 offset:8224
  ds_read_b64_tr_b16 v[142:143], v36 offset:12320
  ds_read_b64_tr_b16 v[144:145], v36 offset:16384
  ds_read_b64_tr_b16 v[146:147], v36 offset:20480
  ds_read_b64_tr_b16 v[148:149], v36 offset:16416
  ds_read_b64_tr_b16 v[150:151], v36 offset:20512
  s_waitcnt lgkmcnt(0)
  ds_read_b64_tr_b16 v[152:153], v36 offset:24576
  ds_read_b64_tr_b16 v[154:155], v36 offset:28672
  ds_read_b64_tr_b16 v[156:157], v36 offset:24608
  ds_read_b64_tr_b16 v[158:159], v36 offset:28704
  ds_read_b64_tr_b16 v[160:161], v36 offset:32768
  ds_read_b64_tr_b16 v[162:163], v36 offset:36864
  ds_read_b64_tr_b16 v[164:165], v36 offset:32800
  ds_read_b64_tr_b16 v[166:167], v36 offset:36896
  ds_read_b64_tr_b16 v[168:169], v36 offset:40960
  ds_read_b64_tr_b16 v[170:171], v36 offset:45056
  ds_read_b64_tr_b16 v[172:173], v36 offset:40992
  ds_read_b64_tr_b16 v[174:175], v36 offset:45088
  s_waitcnt lgkmcnt(0)
  ds_read_b64_tr_b16 v[176:177], v36 offset:49152
  ds_read_b64_tr_b16 v[178:179], v36 offset:53248
  ds_read_b64_tr_b16 v[180:181], v36 offset:49184
  ds_read_b64_tr_b16 v[182:183], v36 offset:53280
  ds_read_b64_tr_b16 v[184:185], v36 offset:57344
  ds_read_b64_tr_b16 v[186:187], v36 offset:61440
  ds_read_b64_tr_b16 v[188:189], v36 offset:57376
  ds_read_b64_tr_b16 v[190:191], v36 offset:61472
  s_waitcnt lgkmcnt(0)
  s_barrier
  s_waitcnt vmcnt(0)
  s_barrier
  v_add_u32 v28, 65536, v36
  ds_read_b64_tr_b16 v[192:193], v28 offset:0
  v_add_u32 v28, 65536, v36
  ds_read_b64_tr_b16 v[194:195], v28 offset:4096
  v_add_u32 v28, 65536, v36
  ds_read_b64_tr_b16 v[196:197], v28 offset:32
  v_add_u32 v28, 65536, v36
  ds_read_b64_tr_b16 v[198:199], v28 offset:4128
  v_add_u32 v28, 65536, v36
  ds_read_b64_tr_b16 v[200:201], v28 offset:8192
  v_add_u32 v28, 65536, v36
  ds_read_b64_tr_b16 v[202:203], v28 offset:12288
  v_add_u32 v28, 65536, v36
  ds_read_b64_tr_b16 v[204:205], v28 offset:8224
  v_add_u32 v28, 65536, v36
  ds_read_b64_tr_b16 v[206:207], v28 offset:12320
  v_add_u32 v28, 65536, v36
  ds_read_b64_tr_b16 v[208:209], v28 offset:16384
  v_add_u32 v28, 65536, v36
  ds_read_b64_tr_b16 v[210:211], v28 offset:20480
  v_add_u32 v28, 65536, v36
  ds_read_b64_tr_b16 v[212:213], v28 offset:16416
  v_add_u32 v28, 65536, v36
  ds_read_b64_tr_b16 v[214:215], v28 offset:20512
  s_waitcnt lgkmcnt(0)
  v_add_u32 v28, 65536, v36
  ds_read_b64_tr_b16 v[216:217], v28 offset:24576
  v_add_u32 v28, 65536, v36
  ds_read_b64_tr_b16 v[218:219], v28 offset:28672
  v_add_u32 v28, 65536, v36
  ds_read_b64_tr_b16 v[220:221], v28 offset:24608
  v_add_u32 v28, 65536, v36
  ds_read_b64_tr_b16 v[222:223], v28 offset:28704
  v_add_u32 v28, 65536, v36
  ds_read_b64_tr_b16 v[224:225], v28 offset:32768
  v_add_u32 v28, 65536, v36
  ds_read_b64_tr_b16 v[226:227], v28 offset:36864
  v_add_u32 v28, 65536, v36
  ds_read_b64_tr_b16 v[228:229], v28 offset:32800
  v_add_u32 v28, 65536, v36
  ds_read_b64_tr_b16 v[230:231], v28 offset:36896
  v_add_u32 v28, 65536, v36
  ds_read_b64_tr_b16 v[232:233], v28 offset:40960
  v_add_u32 v28, 65536, v36
  ds_read_b64_tr_b16 v[234:235], v28 offset:45056
  v_add_u32 v28, 65536, v36
  ds_read_b64_tr_b16 v[236:237], v28 offset:40992
  v_add_u32 v28, 65536, v36
  ds_read_b64_tr_b16 v[238:239], v28 offset:45088
  s_waitcnt lgkmcnt(0)
  v_add_u32 v28, 65536, v36
  ds_read_b64_tr_b16 v[240:241], v28 offset:49152
  v_add_u32 v28, 65536, v36
  ds_read_b64_tr_b16 v[242:243], v28 offset:53248
  v_add_u32 v28, 65536, v36
  ds_read_b64_tr_b16 v[244:245], v28 offset:49184
  v_add_u32 v28, 65536, v36
  ds_read_b64_tr_b16 v[246:247], v28 offset:53280
  v_add_u32 v28, 65536, v36
  ds_read_b64_tr_b16 v[248:249], v28 offset:57344
  v_add_u32 v28, 65536, v36
  ds_read_b64_tr_b16 v[250:251], v28 offset:61440
  v_add_u32 v28, 65536, v36
  ds_read_b64_tr_b16 v[252:253], v28 offset:57376
  v_add_u32 v28, 65536, v36
  ds_read_b64_tr_b16 v[254:255], v28 offset:61472
  s_waitcnt lgkmcnt(0)
  s_barrier
  s_cmp_eq_u32 s24, 0
  s_cbranch_scc0 L_wd_iwE
  s_mov_b32 s28, 131072
  s_mov_b32 s29, 2
  v_mov_b32 v18, 36
L_wn_iwE:
  buffer_load_dword v19, v18, s[12:15], 0 offen sc1
  s_waitcnt vmcnt(0)
  v_readfirstlane_b32 s3, v19
  s_sub_u32 s28, s28, 1
  s_cbranch_scc1 L_abort
  s_cmp_ge_u32 s3, 256
  s_cbranch_scc1 L_wd_iwE
  s_sleep 8
  s_branch L_wn_iwE
L_wd_iwE:
  s_barrier
  s_load_dwordx2 s[20:21], s[0:1], 88
  s_waitcnt lgkmcnt(0)
  s_and_b32 s21, s21, 0xffff
  s_mov_b32 s22, 2621440
  s_mov_b32 s23, 0x20000
  v_min_u32 v28, 47, v0
  v_lshrrev_b32 v29, 2, v28
  v_lshlrev_b32 v29, 7, v29
  v_and_b32 v28, 3, v28
  v_lshlrev_b32 v28, 2, v28
  v_add_u32 v28, v28, v29
  v_add_u32 v23, 94208, v28
  s_mul_i32 s4, s53, 1536
  v_add_u32 v23, s4, v23
  s_mov_b64 s[42:43], -1
  s_lshl_b32 s4, s37, 2
  s_add_u32 s4, s4, s24
  s_lshl_b32 s36, s4, 10
  s_lshl_b32 s38, s4, 6
  s_mul_i32 s5, s53, 32
  s_add_u32 s4, s4, s5
  s_lshl_b32 s4, s4, 7
  s_add_u32 s35, s4, 102400
  v_mul_u32_u24 v25, 1280, v22
  v_and_b32 v28, 1, v21
  v_lshlrev_b32 v28, 5, v28
  v_add_u32 v25, v25, v28
  v_lshrrev_b32 v28, 1, v21
  v_lshlrev_b32 v28, 4, v28
  v_add_u32 v25, v25, v28
  s_mov_b32 s31, 0
  s_mov_b32 s33, 0
  s_mov_b32 s34, 0
L_E_top:
  s_lshr_b32 s57, s31, 1
  s_lshl_b32 s56, s57, 1
  s_sub_u32 s58, s56, 40
  s_cmp_lt_u32 s57, 40
  s_cselect_b32 s58, s57, s58
  s_add_u32 s56, s56, 41
  s_cmp_eq_u32 s53, 1
  s_cselect_b32 s58, s56, s58
  s_lshl_b32 s58, s58, 1
  s_and_b32 s57, s31, 1
  s_add_u32 s54, s58, s57
  s_cmp_eq_u32 s33, 1
  s_cbranch_scc1 L_E_pref
  s_mov_b32 s28, 131072
  s_mov_b32 s29, 60
L_E_poll:
  buffer_load_dword v28, v23, s[8:11], 0 offen sc1
  s_sub_u32 s28, s28, 1
  s_cbranch_scc1 L_abort
  s_waitcnt vmcnt(0)
  s_cmp_eq_u32 s34, 0
  s_cbranch_scc1 L_E_npa
  s_mov_b64 exec, 1
  v_mov_b32 v29, s34
  v_mov_b32 v30, 0
  buffer_store_dword v29, v30, s[8:11], s35 offen sc1
  s_mov_b64 exec, -1
  s_mov_b32 s34, 0
L_E_npa:
  s_lshr_b32 s41, s31, 1
  s_add_u32 s41, s41, 1
  v_cmp_gt_u32 vcc, s41, v28
  s_and_b64 vcc, vcc, s[42:43]
  s_cmp_eq_u64 vcc, 0
  s_cbranch_scc0 L_E_poll
  s_lshr_b32 s57, s31, 1
  s_lshl_b32 s56, s57, 1
  s_sub_u32 s58, s56, 40
  s_cmp_lt_u32 s57, 40
  s_cselect_b32 s58, s57, s58
  s_add_u32 s56, s56, 41
  s_cmp_eq_u32 s53, 1
  s_cselect_b32 s58, s56, s58
  s_lshl_b32 s58, s58, 1
  s_and_b32 s57, s31, 1
  s_add_u32 s59, s58, s57
  s_mul_i32 s32, s59, 49152
  s_add_u32 s32, s32, 149835776
  s_lshl_b32 s4, s24, 10
  s_add_u32 s32, s32, s4
  s_and_b32 s50, s31, 1
  s_mul_i32 s50, s50, 49152
  s_add_u32 s50, s50, s4
  s_add_u32 m0, s50, 0
  s_add_u32 s5, s32, 0
  buffer_load_dwordx4 v20, s[8:11], s5 offen sc1 lds
  s_add_u32 m0, s50, 4096
  s_add_u32 s5, s32, 4096
  buffer_load_dwordx4 v20, s[8:11], s5 offen sc1 lds
  s_add_u32 m0, s50, 8192
  s_add_u32 s5, s32, 8192
  buffer_load_dwordx4 v20, s[8:11], s5 offen sc1 lds
  s_add_u32 m0, s50, 12288
  s_add_u32 s5, s32, 12288
  buffer_load_dwordx4 v20, s[8:11], s5 offen sc1 lds
  s_add_u32 m0, s50, 16384
  s_add_u32 s5, s32, 16384
  buffer_load_dwordx4 v20, s[8:11], s5 offen sc1 lds
  s_add_u32 m0, s50, 20480
  s_add_u32 s5, s32, 20480
  buffer_load_dwordx4 v20, s[8:11], s5 offen sc1 lds
  s_add_u32 m0, s50, 24576
  s_add_u32 s5, s32, 24576
  buffer_load_dwordx4 v20, s[8:11], s5 offen sc1 lds
  s_add_u32 m0, s50, 28672
  s_add_u32 s5, s32, 28672
  buffer_load_dwordx4 v20, s[8:11], s5 offen sc1 lds
  s_add_u32 m0, s50, 32768
  s_add_u32 s5, s32, 32768
  buffer_load_dwordx4 v20, s[8:11], s5 offen sc1 lds
  s_add_u32 m0, s50, 36864
  s_add_u32 s5, s32, 36864
  buffer_load_dwordx4 v20, s[8:11], s5 offen sc1 lds
  s_add_u32 m0, s50, 40960
  s_add_u32 s5, s32, 40960
  buffer_load_dwordx4 v20, s[8:11], s5 offen sc1 lds
  s_add_u32 m0, s50, 45056
  s_add_u32 s5, s32, 45056
  buffer_load_dwordx4 v20, s[8:11], s5 offen sc1 lds
  s_mov_b32 s51, 1
  s_branch L_E_go
L_E_pref:
  s_waitcnt vmcnt(10)
  s_mov_b32 s51, 0
L_E_go:
  s_and_b32 s6, s31, 1
  s_mul_i32 s6, s6, 49152
  v_add_u32 v24, s6, v20
  s_mov_b32 s33, 0
  s_add_u32 s7, s31, 1
  s_cmp_ge_u32 s7, s52
  s_cbranch_scc1 L_E_cB
  s_lshr_b32 s41, s7, 1
  s_add_u32 s41, s41, 1
  v_cmp_gt_u32 vcc, s41, v28
  s_and_b64 vcc, vcc, s[42:43]
  s_cmp_eq_u64 vcc, 0
  s_cbranch_scc0 L_E_cB
  s_mov_b32 s33, 1
  s_lshr_b32 s57, s7, 1
  s_lshl_b32 s56, s57, 1
  s_sub_u32 s58, s56, 40
  s_cmp_lt_u32 s57, 40
  s_cselect_b32 s58, s57, s58
  s_add_u32 s56, s56, 41
  s_cmp_eq_u32 s53, 1
  s_cselect_b32 s58, s56, s58
  s_lshl_b32 s58, s58, 1
  s_and_b32 s57, s7, 1
  s_add_u32 s59, s58, s57
  s_mul_i32 s32, s59, 49152
  s_add_u32 s32, s32, 149835776
  s_lshl_b32 s4, s24, 10
  s_add_u32 s32, s32, s4
  s_and_b32 s50, s7, 1
  s_mul_i32 s50, s50, 49152
  s_add_u32 s50, s50, s4
  s_cmp_eq_u32 s51, 1
  s_cbranch_scc1 L_E_cAc
  s_mul_i32 s4, s54, 20480
  s_add_u32 s4, s4, s36
  s_add_u32 s4, s4, 144592896
  buffer_load_dwordx4 v[88:91], v20, s[8:11], s4 offen sc1
  s_waitcnt vmcnt(12)
  s_barrier
  ds_read_b128 v[72:75], v24 offset:0
  ds_read_b128 v[76:79], v24 offset:1024
  ds_read_b128 v[80:83], v24 offset:2048
  ds_read_b128 v[84:87], v24 offset:3072
  s_waitcnt lgkmcnt(3)
  v_mfma_f32_16x16x32_bf16 v[64:67], a[0:3], v[72:75], 0
  v_mfma_f32_16x16x32_bf16 v[68:71], a[4:7], v[72:75], 0
  ds_read_b128 v[72:75], v24 offset:4096
  s_waitcnt lgkmcnt(3)
  v_mfma_f32_16x16x32_bf16 v[64:67], a[8:11], v[76:79], v[64:67]
  s_add_u32 m0, s50, 0
  s_add_u32 s5, s32, 0
  buffer_load_dwordx4 v20, s[8:11], s5 offen sc1 lds
  v_mfma_f32_16x16x32_bf16 v[68:71], a[12:15], v[76:79], v[68:71]
  ds_read_b128 v[76:79], v24 offset:5120
  s_waitcnt lgkmcnt(3)
  v_mfma_f32_16x16x32_bf16 v[64:67], a[16:19], v[80:83], v[64:67]
  v_mfma_f32_16x16x32_bf16 v[68:71], a[20:23], v[80:83], v[68:71]
  ds_read_b128 v[80:83], v24 offset:6144
  s_waitcnt lgkmcnt(3)
  v_mfma_f32_16x16x32_bf16 v[64:67], a[24:27], v[84:87], v[64:67]
  v_mfma_f32_16x16x32_bf16 v[68:71], a[28:31], v[84:87], v[68:71]
  ds_read_b128 v[84:87], v24 offset:7168
  s_waitcnt lgkmcnt(3)
  v_mfma_f32_16x16x32_bf16 v[64:67], a[32:35], v[72:75], v[64:67]
  v_mfma_f32_16x16x32_bf16 v[68:71], a[36:39], v[72:75], v[68:71]
  ds_read_b128 v[72:75], v24 offset:8192
  s_waitcnt lgkmcnt(3)
  v_mfma_f32_16x16x32_bf16 v[64:67], a[40:43], v[76:79], v[64:67]
  s_add_u32 m0, s50, 4096
  s_add_u32 s5, s32, 4096
  buffer_load_dwordx4 v20, s[8:11], s5 offen sc1 lds
  v_mfma_f32_16x16x32_bf16 v[68:71], a[44:47], v[76:79], v[68:71]
  ds_read_b128 v[76:79], v24 offset:9216
  s_waitcnt lgkmcnt(3)
  v_mfma_f32_16x16x32_bf16 v[64:67], a[48:51], v[80:83], v[64:67]
  v_mfma_f32_16x16x32_bf16 v[68:71], a[52:55], v[80:83], v[68:71]
  ds_read_b128 v[80:83], v24 offset:10240
  s_waitcnt lgkmcnt(3)
  v_mfma_f32_16x16x32_bf16 v[64:67], a[56:59], v[84:87], v[64:67]
  v_mfma_f32_16x16x32_bf16 v[68:71], a[60:63], v[84:87], v[68:71]
  ds_read_b128 v[84:87], v24 offset:11264
  s_waitcnt lgkmcnt(3)
  v_mfma_f32_16x16x32_bf16 v[64:67], a[64:67], v[72:75], v[64:67]
  v_mfma_f32_16x16x32_bf16 v[68:71], a[68:71], v[72:75], v[68:71]
  ds_read_b128 v[72:75], v24 offset:12288
  s_waitcnt lgkmcnt(3)
  v_mfma_f32_16x16x32_bf16 v[64:67], a[72:75], v[76:79], v[64:67]
  s_add_u32 m0, s50, 8192
  s_add_u32 s5, s32, 8192
  buffer_load_dwordx4 v20, s[8:11], s5 offen sc1 lds
  v_mfma_f32_16x16x32_bf16 v[68:71], a[76:79], v[76:79], v[68:71]
  ds_read_b128 v[76:79], v24 offset:13312
  s_waitcnt lgkmcnt(3)
  v_mfma_f32_16x16x32_bf16 v[64:67], a[80:83], v[80:83], v[64:67]
  v_mfma_f32_16x16x32_bf16 v[68:71], a[84:87], v[80:83], v[68:71]
  ds_read_b128 v[80:83], v24 offset:14336
  s_waitcnt lgkmcnt(3)
  v_mfma_f32_16x16x32_bf16 v[64:67], a[88:91], v[84:87], v[64:67]
  v_mfma_f32_16x16x32_bf16 v[68:71], a[92:95], v[84:87], v[68:71]
  ds_read_b128 v[84:87], v24 offset:15360
  s_waitcnt lgkmcnt(3)
  v_mfma_f32_16x16x32_bf16 v[64:67], a[96:99], v[72:75], v[64:67]
  v_mfma_f32_16x16x32_bf16 v[68:71], a[100:103], v[72:75], v[68:71]
  s_waitcnt vmcnt(10)
  s_barrier
  ds_read_b128 v[72:75], v24 offset:16384
  s_waitcnt lgkmcnt(3)
  v_mfma_f32_16x16x32_bf16 v[64:67], a[104:107], v[76:79], v[64:67]
  s_add_u32 m0, s50, 12288
  s_add_u32 s5, s32, 12288
  buffer_load_dwordx4 v20, s[8:11], s5 offen sc1 lds
  v_mfma_f32_16x16x32_bf16 v[68:71], a[108:111], v[76:79], v[68:71]
  ds_read_b128 v[76:79], v24 offset:17408
  s_waitcnt lgkmcnt(3)
  v_mfma_f32_16x16x32_bf16 v[64:67], a[112:115], v[80:83], v[64:67]
  v_mfma_f32_16x16x32_bf16 v[68:71], a[116:119], v[80:83], v[68:71]
  ds_read_b128 v[80:83], v24 offset:18432
  s_waitcnt lgkmcnt(3)
  v_mfma_f32_16x16x32_bf16 v[64:67], a[120:123], v[84:87], v[64:67]
  v_mfma_f32_16x16x32_bf16 v[68:71], a[124:127], v[84:87], v[68:71]
  ds_read_b128 v[84:87], v24 offset:19456
  s_waitcnt lgkmcnt(3)
  v_mfma_f32_16x16x32_bf16 v[64:67], a[128:131], v[72:75], v[64:67]
  buffer_load_dword v28, v23, s[8:11], 0 offen sc1
  v_mfma_f32_16x16x32_bf16 v[68:71], a[132:135], v[72:75], v[68:71]
  ds_read_b128 v[72:75], v24 offset:20480
  s_waitcnt lgkmcnt(3)
  v_mfma_f32_16x16x32_bf16 v[64:67], a[136:139], v[76:79], v[64:67]
  s_add_u32 m0, s50, 16384
  s_add_u32 s5, s32, 16384
  buffer_load_dwordx4 v20, s[8:11], s5 offen sc1 lds
  v_mfma_f32_16x16x32_bf16 v[68:71], a[140:143], v[76:79], v[68:71]
  ds_read_b128 v[76:79], v24 offset:21504
  s_waitcnt lgkmcnt(3)
  v_mfma_f32_16x16x32_bf16 v[64:67], a[144:147], v[80:83], v[64:67]
  v_mfma_f32_16x16x32_bf16 v[68:71], a[148:151], v[80:83], v[68:71]
  ds_read_b128 v[80:83], v24 offset:22528
  s_waitcnt lgkmcnt(3)
  v_mfma_f32_16x16x32_bf16 v[64:67], a[152:155], v[84:87], v[64:67]
  v_mfma_f32_16x16x32_bf16 v[68:71], a[156:159], v[84:87], v[68:71]
  ds_read_b128 v[84:87], v24 offset:23552
  s_waitcnt lgkmcnt(3)
  v_mfma_f32_16x16x32_bf16 v[64:67], a[160:163], v[72:75], v[64:67]
  v_mfma_f32_16x16x32_bf16 v[68:71], a[164:167], v[72:75], v[68:71]
  ds_read_b128 v[72:75], v24 offset:24576
  s_waitcnt lgkmcnt(3)
  v_mfma_f32_16x16x32_bf16 v[64:67], a[168:171], v[76:79], v[64:67]
  s_add_u32 m0, s50, 20480
  s_add_u32 s5, s32, 20480
  buffer_load_dwordx4 v20, s[8:11], s5 offen sc1 lds
  v_mfma_f32_16x16x32_bf16 v[68:71], a[172:175], v[76:79], v[68:71]
  ds_read_b128 v[76:79], v24 offset:25600
  s_waitcnt lgkmcnt(3)
  v_mfma_f32_16x16x32_bf16 v[64:67], a[176:179], v[80:83], v[64:67]
  v_mfma_f32_16x16x32_bf16 v[68:71], a[180:183], v[80:83], v[68:71]
  ds_read_b128 v[80:83], v24 offset:26624
  s_waitcnt lgkmcnt(3)
  v_mfma_f32_16x16x32_bf16 v[64:67], a[184:187], v[84:87], v[64:67]
  v_mfma_f32_16x16x32_bf16 v[68:71], a[188:191], v[84:87], v[68:71]
  ds_read_b128 v[84:87], v24 offset:27648
  s_waitcnt lgkmcnt(3)
  v_mfma_f32_16x16x32_bf16 v[64:67], a[192:195], v[72:75], v[64:67]
  v_mfma_f32_16x16x32_bf16 v[68:71], a[196:199], v[72:75], v[68:71]
  ds_read_b128 v[72:75], v24 offset:28672
  s_waitcnt lgkmcnt(3)
  v_mfma_f32_16x16x32_bf16 v[64:67], a[200:203], v[76:79], v[64:67]
  s_add_u32 m0, s50, 24576
  s_add_u32 s5, s32, 24576
  buffer_load_dwordx4 v20, s[8:11], s5 offen sc1 lds
  v_mfma_f32_16x16x32_bf16 v[68:71], a[204:207], v[76:79], v[68:71]
  ds_read_b128 v[76:79], v24 offset:29696
  s_waitcnt lgkmcnt(3)
  v_mfma_f32_16x16x32_bf16 v[64:67], a[208:211], v[80:83], v[64:67]
  v_mfma_f32_16x16x32_bf16 v[68:71], a[212:215], v[80:83], v[68:71]
  ds_read_b128 v[80:83], v24 offset:30720
  s_waitcnt lgkmcnt(3)
  v_mfma_f32_16x16x32_bf16 v[64:67], a[216:219], v[84:87], v[64:67]
  v_mfma_f32_16x16x32_bf16 v[68:71], a[220:223], v[84:87], v[68:71]
  ds_read_b128 v[84:87], v24 offset:31744
  s_waitcnt lgkmcnt(3)
  v_mfma_f32_16x16x32_bf16 v[64:67], a[224:227], v[72:75], v[64:67]
  v_mfma_f32_16x16x32_bf16 v[68:71], a[228:231], v[72:75], v[68:71]
  s_waitcnt vmcnt(11)
  s_barrier
  ds_read_b128 v[72:75], v24 offset:32768
  s_waitcnt lgkmcnt(3)
  v_mfma_f32_16x16x32_bf16 v[64:67], a[232:235], v[76:79], v[64:67]
  s_add_u32 m0, s50, 28672
  s_add_u32 s5, s32, 28672
  buffer_load_dwordx4 v20, s[8:11], s5 offen sc1 lds
  v_mfma_f32_16x16x32_bf16 v[68:71], a[236:239], v[76:79], v[68:71]
  ds_read_b128 v[76:79], v24 offset:33792
  s_waitcnt lgkmcnt(3)
  v_mfma_f32_16x16x32_bf16 v[64:67], a[240:243], v[80:83], v[64:67]
  v_mfma_f32_16x16x32_bf16 v[68:71], a[244:247], v[80:83], v[68:71]
  ds_read_b128 v[80:83], v24 offset:34816
  s_waitcnt lgkmcnt(3)
  v_mfma_f32_16x16x32_bf16 v[64:67], a[248:251], v[84:87], v[64:67]
  v_mfma_f32_16x16x32_bf16 v[68:71], a[252:255], v[84:87], v[68:71]
  ds_read_b128 v[84:87], v24 offset:35840
  s_waitcnt lgkmcnt(3)
  v_mfma_f32_16x16x32_bf16 v[64:67], v[128:131], v[72:75], v[64:67]
  v_mfma_f32_16x16x32_bf16 v[68:71], v[132:135], v[72:75], v[68:71]
  ds_read_b128 v[72:75], v24 offset:36864
  s_waitcnt lgkmcnt(3)
  v_mfma_f32_16x16x32_bf16 v[64:67], v[136:139], v[76:79], v[64:67]
  s_add_u32 m0, s50, 32768
  s_add_u32 s5, s32, 32768
  buffer_load_dwordx4 v20, s[8:11], s5 offen sc1 lds
  v_mfma_f32_16x16x32_bf16 v[68:71], v[140:143], v[76:79], v[68:71]
  ds_read_b128 v[76:79], v24 offset:37888
  s_waitcnt lgkmcnt(3)
  v_mfma_f32_16x16x32_bf16 v[64:67], v[144:147], v[80:83], v[64:67]
  v_mfma_f32_16x16x32_bf16 v[68:71], v[148:151], v[80:83], v[68:71]
  ds_read_b128 v[80:83], v24 offset:38912
  s_waitcnt lgkmcnt(3)
  v_mfma_f32_16x16x32_bf16 v[64:67], v[152:155], v[84:87], v[64:67]
  v_mfma_f32_16x16x32_bf16 v[68:71], v[156:159], v[84:87], v[68:71]
  ds_read_b128 v[84:87], v24 offset:39936
  s_waitcnt lgkmcnt(3)
  v_mfma_f32_16x16x32_bf16 v[64:67], v[160:163], v[72:75], v[64:67]
  v_mfma_f32_16x16x32_bf16 v[68:71], v[164:167], v[72:75], v[68:71]
  ds_read_b128 v[72:75], v24 offset:40960
  s_waitcnt lgkmcnt(3)
  v_mfma_f32_16x16x32_bf16 v[64:67], v[168:171], v[76:79], v[64:67]
  s_add_u32 m0, s50, 36864
  s_add_u32 s5, s32, 36864
  buffer_load_dwordx4 v20, s[8:11], s5 offen sc1 lds
  v_mfma_f32_16x16x32_bf16 v[68:71], v[172:175], v[76:79], v[68:71]
  ds_read_b128 v[76:79], v24 offset:41984
  s_waitcnt lgkmcnt(3)
  v_mfma_f32_16x16x32_bf16 v[64:67], v[176:179], v[80:83], v[64:67]
  v_mfma_f32_16x16x32_bf16 v[68:71], v[180:183], v[80:83], v[68:71]
  ds_read_b128 v[80:83], v24 offset:43008
  s_waitcnt lgkmcnt(3)
  v_mfma_f32_16x16x32_bf16 v[64:67], v[184:187], v[84:87], v[64:67]
  v_mfma_f32_16x16x32_bf16 v[68:71], v[188:191], v[84:87], v[68:71]
  ds_read_b128 v[84:87], v24 offset:44032
  s_waitcnt lgkmcnt(3)
  v_mfma_f32_16x16x32_bf16 v[64:67], v[192:195], v[72:75], v[64:67]
  v_mfma_f32_16x16x32_bf16 v[68:71], v[196:199], v[72:75], v[68:71]
  ds_read_b128 v[72:75], v24 offset:45056
  s_waitcnt lgkmcnt(3)
  v_mfma_f32_16x16x32_bf16 v[64:67], v[200:203], v[76:79], v[64:67]
  s_add_u32 m0, s50, 40960
  s_add_u32 s5, s32, 40960
  buffer_load_dwordx4 v20, s[8:11], s5 offen sc1 lds
  v_mfma_f32_16x16x32_bf16 v[68:71], v[204:207], v[76:79], v[68:71]
  ds_read_b128 v[76:79], v24 offset:46080
  s_waitcnt lgkmcnt(3)
  v_mfma_f32_16x16x32_bf16 v[64:67], v[208:211], v[80:83], v[64:67]
  v_mfma_f32_16x16x32_bf16 v[68:71], v[212:215], v[80:83], v[68:71]
  ds_read_b128 v[80:83], v24 offset:47104
  s_waitcnt lgkmcnt(3)
  v_mfma_f32_16x16x32_bf16 v[64:67], v[216:219], v[84:87], v[64:67]
  v_mfma_f32_16x16x32_bf16 v[68:71], v[220:223], v[84:87], v[68:71]
  ds_read_b128 v[84:87], v24 offset:48128
  s_waitcnt lgkmcnt(3)
  v_mfma_f32_16x16x32_bf16 v[64:67], v[224:227], v[72:75], v[64:67]
  v_mfma_f32_16x16x32_bf16 v[68:71], v[228:231], v[72:75], v[68:71]
  s_waitcnt lgkmcnt(2)
  v_mfma_f32_16x16x32_bf16 v[64:67], v[232:235], v[76:79], v[64:67]
  s_add_u32 m0, s50, 45056
  s_add_u32 s5, s32, 45056
  buffer_load_dwordx4 v20, s[8:11], s5 offen sc1 lds
  v_mfma_f32_16x16x32_bf16 v[68:71], v[236:239], v[76:79], v[68:71]
  s_waitcnt lgkmcnt(1)
  v_mfma_f32_16x16x32_bf16 v[64:67], v[240:243], v[80:83], v[64:67]
  v_mfma_f32_16x16x32_bf16 v[68:71], v[244:247], v[80:83], v[68:71]
  s_waitcnt lgkmcnt(0)
  v_mfma_f32_16x16x32_bf16 v[64:67], v[248:251], v[84:87], v[64:67]
  v_mfma_f32_16x16x32_bf16 v[68:71], v[252:255], v[84:87], v[68:71]
  s_waitcnt vmcnt(13)
  s_branch L_E_ep
L_E_cAc:
  s_mul_i32 s4, s54, 20480
  s_add_u32 s4, s4, s36
  s_add_u32 s4, s4, 144592896
  buffer_load_dwordx4 v[88:91], v20, s[8:11], s4 offen sc1
  s_waitcnt vmcnt(9)
  s_barrier
  ds_read_b128 v[72:75], v24 offset:0
  ds_read_b128 v[76:79], v24 offset:1024
  ds_read_b128 v[80:83], v24 offset:2048
  ds_read_b128 v[84:87], v24 offset:3072
  s_waitcnt lgkmcnt(3)
  v_mfma_f32_16x16x32_bf16 v[64:67], a[0:3], v[72:75], 0
  v_mfma_f32_16x16x32_bf16 v[68:71], a[4:7], v[72:75], 0
  ds_read_b128 v[72:75], v24 offset:4096
  s_waitcnt lgkmcnt(3)
  v_mfma_f32_16x16x32_bf16 v[64:67], a[8:11], v[76:79], v[64:67]
  s_add_u32 m0, s50, 0
  s_add_u32 s5, s32, 0
  buffer_load_dwordx4 v20, s[8:11], s5 offen sc1 lds
  v_mfma_f32_16x16x32_bf16 v[68:71], a[12:15], v[76:79], v[68:71]
  ds_read_b128 v[76:79], v24 offset:5120
  s_waitcnt lgkmcnt(3)
  v_mfma_f32_16x16x32_bf16 v[64:67], a[16:19], v[80:83], v[64:67]
  v_mfma_f32_16x16x32_bf16 v[68:71], a[20:23], v[80:83], v[68:71]
  ds_read_b128 v[80:83], v24 offset:6144
  s_waitcnt lgkmcnt(3)
  v_mfma_f32_16x16x32_bf16 v[64:67], a[24:27], v[84:87], v[64:67]
  v_mfma_f32_16x16x32_bf16 v[68:71], a[28:31], v[84:87], v[68:71]
  ds_read_b128 v[84:87], v24 offset:7168
  s_waitcnt lgkmcnt(3)
  v_mfma_f32_16x16x32_bf16 v[64:67], a[32:35], v[72:75], v[64:67]
  v_mfma_f32_16x16x32_bf16 v[68:71], a[36:39], v[72:75], v[68:71]
  ds_read_b128 v[72:75], v24 offset:8192
  s_waitcnt lgkmcnt(3)
  v_mfma_f32_16x16x32_bf16 v[64:67], a[40:43], v[76:79], v[64:67]
  s_add_u32 m0, s50, 4096
  s_add_u32 s5, s32, 4096
  buffer_load_dwordx4 v20, s[8:11], s5 offen sc1 lds
  v_mfma_f32_16x16x32_bf16 v[68:71], a[44:47], v[76:79], v[68:71]
  ds_read_b128 v[76:79], v24 offset:9216
  s_waitcnt lgkmcnt(3)
  v_mfma_f32_16x16x32_bf16 v[64:67], a[48:51], v[80:83], v[64:67]
  v_mfma_f32_16x16x32_bf16 v[68:71], a[52:55], v[80:83], v[68:71]
  ds_read_b128 v[80:83], v24 offset:10240
  s_waitcnt lgkmcnt(3)
  v_mfma_f32_16x16x32_bf16 v[64:67], a[56:59], v[84:87], v[64:67]
  v_mfma_f32_16x16x32_bf16 v[68:71], a[60:63], v[84:87], v[68:71]
  ds_read_b128 v[84:87], v24 offset:11264
  s_waitcnt lgkmcnt(3)
  v_mfma_f32_16x16x32_bf16 v[64:67], a[64:67], v[72:75], v[64:67]
  v_mfma_f32_16x16x32_bf16 v[68:71], a[68:71], v[72:75], v[68:71]
  ds_read_b128 v[72:75], v24 offset:12288
  s_waitcnt lgkmcnt(3)
  v_mfma_f32_16x16x32_bf16 v[64:67], a[72:75], v[76:79], v[64:67]
  s_add_u32 m0, s50, 8192
  s_add_u32 s5, s32, 8192
  buffer_load_dwordx4 v20, s[8:11], s5 offen sc1 lds
  v_mfma_f32_16x16x32_bf16 v[68:71], a[76:79], v[76:79], v[68:71]
  ds_read_b128 v[76:79], v24 offset:13312
  s_waitcnt lgkmcnt(3)
  v_mfma_f32_16x16x32_bf16 v[64:67], a[80:83], v[80:83], v[64:67]
  v_mfma_f32_16x16x32_bf16 v[68:71], a[84:87], v[80:83], v[68:71]
  ds_read_b128 v[80:83], v24 offset:14336
  s_waitcnt lgkmcnt(3)
  v_mfma_f32_16x16x32_bf16 v[64:67], a[88:91], v[84:87], v[64:67]
  v_mfma_f32_16x16x32_bf16 v[68:71], a[92:95], v[84:87], v[68:71]
  ds_read_b128 v[84:87], v24 offset:15360
  s_waitcnt lgkmcnt(3)
  v_mfma_f32_16x16x32_bf16 v[64:67], a[96:99], v[72:75], v[64:67]
  v_mfma_f32_16x16x32_bf16 v[68:71], a[100:103], v[72:75], v[68:71]
  s_waitcnt vmcnt(8)
  s_barrier
  ds_read_b128 v[72:75], v24 offset:16384
  s_waitcnt lgkmcnt(3)
  v_mfma_f32_16x16x32_bf16 v[64:67], a[104:107], v[76:79], v[64:67]
  s_add_u32 m0, s50, 12288
  s_add_u32 s5, s32, 12288
  buffer_load_dwordx4 v20, s[8:11], s5 offen sc1 lds
  v_mfma_f32_16x16x32_bf16 v[68:71], a[108:111], v[76:79], v[68:71]
  ds_read_b128 v[76:79], v24 offset:17408
  s_waitcnt lgkmcnt(3)
  v_mfma_f32_16x16x32_bf16 v[64:67], a[112:115], v[80:83], v[64:67]
  v_mfma_f32_16x16x32_bf16 v[68:71], a[116:119], v[80:83], v[68:71]
  ds_read_b128 v[80:83], v24 offset:18432
  s_waitcnt lgkmcnt(3)
  v_mfma_f32_16x16x32_bf16 v[64:67], a[120:123], v[84:87], v[64:67]
  v_mfma_f32_16x16x32_bf16 v[68:71], a[124:127], v[84:87], v[68:71]
  ds_read_b128 v[84:87], v24 offset:19456
  s_waitcnt lgkmcnt(3)
  v_mfma_f32_16x16x32_bf16 v[64:67], a[128:131], v[72:75], v[64:67]
  buffer_load_dword v28, v23, s[8:11], 0 offen sc1
  v_mfma_f32_16x16x32_bf16 v[68:71], a[132:135], v[72:75], v[68:71]
  ds_read_b128 v[72:75], v24 offset:20480
  s_waitcnt lgkmcnt(3)
  v_mfma_f32_16x16x32_bf16 v[64:67], a[136:139], v[76:79], v[64:67]
  s_add_u32 m0, s50, 16384
  s_add_u32 s5, s32, 16384
  buffer_load_dwordx4 v20, s[8:11], s5 offen sc1 lds
  v_mfma_f32_16x16x32_bf16 v[68:71], a[140:143], v[76:79], v[68:71]
  ds_read_b128 v[76:79], v24 offset:21504
  s_waitcnt lgkmcnt(3)
  v_mfma_f32_16x16x32_bf16 v[64:67], a[144:147], v[80:83], v[64:67]
  v_mfma_f32_16x16x32_bf16 v[68:71], a[148:151], v[80:83], v[68:71]
  ds_read_b128 v[80:83], v24 offset:22528
  s_waitcnt lgkmcnt(3)
  v_mfma_f32_16x16x32_bf16 v[64:67], a[152:155], v[84:87], v[64:67]
  v_mfma_f32_16x16x32_bf16 v[68:71], a[156:159], v[84:87], v[68:71]
  ds_read_b128 v[84:87], v24 offset:23552
  s_waitcnt lgkmcnt(3)
  v_mfma_f32_16x16x32_bf16 v[64:67], a[160:163], v[72:75], v[64:67]
  v_mfma_f32_16x16x32_bf16 v[68:71], a[164:167], v[72:75], v[68:71]
  ds_read_b128 v[72:75], v24 offset:24576
  s_waitcnt lgkmcnt(3)
  v_mfma_f32_16x16x32_bf16 v[64:67], a[168:171], v[76:79], v[64:67]
  s_add_u32 m0, s50, 20480
  s_add_u32 s5, s32, 20480
  buffer_load_dwordx4 v20, s[8:11], s5 offen sc1 lds
  v_mfma_f32_16x16x32_bf16 v[68:71], a[172:175], v[76:79], v[68:71]
  ds_read_b128 v[76:79], v24 offset:25600
  s_waitcnt lgkmcnt(3)
  v_mfma_f32_16x16x32_bf16 v[64:67], a[176:179], v[80:83], v[64:67]
  v_mfma_f32_16x16x32_bf16 v[68:71], a[180:183], v[80:83], v[68:71]
  ds_read_b128 v[80:83], v24 offset:26624
  s_waitcnt lgkmcnt(3)
  v_mfma_f32_16x16x32_bf16 v[64:67], a[184:187], v[84:87], v[64:67]
  v_mfma_f32_16x16x32_bf16 v[68:71], a[188:191], v[84:87], v[68:71]
  ds_read_b128 v[84:87], v24 offset:27648
  s_waitcnt lgkmcnt(3)
  v_mfma_f32_16x16x32_bf16 v[64:67], a[192:195], v[72:75], v[64:67]
  v_mfma_f32_16x16x32_bf16 v[68:71], a[196:199], v[72:75], v[68:71]
  ds_read_b128 v[72:75], v24 offset:28672
  s_waitcnt lgkmcnt(3)
  v_mfma_f32_16x16x32_bf16 v[64:67], a[200:203], v[76:79], v[64:67]
  s_add_u32 m0, s50, 24576
  s_add_u32 s5, s32, 24576
  buffer_load_dwordx4 v20, s[8:11], s5 offen sc1 lds
  v_mfma_f32_16x16x32_bf16 v[68:71], a[204:207], v[76:79], v[68:71]
  ds_read_b128 v[76:79], v24 offset:29696
  s_waitcnt lgkmcnt(3)
  v_mfma_f32_16x16x32_bf16 v[64:67], a[208:211], v[80:83], v[64:67]
  v_mfma_f32_16x16x32_bf16 v[68:71], a[212:215], v[80:83], v[68:71]
  ds_read_b128 v[80:83], v24 offset:30720
  s_waitcnt lgkmcnt(3)
  v_mfma_f32_16x16x32_bf16 v[64:67], a[216:219], v[84:87], v[64:67]
  v_mfma_f32_16x16x32_bf16 v[68:71], a[220:223], v[84:87], v[68:71]
  ds_read_b128 v[84:87], v24 offset:31744
  s_waitcnt lgkmcnt(3)
  v_mfma_f32_16x16x32_bf16 v[64:67], a[224:227], v[72:75], v[64:67]
  v_mfma_f32_16x16x32_bf16 v[68:71], a[228:231], v[72:75], v[68:71]
  s_waitcnt vmcnt(9)
  s_barrier
  ds_read_b128 v[72:75], v24 offset:32768
  s_waitcnt lgkmcnt(3)
  v_mfma_f32_16x16x32_bf16 v[64:67], a[232:235], v[76:79], v[64:67]
  s_add_u32 m0, s50, 28672
  s_add_u32 s5, s32, 28672
  buffer_load_dwordx4 v20, s[8:11], s5 offen sc1 lds
  v_mfma_f32_16x16x32_bf16 v[68:71], a[236:239], v[76:79], v[68:71]
  ds_read_b128 v[76:79], v24 offset:33792
  s_waitcnt lgkmcnt(3)
  v_mfma_f32_16x16x32_bf16 v[64:67], a[240:243], v[80:83], v[64:67]
  v_mfma_f32_16x16x32_bf16 v[68:71], a[244:247], v[80:83], v[68:71]
  ds_read_b128 v[80:83], v24 offset:34816
  s_waitcnt lgkmcnt(3)
  v_mfma_f32_16x16x32_bf16 v[64:67], a[248:251], v[84:87], v[64:67]
  v_mfma_f32_16x16x32_bf16 v[68:71], a[252:255], v[84:87], v[68:71]
  ds_read_b128 v[84:87], v24 offset:35840
  s_waitcnt lgkmcnt(3)
  v_mfma_f32_16x16x32_bf16 v[64:67], v[128:131], v[72:75], v[64:67]
  v_mfma_f32_16x16x32_bf16 v[68:71], v[132:135], v[72:75], v[68:71]
  ds_read_b128 v[72:75], v24 offset:36864
  s_waitcnt lgkmcnt(3)
  v_mfma_f32_16x16x32_bf16 v[64:67], v[136:139], v[76:79], v[64:67]
  s_add_u32 m0, s50, 32768
  s_add_u32 s5, s32, 32768
  buffer_load_dwordx4 v20, s[8:11], s5 offen sc1 lds
  v_mfma_f32_16x16x32_bf16 v[68:71], v[140:143], v[76:79], v[68:71]
  ds_read_b128 v[76:79], v24 offset:37888
  s_waitcnt lgkmcnt(3)
  v_mfma_f32_16x16x32_bf16 v[64:67], v[144:147], v[80:83], v[64:67]
  v_mfma_f32_16x16x32_bf16 v[68:71], v[148:151], v[80:83], v[68:71]
  ds_read_b128 v[80:83], v24 offset:38912
  s_waitcnt lgkmcnt(3)
  v_mfma_f32_16x16x32_bf16 v[64:67], v[152:155], v[84:87], v[64:67]
  v_mfma_f32_16x16x32_bf16 v[68:71], v[156:159], v[84:87], v[68:71]
  ds_read_b128 v[84:87], v24 offset:39936
  s_waitcnt lgkmcnt(3)
  v_mfma_f32_16x16x32_bf16 v[64:67], v[160:163], v[72:75], v[64:67]
  v_mfma_f32_16x16x32_bf16 v[68:71], v[164:167], v[72:75], v[68:71]
  ds_read_b128 v[72:75], v24 offset:40960
  s_waitcnt lgkmcnt(3)
  v_mfma_f32_16x16x32_bf16 v[64:67], v[168:171], v[76:79], v[64:67]
  s_add_u32 m0, s50, 36864
  s_add_u32 s5, s32, 36864
  buffer_load_dwordx4 v20, s[8:11], s5 offen sc1 lds
  v_mfma_f32_16x16x32_bf16 v[68:71], v[172:175], v[76:79], v[68:71]
  ds_read_b128 v[76:79], v24 offset:41984
  s_waitcnt lgkmcnt(3)
  v_mfma_f32_16x16x32_bf16 v[64:67], v[176:179], v[80:83], v[64:67]
  v_mfma_f32_16x16x32_bf16 v[68:71], v[180:183], v[80:83], v[68:71]
  ds_read_b128 v[80:83], v24 offset:43008
  s_waitcnt lgkmcnt(3)
  v_mfma_f32_16x16x32_bf16 v[64:67], v[184:187], v[84:87], v[64:67]
  v_mfma_f32_16x16x32_bf16 v[68:71], v[188:191], v[84:87], v[68:71]
  ds_read_b128 v[84:87], v24 offset:44032
  s_waitcnt lgkmcnt(3)
  v_mfma_f32_16x16x32_bf16 v[64:67], v[192:195], v[72:75], v[64:67]
  v_mfma_f32_16x16x32_bf16 v[68:71], v[196:199], v[72:75], v[68:71]
  ds_read_b128 v[72:75], v24 offset:45056
  s_waitcnt lgkmcnt(3)
  v_mfma_f32_16x16x32_bf16 v[64:67], v[200:203], v[76:79], v[64:67]
  s_add_u32 m0, s50, 40960
  s_add_u32 s5, s32, 40960
  buffer_load_dwordx4 v20, s[8:11], s5 offen sc1 lds
  v_mfma_f32_16x16x32_bf16 v[68:71], v[204:207], v[76:79], v[68:71]
  ds_read_b128 v[76:79], v24 offset:46080
  s_waitcnt lgkmcnt(3)
  v_mfma_f32_16x16x32_bf16 v[64:67], v[208:211], v[80:83], v[64:67]
  v_mfma_f32_16x16x32_bf16 v[68:71], v[212:215], v[80:83], v[68:71]
  ds_read_b128 v[80:83], v24 offset:47104
  s_waitcnt lgkmcnt(3)
  v_mfma_f32_16x16x32_bf16 v[64:67], v[216:219], v[84:87], v[64:67]
  v_mfma_f32_16x16x32_bf16 v[68:71], v[220:223], v[84:87], v[68:71]
  ds_read_b128 v[84:87], v24 offset:48128
  s_waitcnt lgkmcnt(3)
  v_mfma_f32_16x16x32_bf16 v[64:67], v[224:227], v[72:75], v[64:67]
  v_mfma_f32_16x16x32_bf16 v[68:71], v[228:231], v[72:75], v[68:71]
  s_waitcnt lgkmcnt(2)
  v_mfma_f32_16x16x32_bf16 v[64:67], v[232:235], v[76:79], v[64:67]
  s_add_u32 m0, s50, 45056
  s_add_u32 s5, s32, 45056
  buffer_load_dwordx4 v20, s[8:11], s5 offen sc1 lds
  v_mfma_f32_16x16x32_bf16 v[68:71], v[236:239], v[76:79], v[68:71]
  s_waitcnt lgkmcnt(1)
  v_mfma_f32_16x16x32_bf16 v[64:67], v[240:243], v[80:83], v[64:67]
  v_mfma_f32_16x16x32_bf16 v[68:71], v[244:247], v[80:83], v[68:71]
  s_waitcnt lgkmcnt(0)
  v_mfma_f32_16x16x32_bf16 v[64:67], v[248:251], v[84:87], v[64:67]
  v_mfma_f32_16x16x32_bf16 v[68:71], v[252:255], v[84:87], v[68:71]
  s_waitcnt vmcnt(13)
  s_branch L_E_ep
L_E_cB:
  s_cmp_eq_u32 s51, 1
  s_cbranch_scc1 L_E_cBc
  s_mul_i32 s4, s54, 20480
  s_add_u32 s4, s4, s36
  s_add_u32 s4, s4, 144592896
  buffer_load_dwordx4 v[88:91], v20, s[8:11], s4 offen sc1
  s_waitcnt vmcnt(12)
  s_barrier
  ds_read_b128 v[72:75], v24 offset:0
  ds_read_b128 v[76:79], v24 offset:1024
  ds_read_b128 v[80:83], v24 offset:2048
  ds_read_b128 v[84:87], v24 offset:3072
  s_waitcnt lgkmcnt(3)
  v_mfma_f32_16x16x32_bf16 v[64:67], a[0:3], v[72:75], 0
  v_mfma_f32_16x16x32_bf16 v[68:71], a[4:7], v[72:75], 0
  ds_read_b128 v[72:75], v24 offset:4096
  s_waitcnt lgkmcnt(3)
  v_mfma_f32_16x16x32_bf16 v[64:67], a[8:11], v[76:79], v[64:67]
  v_mfma_f32_16x16x32_bf16 v[68:71], a[12:15], v[76:79], v[68:71]
  ds_read_b128 v[76:79], v24 offset:5120
  s_waitcnt lgkmcnt(3)
  v_mfma_f32_16x16x32_bf16 v[64:67], a[16:19], v[80:83], v[64:67]
  v_mfma_f32_16x16x32_bf16 v[68:71], a[20:23], v[80:83], v[68:71]
  ds_read_b128 v[80:83], v24 offset:6144
  s_waitcnt lgkmcnt(3)
  v_mfma_f32_16x16x32_bf16 v[64:67], a[24:27], v[84:87], v[64:67]
  v_mfma_f32_16x16x32_bf16 v[68:71], a[28:31], v[84:87], v[68:71]
  ds_read_b128 v[84:87], v24 offset:7168
  s_waitcnt lgkmcnt(3)
  v_mfma_f32_16x16x32_bf16 v[64:67], a[32:35], v[72:75], v[64:67]
  v_mfma_f32_16x16x32_bf16 v[68:71], a[36:39], v[72:75], v[68:71]
  ds_read_b128 v[72:75], v24 offset:8192
  s_waitcnt lgkmcnt(3)
  v_mfma_f32_16x16x32_bf16 v[64:67], a[40:43], v[76:79], v[64:67]
  v_mfma_f32_16x16x32_bf16 v[68:71], a[44:47], v[76:79], v[68:71]
  ds_read_b128 v[76:79], v24 offset:9216
  s_waitcnt lgkmcnt(3)
  v_mfma_f32_16x16x32_bf16 v[64:67], a[48:51], v[80:83], v[64:67]
  v_mfma_f32_16x16x32_bf16 v[68:71], a[52:55], v[80:83], v[68:71]
  ds_read_b128 v[80:83], v24 offset:10240
  s_waitcnt lgkmcnt(3)
  v_mfma_f32_16x16x32_bf16 v[64:67], a[56:59], v[84:87], v[64:67]
  v_mfma_f32_16x16x32_bf16 v[68:71], a[60:63], v[84:87], v[68:71]
  ds_read_b128 v[84:87], v24 offset:11264
  s_waitcnt lgkmcnt(3)
  v_mfma_f32_16x16x32_bf16 v[64:67], a[64:67], v[72:75], v[64:67]
  v_mfma_f32_16x16x32_bf16 v[68:71], a[68:71], v[72:75], v[68:71]
  ds_read_b128 v[72:75], v24 offset:12288
  s_waitcnt lgkmcnt(3)
  v_mfma_f32_16x16x32_bf16 v[64:67], a[72:75], v[76:79], v[64:67]
  v_mfma_f32_16x16x32_bf16 v[68:71], a[76:79], v[76:79], v[68:71]
  ds_read_b128 v[76:79], v24 offset:13312
  s_waitcnt lgkmcnt(3)
  v_mfma_f32_16x16x32_bf16 v[64:67], a[80:83], v[80:83], v[64:67]
  v_mfma_f32_16x16x32_bf16 v[68:71], a[84:87], v[80:83], v[68:71]
  ds_read_b128 v[80:83], v24 offset:14336
  s_waitcnt lgkmcnt(3)
  v_mfma_f32_16x16x32_bf16 v[64:67], a[88:91], v[84:87], v[64:67]
  v_mfma_f32_16x16x32_bf16 v[68:71], a[92:95], v[84:87], v[68:71]
  ds_read_b128 v[84:87], v24 offset:15360
  s_waitcnt lgkmcnt(3)
  v_mfma_f32_16x16x32_bf16 v[64:67], a[96:99], v[72:75], v[64:67]
  v_mfma_f32_16x16x32_bf16 v[68:71], a[100:103], v[72:75], v[68:71]
  s_waitcnt vmcnt(7)
  s_barrier
  ds_read_b128 v[72:75], v24 offset:16384
  s_waitcnt lgkmcnt(3)
  v_mfma_f32_16x16x32_bf16 v[64:67], a[104:107], v[76:79], v[64:67]
  v_mfma_f32_16x16x32_bf16 v[68:71], a[108:111], v[76:79], v[68:71]
  ds_read_b128 v[76:79], v24 offset:17408
  s_waitcnt lgkmcnt(3)
  v_mfma_f32_16x16x32_bf16 v[64:67], a[112:115], v[80:83], v[64:67]
  v_mfma_f32_16x16x32_bf16 v[68:71], a[116:119], v[80:83], v[68:71]
  ds_read_b128 v[80:83], v24 offset:18432
  s_waitcnt lgkmcnt(3)
  v_mfma_f32_16x16x32_bf16 v[64:67], a[120:123], v[84:87], v[64:67]
  v_mfma_f32_16x16x32_bf16 v[68:71], a[124:127], v[84:87], v[68:71]
  ds_read_b128 v[84:87], v24 offset:19456
  s_waitcnt lgkmcnt(3)
  v_mfma_f32_16x16x32_bf16 v[64:67], a[128:131], v[72:75], v[64:67]
  buffer_load_dword v28, v23, s[8:11], 0 offen sc1
  v_mfma_f32_16x16x32_bf16 v[68:71], a[132:135], v[72:75], v[68:71]
  ds_read_b128 v[72:75], v24 offset:20480
  s_waitcnt lgkmcnt(3)
  v_mfma_f32_16x16x32_bf16 v[64:67], a[136:139], v[76:79], v[64:67]
  v_mfma_f32_16x16x32_bf16 v[68:71], a[140:143], v[76:79], v[68:71]
  ds_read_b128 v[76:79], v24 offset:21504
  s_waitcnt lgkmcnt(3)
  v_mfma_f32_16x16x32_bf16 v[64:67], a[144:147], v[80:83], v[64:67]
  v_mfma_f32_16x16x32_bf16 v[68:71], a[148:151], v[80:83], v[68:71]
  ds_read_b128 v[80:83], v24 offset:22528
  s_waitcnt lgkmcnt(3)
  v_mfma_f32_16x16x32_bf16 v[64:67], a[152:155], v[84:87], v[64:67]
  v_mfma_f32_16x16x32_bf16 v[68:71], a[156:159], v[84:87], v[68:71]
  ds_read_b128 v[84:87], v24 offset:23552
  s_waitcnt lgkmcnt(3)
  v_mfma_f32_16x16x32_bf16 v[64:67], a[160:163], v[72:75], v[64:67]
  v_mfma_f32_16x16x32_bf16 v[68:71], a[164:167], v[72:75], v[68:71]
  ds_read_b128 v[72:75], v24 offset:24576
  s_waitcnt lgkmcnt(3)
  v_mfma_f32_16x16x32_bf16 v[64:67], a[168:171], v[76:79], v[64:67]
  v_mfma_f32_16x16x32_bf16 v[68:71], a[172:175], v[76:79], v[68:71]
  ds_read_b128 v[76:79], v24 offset:25600
  s_waitcnt lgkmcnt(3)
  v_mfma_f32_16x16x32_bf16 v[64:67], a[176:179], v[80:83], v[64:67]
  v_mfma_f32_16x16x32_bf16 v[68:71], a[180:183], v[80:83], v[68:71]
  ds_read_b128 v[80:83], v24 offset:26624
  s_waitcnt lgkmcnt(3)
  v_mfma_f32_16x16x32_bf16 v[64:67], a[184:187], v[84:87], v[64:67]
  v_mfma_f32_16x16x32_bf16 v[68:71], a[188:191], v[84:87], v[68:71]
  ds_read_b128 v[84:87], v24 offset:27648
  s_waitcnt lgkmcnt(3)
  v_mfma_f32_16x16x32_bf16 v[64:67], a[192:195], v[72:75], v[64:67]
  v_mfma_f32_16x16x32_bf16 v[68:71], a[196:199], v[72:75], v[68:71]
  ds_read_b128 v[72:75], v24 offset:28672
  s_waitcnt lgkmcnt(3)
  v_mfma_f32_16x16x32_bf16 v[64:67], a[200:203], v[76:79], v[64:67]
  v_mfma_f32_16x16x32_bf16 v[68:71], a[204:207], v[76:79], v[68:71]
  ds_read_b128 v[76:79], v24 offset:29696
  s_waitcnt lgkmcnt(3)
  v_mfma_f32_16x16x32_bf16 v[64:67], a[208:211], v[80:83], v[64:67]
  v_mfma_f32_16x16x32_bf16 v[68:71], a[212:215], v[80:83], v[68:71]
  ds_read_b128 v[80:83], v24 offset:30720
  s_waitcnt lgkmcnt(3)
  v_mfma_f32_16x16x32_bf16 v[64:67], a[216:219], v[84:87], v[64:67]
  v_mfma_f32_16x16x32_bf16 v[68:71], a[220:223], v[84:87], v[68:71]
  ds_read_b128 v[84:87], v24 offset:31744
  s_waitcnt lgkmcnt(3)
  v_mfma_f32_16x16x32_bf16 v[64:67], a[224:227], v[72:75], v[64:67]
  v_mfma_f32_16x16x32_bf16 v[68:71], a[228:231], v[72:75], v[68:71]
  s_waitcnt vmcnt(4)
  s_barrier
  ds_read_b128 v[72:75], v24 offset:32768
  s_waitcnt lgkmcnt(3)
  v_mfma_f32_16x16x32_bf16 v[64:67], a[232:235], v[76:79], v[64:67]
  v_mfma_f32_16x16x32_bf16 v[68:71], a[236:239], v[76:79], v[68:71]
  ds_read_b128 v[76:79], v24 offset:33792
  s_waitcnt lgkmcnt(3)
  v_mfma_f32_16x16x32_bf16 v[64:67], a[240:243], v[80:83], v[64:67]
  v_mfma_f32_16x16x32_bf16 v[68:71], a[244:247], v[80:83], v[68:71]
  ds_read_b128 v[80:83], v24 offset:34816
  s_waitcnt lgkmcnt(3)
  v_mfma_f32_16x16x32_bf16 v[64:67], a[248:251], v[84:87], v[64:67]
  v_mfma_f32_16x16x32_bf16 v[68:71], a[252:255], v[84:87], v[68:71]
  ds_read_b128 v[84:87], v24 offset:35840
  s_waitcnt lgkmcnt(3)
  v_mfma_f32_16x16x32_bf16 v[64:67], v[128:131], v[72:75], v[64:67]
  v_mfma_f32_16x16x32_bf16 v[68:71], v[132:135], v[72:75], v[68:71]
  ds_read_b128 v[72:75], v24 offset:36864
  s_waitcnt lgkmcnt(3)
  v_mfma_f32_16x16x32_bf16 v[64:67], v[136:139], v[76:79], v[64:67]
  v_mfma_f32_16x16x32_bf16 v[68:71], v[140:143], v[76:79], v[68:71]
  ds_read_b128 v[76:79], v24 offset:37888
  s_waitcnt lgkmcnt(3)
  v_mfma_f32_16x16x32_bf16 v[64:67], v[144:147], v[80:83], v[64:67]
  v_mfma_f32_16x16x32_bf16 v[68:71], v[148:151], v[80:83], v[68:71]
  ds_read_b128 v[80:83], v24 offset:38912
  s_waitcnt lgkmcnt(3)
  v_mfma_f32_16x16x32_bf16 v[64:67], v[152:155], v[84:87], v[64:67]
  v_mfma_f32_16x16x32_bf16 v[68:71], v[156:159], v[84:87], v[68:71]
  ds_read_b128 v[84:87], v24 offset:39936
  s_waitcnt lgkmcnt(3)
  v_mfma_f32_16x16x32_bf16 v[64:67], v[160:163], v[72:75], v[64:67]
  v_mfma_f32_16x16x32_bf16 v[68:71], v[164:167], v[72:75], v[68:71]
  ds_read_b128 v[72:75], v24 offset:40960
  s_waitcnt lgkmcnt(3)
  v_mfma_f32_16x16x32_bf16 v[64:67], v[168:171], v[76:79], v[64:67]
  v_mfma_f32_16x16x32_bf16 v[68:71], v[172:175], v[76:79], v[68:71]
  ds_read_b128 v[76:79], v24 offset:41984
  s_waitcnt lgkmcnt(3)
  v_mfma_f32_16x16x32_bf16 v[64:67], v[176:179], v[80:83], v[64:67]
  v_mfma_f32_16x16x32_bf16 v[68:71], v[180:183], v[80:83], v[68:71]
  ds_read_b128 v[80:83], v24 offset:43008
  s_waitcnt lgkmcnt(3)
  v_mfma_f32_16x16x32_bf16 v[64:67], v[184:187], v[84:87], v[64:67]
  v_mfma_f32_16x16x32_bf16 v[68:71], v[188:191], v[84:87], v[68:71]
  ds_read_b128 v[84:87], v24 offset:44032
  s_waitcnt lgkmcnt(3)
  v_mfma_f32_16x16x32_bf16 v[64:67], v[192:195], v[72:75], v[64:67]
  v_mfma_f32_16x16x32_bf16 v[68:71], v[196:199], v[72:75], v[68:71]
  ds_read_b128 v[72:75], v24 offset:45056
  s_waitcnt lgkmcnt(3)
  v_mfma_f32_16x16x32_bf16 v[64:67], v[200:203], v[76:79], v[64:67]
  v_mfma_f32_16x16x32_bf16 v[68:71], v[204:207], v[76:79], v[68:71]
  ds_read_b128 v[76:79], v24 offset:46080
  s_waitcnt lgkmcnt(3)
  v_mfma_f32_16x16x32_bf16 v[64:67], v[208:211], v[80:83], v[64:67]
  v_mfma_f32_16x16x32_bf16 v[68:71], v[212:215], v[80:83], v[68:71]
  ds_read_b128 v[80:83], v24 offset:47104
  s_waitcnt lgkmcnt(3)
  v_mfma_f32_16x16x32_bf16 v[64:67], v[216:219], v[84:87], v[64:67]
  v_mfma_f32_16x16x32_bf16 v[68:71], v[220:223], v[84:87], v[68:71]
  ds_read_b128 v[84:87], v24 offset:48128
  s_waitcnt lgkmcnt(3)
  v_mfma_f32_16x16x32_bf16 v[64:67], v[224:227], v[72:75], v[64:67]
  v_mfma_f32_16x16x32_bf16 v[68:71], v[228:231], v[72:75], v[68:71]
  s_waitcnt lgkmcnt(2)
  v_mfma_f32_16x16x32_bf16 v[64:67], v[232:235], v[76:79], v[64:67]
  v_mfma_f32_16x16x32_bf16 v[68:71], v[236:239], v[76:79], v[68:71]
  s_waitcnt lgkmcnt(1)
  v_mfma_f32_16x16x32_bf16 v[64:67], v[240:243], v[80:83], v[64:67]
  v_mfma_f32_16x16x32_bf16 v[68:71], v[244:247], v[80:83], v[68:71]
  s_waitcnt lgkmcnt(0)
  v_mfma_f32_16x16x32_bf16 v[64:67], v[248:251], v[84:87], v[64:67]
  v_mfma_f32_16x16x32_bf16 v[68:71], v[252:255], v[84:87], v[68:71]
  s_waitcnt vmcnt(1)
  s_branch L_E_ep
L_E_cBc:
  s_mul_i32 s4, s54, 20480
  s_add_u32 s4, s4, s36
  s_add_u32 s4, s4, 144592896
  buffer_load_dwordx4 v[88:91], v20, s[8:11], s4 offen sc1
  s_waitcnt vmcnt(9)
  s_barrier
  ds_read_b128 v[72:75], v24 offset:0
  ds_read_b128 v[76:79], v24 offset:1024
  ds_read_b128 v[80:83], v24 offset:2048
  ds_read_b128 v[84:87], v24 offset:3072
  s_waitcnt lgkmcnt(3)
  v_mfma_f32_16x16x32_bf16 v[64:67], a[0:3], v[72:75], 0
  v_mfma_f32_16x16x32_bf16 v[68:71], a[4:7], v[72:75], 0
  ds_read_b128 v[72:75], v24 offset:4096
  s_waitcnt lgkmcnt(3)
  v_mfma_f32_16x16x32_bf16 v[64:67], a[8:11], v[76:79], v[64:67]
  v_mfma_f32_16x16x32_bf16 v[68:71], a[12:15], v[76:79], v[68:71]
  ds_read_b128 v[76:79], v24 offset:5120
  s_waitcnt lgkmcnt(3)
  v_mfma_f32_16x16x32_bf16 v[64:67], a[16:19], v[80:83], v[64:67]
  v_mfma_f32_16x16x32_bf16 v[68:71], a[20:23], v[80:83], v[68:71]
  ds_read_b128 v[80:83], v24 offset:6144
  s_waitcnt lgkmcnt(3)
  v_mfma_f32_16x16x32_bf16 v[64:67], a[24:27], v[84:87], v[64:67]
  v_mfma_f32_16x16x32_bf16 v[68:71], a[28:31], v[84:87], v[68:71]
  ds_read_b128 v[84:87], v24 offset:7168
  s_waitcnt lgkmcnt(3)
  v_mfma_f32_16x16x32_bf16 v[64:67], a[32:35], v[72:75], v[64:67]
  v_mfma_f32_16x16x32_bf16 v[68:71], a[36:39], v[72:75], v[68:71]
  ds_read_b128 v[72:75], v24 offset:8192
  s_waitcnt lgkmcnt(3)
  v_mfma_f32_16x16x32_bf16 v[64:67], a[40:43], v[76:79], v[64:67]
  v_mfma_f32_16x16x32_bf16 v[68:71], a[44:47], v[76:79], v[68:71]
  ds_read_b128 v[76:79], v24 offset:9216
  s_waitcnt lgkmcnt(3)
  v_mfma_f32_16x16x32_bf16 v[64:67], a[48:51], v[80:83], v[64:67]
  v_mfma_f32_16x16x32_bf16 v[68:71], a[52:55], v[80:83], v[68:71]
  ds_read_b128 v[80:83], v24 offset:10240
  s_waitcnt lgkmcnt(3)
  v_mfma_f32_16x16x32_bf16 v[64:67], a[56:59], v[84:87], v[64:67]
  v_mfma_f32_16x16x32_bf16 v[68:71], a[60:63], v[84:87], v[68:71]
  ds_read_b128 v[84:87], v24 offset:11264
  s_waitcnt lgkmcnt(3)
  v_mfma_f32_16x16x32_bf16 v[64:67], a[64:67], v[72:75], v[64:67]
  v_mfma_f32_16x16x32_bf16 v[68:71], a[68:71], v[72:75], v[68:71]
  ds_read_b128 v[72:75], v24 offset:12288
  s_waitcnt lgkmcnt(3)
  v_mfma_f32_16x16x32_bf16 v[64:67], a[72:75], v[76:79], v[64:67]
  v_mfma_f32_16x16x32_bf16 v[68:71], a[76:79], v[76:79], v[68:71]
  ds_read_b128 v[76:79], v24 offset:13312
  s_waitcnt lgkmcnt(3)
  v_mfma_f32_16x16x32_bf16 v[64:67], a[80:83], v[80:83], v[64:67]
  v_mfma_f32_16x16x32_bf16 v[68:71], a[84:87], v[80:83], v[68:71]
  ds_read_b128 v[80:83], v24 offset:14336
  s_waitcnt lgkmcnt(3)
  v_mfma_f32_16x16x32_bf16 v[64:67], a[88:91], v[84:87], v[64:67]
  v_mfma_f32_16x16x32_bf16 v[68:71], a[92:95], v[84:87], v[68:71]
  ds_read_b128 v[84:87], v24 offset:15360
  s_waitcnt lgkmcnt(3)
  v_mfma_f32_16x16x32_bf16 v[64:67], a[96:99], v[72:75], v[64:67]
  v_mfma_f32_16x16x32_bf16 v[68:71], a[100:103], v[72:75], v[68:71]
  s_waitcnt vmcnt(5)
  s_barrier
  ds_read_b128 v[72:75], v24 offset:16384
  s_waitcnt lgkmcnt(3)
  v_mfma_f32_16x16x32_bf16 v[64:67], a[104:107], v[76:79], v[64:67]
  v_mfma_f32_16x16x32_bf16 v[68:71], a[108:111], v[76:79], v[68:71]
  ds_read_b128 v[76:79], v24 offset:17408
  s_waitcnt lgkmcnt(3)
  v_mfma_f32_16x16x32_bf16 v[64:67], a[112:115], v[80:83], v[64:67]
  v_mfma_f32_16x16x32_bf16 v[68:71], a[116:119], v[80:83], v[68:71]
  ds_read_b128 v[80:83], v24 offset:18432
  s_waitcnt lgkmcnt(3)
  v_mfma_f32_16x16x32_bf16 v[64:67], a[120:123], v[84:87], v[64:67]
  v_mfma_f32_16x16x32_bf16 v[68:71], a[124:127], v[84:87], v[68:71]
  ds_read_b128 v[84:87], v24 offset:19456
  s_waitcnt lgkmcnt(3)
  v_mfma_f32_16x16x32_bf16 v[64:67], a[128:131], v[72:75], v[64:67]
  buffer_load_dword v28, v23, s[8:11], 0 offen sc1
  v_mfma_f32_16x16x32_bf16 v[68:71], a[132:135], v[72:75], v[68:71]
  ds_read_b128 v[72:75], v24 offset:20480
  s_waitcnt lgkmcnt(3)
  v_mfma_f32_16x16x32_bf16 v[64:67], a[136:139], v[76:79], v[64:67]
  v_mfma_f32_16x16x32_bf16 v[68:71], a[140:143], v[76:79], v[68:71]
  ds_read_b128 v[76:79], v24 offset:21504
  s_waitcnt lgkmcnt(3)
  v_mfma_f32_16x16x32_bf16 v[64:67], a[144:147], v[80:83], v[64:67]
  v_mfma_f32_16x16x32_bf16 v[68:71], a[148:151], v[80:83], v[68:71]
  ds_read_b128 v[80:83], v24 offset:22528
  s_waitcnt lgkmcnt(3)
  v_mfma_f32_16x16x32_bf16 v[64:67], a[152:155], v[84:87], v[64:67]
  v_mfma_f32_16x16x32_bf16 v[68:71], a[156:159], v[84:87], v[68:71]
  ds_read_b128 v[84:87], v24 offset:23552
  s_waitcnt lgkmcnt(3)
  v_mfma_f32_16x16x32_bf16 v[64:67], a[160:163], v[72:75], v[64:67]
  v_mfma_f32_16x16x32_bf16 v[68:71], a[164:167], v[72:75], v[68:71]
  ds_read_b128 v[72:75], v24 offset:24576
  s_waitcnt lgkmcnt(3)
  v_mfma_f32_16x16x32_bf16 v[64:67], a[168:171], v[76:79], v[64:67]
  v_mfma_f32_16x16x32_bf16 v[68:71], a[172:175], v[76:79], v[68:71]
  ds_read_b128 v[76:79], v24 offset:25600
  s_waitcnt lgkmcnt(3)
  v_mfma_f32_16x16x32_bf16 v[64:67], a[176:179], v[80:83], v[64:67]
  v_mfma_f32_16x16x32_bf16 v[68:71], a[180:183], v[80:83], v[68:71]
  ds_read_b128 v[80:83], v24 offset:26624
  s_waitcnt lgkmcnt(3)
  v_mfma_f32_16x16x32_bf16 v[64:67], a[184:187], v[84:87], v[64:67]
  v_mfma_f32_16x16x32_bf16 v[68:71], a[188:191], v[84:87], v[68:71]
  ds_read_b128 v[84:87], v24 offset:27648
  s_waitcnt lgkmcnt(3)
  v_mfma_f32_16x16x32_bf16 v[64:67], a[192:195], v[72:75], v[64:67]
  v_mfma_f32_16x16x32_bf16 v[68:71], a[196:199], v[72:75], v[68:71]
  ds_read_b128 v[72:75], v24 offset:28672
  s_waitcnt lgkmcnt(3)
  v_mfma_f32_16x16x32_bf16 v[64:67], a[200:203], v[76:79], v[64:67]
  v_mfma_f32_16x16x32_bf16 v[68:71], a[204:207], v[76:79], v[68:71]
  ds_read_b128 v[76:79], v24 offset:29696
  s_waitcnt lgkmcnt(3)
  v_mfma_f32_16x16x32_bf16 v[64:67], a[208:211], v[80:83], v[64:67]
  v_mfma_f32_16x16x32_bf16 v[68:71], a[212:215], v[80:83], v[68:71]
  ds_read_b128 v[80:83], v24 offset:30720
  s_waitcnt lgkmcnt(3)
  v_mfma_f32_16x16x32_bf16 v[64:67], a[216:219], v[84:87], v[64:67]
  v_mfma_f32_16x16x32_bf16 v[68:71], a[220:223], v[84:87], v[68:71]
  ds_read_b128 v[84:87], v24 offset:31744
  s_waitcnt lgkmcnt(3)
  v_mfma_f32_16x16x32_bf16 v[64:67], a[224:227], v[72:75], v[64:67]
  v_mfma_f32_16x16x32_bf16 v[68:71], a[228:231], v[72:75], v[68:71]
  s_waitcnt vmcnt(2)
  s_barrier
  ds_read_b128 v[72:75], v24 offset:32768
  s_waitcnt lgkmcnt(3)
  v_mfma_f32_16x16x32_bf16 v[64:67], a[232:235], v[76:79], v[64:67]
  v_mfma_f32_16x16x32_bf16 v[68:71], a[236:239], v[76:79], v[68:71]
  ds_read_b128 v[76:79], v24 offset:33792
  s_waitcnt lgkmcnt(3)
  v_mfma_f32_16x16x32_bf16 v[64:67], a[240:243], v[80:83], v[64:67]
  v_mfma_f32_16x16x32_bf16 v[68:71], a[244:247], v[80:83], v[68:71]
  ds_read_b128 v[80:83], v24 offset:34816
  s_waitcnt lgkmcnt(3)
  v_mfma_f32_16x16x32_bf16 v[64:67], a[248:251], v[84:87], v[64:67]
  v_mfma_f32_16x16x32_bf16 v[68:71], a[252:255], v[84:87], v[68:71]
  ds_read_b128 v[84:87], v24 offset:35840
  s_waitcnt lgkmcnt(3)
  v_mfma_f32_16x16x32_bf16 v[64:67], v[128:131], v[72:75], v[64:67]
  v_mfma_f32_16x16x32_bf16 v[68:71], v[132:135], v[72:75], v[68:71]
  ds_read_b128 v[72:75], v24 offset:36864
  s_waitcnt lgkmcnt(3)
  v_mfma_f32_16x16x32_bf16 v[64:67], v[136:139], v[76:79], v[64:67]
  v_mfma_f32_16x16x32_bf16 v[68:71], v[140:143], v[76:79], v[68:71]
  ds_read_b128 v[76:79], v24 offset:37888
  s_waitcnt lgkmcnt(3)
  v_mfma_f32_16x16x32_bf16 v[64:67], v[144:147], v[80:83], v[64:67]
  v_mfma_f32_16x16x32_bf16 v[68:71], v[148:151], v[80:83], v[68:71]
  ds_read_b128 v[80:83], v24 offset:38912
  s_waitcnt lgkmcnt(3)
  v_mfma_f32_16x16x32_bf16 v[64:67], v[152:155], v[84:87], v[64:67]
  v_mfma_f32_16x16x32_bf16 v[68:71], v[156:159], v[84:87], v[68:71]
  ds_read_b128 v[84:87], v24 offset:39936
  s_waitcnt lgkmcnt(3)
  v_mfma_f32_16x16x32_bf16 v[64:67], v[160:163], v[72:75], v[64:67]
  v_mfma_f32_16x16x32_bf16 v[68:71], v[164:167], v[72:75], v[68:71]
  ds_read_b128 v[72:75], v24 offset:40960
  s_waitcnt lgkmcnt(3)
  v_mfma_f32_16x16x32_bf16 v[64:67], v[168:171], v[76:79], v[64:67]
  v_mfma_f32_16x16x32_bf16 v[68:71], v[172:175], v[76:79], v[68:71]
  ds_read_b128 v[76:79], v24 offset:41984
  s_waitcnt lgkmcnt(3)
  v_mfma_f32_16x16x32_bf16 v[64:67], v[176:179], v[80:83], v[64:67]
  v_mfma_f32_16x16x32_bf16 v[68:71], v[180:183], v[80:83], v[68:71]
  ds_read_b128 v[80:83], v24 offset:43008
  s_waitcnt lgkmcnt(3)
  v_mfma_f32_16x16x32_bf16 v[64:67], v[184:187], v[84:87], v[64:67]
  v_mfma_f32_16x16x32_bf16 v[68:71], v[188:191], v[84:87], v[68:71]
  ds_read_b128 v[84:87], v24 offset:44032
  s_waitcnt lgkmcnt(3)
  v_mfma_f32_16x16x32_bf16 v[64:67], v[192:195], v[72:75], v[64:67]
  v_mfma_f32_16x16x32_bf16 v[68:71], v[196:199], v[72:75], v[68:71]
  ds_read_b128 v[72:75], v24 offset:45056
  s_waitcnt lgkmcnt(3)
  v_mfma_f32_16x16x32_bf16 v[64:67], v[200:203], v[76:79], v[64:67]
  v_mfma_f32_16x16x32_bf16 v[68:71], v[204:207], v[76:79], v[68:71]
  ds_read_b128 v[76:79], v24 offset:46080
  s_waitcnt lgkmcnt(3)
  v_mfma_f32_16x16x32_bf16 v[64:67], v[208:211], v[80:83], v[64:67]
  v_mfma_f32_16x16x32_bf16 v[68:71], v[212:215], v[80:83], v[68:71]
  ds_read_b128 v[80:83], v24 offset:47104
  s_waitcnt lgkmcnt(3)
  v_mfma_f32_16x16x32_bf16 v[64:67], v[216:219], v[84:87], v[64:67]
  v_mfma_f32_16x16x32_bf16 v[68:71], v[220:223], v[84:87], v[68:71]
  ds_read_b128 v[84:87], v24 offset:48128
  s_waitcnt lgkmcnt(3)
  v_mfma_f32_16x16x32_bf16 v[64:67], v[224:227], v[72:75], v[64:67]
  v_mfma_f32_16x16x32_bf16 v[68:71], v[228:231], v[72:75], v[68:71]
  s_waitcnt lgkmcnt(2)
  v_mfma_f32_16x16x32_bf16 v[64:67], v[232:235], v[76:79], v[64:67]
  v_mfma_f32_16x16x32_bf16 v[68:71], v[236:239], v[76:79], v[68:71]
  s_waitcnt lgkmcnt(1)
  v_mfma_f32_16x16x32_bf16 v[64:67], v[240:243], v[80:83], v[64:67]
  v_mfma_f32_16x16x32_bf16 v[68:71], v[244:247], v[80:83], v[68:71]
  s_waitcnt lgkmcnt(0)
  v_mfma_f32_16x16x32_bf16 v[64:67], v[248:251], v[84:87], v[64:67]
  v_mfma_f32_16x16x32_bf16 v[68:71], v[252:255], v[84:87], v[68:71]
  s_waitcnt vmcnt(1)
L_E_ep:
  s_mov_b64 exec, 1
  v_mov_b32 v29, s31
  v_mov_b32 v30, 0
  buffer_store_dword v29, v30, s[8:11], s35 offen sc1
  s_mov_b64 exec, -1
  s_mul_i32 s4, s54, 20480
  s_add_u32 s4, s4, s38
  v_lshlrev_b32 v92, 16, v88
  v_and_b32 v93, 0xffff0000, v88
  v_add_f32 v64, v64, v92
  v_add_f32 v65, v65, v93
  v_lshlrev_b32 v92, 16, v89
  v_and_b32 v93, 0xffff0000, v89
  v_add_f32 v66, v66, v92
  v_add_f32 v67, v67, v93
  v_lshlrev_b32 v92, 16, v90
  v_and_b32 v93, 0xffff0000, v90
  v_add_f32 v68, v68, v92
  v_add_f32 v69, v69, v93
  v_lshlrev_b32 v92, 16, v91
  v_and_b32 v93, 0xffff0000, v91
  v_add_f32 v70, v70, v92
  v_add_f32 v71, v71, v93
  v_cvt_pk_bf16_f32 v96, v64, v65
  v_cvt_pk_bf16_f32 v97, v66, v67
  v_cvt_pk_bf16_f32 v98, v68, v69
  v_cvt_pk_bf16_f32 v99, v70, v71
  s_nop 0
  v_permlane16_swap_b32 v96, v98
  v_permlane16_swap_b32 v97, v99
  buffer_store_dwordx4 v[96:99], v25, s[20:23], s4 offen
  s_add_u32 s31, s31, 1
  s_mov_b32 s34, s31
  s_cmp_lt_u32 s31, s52
  s_cbranch_scc1 L_E_top
  s_waitcnt vmcnt(0)
  s_cmp_eq_u32 s34, 0
  s_cbranch_scc1 L_E_npc
  s_mov_b64 exec, 1
  v_mov_b32 v29, s34
  v_mov_b32 v30, 0
  buffer_store_dword v29, v30, s[8:11], s35 offen sc1
  s_mov_b64 exec, -1
  s_mov_b32 s34, 0
L_E_npc:
  s_waitcnt vmcnt(0)
  s_branch L_exit
L_roleR:
  s_sub_u32 s55, s30, 125
  s_mov_b32 s53, 0
L_R_par:
  s_mov_b32 s36, s55
  s_lshl_b32 s4, s36, 7
  s_lshl_b32 s5, s24, 2
  s_add_u32 s4, s4, s5
  s_mul_i32 s5, s53, 384
  s_add_u32 s4, s4, s5
  s_add_u32 s35, s4, 90112
  s_and_b32 s37, s24, 1
  s_mov_b32 s52, 52
  s_cmp_eq_u32 s53, 1
  s_cmov_b32 s52, 12
  s_cmp_eq_u32 s53, 1
  s_cbranch_scc1 L_R_second
  s_mov_b64 exec, 1
  v_mov_b32 v28, 0
  v_mov_b32 v29, 0
  buffer_store_dword v28, v29, s[8:11], s35 offen sc1
  s_mov_b64 exec, -1
  s_load_dwordx2 s[20:21], s[0:1], 0
  s_waitcnt lgkmcnt(0)
  s_and_b32 s21, s21, 0xffff
  s_mov_b32 s22, 2621440
  s_mov_b32 s23, 0x20000
  s_lshl_b32 s4, s30, 4
  s_mul_i32 s4, s4, 1280
  s_mul_i32 s5, s24, 320
  s_add_u32 s4, s4, s5
  v_mul_u32_u24 v28, 1280, v22
  v_lshlrev_b32 v29, 4, v21
  v_add_u32 v28, v28, v29
  buffer_load_dwordx4 v[40:43], v28, s[20:23], s4 offen offset:0
  buffer_load_dwordx4 v[44:47], v28, s[20:23], s4 offen offset:64
  buffer_load_dwordx4 v[48:51], v28, s[20:23], s4 offen offset:128
  buffer_load_dwordx4 v[52:55], v28, s[20:23], s4 offen offset:192
  buffer_load_dwordx4 v[56:59], v28, s[20:23], s4 offen offset:256
  s_waitcnt vmcnt(0)
  v_lshlrev_b32 v64, 16, v40
  v_and_b32 v65, 0xffff0000, v40
  v_lshlrev_b32 v66, 16, v41
  v_and_b32 v67, 0xffff0000, v41
  v_lshlrev_b32 v68, 16, v42
  v_and_b32 v69, 0xffff0000, v42
  v_lshlrev_b32 v70, 16, v43
  v_and_b32 v71, 0xffff0000, v43
  v_lshlrev_b32 v72, 16, v44
  v_and_b32 v73, 0xffff0000, v44
  v_lshlrev_b32 v74, 16, v45
  v_and_b32 v75, 0xffff0000, v45
  v_lshlrev_b32 v76, 16, v46
  v_and_b32 v77, 0xffff0000, v46
  v_lshlrev_b32 v78, 16, v47
  v_and_b32 v79, 0xffff0000, v47
  v_lshlrev_b32 v80, 16, v48
  v_and_b32 v81, 0xffff0000, v48
  v_lshlrev_b32 v82, 16, v49
  v_and_b32 v83, 0xffff0000, v49
  v_lshlrev_b32 v84, 16, v50
  v_and_b32 v85, 0xffff0000, v50
  v_lshlrev_b32 v86, 16, v51
  v_and_b32 v87, 0xffff0000, v51
  v_lshlrev_b32 v88, 16, v52
  v_and_b32 v89, 0xffff0000, v52
  v_lshlrev_b32 v90, 16, v53
  v_and_b32 v91, 0xffff0000, v53
  v_lshlrev_b32 v92, 16, v54
  v_and_b32 v93, 0xffff0000, v54
  v_lshlrev_b32 v94, 16, v55
  v_and_b32 v95, 0xffff0000, v55
  v_lshlrev_b32 v96, 16, v56
  v_and_b32 v97, 0xffff0000, v56
  v_lshlrev_b32 v98, 16, v57
  v_and_b32 v99, 0xffff0000, v57
  v_lshlrev_b32 v100, 16, v58
  v_and_b32 v101, 0xffff0000, v58
  v_lshlrev_b32 v102, 16, v59
  v_and_b32 v103, 0xffff0000, v59
  s_mov_b32 s47, 131072
  v_pk_add_f32 v[104:105], v[64:65], v[66:67]
  v_pk_mul_f32 v[106:107], v[64:65], v[64:65]
  v_pk_fma_f32 v[106:107], v[66:67], v[66:67], v[106:107]
  v_pk_add_f32 v[104:105], v[104:105], v[68:69]
  v_pk_fma_f32 v[106:107], v[68:69], v[68:69], v[106:107]
  v_pk_add_f32 v[104:105], v[104:105], v[70:71]
  v_pk_fma_f32 v[106:107], v[70:71], v[70:71], v[106:107]
  v_pk_add_f32 v[104:105], v[104:105], v[72:73]
  v_pk_fma_f32 v[106:107], v[72:73], v[72:73], v[106:107]
  v_pk_add_f32 v[104:105], v[104:105], v[74:75]
  v_pk_fma_f32 v[106:107], v[74:75], v[74:75], v[106:107]
  v_pk_add_f32 v[104:105], v[104:105], v[76:77]
  v_pk_fma_f32 v[106:107], v[76:77], v[76:77], v[106:107]
  v_pk_add_f32 v[104:105], v[104:105], v[78:79]
  v_pk_fma_f32 v[106:107], v[78:79], v[78:79], v[106:107]
  v_pk_add_f32 v[104:105], v[104:105], v[80:81]
  v_pk_fma_f32 v[106:107], v[80:81], v[80:81], v[106:107]
  v_pk_add_f32 v[104:105], v[104:105], v[82:83]
  v_pk_fma_f32 v[106:107], v[82:83], v[82:83], v[106:107]
  v_pk_add_f32 v[104:105], v[104:105], v[84:85]
  v_pk_fma_f32 v[106:107], v[84:85], v[84:85], v[106:107]
  v_pk_add_f32 v[104:105], v[104:105], v[86:87]
  v_pk_fma_f32 v[106:107], v[86:87], v[86:87], v[106:107]
  v_pk_add_f32 v[104:105], v[104:105], v[88:89]
  v_pk_fma_f32 v[106:107], v[88:89], v[88:89], v[106:107]
  v_pk_add_f32 v[104:105], v[104:105], v[90:91]
  v_pk_fma_f32 v[106:107], v[90:91], v[90:91], v[106:107]
  v_pk_add_f32 v[104:105], v[104:105], v[92:93]
  v_pk_fma_f32 v[106:107], v[92:93], v[92:93], v[106:107]
  v_pk_add_f32 v[104:105], v[104:105], v[94:95]
  v_pk_fma_f32 v[106:107], v[94:95], v[94:95], v[106:107]
  v_pk_add_f32 v[104:105], v[104:105], v[96:97]
  v_pk_fma_f32 v[106:107], v[96:97], v[96:97], v[106:107]
  v_pk_add_f32 v[104:105], v[104:105], v[98:99]
  v_pk_fma_f32 v[106:107], v[98:99], v[98:99], v[106:107]
  v_pk_add_f32 v[104:105], v[104:105], v[100:101]
  v_pk_fma_f32 v[106:107], v[100:101], v[100:101], v[106:107]
  v_pk_add_f32 v[104:105], v[104:105], v[102:103]
  v_pk_fma_f32 v[106:107], v[102:103], v[102:103], v[106:107]
  v_add_f32 v104, v104, v105
  v_add_f32 v105, v106, v107
  v_mov_b32 v108, v104
  v_mov_b32 v109, v105
  s_nop 0
  v_permlane16_swap_b32 v104, v108
  v_permlane16_swap_b32 v105, v109
  v_pk_add_f32 v[104:105], v[104:105], v[108:109]
  v_mov_b32 v108, v104
  v_mov_b32 v109, v105
  s_nop 0
  v_permlane32_swap_b32 v104, v108
  v_permlane32_swap_b32 v105, v109
  v_pk_add_f32 v[104:105], v[104:105], v[108:109]
  v_lshlrev_b32 v108, 3, v22
  v_add_u32 v108, s47, v108
  s_lshl_b32 s4, s24, 7
  v_add_u32 v109, s4, v108
  ds_write_b64 v109, v[104:105]
  s_waitcnt lgkmcnt(0)
  s_barrier
  ds_read_b64 v[104:105], v108
  ds_read_b64 v[106:107], v108 offset:128
  ds_read_b64 v[110:111], v108 offset:256
  ds_read_b64 v[112:113], v108 offset:384
  s_waitcnt lgkmcnt(2)
  v_pk_add_f32 v[104:105], v[104:105], v[106:107]
  s_waitcnt lgkmcnt(0)
  v_pk_add_f32 v[106:107], v[110:111], v[112:113]
  v_pk_add_f32 v[104:105], v[104:105], v[106:107]
  v_mul_f32 v104, 986500301, v104
  v_mul_f32 v106, v104, v104
  v_mov_b32 v107, 925353388
  v_fmac_f32 v107, 986500301, v105
  v_sub_f32 v107, v107, v106
  v_max_f32 v107, 925353388, v107
  v_rsq_f32 v106, v107
  s_nop 0
  v_mul_f32 v104, v104, v106
  v_pk_fma_f32 v[64:65], v[64:65], v[106:107], v[104:105] op_sel_hi:[1,0,0] neg_lo:[0,0,1] neg_hi:[0,0,1]
  v_pk_fma_f32 v[66:67], v[66:67], v[106:107], v[104:105] op_sel_hi:[1,0,0] neg_lo:[0,0,1] neg_hi:[0,0,1]
  v_pk_fma_f32 v[68:69], v[68:69], v[106:107], v[104:105] op_sel_hi:[1,0,0] neg_lo:[0,0,1] neg_hi:[0,0,1]
  v_pk_fma_f32 v[70:71], v[70:71], v[106:107], v[104:105] op_sel_hi:[1,0,0] neg_lo:[0,0,1] neg_hi:[0,0,1]
  v_pk_fma_f32 v[72:73], v[72:73], v[106:107], v[104:105] op_sel_hi:[1,0,0] neg_lo:[0,0,1] neg_hi:[0,0,1]
  v_pk_fma_f32 v[74:75], v[74:75], v[106:107], v[104:105] op_sel_hi:[1,0,0] neg_lo:[0,0,1] neg_hi:[0,0,1]
  v_pk_fma_f32 v[76:77], v[76:77], v[106:107], v[104:105] op_sel_hi:[1,0,0] neg_lo:[0,0,1] neg_hi:[0,0,1]
  v_pk_fma_f32 v[78:79], v[78:79], v[106:107], v[104:105] op_sel_hi:[1,0,0] neg_lo:[0,0,1] neg_hi:[0,0,1]
  v_pk_fma_f32 v[80:81], v[80:81], v[106:107], v[104:105] op_sel_hi:[1,0,0] neg_lo:[0,0,1] neg_hi:[0,0,1]
  v_pk_fma_f32 v[82:83], v[82:83], v[106:107], v[104:105] op_sel_hi:[1,0,0] neg_lo:[0,0,1] neg_hi:[0,0,1]
  v_pk_fma_f32 v[84:85], v[84:85], v[106:107], v[104:105] op_sel_hi:[1,0,0] neg_lo:[0,0,1] neg_hi:[0,0,1]
  v_pk_fma_f32 v[86:87], v[86:87], v[106:107], v[104:105] op_sel_hi:[1,0,0] neg_lo:[0,0,1] neg_hi:[0,0,1]
  v_pk_fma_f32 v[88:89], v[88:89], v[106:107], v[104:105] op_sel_hi:[1,0,0] neg_lo:[0,0,1] neg_hi:[0,0,1]
  v_pk_fma_f32 v[90:91], v[90:91], v[106:107], v[104:105] op_sel_hi:[1,0,0] neg_lo:[0,0,1] neg_hi:[0,0,1]
  v_pk_fma_f32 v[92:93], v[92:93], v[106:107], v[104:105] op_sel_hi:[1,0,0] neg_lo:[0,0,1] neg_hi:[0,0,1]
  v_pk_fma_f32 v[94:95], v[94:95], v[106:107], v[104:105] op_sel_hi:[1,0,0] neg_lo:[0,0,1] neg_hi:[0,0,1]
  v_pk_fma_f32 v[96:97], v[96:97], v[106:107], v[104:105] op_sel_hi:[1,0,0] neg_lo:[0,0,1] neg_hi:[0,0,1]
  v_pk_fma_f32 v[98:99], v[98:99], v[106:107], v[104:105] op_sel_hi:[1,0,0] neg_lo:[0,0,1] neg_hi:[0,0,1]
  v_pk_fma_f32 v[100:101], v[100:101], v[106:107], v[104:105] op_sel_hi:[1,0,0] neg_lo:[0,0,1] neg_hi:[0,0,1]
  v_pk_fma_f32 v[102:103], v[102:103], v[106:107], v[104:105] op_sel_hi:[1,0,0] neg_lo:[0,0,1] neg_hi:[0,0,1]
  v_cvt_pk_bf16_f32 v40, v64, v65
  v_cvt_pk_bf16_f32 v41, v66, v67
  v_cvt_pk_bf16_f32 v42, v68, v69
  v_cvt_pk_bf16_f32 v43, v70, v71
  v_cvt_pk_bf16_f32 v44, v72, v73
  v_cvt_pk_bf16_f32 v45, v74, v75
  v_cvt_pk_bf16_f32 v46, v76, v77
  v_cvt_pk_bf16_f32 v47, v78, v79
  v_cvt_pk_bf16_f32 v48, v80, v81
  v_cvt_pk_bf16_f32 v49, v82, v83
  v_cvt_pk_bf16_f32 v50, v84, v85
  v_cvt_pk_bf16_f32 v51, v86, v87
  v_cvt_pk_bf16_f32 v52, v88, v89
  v_cvt_pk_bf16_f32 v53, v90, v91
  v_cvt_pk_bf16_f32 v54, v92, v93
  v_cvt_pk_bf16_f32 v55, v94, v95
  v_cvt_pk_bf16_f32 v56, v96, v97
  v_cvt_pk_bf16_f32 v57, v98, v99
  v_cvt_pk_bf16_f32 v58, v100, v101
  v_cvt_pk_bf16_f32 v59, v102, v103
  s_lshr_b32 s4, s30, 1
  s_mul_i32 s4, s4, 40960
  s_and_b32 s5, s30, 1
  s_lshl_b32 s5, s5, 10
  s_add_u32 s4, s4, s5
  s_mul_i32 s5, s24, 10240
  s_add_u32 s4, s4, s5
  s_add_u32 s4, s4, 5656576
  s_add_u32 s5, s4, 0
  buffer_store_dwordx4 v[40:43], v20, s[8:11], s5 offen sc1
  s_add_u32 s5, s4, 2048
  buffer_store_dwordx4 v[44:47], v20, s[8:11], s5 offen sc1
  s_add_u32 s5, s4, 4096
  buffer_store_dwordx4 v[48:51], v20, s[8:11], s5 offen sc1
  s_add_u32 s5, s4, 6144
  buffer_store_dwordx4 v[52:55], v20, s[8:11], s5 offen sc1
  s_add_u32 s5, s4, 8192
  buffer_store_dwordx4 v[56:59], v20, s[8:11], s5 offen sc1
  s_waitcnt vmcnt(0)
  s_barrier
  s_cmp_eq_u32 s24, 0
  s_cbranch_scc0 L_ia_R
  s_mov_b64 exec, 1
  v_mov_b32 v1, 36
  v_mov_b32 v2, 1
  buffer_atomic_add v2, v1, s[12:15], 0 offen
  s_mov_b64 exec, -1
L_ia_R:
  s_cmp_eq_u32 s36, 0
  s_cbranch_scc0 L_R_nocal
  s_cmp_eq_u32 s24, 0
  s_cbranch_scc0 L_R_nocal
  s_add_u32 s60, s8, 1298432
  s_sub_u32 s60, 0, s60
  s_and_b32 s60, s60, 0x1fffff
  s_add_u32 s60, s60, 1298432
  s_mov_b64 exec, 1
  v_mov_b32 v19, 0
  s_add_u32 s4, s60, 0x1c0000
  buffer_load_dword v18, v19, s[8:11], s4 offen sc1
  s_waitcnt vmcnt(0)
  s_mov_b32 s6, -1
  s_mov_b32 s7, -1
  s_add_u32 s4, s60, 1572864
  buffer_store_dword v19, v19, s[8:11], s4 offen sc1
  s_add_u32 s4, s60, 1581056
  buffer_store_dword v19, v19, s[8:11], s4 offen sc1
  s_add_u32 s4, s60, 1573376
  buffer_store_dword v19, v19, s[8:11], s4 offen sc1
  s_add_u32 s4, s60, 1581568
  buffer_store_dword v19, v19, s[8:11], s4 offen sc1
  s_add_u32 s4, s60, 1573888
  buffer_store_dword v19, v19, s[8:11], s4 offen sc1
  s_add_u32 s4, s60, 1582080
  buffer_store_dword v19, v19, s[8:11], s4 offen sc1
  s_add_u32 s4, s60, 1574400
  buffer_store_dword v19, v19, s[8:11], s4 offen sc1
  s_add_u32 s4, s60, 1582592
  buffer_store_dword v19, v19, s[8:11], s4 offen sc1
  s_add_u32 s4, s60, 1574912
  buffer_store_dword v19, v19, s[8:11], s4 offen sc1
  s_add_u32 s4, s60, 1583104
  buffer_store_dword v19, v19, s[8:11], s4 offen sc1
  s_add_u32 s4, s60, 1575424
  buffer_store_dword v19, v19, s[8:11], s4 offen sc1
  s_add_u32 s4, s60, 1583616
  buffer_store_dword v19, v19, s[8:11], s4 offen sc1
  s_add_u32 s4, s60, 1575936
  buffer_store_dword v19, v19, s[8:11], s4 offen sc1
  s_add_u32 s4, s60, 1584128
  buffer_store_dword v19, v19, s[8:11], s4 offen sc1
  s_add_u32 s4, s60, 1576448
  buffer_store_dword v19, v19, s[8:11], s4 offen sc1
  s_add_u32 s4, s60, 1584640
  buffer_store_dword v19, v19, s[8:11], s4 offen sc1
  s_waitcnt vmcnt(0)
  s_add_u32 s4, s60, 1572864
  s_memtime s[64:65]
  s_waitcnt lgkmcnt(0)
  buffer_load_dword v18, v19, s[8:11], s4 offen sc1
  s_waitcnt vmcnt(0)
  s_memtime s[66:67]
  s_waitcnt lgkmcnt(0)
  s_sub_u32 s5, s66, s64
  s_min_u32 s6, s6, s5
  s_add_u32 s4, s60, 1581056
  s_memtime s[64:65]
  s_waitcnt lgkmcnt(0)
  buffer_load_dword v18, v19, s[8:11], s4 offen sc1
  s_waitcnt vmcnt(0)
  s_memtime s[66:67]
  s_waitcnt lgkmcnt(0)
  s_sub_u32 s5, s66, s64
  s_min_u32 s7, s7, s5
  s_add_u32 s4, s60, 1573376
  s_memtime s[64:65]
  s_waitcnt lgkmcnt(0)
  buffer_load_dword v18, v19, s[8:11], s4 offen sc1
  s_waitcnt vmcnt(0)
  s_memtime s[66:67]
  s_waitcnt lgkmcnt(0)
  s_sub_u32 s5, s66, s64
  s_min_u32 s6, s6, s5
  s_add_u32 s4, s60, 1581568
  s_memtime s[64:65]
  s_waitcnt lgkmcnt(0)
  buffer_load_dword v18, v19, s[8:11], s4 offen sc1
  s_waitcnt vmcnt(0)
  s_memtime s[66:67]
  s_waitcnt lgkmcnt(0)
  s_sub_u32 s5, s66, s64
  s_min_u32 s7, s7, s5
  s_add_u32 s4, s60, 1573888
  s_memtime s[64:65]
  s_waitcnt lgkmcnt(0)
  buffer_load_dword v18, v19, s[8:11], s4 offen sc1
  s_waitcnt vmcnt(0)
  s_memtime s[66:67]
  s_waitcnt lgkmcnt(0)
  s_sub_u32 s5, s66, s64
  s_min_u32 s6, s6, s5
  s_add_u32 s4, s60, 1582080
  s_memtime s[64:65]
  s_waitcnt lgkmcnt(0)
  buffer_load_dword v18, v19, s[8:11], s4 offen sc1
  s_waitcnt vmcnt(0)
  s_memtime s[66:67]
  s_waitcnt lgkmcnt(0)
  s_sub_u32 s5, s66, s64
  s_min_u32 s7, s7, s5
  s_add_u32 s4, s60, 1574400
  s_memtime s[64:65]
  s_waitcnt lgkmcnt(0)
  buffer_load_dword v18, v19, s[8:11], s4 offen sc1
  s_waitcnt vmcnt(0)
  s_memtime s[66:67]
  s_waitcnt lgkmcnt(0)
  s_sub_u32 s5, s66, s64
  s_min_u32 s6, s6, s5
  s_add_u32 s4, s60, 1582592
  s_memtime s[64:65]
  s_waitcnt lgkmcnt(0)
  buffer_load_dword v18, v19, s[8:11], s4 offen sc1
  s_waitcnt vmcnt(0)
  s_memtime s[66:67]
  s_waitcnt lgkmcnt(0)
  s_sub_u32 s5, s66, s64
  s_min_u32 s7, s7, s5
  s_add_u32 s4, s60, 1574912
  s_memtime s[64:65]
  s_waitcnt lgkmcnt(0)
  buffer_load_dword v18, v19, s[8:11], s4 offen sc1
  s_waitcnt vmcnt(0)
  s_memtime s[66:67]
  s_waitcnt lgkmcnt(0)
  s_sub_u32 s5, s66, s64
  s_min_u32 s6, s6, s5
  s_add_u32 s4, s60, 1583104
  s_memtime s[64:65]
  s_waitcnt lgkmcnt(0)
  buffer_load_dword v18, v19, s[8:11], s4 offen sc1
  s_waitcnt vmcnt(0)
  s_memtime s[66:67]
  s_waitcnt lgkmcnt(0)
  s_sub_u32 s5, s66, s64
  s_min_u32 s7, s7, s5
  s_add_u32 s4, s60, 1575424
  s_memtime s[64:65]
  s_waitcnt lgkmcnt(0)
  buffer_load_dword v18, v19, s[8:11], s4 offen sc1
  s_waitcnt vmcnt(0)
  s_memtime s[66:67]
  s_waitcnt lgkmcnt(0)
  s_sub_u32 s5, s66, s64
  s_min_u32 s6, s6, s5
  s_add_u32 s4, s60, 1583616
  s_memtime s[64:65]
  s_waitcnt lgkmcnt(0)
  buffer_load_dword v18, v19, s[8:11], s4 offen sc1
  s_waitcnt vmcnt(0)
  s_memtime s[66:67]
  s_waitcnt lgkmcnt(0)
  s_sub_u32 s5, s66, s64
  s_min_u32 s7, s7, s5
  s_add_u32 s4, s60, 1575936
  s_memtime s[64:65]
  s_waitcnt lgkmcnt(0)
  buffer_load_dword v18, v19, s[8:11], s4 offen sc1
  s_waitcnt vmcnt(0)
  s_memtime s[66:67]
  s_waitcnt lgkmcnt(0)
  s_sub_u32 s5, s66, s64
  s_min_u32 s6, s6, s5
  s_add_u32 s4, s60, 1584128
  s_memtime s[64:65]
  s_waitcnt lgkmcnt(0)
  buffer_load_dword v18, v19, s[8:11], s4 offen sc1
  s_waitcnt vmcnt(0)
  s_memtime s[66:67]
  s_waitcnt lgkmcnt(0)
  s_sub_u32 s5, s66, s64
  s_min_u32 s7, s7, s5
  s_add_u32 s4, s60, 1576448
  s_memtime s[64:65]
  s_waitcnt lgkmcnt(0)
  buffer_load_dword v18, v19, s[8:11], s4 offen sc1
  s_waitcnt vmcnt(0)
  s_memtime s[66:67]
  s_waitcnt lgkmcnt(0)
  s_sub_u32 s5, s66, s64
  s_min_u32 s6, s6, s5
  s_add_u32 s4, s60, 1584640
  s_memtime s[64:65]
  s_waitcnt lgkmcnt(0)
  buffer_load_dword v18, v19, s[8:11], s4 offen sc1
  s_waitcnt vmcnt(0)
  s_memtime s[66:67]
  s_waitcnt lgkmcnt(0)
  s_sub_u32 s5, s66, s64
  s_min_u32 s7, s7, s5
  s_cmp_lt_u32 s7, s6
  s_cselect_b32 s4, 1, 2
  v_mov_b32 v18, s4
  v_mov_b32 v19, 44
  buffer_store_dword v18, v19, s[12:15], 0 offen sc1
  s_mov_b64 exec, -1
L_R_nocal:
L_R_second:
  s_load_dwordx2 s[16:17], s[0:1], 0
  s_waitcnt lgkmcnt(0)
  s_and_b32 s17, s17, 0xffff
  s_mov_b32 s18, 2621440
  s_mov_b32 s19, 0x20000
  v_min_u32 v28, 39, v0
  v_mul_u32_u24 v29, 26, v28
  v_lshrrev_b32 v29, 8, v29
  v_mul_u32_u24 v30, 10, v29
  v_add_u32 v28, v28, v30
  s_mul_i32 s4, s37, 10
  v_add_u32 v28, s4, v28
  v_lshrrev_b32 v29, 2, v28
  v_lshlrev_b32 v29, 7, v29
  v_and_b32 v28, 3, v28
  v_lshlrev_b32 v28, 2, v28
  v_add_u32 v28, v28, v29
  v_add_u32 v23, 77824, v28
  s_mul_i32 s4, s53, 2560
  v_add_u32 v23, s4, v23
  v_mul_u32_u24 v25, 1280, v22
  v_lshlrev_b32 v28, 3, v21
  v_add_u32 v25, v25, v28
  v_lshlrev_b32 v28, 2, v21
  v_sub_u32 v28, v22, v28
  v_mov_b32 v29, 0x3f80
  v_mov_b32 v30, 0x3f800000
  v_mov_b32 v31, 0
  v_cmp_eq_u32 vcc, 0, v28
  s_nop 1
  v_cndmask_b32 v120, v31, v29, vcc
  v_cmp_eq_u32 vcc, 1, v28
  s_nop 1
  v_cndmask_b32 v120, v120, v30, vcc
  v_cmp_eq_u32 vcc, 2, v28
  s_nop 1
  v_cndmask_b32 v121, v31, v29, vcc
  v_cmp_eq_u32 vcc, 3, v28
  s_nop 1
  v_cndmask_b32 v121, v121, v30, vcc
  v_mov_b32 v122, 0
  v_mov_b32 v123, 0
  v_mov_b32 v124, 0
  v_mov_b32 v125, 0
  v_mov_b32 v126, v120
  v_mov_b32 v127, v121
  s_cmp_eq_u32 s24, 0
  s_cbranch_scc0 L_wd_iwR
  s_mov_b32 s28, 131072
  s_mov_b32 s29, 2
  v_mov_b32 v18, 36
L_wn_iwR:
  buffer_load_dword v19, v18, s[12:15], 0 offen sc1
  s_waitcnt vmcnt(0)
  v_readfirstlane_b32 s3, v19
  s_sub_u32 s28, s28, 1
  s_cbranch_scc1 L_abort
  s_cmp_ge_u32 s3, 256
  s_cbranch_scc1 L_wd_iwR
  s_sleep 8
  s_branch L_wn_iwR
L_wd_iwR:
  s_barrier
  s_mov_b32 s31, s36
  s_mov_b32 s34, 0
  s_mov_b32 s45, 0
L_R_top:
  s_mov_b32 s28, 131072
  s_mov_b32 s29, 80
  s_lshl_b32 s41, s31, 1
  s_lshr_b32 s4, s24, 1
  s_add_u32 s41, s41, s4
  s_add_u32 s41, s41, 1
  s_lshl_b32 s56, s31, 1
  s_sub_u32 s54, s56, 40
  s_cmp_lt_u32 s31, 40
  s_cselect_b32 s54, s31, s54
  s_add_u32 s56, s56, 41
  s_cmp_eq_u32 s53, 1
  s_cselect_b32 s54, s56, s54
  s_lshl_b32 s44, s54, 1
  s_lshr_b32 s4, s24, 1
  s_add_u32 s44, s44, s4
L_R_p:
  buffer_load_dword v28, v23, s[8:11], 0 offen sc1
  s_sub_u32 s28, s28, 1
  s_cbranch_scc1 L_abort
  s_waitcnt vmcnt(0)
  s_cmp_eq_u32 s34, 0
  s_cbranch_scc1 L_R_np
  s_mov_b64 exec, 1
  v_mov_b32 v29, s34
  v_mov_b32 v30, 0
  buffer_store_dword v29, v30, s[8:11], s35 offen sc1
  s_mov_b64 exec, -1
  s_mov_b32 s34, 0
L_R_np:
  v_cmp_gt_u32 vcc, s41, v28
  s_cbranch_vccnz L_R_p
  s_mul_i32 s4, s44, 81920
  s_mul_i32 s5, s37, 10240
  s_add_u32 s4, s4, s5
  s_add_u32 s4, s4, 134107136
  s_add_u32 s6, s4, 0
  buffer_load_dwordx4 a[0:3], v20, s[8:11], s6 offen sc1
  s_add_u32 s6, s4, 20480
  buffer_load_dwordx4 a[4:7], v20, s[8:11], s6 offen sc1
  s_add_u32 s6, s4, 40960
  buffer_load_dwordx4 a[8:11], v20, s[8:11], s6 offen sc1
  s_add_u32 s6, s4, 61440
  buffer_load_dwordx4 a[12:15], v20, s[8:11], s6 offen sc1
  s_add_u32 s6, s4, 1024
  buffer_load_dwordx4 a[16:19], v20, s[8:11], s6 offen sc1
  s_add_u32 s6, s4, 21504
  buffer_load_dwordx4 a[20:23], v20, s[8:11], s6 offen sc1
  s_add_u32 s6, s4, 41984
  buffer_load_dwordx4 a[24:27], v20, s[8:11], s6 offen sc1
  s_add_u32 s6, s4, 62464
  buffer_load_dwordx4 a[28:31], v20, s[8:11], s6 offen sc1
  s_add_u32 s6, s4, 2048
  buffer_load_dwordx4 a[32:35], v20, s[8:11], s6 offen sc1
  s_add_u32 s6, s4, 22528
  buffer_load_dwordx4 a[36:39], v20, s[8:11], s6 offen sc1
  s_add_u32 s6, s4, 43008
  buffer_load_dwordx4 a[40:43], v20, s[8:11], s6 offen sc1
  s_add_u32 s6, s4, 63488
  buffer_load_dwordx4 a[44:47], v20, s[8:11], s6 offen sc1
  s_add_u32 s6, s4, 3072
  buffer_load_dwordx4 a[48:51], v20, s[8:11], s6 offen sc1
  s_add_u32 s6, s4, 23552
  buffer_load_dwordx4 a[52:55], v20, s[8:11], s6 offen sc1
  s_add_u32 s6, s4, 44032
  buffer_load_dwordx4 a[56:59], v20, s[8:11], s6 offen sc1
  s_add_u32 s6, s4, 64512
  buffer_load_dwordx4 a[60:63], v20, s[8:11], s6 offen sc1
  s_add_u32 s6, s4, 4096
  buffer_load_dwordx4 a[64:67], v20, s[8:11], s6 offen sc1
  s_add_u32 s6, s4, 24576
  buffer_load_dwordx4 a[68:71], v20, s[8:11], s6 offen sc1
  s_add_u32 s6, s4, 45056
  buffer_load_dwordx4 a[72:75], v20, s[8:11], s6 offen sc1
  s_add_u32 s6, s4, 65536
  buffer_load_dwordx4 a[76:79], v20, s[8:11], s6 offen sc1
  s_add_u32 s6, s4, 5120
  buffer_load_dwordx4 a[80:83], v20, s[8:11], s6 offen sc1
  s_add_u32 s6, s4, 25600
  buffer_load_dwordx4 a[84:87], v20, s[8:11], s6 offen sc1
  s_add_u32 s6, s4, 46080
  buffer_load_dwordx4 a[88:91], v20, s[8:11], s6 offen sc1
  s_add_u32 s6, s4, 66560
  buffer_load_dwordx4 a[92:95], v20, s[8:11], s6 offen sc1
  s_add_u32 s6, s4, 6144
  buffer_load_dwordx4 a[96:99], v20, s[8:11], s6 offen sc1
  s_add_u32 s6, s4, 26624
  buffer_load_dwordx4 a[100:103], v20, s[8:11], s6 offen sc1
  s_add_u32 s6, s4, 47104
  buffer_load_dwordx4 a[104:107], v20, s[8:11], s6 offen sc1
  s_add_u32 s6, s4, 67584
  buffer_load_dwordx4 a[108:111], v20, s[8:11], s6 offen sc1
  s_add_u32 s6, s4, 7168
  buffer_load_dwordx4 a[112:115], v20, s[8:11], s6 offen sc1
  s_add_u32 s6, s4, 27648
  buffer_load_dwordx4 a[116:119], v20, s[8:11], s6 offen sc1
  s_add_u32 s6, s4, 48128
  buffer_load_dwordx4 a[120:123], v20, s[8:11], s6 offen sc1
  s_add_u32 s6, s4, 68608
  buffer_load_dwordx4 a[124:127], v20, s[8:11], s6 offen sc1
  s_add_u32 s6, s4, 8192
  buffer_load_dwordx4 a[128:131], v20, s[8:11], s6 offen sc1
  s_add_u32 s6, s4, 28672
  buffer_load_dwordx4 a[132:135], v20, s[8:11], s6 offen sc1
  s_add_u32 s6, s4, 49152
  buffer_load_dwordx4 a[136:139], v20, s[8:11], s6 offen sc1
  s_add_u32 s6, s4, 69632
  buffer_load_dwordx4 a[140:143], v20, s[8:11], s6 offen sc1
  s_add_u32 s6, s4, 9216
  buffer_load_dwordx4 a[144:147], v20, s[8:11], s6 offen sc1
  s_add_u32 s6, s4, 29696
  buffer_load_dwordx4 a[148:151], v20, s[8:11], s6 offen sc1
  s_add_u32 s6, s4, 50176
  buffer_load_dwordx4 a[152:155], v20, s[8:11], s6 offen sc1
  s_add_u32 s6, s4, 70656
  buffer_load_dwordx4 a[156:159], v20, s[8:11], s6 offen sc1
  s_waitcnt vmcnt(36)
  v_mfma_f32_16x16x32_bf16 v[40:43], v[120:123], a[0:3], 0
  v_mfma_f32_16x16x32_bf16 v[44:47], v[124:127], a[0:3], 0
  v_mfma_f32_16x16x32_bf16 v[40:43], v[120:123], a[4:7], v[40:43]
  v_mfma_f32_16x16x32_bf16 v[44:47], v[124:127], a[4:7], v[44:47]
  v_mfma_f32_16x16x32_bf16 v[40:43], v[120:123], a[8:11], v[40:43]
  v_mfma_f32_16x16x32_bf16 v[44:47], v[124:127], a[8:11], v[44:47]
  v_mfma_f32_16x16x32_bf16 v[40:43], v[120:123], a[12:15], v[40:43]
  v_mfma_f32_16x16x32_bf16 v[44:47], v[124:127], a[12:15], v[44:47]
  s_waitcnt vmcnt(32)
  v_mfma_f32_16x16x32_bf16 v[48:51], v[120:123], a[16:19], 0
  v_mfma_f32_16x16x32_bf16 v[52:55], v[124:127], a[16:19], 0
  v_mfma_f32_16x16x32_bf16 v[48:51], v[120:123], a[20:23], v[48:51]
  v_mfma_f32_16x16x32_bf16 v[52:55], v[124:127], a[20:23], v[52:55]
  v_mfma_f32_16x16x32_bf16 v[48:51], v[120:123], a[24:27], v[48:51]
  v_mfma_f32_16x16x32_bf16 v[52:55], v[124:127], a[24:27], v[52:55]
  v_mfma_f32_16x16x32_bf16 v[48:51], v[120:123], a[28:31], v[48:51]
  v_mfma_f32_16x16x32_bf16 v[52:55], v[124:127], a[28:31], v[52:55]
  s_waitcnt vmcnt(28)
  v_mfma_f32_16x16x32_bf16 v[56:59], v[120:123], a[32:35], 0
  v_mfma_f32_16x16x32_bf16 v[60:63], v[124:127], a[32:35], 0
  v_mfma_f32_16x16x32_bf16 v[56:59], v[120:123], a[36:39], v[56:59]
  v_mfma_f32_16x16x32_bf16 v[60:63], v[124:127], a[36:39], v[60:63]
  v_mfma_f32_16x16x32_bf16 v[56:59], v[120:123], a[40:43], v[56:59]
  v_mfma_f32_16x16x32_bf16 v[60:63], v[124:127], a[40:43], v[60:63]
  v_mfma_f32_16x16x32_bf16 v[56:59], v[120:123], a[44:47], v[56:59]
  v_mfma_f32_16x16x32_bf16 v[60:63], v[124:127], a[44:47], v[60:63]
  s_waitcnt vmcnt(24)
  v_mfma_f32_16x16x32_bf16 v[64:67], v[120:123], a[48:51], 0
  v_mfma_f32_16x16x32_bf16 v[68:71], v[124:127], a[48:51], 0
  v_mfma_f32_16x16x32_bf16 v[64:67], v[120:123], a[52:55], v[64:67]
  v_mfma_f32_16x16x32_bf16 v[68:71], v[124:127], a[52:55], v[68:71]
  v_mfma_f32_16x16x32_bf16 v[64:67], v[120:123], a[56:59], v[64:67]
  v_mfma_f32_16x16x32_bf16 v[68:71], v[124:127], a[56:59], v[68:71]
  v_mfma_f32_16x16x32_bf16 v[64:67], v[120:123], a[60:63], v[64:67]
  v_mfma_f32_16x16x32_bf16 v[68:71], v[124:127], a[60:63], v[68:71]
  s_waitcnt vmcnt(20)
  v_mfma_f32_16x16x32_bf16 v[72:75], v[120:123], a[64:67], 0
  v_mfma_f32_16x16x32_bf16 v[76:79], v[124:127], a[64:67], 0
  v_mfma_f32_16x16x32_bf16 v[72:75], v[120:123], a[68:71], v[72:75]
  v_mfma_f32_16x16x32_bf16 v[76:79], v[124:127], a[68:71], v[76:79]
  v_mfma_f32_16x16x32_bf16 v[72:75], v[120:123], a[72:75], v[72:75]
  v_mfma_f32_16x16x32_bf16 v[76:79], v[124:127], a[72:75], v[76:79]
  v_mfma_f32_16x16x32_bf16 v[72:75], v[120:123], a[76:79], v[72:75]
  v_mfma_f32_16x16x32_bf16 v[76:79], v[124:127], a[76:79], v[76:79]
  s_waitcnt vmcnt(16)
  v_mfma_f32_16x16x32_bf16 v[80:83], v[120:123], a[80:83], 0
  v_mfma_f32_16x16x32_bf16 v[84:87], v[124:127], a[80:83], 0
  v_mfma_f32_16x16x32_bf16 v[80:83], v[120:123], a[84:87], v[80:83]
  v_mfma_f32_16x16x32_bf16 v[84:87], v[124:127], a[84:87], v[84:87]
  v_mfma_f32_16x16x32_bf16 v[80:83], v[120:123], a[88:91], v[80:83]
  v_mfma_f32_16x16x32_bf16 v[84:87], v[124:127], a[88:91], v[84:87]
  v_mfma_f32_16x16x32_bf16 v[80:83], v[120:123], a[92:95], v[80:83]
  v_mfma_f32_16x16x32_bf16 v[84:87], v[124:127], a[92:95], v[84:87]
  s_waitcnt vmcnt(12)
  v_mfma_f32_16x16x32_bf16 v[88:91], v[120:123], a[96:99], 0
  v_mfma_f32_16x16x32_bf16 v[92:95], v[124:127], a[96:99], 0
  v_mfma_f32_16x16x32_bf16 v[88:91], v[120:123], a[100:103], v[88:91]
  v_mfma_f32_16x16x32_bf16 v[92:95], v[124:127], a[100:103], v[92:95]
  v_mfma_f32_16x16x32_bf16 v[88:91], v[120:123], a[104:107], v[88:91]
  v_mfma_f32_16x16x32_bf16 v[92:95], v[124:127], a[104:107], v[92:95]
  v_mfma_f32_16x16x32_bf16 v[88:91], v[120:123], a[108:111], v[88:91]
  v_mfma_f32_16x16x32_bf16 v[92:95], v[124:127], a[108:111], v[92:95]
  s_waitcnt vmcnt(8)
  v_mfma_f32_16x16x32_bf16 v[96:99], v[120:123], a[112:115], 0
  v_mfma_f32_16x16x32_bf16 v[100:103], v[124:127], a[112:115], 0
  v_mfma_f32_16x16x32_bf16 v[96:99], v[120:123], a[116:119], v[96:99]
  v_mfma_f32_16x16x32_bf16 v[100:103], v[124:127], a[116:119], v[100:103]
  v_mfma_f32_16x16x32_bf16 v[96:99], v[120:123], a[120:123], v[96:99]
  v_mfma_f32_16x16x32_bf16 v[100:103], v[124:127], a[120:123], v[100:103]
  v_mfma_f32_16x16x32_bf16 v[96:99], v[120:123], a[124:127], v[96:99]
  v_mfma_f32_16x16x32_bf16 v[100:103], v[124:127], a[124:127], v[100:103]
  s_waitcnt vmcnt(4)
  v_mfma_f32_16x16x32_bf16 v[104:107], v[120:123], a[128:131], 0
  v_mfma_f32_16x16x32_bf16 v[108:111], v[124:127], a[128:131], 0
  v_mfma_f32_16x16x32_bf16 v[104:107], v[120:123], a[132:135], v[104:107]
  v_mfma_f32_16x16x32_bf16 v[108:111], v[124:127], a[132:135], v[108:111]
  v_mfma_f32_16x16x32_bf16 v[104:107], v[120:123], a[136:139], v[104:107]
  v_mfma_f32_16x16x32_bf16 v[108:111], v[124:127], a[136:139], v[108:111]
  v_mfma_f32_16x16x32_bf16 v[104:107], v[120:123], a[140:143], v[104:107]
  v_mfma_f32_16x16x32_bf16 v[108:111], v[124:127], a[140:143], v[108:111]
  s_waitcnt vmcnt(0)
  v_mfma_f32_16x16x32_bf16 v[112:115], v[120:123], a[144:147], 0
  v_mfma_f32_16x16x32_bf16 v[116:119], v[124:127], a[144:147], 0
  v_mfma_f32_16x16x32_bf16 v[112:115], v[120:123], a[148:151], v[112:115]
  v_mfma_f32_16x16x32_bf16 v[116:119], v[124:127], a[148:151], v[116:119]
  v_mfma_f32_16x16x32_bf16 v[112:115], v[120:123], a[152:155], v[112:115]
  v_mfma_f32_16x16x32_bf16 v[116:119], v[124:127], a[152:155], v[116:119]
  v_mfma_f32_16x16x32_bf16 v[112:115], v[120:123], a[156:159], v[112:115]
  v_mfma_f32_16x16x32_bf16 v[116:119], v[124:127], a[156:159], v[116:119]
  v_cvt_pk_bf16_f32 v128, v40, v41
  v_cvt_pk_bf16_f32 v129, v42, v43
  v_cvt_pk_bf16_f32 v130, v44, v45
  v_cvt_pk_bf16_f32 v131, v46, v47
  v_cvt_pk_bf16_f32 v132, v48, v49
  v_cvt_pk_bf16_f32 v133, v50, v51
  v_cvt_pk_bf16_f32 v134, v52, v53
  v_cvt_pk_bf16_f32 v135, v54, v55
  v_cvt_pk_bf16_f32 v136, v56, v57
  v_cvt_pk_bf16_f32 v137, v58, v59
  v_cvt_pk_bf16_f32 v138, v60, v61
  v_cvt_pk_bf16_f32 v139, v62, v63
  v_cvt_pk_bf16_f32 v140, v64, v65
  v_cvt_pk_bf16_f32 v141, v66, v67
  v_cvt_pk_bf16_f32 v142, v68, v69
  v_cvt_pk_bf16_f32 v143, v70, v71
  v_cvt_pk_bf16_f32 v144, v72, v73
  v_cvt_pk_bf16_f32 v145, v74, v75
  v_cvt_pk_bf16_f32 v146, v76, v77
  v_cvt_pk_bf16_f32 v147, v78, v79
  v_cvt_pk_bf16_f32 v148, v80, v81
  v_cvt_pk_bf16_f32 v149, v82, v83
  v_cvt_pk_bf16_f32 v150, v84, v85
  v_cvt_pk_bf16_f32 v151, v86, v87
  v_cvt_pk_bf16_f32 v152, v88, v89
  v_cvt_pk_bf16_f32 v153, v90, v91
  v_cvt_pk_bf16_f32 v154, v92, v93
  v_cvt_pk_bf16_f32 v155, v94, v95
  v_cvt_pk_bf16_f32 v156, v96, v97
  v_cvt_pk_bf16_f32 v157, v98, v99
  v_cvt_pk_bf16_f32 v158, v100, v101
  v_cvt_pk_bf16_f32 v159, v102, v103
  v_cvt_pk_bf16_f32 v160, v104, v105
  v_cvt_pk_bf16_f32 v161, v106, v107
  v_cvt_pk_bf16_f32 v162, v108, v109
  v_cvt_pk_bf16_f32 v163, v110, v111
  v_cvt_pk_bf16_f32 v164, v112, v113
  v_cvt_pk_bf16_f32 v165, v114, v115
  v_cvt_pk_bf16_f32 v166, v116, v117
  v_cvt_pk_bf16_f32 v167, v118, v119
  v_pk_add_f32 v[28:29], v[40:41], v[42:43]
  v_pk_mul_f32 v[30:31], v[40:41], v[40:41]
  v_pk_fma_f32 v[30:31], v[42:43], v[42:43], v[30:31]
  v_pk_add_f32 v[28:29], v[28:29], v[44:45]
  v_pk_fma_f32 v[30:31], v[44:45], v[44:45], v[30:31]
  v_pk_add_f32 v[28:29], v[28:29], v[46:47]
  v_pk_fma_f32 v[30:31], v[46:47], v[46:47], v[30:31]
  v_pk_add_f32 v[28:29], v[28:29], v[48:49]
  v_pk_fma_f32 v[30:31], v[48:49], v[48:49], v[30:31]
  v_pk_add_f32 v[28:29], v[28:29], v[50:51]
  v_pk_fma_f32 v[30:31], v[50:51], v[50:51], v[30:31]
  v_pk_add_f32 v[28:29], v[28:29], v[52:53]
  v_pk_fma_f32 v[30:31], v[52:53], v[52:53], v[30:31]
  v_pk_add_f32 v[28:29], v[28:29], v[54:55]
  v_pk_fma_f32 v[30:31], v[54:55], v[54:55], v[30:31]
  v_pk_add_f32 v[28:29], v[28:29], v[56:57]
  v_pk_fma_f32 v[30:31], v[56:57], v[56:57], v[30:31]
  v_pk_add_f32 v[28:29], v[28:29], v[58:59]
  v_pk_fma_f32 v[30:31], v[58:59], v[58:59], v[30:31]
  v_pk_add_f32 v[28:29], v[28:29], v[60:61]
  v_pk_fma_f32 v[30:31], v[60:61], v[60:61], v[30:31]
  v_pk_add_f32 v[28:29], v[28:29], v[62:63]
  v_pk_fma_f32 v[30:31], v[62:63], v[62:63], v[30:31]
  v_pk_add_f32 v[28:29], v[28:29], v[64:65]
  v_pk_fma_f32 v[30:31], v[64:65], v[64:65], v[30:31]
  v_pk_add_f32 v[28:29], v[28:29], v[66:67]
  v_pk_fma_f32 v[30:31], v[66:67], v[66:67], v[30:31]
  v_pk_add_f32 v[28:29], v[28:29], v[68:69]
  v_pk_fma_f32 v[30:31], v[68:69], v[68:69], v[30:31]
  v_pk_add_f32 v[28:29], v[28:29], v[70:71]
  v_pk_fma_f32 v[30:31], v[70:71], v[70:71], v[30:31]
  v_pk_add_f32 v[28:29], v[28:29], v[72:73]
  v_pk_fma_f32 v[30:31], v[72:73], v[72:73], v[30:31]
  v_pk_add_f32 v[28:29], v[28:29], v[74:75]
  v_pk_fma_f32 v[30:31], v[74:75], v[74:75], v[30:31]
  v_pk_add_f32 v[28:29], v[28:29], v[76:77]
  v_pk_fma_f32 v[30:31], v[76:77], v[76:77], v[30:31]
  v_pk_add_f32 v[28:29], v[28:29], v[78:79]
  v_pk_fma_f32 v[30:31], v[78:79], v[78:79], v[30:31]
  v_pk_add_f32 v[28:29], v[28:29], v[80:81]
  v_pk_fma_f32 v[30:31], v[80:81], v[80:81], v[30:31]
  v_pk_add_f32 v[28:29], v[28:29], v[82:83]
  v_pk_fma_f32 v[30:31], v[82:83], v[82:83], v[30:31]
  v_pk_add_f32 v[28:29], v[28:29], v[84:85]
  v_pk_fma_f32 v[30:31], v[84:85], v[84:85], v[30:31]
  v_pk_add_f32 v[28:29], v[28:29], v[86:87]
  v_pk_fma_f32 v[30:31], v[86:87], v[86:87], v[30:31]
  v_pk_add_f32 v[28:29], v[28:29], v[88:89]
  v_pk_fma_f32 v[30:31], v[88:89], v[88:89], v[30:31]
  v_pk_add_f32 v[28:29], v[28:29], v[90:91]
  v_pk_fma_f32 v[30:31], v[90:91], v[90:91], v[30:31]
  v_pk_add_f32 v[28:29], v[28:29], v[92:93]
  v_pk_fma_f32 v[30:31], v[92:93], v[92:93], v[30:31]
  v_pk_add_f32 v[28:29], v[28:29], v[94:95]
  v_pk_fma_f32 v[30:31], v[94:95], v[94:95], v[30:31]
  v_pk_add_f32 v[28:29], v[28:29], v[96:97]
  v_pk_fma_f32 v[30:31], v[96:97], v[96:97], v[30:31]
  v_pk_add_f32 v[28:29], v[28:29], v[98:99]
  v_pk_fma_f32 v[30:31], v[98:99], v[98:99], v[30:31]
  v_pk_add_f32 v[28:29], v[28:29], v[100:101]
  v_pk_fma_f32 v[30:31], v[100:101], v[100:101], v[30:31]
  v_pk_add_f32 v[28:29], v[28:29], v[102:103]
  v_pk_fma_f32 v[30:31], v[102:103], v[102:103], v[30:31]
  v_pk_add_f32 v[28:29], v[28:29], v[104:105]
  v_pk_fma_f32 v[30:31], v[104:105], v[104:105], v[30:31]
  v_pk_add_f32 v[28:29], v[28:29], v[106:107]
  v_pk_fma_f32 v[30:31], v[106:107], v[106:107], v[30:31]
  v_pk_add_f32 v[28:29], v[28:29], v[108:109]
  v_pk_fma_f32 v[30:31], v[108:109], v[108:109], v[30:31]
  v_pk_add_f32 v[28:29], v[28:29], v[110:111]
  v_pk_fma_f32 v[30:31], v[110:111], v[110:111], v[30:31]
  v_pk_add_f32 v[28:29], v[28:29], v[112:113]
  v_pk_fma_f32 v[30:31], v[112:113], v[112:113], v[30:31]
  v_pk_add_f32 v[28:29], v[28:29], v[114:115]
  v_pk_fma_f32 v[30:31], v[114:115], v[114:115], v[30:31]
  v_pk_add_f32 v[28:29], v[28:29], v[116:117]
  v_pk_fma_f32 v[30:31], v[116:117], v[116:117], v[30:31]
  v_pk_add_f32 v[28:29], v[28:29], v[118:119]
  v_pk_fma_f32 v[30:31], v[118:119], v[118:119], v[30:31]
  v_add_f32 v28, v28, v29
  v_add_f32 v29, v30, v31
  v_mov_b32 v32, v28
  v_mov_b32 v33, v29
  s_nop 0
  v_permlane16_swap_b32 v28, v32
  v_permlane16_swap_b32 v29, v33
  v_pk_add_f32 v[28:29], v[28:29], v[32:33]
  v_mov_b32 v32, v28
  v_mov_b32 v33, v29
  s_nop 0
  v_permlane32_swap_b32 v28, v32
  v_permlane32_swap_b32 v29, v33
  v_pk_add_f32 v[28:29], v[28:29], v[32:33]
  v_lshlrev_b32 v32, 3, v22
  v_add_u32 v32, s45, v32
  s_lshl_b32 s4, s24, 7
  v_add_u32 v33, s4, v32
  ds_write_b64 v33, v[28:29]
  s_xor_b32 s4, s4, 128
  v_add_u32 v33, s4, v32
  s_waitcnt lgkmcnt(0)
  s_barrier
  ds_read_b64 v[30:31], v33
  s_waitcnt lgkmcnt(0)
  v_pk_add_f32 v[28:29], v[28:29], v[30:31]
  v_mul_f32 v28, 986500301, v28
  v_mul_f32 v30, v28, v28
  v_mov_b32 v31, 925353388
  v_fmac_f32 v31, 986500301, v29
  v_sub_f32 v31, v31, v30
  v_max_f32 v31, 925353388, v31
  v_rsq_f32 v30, v31
  s_nop 0
  v_mul_f32 v28, v28, v30
  v_pk_fma_f32 v[40:41], v[40:41], v[30:31], v[28:29] op_sel_hi:[1,0,0] neg_lo:[0,0,1] neg_hi:[0,0,1]
  v_pk_fma_f32 v[42:43], v[42:43], v[30:31], v[28:29] op_sel_hi:[1,0,0] neg_lo:[0,0,1] neg_hi:[0,0,1]
  v_pk_fma_f32 v[44:45], v[44:45], v[30:31], v[28:29] op_sel_hi:[1,0,0] neg_lo:[0,0,1] neg_hi:[0,0,1]
  v_pk_fma_f32 v[46:47], v[46:47], v[30:31], v[28:29] op_sel_hi:[1,0,0] neg_lo:[0,0,1] neg_hi:[0,0,1]
  v_pk_fma_f32 v[48:49], v[48:49], v[30:31], v[28:29] op_sel_hi:[1,0,0] neg_lo:[0,0,1] neg_hi:[0,0,1]
  v_pk_fma_f32 v[50:51], v[50:51], v[30:31], v[28:29] op_sel_hi:[1,0,0] neg_lo:[0,0,1] neg_hi:[0,0,1]
  v_pk_fma_f32 v[52:53], v[52:53], v[30:31], v[28:29] op_sel_hi:[1,0,0] neg_lo:[0,0,1] neg_hi:[0,0,1]
  v_pk_fma_f32 v[54:55], v[54:55], v[30:31], v[28:29] op_sel_hi:[1,0,0] neg_lo:[0,0,1] neg_hi:[0,0,1]
  v_pk_fma_f32 v[56:57], v[56:57], v[30:31], v[28:29] op_sel_hi:[1,0,0] neg_lo:[0,0,1] neg_hi:[0,0,1]
  v_pk_fma_f32 v[58:59], v[58:59], v[30:31], v[28:29] op_sel_hi:[1,0,0] neg_lo:[0,0,1] neg_hi:[0,0,1]
  v_pk_fma_f32 v[60:61], v[60:61], v[30:31], v[28:29] op_sel_hi:[1,0,0] neg_lo:[0,0,1] neg_hi:[0,0,1]
  v_pk_fma_f32 v[62:63], v[62:63], v[30:31], v[28:29] op_sel_hi:[1,0,0] neg_lo:[0,0,1] neg_hi:[0,0,1]
  v_pk_fma_f32 v[64:65], v[64:65], v[30:31], v[28:29] op_sel_hi:[1,0,0] neg_lo:[0,0,1] neg_hi:[0,0,1]
  v_pk_fma_f32 v[66:67], v[66:67], v[30:31], v[28:29] op_sel_hi:[1,0,0] neg_lo:[0,0,1] neg_hi:[0,0,1]
  v_pk_fma_f32 v[68:69], v[68:69], v[30:31], v[28:29] op_sel_hi:[1,0,0] neg_lo:[0,0,1] neg_hi:[0,0,1]
  v_pk_fma_f32 v[70:71], v[70:71], v[30:31], v[28:29] op_sel_hi:[1,0,0] neg_lo:[0,0,1] neg_hi:[0,0,1]
  v_pk_fma_f32 v[72:73], v[72:73], v[30:31], v[28:29] op_sel_hi:[1,0,0] neg_lo:[0,0,1] neg_hi:[0,0,1]
  v_pk_fma_f32 v[74:75], v[74:75], v[30:31], v[28:29] op_sel_hi:[1,0,0] neg_lo:[0,0,1] neg_hi:[0,0,1]
  v_pk_fma_f32 v[76:77], v[76:77], v[30:31], v[28:29] op_sel_hi:[1,0,0] neg_lo:[0,0,1] neg_hi:[0,0,1]
  v_pk_fma_f32 v[78:79], v[78:79], v[30:31], v[28:29] op_sel_hi:[1,0,0] neg_lo:[0,0,1] neg_hi:[0,0,1]
  v_pk_fma_f32 v[80:81], v[80:81], v[30:31], v[28:29] op_sel_hi:[1,0,0] neg_lo:[0,0,1] neg_hi:[0,0,1]
  v_pk_fma_f32 v[82:83], v[82:83], v[30:31], v[28:29] op_sel_hi:[1,0,0] neg_lo:[0,0,1] neg_hi:[0,0,1]
  v_pk_fma_f32 v[84:85], v[84:85], v[30:31], v[28:29] op_sel_hi:[1,0,0] neg_lo:[0,0,1] neg_hi:[0,0,1]
  v_pk_fma_f32 v[86:87], v[86:87], v[30:31], v[28:29] op_sel_hi:[1,0,0] neg_lo:[0,0,1] neg_hi:[0,0,1]
  v_pk_fma_f32 v[88:89], v[88:89], v[30:31], v[28:29] op_sel_hi:[1,0,0] neg_lo:[0,0,1] neg_hi:[0,0,1]
  v_pk_fma_f32 v[90:91], v[90:91], v[30:31], v[28:29] op_sel_hi:[1,0,0] neg_lo:[0,0,1] neg_hi:[0,0,1]
  v_pk_fma_f32 v[92:93], v[92:93], v[30:31], v[28:29] op_sel_hi:[1,0,0] neg_lo:[0,0,1] neg_hi:[0,0,1]
  v_pk_fma_f32 v[94:95], v[94:95], v[30:31], v[28:29] op_sel_hi:[1,0,0] neg_lo:[0,0,1] neg_hi:[0,0,1]
  v_pk_fma_f32 v[96:97], v[96:97], v[30:31], v[28:29] op_sel_hi:[1,0,0] neg_lo:[0,0,1] neg_hi:[0,0,1]
  v_pk_fma_f32 v[98:99], v[98:99], v[30:31], v[28:29] op_sel_hi:[1,0,0] neg_lo:[0,0,1] neg_hi:[0,0,1]
  v_pk_fma_f32 v[100:101], v[100:101], v[30:31], v[28:29] op_sel_hi:[1,0,0] neg_lo:[0,0,1] neg_hi:[0,0,1]
  v_pk_fma_f32 v[102:103], v[102:103], v[30:31], v[28:29] op_sel_hi:[1,0,0] neg_lo:[0,0,1] neg_hi:[0,0,1]
  v_pk_fma_f32 v[104:105], v[104:105], v[30:31], v[28:29] op_sel_hi:[1,0,0] neg_lo:[0,0,1] neg_hi:[0,0,1]
  v_pk_fma_f32 v[106:107], v[106:107], v[30:31], v[28:29] op_sel_hi:[1,0,0] neg_lo:[0,0,1] neg_hi:[0,0,1]
  v_pk_fma_f32 v[108:109], v[108:109], v[30:31], v[28:29] op_sel_hi:[1,0,0] neg_lo:[0,0,1] neg_hi:[0,0,1]
  v_pk_fma_f32 v[110:111], v[110:111], v[30:31], v[28:29] op_sel_hi:[1,0,0] neg_lo:[0,0,1] neg_hi:[0,0,1]
  v_pk_fma_f32 v[112:113], v[112:113], v[30:31], v[28:29] op_sel_hi:[1,0,0] neg_lo:[0,0,1] neg_hi:[0,0,1]
  v_pk_fma_f32 v[114:115], v[114:115], v[30:31], v[28:29] op_sel_hi:[1,0,0] neg_lo:[0,0,1] neg_hi:[0,0,1]
  v_pk_fma_f32 v[116:117], v[116:117], v[30:31], v[28:29] op_sel_hi:[1,0,0] neg_lo:[0,0,1] neg_hi:[0,0,1]
  v_pk_fma_f32 v[118:119], v[118:119], v[30:31], v[28:29] op_sel_hi:[1,0,0] neg_lo:[0,0,1] neg_hi:[0,0,1]
  v_cvt_pk_bf16_f32 v168, v40, v41
  v_cvt_pk_bf16_f32 v169, v42, v43
  v_cvt_pk_bf16_f32 v170, v44, v45
  v_cvt_pk_bf16_f32 v171, v46, v47
  v_cvt_pk_bf16_f32 v172, v48, v49
  v_cvt_pk_bf16_f32 v173, v50, v51
  v_cvt_pk_bf16_f32 v174, v52, v53
  v_cvt_pk_bf16_f32 v175, v54, v55
  v_cvt_pk_bf16_f32 v176, v56, v57
  v_cvt_pk_bf16_f32 v177, v58, v59
  v_cvt_pk_bf16_f32 v178, v60, v61
  v_cvt_pk_bf16_f32 v179, v62, v63
  v_cvt_pk_bf16_f32 v180, v64, v65
  v_cvt_pk_bf16_f32 v181, v66, v67
  v_cvt_pk_bf16_f32 v182, v68, v69
  v_cvt_pk_bf16_f32 v183, v70, v71
  v_cvt_pk_bf16_f32 v184, v72, v73
  v_cvt_pk_bf16_f32 v185, v74, v75
  v_cvt_pk_bf16_f32 v186, v76, v77
  v_cvt_pk_bf16_f32 v187, v78, v79
  v_cvt_pk_bf16_f32 v188, v80, v81
  v_cvt_pk_bf16_f32 v189, v82, v83
  v_cvt_pk_bf16_f32 v190, v84, v85
  v_cvt_pk_bf16_f32 v191, v86, v87
  v_cvt_pk_bf16_f32 v192, v88, v89
  v_cvt_pk_bf16_f32 v193, v90, v91
  v_cvt_pk_bf16_f32 v194, v92, v93
  v_cvt_pk_bf16_f32 v195, v94, v95
  v_cvt_pk_bf16_f32 v196, v96, v97
  v_cvt_pk_bf16_f32 v197, v98, v99
  v_cvt_pk_bf16_f32 v198, v100, v101
  v_cvt_pk_bf16_f32 v199, v102, v103
  v_cvt_pk_bf16_f32 v200, v104, v105
  v_cvt_pk_bf16_f32 v201, v106, v107
  v_cvt_pk_bf16_f32 v202, v108, v109
  v_cvt_pk_bf16_f32 v203, v110, v111
  v_cvt_pk_bf16_f32 v204, v112, v113
  v_cvt_pk_bf16_f32 v205, v114, v115
  v_cvt_pk_bf16_f32 v206, v116, v117
  v_cvt_pk_bf16_f32 v207, v118, v119
  s_xor_b32 s45, s45, 512
  s_mul_i32 s4, s54, 40960
  s_mul_i32 s5, s37, 20480
  s_add_u32 s4, s4, s5
  s_lshr_b32 s5, s24, 1
  s_lshl_b32 s5, s5, 10
  s_add_u32 s4, s4, s5
  s_add_u32 s4, s4, 147214336
  s_add_u32 s6, s4, 0
  buffer_store_dwordx4 v[168:171], v20, s[8:11], s6 offen sc1
  s_add_u32 s6, s4, 2048
  buffer_store_dwordx4 v[172:175], v20, s[8:11], s6 offen sc1
  s_add_u32 s6, s4, 4096
  buffer_store_dwordx4 v[176:179], v20, s[8:11], s6 offen sc1
  s_add_u32 s6, s4, 6144
  buffer_store_dwordx4 v[180:183], v20, s[8:11], s6 offen sc1
  s_add_u32 s6, s4, 8192
  buffer_store_dwordx4 v[184:187], v20, s[8:11], s6 offen sc1
  s_add_u32 s6, s4, 10240
  buffer_store_dwordx4 v[188:191], v20, s[8:11], s6 offen sc1
  s_add_u32 s6, s4, 12288
  buffer_store_dwordx4 v[192:195], v20, s[8:11], s6 offen sc1
  s_add_u32 s6, s4, 14336
  buffer_store_dwordx4 v[196:199], v20, s[8:11], s6 offen sc1
  s_add_u32 s6, s4, 16384
  buffer_store_dwordx4 v[200:203], v20, s[8:11], s6 offen sc1
  s_add_u32 s6, s4, 18432
  buffer_store_dwordx4 v[204:207], v20, s[8:11], s6 offen sc1
  s_mul_i32 s4, s44, 20480
  s_mul_i32 s5, s37, 10240
  s_add_u32 s4, s4, s5
  s_add_u32 s4, s4, 144592896
  s_add_u32 s6, s4, 0
  buffer_store_dwordx4 v[128:131], v20, s[8:11], s6 offen offset:0 sc1
  buffer_store_dwordx4 v[132:135], v20, s[8:11], s6 offen offset:1024 sc1
  buffer_store_dwordx4 v[136:139], v20, s[8:11], s6 offen offset:2048 sc1
  buffer_store_dwordx4 v[140:143], v20, s[8:11], s6 offen offset:3072 sc1
  s_add_u32 s6, s4, 4096
  buffer_store_dwordx4 v[144:147], v20, s[8:11], s6 offen offset:0 sc1
  buffer_store_dwordx4 v[148:151], v20, s[8:11], s6 offen offset:1024 sc1
  buffer_store_dwordx4 v[152:155], v20, s[8:11], s6 offen offset:2048 sc1
  buffer_store_dwordx4 v[156:159], v20, s[8:11], s6 offen offset:3072 sc1
  s_add_u32 s6, s4, 8192
  buffer_store_dwordx4 v[160:163], v20, s[8:11], s6 offen offset:0 sc1
  buffer_store_dwordx4 v[164:167], v20, s[8:11], s6 offen offset:1024 sc1
  s_add_u32 s34, s31, 1
  s_add_u32 s31, s31, 3
  s_cmp_lt_u32 s31, s52
  s_cbranch_scc1 L_R_top
  s_waitcnt vmcnt(0)
  s_mov_b64 exec, 1
  v_mov_b32 v29, s34
  v_mov_b32 v30, 0
  buffer_store_dword v29, v30, s[8:11], s35 offen sc1
  s_mov_b64 exec, -1
  s_waitcnt vmcnt(0)
  s_branch L_exit
L_chain:
  s_lshr_b32 s3, s26, 2
  s_lshl_b32 s32, s25, 3
  s_add_u32 s32, s32, s3
  s_and_b32 s33, s26, 3
  s_lshr_b32 s34, s26, 4
  s_and_b32 s35, s26, 15
  s_mul_i32 s4, s35, 3
  s_lshl_b32 s5, s35, 1
  s_add_u32 s5, s5, 8
  s_cmp_lt_u32 s35, 8
  s_cselect_b32 s36, s4, s5
  s_cselect_b32 s37, 1, 0
  s_mov_b32 s57, 1037384597
  s_lshr_b32 s4, s26, 2
  s_add_u32 s4, s4, 32
  s_cmp_eq_u32 s24, 3
  s_cselect_b32 s38, s4, s26
  s_and_b32 s5, s26, 3
  s_cmp_eq_u32 s5, 0
  s_cselect_b32 s5, 1, 0
  s_cmp_eq_u32 s24, 3
  s_cselect_b32 s39, s5, 1
  v_lshrrev_b32 v1, 4, v0
  v_and_b32 v2, 15, v0
  v_and_b32 v3, 7, v0
  v_bfe_u32 v4, v0, 3, 1
  v_lshrrev_b32 v5, 5, v0
  v_and_b32 v6, 1, v1
  v_bfe_u32 v7, v0, 2, 2
  v_and_b32 v8, 3, v0
  s_mul_i32 s6, s32, 384
  s_mul_i32 s7, s33, 96
  s_add_u32 s6, s6, s7
  s_load_dwordx2 s[16:17], s[0:1], 16
  s_waitcnt lgkmcnt(0)
  s_and_b32 s17, s17, 0xffff
  s_mov_b32 s18, 7864320
  s_mov_b32 s19, 0x20000
  s_load_dwordx2 s[20:21], s[0:1], 24
  s_waitcnt lgkmcnt(0)
  s_and_b32 s21, s21, 0xffff
  s_mov_b32 s22, 7864320
  s_mov_b32 s23, 0x20000
  s_mov_b32 s4, s24
L_dma_cq:
  s_lshl_b32 s5, s4, 6
  v_add_u32 v10, s5, v0
  v_mul_u32_u24 v11, 43691, v10
  v_lshrrev_b32 v11, 18, v11
  v_mul_u32_u24 v12, 6, v11
  v_sub_u32 v12, v10, v12
  v_lshlrev_b32 v12, 4, v12
  v_mul_u32_u24 v11, 12288, v11
  v_add_u32 v12, v12, v11
  s_lshl_b32 s5, s4, 10
  s_add_u32 s5, s5, 0
  s_mov_b32 m0, s5
  s_add_u32 s4, s4, 4
  buffer_load_dwordx4 v12, s[16:19], s6 offen lds
  s_cmp_lt_u32 s4, 60
  s_cbranch_scc1 L_dma_cq
  s_mov_b32 s4, s24
L_dma_ck:
  s_lshl_b32 s5, s4, 6
  v_add_u32 v10, s5, v0
  v_mul_u32_u24 v11, 43691, v10
  v_lshrrev_b32 v11, 18, v11
  v_mul_u32_u24 v12, 6, v11
  v_sub_u32 v12, v10, v12
  v_lshlrev_b32 v12, 4, v12
  v_mul_u32_u24 v11, 12288, v11
  v_add_u32 v12, v12, v11
  s_lshl_b32 s5, s4, 10
  s_add_u32 s5, s5, 61440
  s_mov_b32 m0, s5
  s_add_u32 s4, s4, 4
  buffer_load_dwordx4 v12, s[20:23], s6 offen lds
  s_cmp_lt_u32 s4, 60
  s_cbranch_scc1 L_dma_ck
  s_mov_b32 s69, s6
  v_lshrrev_b32 v1, 4, v0
  v_and_b32 v2, 15, v0
  v_and_b32 v3, 7, v0
  v_bfe_u32 v4, v0, 3, 1
  v_lshrrev_b32 v5, 5, v0
  v_and_b32 v6, 1, v1
  v_bfe_u32 v7, v0, 2, 2
  v_and_b32 v8, 3, v0
  v_mov_b32 v22, -1
  v_mov_b32 v23, -1
  v_mov_b32 v24, -1
  v_mov_b32 v25, -1
  v_mov_b32 v9, 0x4444
  v_mov_b32 v10, 0xeeee
  v_cmp_eq_u32 vcc, 1, v4
  s_nop 1
  v_cndmask_b32 v20, v9, v10, vcc
  s_lshl_b32 s4, s24, 10
  v_mul_u32_u24 v26, 256, v1
  v_mul_u32_u24 v9, 32, v3
  v_add_u32 v26, v26, v9
  v_mul_u32_u24 v9, 16, v4
  v_add_u32 v26, v26, v9
  v_add_u32 v26, s4, v26
  v_mul_u32_u24 v27, 16, v0
  v_add_u32 v27, s4, v27
  s_lshl_b32 s4, s24, 7
  v_mul_u32_u24 v36, 1280, v3
  v_mul_u32_u24 v9, 32, v1
  v_add_u32 v36, v36, v9
  v_mul_u32_u24 v9, 16, v4
  v_add_u32 v36, v36, v9
  v_add_u32 v36, s4, v36
  v_mul_u32_u24 v28, 16, v0
  s_lshl_b32 s4, s25, 3
  s_lshl_b32 s5, s34, 2
  s_add_u32 s4, s4, s5
  s_add_u32 s4, s4, s24
  s_mul_i32 s4, s4, 3072
  v_mul_u32_u24 v29, 16, v0
  v_add_u32 v29, s4, v29
  s_mul_i32 s4, s24, 1536
  v_mul_u32_u24 v30, 256, v6
  v_mul_u32_u24 v9, 64, v5
  v_add_u32 v30, v30, v9
  v_mul_u32_u24 v9, 4, v2
  v_add_u32 v30, v30, v9
  v_add_u32 v30, 12864, v30
  v_add_u32 v30, s4, v30
  v_and_b32 v10, 31, v0
  s_cmp_eq_u32 s24, 1
  s_cselect_b32 s4, 1024, 0
  s_cselect_b32 s5, 0, 512
  v_mul_u32_u24 v11, s5, v5
  v_lshlrev_b32 v12, 4, v10
  v_add_u32 v11, v11, v12
  v_add_u32 v11, s4, v11
  v_add_u32 v31, 12864, v11
  s_lshl_b32 s4, s25, 1
  s_add_u32 s4, s4, s34
  s_lshl_b32 s4, s4, 9
  s_cmp_eq_u32 s24, 1
  s_cselect_b32 s5, 2, 0
  s_cselect_b32 s6, 0, 1
  s_add_u32 s5, s5, s36
  v_mul_u32_u24 v11, s6, v5
  v_add_u32 v11, s5, v11
  v_lshrrev_b32 v13, 1, v11
  v_lshlrev_b32 v13, 14, v13
  v_and_b32 v14, 1, v11
  v_lshlrev_b32 v14, 12, v14
  v_add_u32 v13, v13, v14
  v_add_u32 v13, v13, v12
  v_add_u32 v32, s4, v13
  s_lshr_b32 s4, s38, 1
  s_lshl_b32 s4, s4, 14
  s_and_b32 s5, s38, 1
  s_lshl_b32 s5, s5, 12
  s_add_u32 s4, s4, s5
  v_mul_u32_u24 v33, 16, v0
  v_add_u32 v33, s4, v33
  s_lshl_b32 s4, s38, 8
  v_mul_u32_u24 v34, 8, v10
  v_mul_u32_u24 v9, 4, v5
  v_add_u32 v34, v34, v9
  v_add_u32 v34, s4, v34
  s_mul_i32 s4, s32, 3
  s_cmp_eq_u32 s24, 3
  s_mov_b32 s5, 96
  s_cmov_b32 s5, 192
  s_add_u32 s4, s4, s5
  v_min_u32 v10, 2, v0
  v_add_u32 v10, s4, v10
  v_lshrrev_b32 v11, 2, v10
  v_lshlrev_b32 v11, 7, v11
  v_and_b32 v10, 3, v10
  v_lshlrev_b32 v10, 2, v10
  v_add_u32 v10, v10, v11
  v_add_u32 v35, 0, v10
  v_and_b32 v10, 31, v0
  s_mul_i32 s4, s33, 3
  s_add_u32 s5, s4, 1
  s_lshr_b32 s5, s5, 1
  s_and_b32 s6, s33, 1
  s_cmp_eq_u32 s6, 0
  s_cselect_b32 s7, 1, -1
  s_add_u32 s7, s5, s7
  s_lshl_b32 s6, s6, 3
  s_lshl_b32 s5, s5, 10
  s_lshl_b32 s7, s7, 10
  s_add_u32 s7, s7, s6
  s_mov_b32 s62, s5
  s_mov_b32 s63, s7
  s_cmp_eq_u32 s24, 3
  s_cbranch_scc1 L_ca_w3
  s_mul_i32 s4, s24, 384
  v_mul_u32_u24 v120, 1280, v5
  v_mul_u32_u24 v9, 24, v2
  v_add_u32 v120, v120, v9
  v_mul_u32_u24 v9, 8, v6
  v_add_u32 v120, v120, v9
  v_add_u32 v120, 10240, v120
  v_add_u32 v120, s4, v120
  s_and_b32 s6, s33, 1
  s_mul_i32 s4, s6, 384
  s_cmp_eq_u32 s6, 0
  s_cselect_b32 s5, 768, 0
  v_mul_u32_u24 v10, 96, v1
  v_mul_u32_u24 v9, 24, v7
  v_add_u32 v10, v10, v9
  v_mul_u32_u24 v9, 8, v8
  v_add_u32 v10, v10, v9
  v_add_u32 v10, 10240, v10
  v_add_u32 v121, s4, v10
  v_add_u32 v122, s5, v10
  s_mul_i32 s4, s33, 1536
  s_lshl_b32 s5, s24, 9
  s_add_u32 s4, s4, s5
  v_mul_u32_u24 v123, 128, v1
  v_mul_u32_u24 v9, 16, v3
  v_add_u32 v123, v123, v9
  v_add_u32 v123, s4, v123
  s_mul_i32 s4, s32, 12288
  s_sub_u32 s5, s24, 1
  s_mul_i32 s5, s5, 6144
  s_add_u32 s4, s4, s5
  s_add_u32 s5, s4, s62
  s_add_u32 s4, s4, s63
  v_mul_u32_u24 v124, 16, v0
  v_add_u32 v124, s5, v124
  v_mul_u32_u24 v125, 16, v0
  v_add_u32 v125, s4, v125
  s_mul_i32 s4, s32, 6144
  s_add_u32 s5, s4, s62
  s_add_u32 s4, s4, s63
  v_mul_u32_u24 v126, 16, v0
  v_add_u32 v126, s5, v126
  s_and_b32 s5, s33, 1
  s_lshl_b32 s5, s5, 3
  s_sub_u32 s4, s4, s5
  s_lshl_b32 s5, s5, 6
  s_add_u32 s4, s4, s5
  v_mul_u32_u24 v127, 64, v1
  v_mul_u32_u24 v9, 8, v2
  v_add_u32 v127, v127, v9
  v_add_u32 v127, s4, v127
  s_branch L_ca_done
L_ca_w3:
  v_mul_u32_u24 v120, 512, v4
  v_mul_u32_u24 v9, 128, v1
  v_add_u32 v120, v120, v9
  v_mul_u32_u24 v9, 16, v3
  v_add_u32 v120, v120, v9
  v_add_u32 v120, 512, v120
  v_mul_u32_u24 v121, 128, v4
  v_mul_u32_u24 v9, 16, v3
  v_add_u32 v121, v121, v9
  v_mul_u32_u24 v9, 4, v1
  v_add_u32 v121, v121, v9
  v_mov_b32 v9, 0xffff
  v_mov_b32 v10, 0xffff0000
  v_cmp_eq_u32 vcc, 1, v4
  s_nop 1
  v_cndmask_b32 v126, v9, v10, vcc
  v_bfe_u32 v10, v0, 1, 1
  v_bfe_u32 v11, v0, 2, 2
  v_and_b32 v12, 1, v0
  v_mul_u32_u24 v28, 256, v1
  v_mul_u32_u24 v9, 128, v10
  v_add_u32 v28, v28, v9
  v_mul_u32_u24 v9, 16, v11
  v_add_u32 v28, v28, v9
  v_mul_u32_u24 v9, 64, v12
  v_add_u32 v28, v28, v9
  v_mov_b32 v9, 0x4444
  v_mov_b32 v11, 0xeeee
  v_cmp_eq_u32 vcc, 1, v10
  s_nop 1
  v_cndmask_b32 v127, v9, v11, vcc
  s_mul_i32 s4, s32, 3072
  s_lshl_b32 s5, s33, 8
  s_add_u32 s4, s4, s5
  v_lshrrev_b32 v10, 1, v1
  v_mul_u32_u24 v122, 1024, v10
  v_mul_u32_u24 v9, 128, v6
  v_add_u32 v122, v122, v9
  v_mul_u32_u24 v9, 16, v3
  v_add_u32 v122, v122, v9
  v_add_u32 v122, s4, v122
  v_mul_u32_u24 v123, 128, v10
  v_mul_u32_u24 v9, 16, v3
  v_add_u32 v123, v123, v9
  v_mul_u32_u24 v9, 8, v6
  v_add_u32 v123, v123, v9
  v_add_u32 v123, 2048, v123
  v_add_u32 v123, s4, v123
  s_mul_i32 s4, s32, 12288
  s_mul_i32 s5, s33, 3072
  s_add_u32 s4, s4, s5
  v_mul_u32_u24 v124, 16, v0
  v_add_u32 v124, s4, v124
  s_mul_i32 s4, s32, 6144
  s_mul_i32 s5, s33, 1536
  s_add_u32 s4, s4, s5
  v_mul_u32_u24 v125, 8, v0
  v_add_u32 v125, s4, v125
L_ca_done:
  s_add_u32 s60, s8, 1298432
  s_sub_u32 s60, 0, s60
  s_and_b32 s60, s60, 0x1fffff
  s_add_u32 s60, s60, 1298432
  s_lshl_b32 s4, s25, 5
  s_add_u32 s4, s4, s26
  s_lshl_b32 s4, s4, 7
  s_mov_b32 s5, 36864
  s_cmp_eq_u32 s24, 1
  s_cmov_b32 s5, 53248
  s_add_u32 s53, s4, s5
  s_cmp_eq_u32 s24, 0
  s_cbranch_scc0 L_ci_n0
  s_mov_b32 exec_lo, 16711935
  s_mov_b32 exec_hi, 0
  s_mul_i32 s4, s32, 6144
  s_add_u32 s4, s4, 118784
  buffer_store_dwordx4 v[22:25], v123, s[8:11], s4 offen sc1
  s_mov_b32 exec_lo, 4294967295
  s_mov_b32 exec_hi, 4294967295
  s_add_u32 s4, s60, 0
  buffer_store_dwordx4 v[22:25], v32, s[8:11], s4 offen sc1
  s_add_u32 s4, s60, 8192
  buffer_store_dwordx4 v[22:25], v32, s[8:11], s4 offen sc1
  s_mov_b32 exec_lo, 16711935
  s_mov_b32 exec_hi, 0
  s_mul_i32 s4, s32, 6144
  s_add_u32 s4, s4, 315392
  buffer_store_dwordx4 v[22:25], v123, s[8:11], s4 offen sc1
  s_mov_b32 exec_lo, 4294967295
  s_mov_b32 exec_hi, 4294967295
  s_add_u32 s4, s60, 327680
  buffer_store_dwordx4 v[22:25], v32, s[8:11], s4 offen sc1
  s_add_u32 s4, s60, 335872
  buffer_store_dwordx4 v[22:25], v32, s[8:11], s4 offen sc1
  s_mov_b32 exec_lo, 16711935
  s_mov_b32 exec_hi, 0
  s_mul_i32 s4, s32, 6144
  s_add_u32 s4, s4, 512000
  buffer_store_dwordx4 v[22:25], v123, s[8:11], s4 offen sc1
  s_mov_b32 exec_lo, 4294967295
  s_mov_b32 exec_hi, 4294967295
  s_add_u32 s4, s60, 655360
  buffer_store_dwordx4 v[22:25], v32, s[8:11], s4 offen sc1
  s_add_u32 s4, s60, 663552
  buffer_store_dwordx4 v[22:25], v32, s[8:11], s4 offen sc1
  s_mov_b32 exec_lo, 16711935
  s_mov_b32 exec_hi, 0
  s_mul_i32 s4, s32, 6144
  s_add_u32 s4, s4, 708608
  buffer_store_dwordx4 v[22:25], v123, s[8:11], s4 offen sc1
  s_mov_b32 exec_lo, 4294967295
  s_mov_b32 exec_hi, 4294967295
  s_add_u32 s4, s60, 983040
  buffer_store_dwordx4 v[22:25], v32, s[8:11], s4 offen sc1
  s_add_u32 s4, s60, 991232
  buffer_store_dwordx4 v[22:25], v32, s[8:11], s4 offen sc1
  s_mov_b64 exec, 1
  v_mov_b32 v104, 0
  v_mov_b32 v105, 0
  buffer_store_dword v104, v105, s[8:11], s53 offen sc1
  s_mov_b64 exec, -1
  s_branch L_ci_done
L_ci_n0:
  s_cmp_eq_u32 s24, 1
  s_cbranch_scc0 L_ci_n1
  s_mov_b32 exec_lo, 16711935
  s_mov_b32 exec_hi, 16711935
  s_mul_i32 s4, s32, 6144
  s_add_u32 s4, s4, 118784
  buffer_store_dwordx4 v[22:25], v123, s[8:11], s4 offen sc1
  s_mov_b32 exec_lo, 4294967295
  s_mov_b32 exec_hi, 4294967295
  s_cmp_eq_u32 s37, 0
  s_cbranch_scc1 L_ip_0
  s_mov_b32 exec_hi, 0
  s_add_u32 s4, s60, 0
  buffer_store_dwordx4 v[22:25], v32, s[8:11], s4 offen sc1
  s_add_u32 s4, s60, 8192
  buffer_store_dwordx4 v[22:25], v32, s[8:11], s4 offen sc1
  s_mov_b32 exec_hi, -1
L_ip_0:
  s_mov_b32 exec_lo, 16711935
  s_mov_b32 exec_hi, 16711935
  s_mul_i32 s4, s32, 6144
  s_add_u32 s4, s4, 315392
  buffer_store_dwordx4 v[22:25], v123, s[8:11], s4 offen sc1
  s_mov_b32 exec_lo, 4294967295
  s_mov_b32 exec_hi, 4294967295
  s_cmp_eq_u32 s37, 0
  s_cbranch_scc1 L_ip_1
  s_mov_b32 exec_hi, 0
  s_add_u32 s4, s60, 327680
  buffer_store_dwordx4 v[22:25], v32, s[8:11], s4 offen sc1
  s_add_u32 s4, s60, 335872
  buffer_store_dwordx4 v[22:25], v32, s[8:11], s4 offen sc1
  s_mov_b32 exec_hi, -1
L_ip_1:
  s_mov_b32 exec_lo, 16711935
  s_mov_b32 exec_hi, 16711935
  s_mul_i32 s4, s32, 6144
  s_add_u32 s4, s4, 512000
  buffer_store_dwordx4 v[22:25], v123, s[8:11], s4 offen sc1
  s_mov_b32 exec_lo, 4294967295
  s_mov_b32 exec_hi, 4294967295
  s_cmp_eq_u32 s37, 0
  s_cbranch_scc1 L_ip_2
  s_mov_b32 exec_hi, 0
  s_add_u32 s4, s60, 655360
  buffer_store_dwordx4 v[22:25], v32, s[8:11], s4 offen sc1
  s_add_u32 s4, s60, 663552
  buffer_store_dwordx4 v[22:25], v32, s[8:11], s4 offen sc1
  s_mov_b32 exec_hi, -1
L_ip_2:
  s_mov_b32 exec_lo, 16711935
  s_mov_b32 exec_hi, 16711935
  s_mul_i32 s4, s32, 6144
  s_add_u32 s4, s4, 708608
  buffer_store_dwordx4 v[22:25], v123, s[8:11], s4 offen sc1
  s_mov_b32 exec_lo, 4294967295
  s_mov_b32 exec_hi, 4294967295
  s_cmp_eq_u32 s37, 0
  s_cbranch_scc1 L_ip_3
  s_mov_b32 exec_hi, 0
  s_add_u32 s4, s60, 983040
  buffer_store_dwordx4 v[22:25], v32, s[8:11], s4 offen sc1
  s_add_u32 s4, s60, 991232
  buffer_store_dwordx4 v[22:25], v32, s[8:11], s4 offen sc1
  s_mov_b32 exec_hi, -1
L_ip_3:
  s_mov_b64 exec, 1
  v_mov_b32 v104, 0
  v_mov_b32 v105, 0
  buffer_store_dword v104, v105, s[8:11], s53 offen sc1
  s_mov_b64 exec, -1
  s_branch L_ci_done
L_ci_n1:
  s_cmp_eq_u32 s24, 2
  s_cbranch_scc0 L_ci_n2
  s_mov_b32 exec_lo, 16711935
  s_mov_b32 exec_hi, 16711935
  s_mul_i32 s4, s32, 6144
  s_add_u32 s4, s4, 118784
  buffer_store_dwordx4 v[22:25], v123, s[8:11], s4 offen sc1
  s_mov_b32 exec_lo, 4294967295
  s_mov_b32 exec_hi, 4294967295
  s_cmp_eq_u32 s39, 0
  s_cbranch_scc1 L_ipa_2_0
  s_mul_i32 s4, s25, 10240
  s_add_u32 s4, s4, 5492736
  buffer_store_dword v22, v34, s[8:11], s4 offen sc1
L_ipa_2_0:
  s_mov_b32 exec_lo, 16711935
  s_mov_b32 exec_hi, 16711935
  s_mul_i32 s4, s32, 6144
  s_add_u32 s4, s4, 315392
  buffer_store_dwordx4 v[22:25], v123, s[8:11], s4 offen sc1
  s_mov_b32 exec_lo, 4294967295
  s_mov_b32 exec_hi, 4294967295
  s_cmp_eq_u32 s39, 0
  s_cbranch_scc1 L_ipa_2_1
  s_mul_i32 s4, s25, 10240
  s_add_u32 s4, s4, 5533696
  buffer_store_dword v22, v34, s[8:11], s4 offen sc1
L_ipa_2_1:
  s_mov_b32 exec_lo, 16711935
  s_mov_b32 exec_hi, 16711935
  s_mul_i32 s4, s32, 6144
  s_add_u32 s4, s4, 512000
  buffer_store_dwordx4 v[22:25], v123, s[8:11], s4 offen sc1
  s_mov_b32 exec_lo, 4294967295
  s_mov_b32 exec_hi, 4294967295
  s_cmp_eq_u32 s39, 0
  s_cbranch_scc1 L_ipa_2_2
  s_mul_i32 s4, s25, 10240
  s_add_u32 s4, s4, 5574656
  buffer_store_dword v22, v34, s[8:11], s4 offen sc1
L_ipa_2_2:
  s_mov_b32 exec_lo, 16711935
  s_mov_b32 exec_hi, 16711935
  s_mul_i32 s4, s32, 6144
  s_add_u32 s4, s4, 708608
  buffer_store_dwordx4 v[22:25], v123, s[8:11], s4 offen sc1
  s_mov_b32 exec_lo, 4294967295
  s_mov_b32 exec_hi, 4294967295
  s_cmp_eq_u32 s39, 0
  s_cbranch_scc1 L_ipa_2_3
  s_mul_i32 s4, s25, 10240
  s_add_u32 s4, s4, 5615616
  buffer_store_dword v22, v34, s[8:11], s4 offen sc1
L_ipa_2_3:
  s_branch L_ci_done
L_ci_n2:
  s_cmp_eq_u32 s24, 3
  s_cbranch_scc0 L_ci_n3
  s_cmp_eq_u32 s39, 0
  s_cbranch_scc1 L_ipa_3_0
  s_mul_i32 s4, s25, 10240
  s_add_u32 s4, s4, 5492736
  buffer_store_dword v22, v34, s[8:11], s4 offen sc1
L_ipa_3_0:
  s_mov_b32 exec_lo, 16711935
  s_mov_b32 exec_hi, 16711935
  s_mov_b32 s4, 905216
  buffer_store_dwordx4 v[22:25], v122, s[8:11], s4 offen sc1
  buffer_store_dwordx2 v[22:23], v123, s[8:11], s4 offen sc1
  s_mov_b32 exec_lo, 4294967295
  s_mov_b32 exec_hi, 4294967295
  s_cmp_eq_u32 s39, 0
  s_cbranch_scc1 L_ipa_3_1
  s_mul_i32 s4, s25, 10240
  s_add_u32 s4, s4, 5533696
  buffer_store_dword v22, v34, s[8:11], s4 offen sc1
L_ipa_3_1:
  s_mov_b32 exec_lo, 16711935
  s_mov_b32 exec_hi, 16711935
  s_mov_b32 s4, 1003520
  buffer_store_dwordx4 v[22:25], v122, s[8:11], s4 offen sc1
  buffer_store_dwordx2 v[22:23], v123, s[8:11], s4 offen sc1
  s_mov_b32 exec_lo, 4294967295
  s_mov_b32 exec_hi, 4294967295
  s_cmp_eq_u32 s39, 0
  s_cbranch_scc1 L_ipa_3_2
  s_mul_i32 s4, s25, 10240
  s_add_u32 s4, s4, 5574656
  buffer_store_dword v22, v34, s[8:11], s4 offen sc1
L_ipa_3_2:
  s_mov_b32 exec_lo, 16711935
  s_mov_b32 exec_hi, 16711935
  s_mov_b32 s4, 1101824
  buffer_store_dwordx4 v[22:25], v122, s[8:11], s4 offen sc1
  buffer_store_dwordx2 v[22:23], v123, s[8:11], s4 offen sc1
  s_mov_b32 exec_lo, 4294967295
  s_mov_b32 exec_hi, 4294967295
  s_cmp_eq_u32 s39, 0
  s_cbranch_scc1 L_ipa_3_3
  s_mul_i32 s4, s25, 10240
  s_add_u32 s4, s4, 5615616
  buffer_store_dword v22, v34, s[8:11], s4 offen sc1
L_ipa_3_3:
  s_mov_b32 exec_lo, 16711935
  s_mov_b32 exec_hi, 16711935
  s_mov_b32 s4, 1200128
  buffer_store_dwordx4 v[22:25], v122, s[8:11], s4 offen sc1
  buffer_store_dwordx2 v[22:23], v123, s[8:11], s4 offen sc1
  s_mov_b32 exec_lo, 4294967295
  s_mov_b32 exec_hi, 4294967295
  s_branch L_ci_done
L_ci_n3:
L_ci_done:
  v_lshrrev_b32 v1, 4, v0
  v_and_b32 v2, 15, v0
  v_and_b32 v3, 7, v0
  v_bfe_u32 v4, v0, 3, 1
  v_lshrrev_b32 v5, 5, v0
  v_and_b32 v6, 1, v1
  v_bfe_u32 v7, v0, 2, 2
  v_and_b32 v8, 3, v0
  s_mov_b32 s6, s69
  v_lshrrev_b32 v10, 1, v1
  v_lshrrev_b32 v11, 1, v7
  v_and_b32 v12, 1, v7
  v_mul_u32_u24 v13, 16, v10
  v_mul_u32_u24 v9, 8, v11
  v_add_u32 v13, v13, v9
  v_mul_u32_u24 v9, 4, v6
  v_add_u32 v13, v13, v9
  v_mul_u32_u24 v9, 1, v12
  v_add_u32 v13, v13, v9
  v_mul_u32_u24 v14, 96, v13
  v_mul_u32_u24 v15, 8, v8
  v_add_u32 v14, v14, v15
  s_waitcnt vmcnt(0)
  s_barrier
  s_cmp_eq_u32 s24, 0
  s_cbranch_scc0 L_ao_chi
  s_mov_b64 exec, 1
  v_mov_b32 v18, 36
  v_mov_b32 v19, 1
  buffer_atomic_add v19, v18, s[12:15], 0 offen
  s_mov_b64 exec, -1
L_ao_chi:
  s_cmp_eq_u32 s24, 3
  s_cbranch_scc1 L_cw_skipqk
  s_lshl_b32 s5, s24, 5
  v_add_u32 v15, s5, v14
  v_add_u32 v16, 61440, v15
  ds_read_b64_tr_b16 a[0:1], v15 offset:0
  ds_read_b64_tr_b16 a[80:81], v16 offset:0
  ds_read_b64_tr_b16 a[2:3], v15 offset:192
  ds_read_b64_tr_b16 a[82:83], v16 offset:192
  ds_read_b64_tr_b16 a[4:5], v15 offset:3072
  ds_read_b64_tr_b16 a[84:85], v16 offset:3072
  ds_read_b64_tr_b16 a[6:7], v15 offset:3264
  ds_read_b64_tr_b16 a[86:87], v16 offset:3264
  s_waitcnt lgkmcnt(0)
  ds_read_b64_tr_b16 a[8:9], v15 offset:6144
  ds_read_b64_tr_b16 a[88:89], v16 offset:6144
  ds_read_b64_tr_b16 a[10:11], v15 offset:6336
  ds_read_b64_tr_b16 a[90:91], v16 offset:6336
  ds_read_b64_tr_b16 a[12:13], v15 offset:9216
  ds_read_b64_tr_b16 a[92:93], v16 offset:9216
  ds_read_b64_tr_b16 a[14:15], v15 offset:9408
  ds_read_b64_tr_b16 a[94:95], v16 offset:9408
  s_waitcnt lgkmcnt(0)
  ds_read_b64_tr_b16 a[16:17], v15 offset:12288
  ds_read_b64_tr_b16 a[96:97], v16 offset:12288
  ds_read_b64_tr_b16 a[18:19], v15 offset:12480
  ds_read_b64_tr_b16 a[98:99], v16 offset:12480
  ds_read_b64_tr_b16 a[20:21], v15 offset:15360
  ds_read_b64_tr_b16 a[100:101], v16 offset:15360
  ds_read_b64_tr_b16 a[22:23], v15 offset:15552
  ds_read_b64_tr_b16 a[102:103], v16 offset:15552
  s_waitcnt lgkmcnt(0)
  ds_read_b64_tr_b16 a[24:25], v15 offset:18432
  ds_read_b64_tr_b16 a[104:105], v16 offset:18432
  ds_read_b64_tr_b16 a[26:27], v15 offset:18624
  ds_read_b64_tr_b16 a[106:107], v16 offset:18624
  ds_read_b64_tr_b16 a[28:29], v15 offset:21504
  ds_read_b64_tr_b16 a[108:109], v16 offset:21504
  ds_read_b64_tr_b16 a[30:31], v15 offset:21696
  ds_read_b64_tr_b16 a[110:111], v16 offset:21696
  s_waitcnt lgkmcnt(0)
  ds_read_b64_tr_b16 a[32:33], v15 offset:24576
  ds_read_b64_tr_b16 a[112:113], v16 offset:24576
  ds_read_b64_tr_b16 a[34:35], v15 offset:24768
  ds_read_b64_tr_b16 a[114:115], v16 offset:24768
  ds_read_b64_tr_b16 a[36:37], v15 offset:27648
  ds_read_b64_tr_b16 a[116:117], v16 offset:27648
  ds_read_b64_tr_b16 a[38:39], v15 offset:27840
  ds_read_b64_tr_b16 a[118:119], v16 offset:27840
  s_waitcnt lgkmcnt(0)
  ds_read_b64_tr_b16 a[40:41], v15 offset:30720
  ds_read_b64_tr_b16 a[120:121], v16 offset:30720
  ds_read_b64_tr_b16 a[42:43], v15 offset:30912
  ds_read_b64_tr_b16 a[122:123], v16 offset:30912
  ds_read_b64_tr_b16 a[44:45], v15 offset:33792
  ds_read_b64_tr_b16 a[124:125], v16 offset:33792
  ds_read_b64_tr_b16 a[46:47], v15 offset:33984
  ds_read_b64_tr_b16 a[126:127], v16 offset:33984
  s_waitcnt lgkmcnt(0)
  ds_read_b64_tr_b16 a[48:49], v15 offset:36864
  ds_read_b64_tr_b16 a[128:129], v16 offset:36864
  ds_read_b64_tr_b16 a[50:51], v15 offset:37056
  ds_read_b64_tr_b16 a[130:131], v16 offset:37056
  ds_read_b64_tr_b16 a[52:53], v15 offset:39936
  ds_read_b64_tr_b16 a[132:133], v16 offset:39936
  ds_read_b64_tr_b16 a[54:55], v15 offset:40128
  ds_read_b64_tr_b16 a[134:135], v16 offset:40128
  s_waitcnt lgkmcnt(0)
  ds_read_b64_tr_b16 a[56:57], v15 offset:43008
  ds_read_b64_tr_b16 a[136:137], v16 offset:43008
  ds_read_b64_tr_b16 a[58:59], v15 offset:43200
  ds_read_b64_tr_b16 a[138:139], v16 offset:43200
  ds_read_b64_tr_b16 a[60:61], v15 offset:46080
  ds_read_b64_tr_b16 a[140:141], v16 offset:46080
  ds_read_b64_tr_b16 a[62:63], v15 offset:46272
  ds_read_b64_tr_b16 a[142:143], v16 offset:46272
  s_waitcnt lgkmcnt(0)
  ds_read_b64_tr_b16 a[64:65], v15 offset:49152
  ds_read_b64_tr_b16 a[144:145], v16 offset:49152
  ds_read_b64_tr_b16 a[66:67], v15 offset:49344
  ds_read_b64_tr_b16 a[146:147], v16 offset:49344
  ds_read_b64_tr_b16 a[68:69], v15 offset:52224
  ds_read_b64_tr_b16 a[148:149], v16 offset:52224
  ds_read_b64_tr_b16 a[70:71], v15 offset:52416
  ds_read_b64_tr_b16 a[150:151], v16 offset:52416
  s_waitcnt lgkmcnt(0)
  ds_read_b64_tr_b16 a[72:73], v15 offset:55296
  ds_read_b64_tr_b16 a[152:153], v16 offset:55296
  ds_read_b64_tr_b16 a[74:75], v15 offset:55488
  ds_read_b64_tr_b16 a[154:155], v16 offset:55488
  ds_read_b64_tr_b16 a[76:77], v15 offset:58368
  ds_read_b64_tr_b16 a[156:157], v16 offset:58368
  ds_read_b64_tr_b16 a[78:79], v15 offset:58560
  ds_read_b64_tr_b16 a[158:159], v16 offset:58560
  s_waitcnt lgkmcnt(0)
L_cw_skipqk:
  s_barrier
  s_load_dwordx2 s[16:17], s[0:1], 32
  s_waitcnt lgkmcnt(0)
  s_and_b32 s17, s17, 0xffff
  s_mov_b32 s18, 7864320
  s_mov_b32 s19, 0x20000
  s_load_dwordx2 s[20:21], s[0:1], 40
  s_waitcnt lgkmcnt(0)
  s_and_b32 s21, s21, 0xffff
  s_mov_b32 s22, 7864320
  s_mov_b32 s23, 0x20000
  s_mov_b32 s4, s24
L_dma_cv:
  s_lshl_b32 s5, s4, 6
  v_add_u32 v10, s5, v0
  v_mul_u32_u24 v11, 43691, v10
  v_lshrrev_b32 v11, 18, v11
  v_mul_u32_u24 v12, 6, v11
  v_sub_u32 v12, v10, v12
  v_lshlrev_b32 v12, 4, v12
  v_mul_u32_u24 v11, 12288, v11
  v_add_u32 v12, v12, v11
  s_lshl_b32 s5, s4, 10
  s_add_u32 s5, s5, 0
  s_mov_b32 m0, s5
  s_add_u32 s4, s4, 4
  buffer_load_dwordx4 v12, s[16:19], s6 offen lds
  s_cmp_lt_u32 s4, 60
  s_cbranch_scc1 L_dma_cv
  s_lshl_b32 s6, s25, 3
  s_lshl_b32 s7, s34, 2
  s_add_u32 s6, s6, s7
  s_mul_i32 s6, s6, 245760
  s_lshl_b32 s7, s36, 5
  s_add_u32 s6, s6, s7
  s_mov_b32 s4, s24
L_dma_co:
  s_lshl_b32 s5, s4, 6
  v_add_u32 v10, s5, v0
  v_mul_u32_u24 v11, 43691, v10
  v_lshrrev_b32 v11, 18, v11
  v_mul_u32_u24 v12, 6, v11
  v_sub_u32 v12, v10, v12
  v_lshlrev_b32 v12, 4, v12
  v_mul_u32_u24 v11, 1280, v11
  v_add_u32 v12, v12, v11
  s_lshl_b32 s5, s4, 10
  s_add_u32 s5, s5, 61440
  s_mov_b32 m0, s5
  s_add_u32 s4, s4, 4
  buffer_load_dwordx4 v12, s[20:23], s6 offen lds
  s_cmp_lt_u32 s4, 72
  s_cbranch_scc1 L_dma_co
  v_lshrrev_b32 v10, 1, v1
  v_lshrrev_b32 v11, 1, v7
  v_and_b32 v12, 1, v7
  v_mul_u32_u24 v13, 48, v10
  v_mul_u32_u24 v9, 16, v6
  v_add_u32 v13, v13, v9
  v_mul_u32_u24 v9, 4, v11
  v_add_u32 v13, v13, v9
  v_mul_u32_u24 v9, 1, v12
  v_add_u32 v13, v13, v9
  v_mul_u32_u24 v17, 96, v13
  v_mul_u32_u24 v13, 48, v10
  v_mul_u32_u24 v9, 4, v6
  v_add_u32 v13, v13, v9
  v_mul_u32_u24 v9, 8, v11
  v_add_u32 v13, v13, v9
  v_mul_u32_u24 v9, 1, v12
  v_add_u32 v13, v13, v9
  v_mul_u32_u24 v18, 96, v13
  v_mul_u32_u24 v15, 8, v8
  s_mul_i32 s5, s24, 18432
  s_add_u32 s5, s5, 61440
  v_add_u32 v15, s5, v15
  v_add_u32 v17, v17, v15
  v_add_u32 v18, v18, v15
  s_waitcnt vmcnt(0)
  s_barrier
  s_cmp_eq_u32 s24, 3
  s_cbranch_scc1 L_cw_w3
  ds_read_b64_tr_b16 a[160:161], v17 offset:0
  ds_read_b64_tr_b16 a[162:163], v17 offset:192
  ds_read_b64_tr_b16 a[164:165], v17 offset:9216
  ds_read_b64_tr_b16 a[166:167], v17 offset:9408
  ds_read_b64_tr_b16 a[168:169], v17 offset:32
  ds_read_b64_tr_b16 a[170:171], v17 offset:224
  ds_read_b64_tr_b16 a[172:173], v17 offset:9248
  ds_read_b64_tr_b16 a[174:175], v17 offset:9440
  ds_read_b64_tr_b16 a[176:177], v17 offset:64
  ds_read_b64_tr_b16 a[178:179], v17 offset:256
  ds_read_b64_tr_b16 a[180:181], v17 offset:9280
  ds_read_b64_tr_b16 a[182:183], v17 offset:9472
  s_waitcnt lgkmcnt(0)
  ds_read_b64_tr_b16 a[184:185], v17 offset:768
  ds_read_b64_tr_b16 a[186:187], v17 offset:960
  ds_read_b64_tr_b16 a[188:189], v17 offset:9984
  ds_read_b64_tr_b16 a[190:191], v17 offset:10176
  ds_read_b64_tr_b16 a[192:193], v17 offset:800
  ds_read_b64_tr_b16 a[194:195], v17 offset:992
  ds_read_b64_tr_b16 a[196:197], v17 offset:10016
  ds_read_b64_tr_b16 a[198:199], v17 offset:10208
  ds_read_b64_tr_b16 a[200:201], v17 offset:832
  ds_read_b64_tr_b16 a[202:203], v17 offset:1024
  ds_read_b64_tr_b16 a[204:205], v17 offset:10048
  ds_read_b64_tr_b16 a[206:207], v17 offset:10240
  s_waitcnt lgkmcnt(0)
  ds_read_b64_tr_b16 a[208:209], v18 offset:3072
  ds_read_b64_tr_b16 a[210:211], v18 offset:3264
  ds_read_b64_tr_b16 a[212:213], v18 offset:12288
  ds_read_b64_tr_b16 a[214:215], v18 offset:12480
  ds_read_b64_tr_b16 a[216:217], v18 offset:3104
  ds_read_b64_tr_b16 a[218:219], v18 offset:3296
  ds_read_b64_tr_b16 a[220:221], v18 offset:12320
  ds_read_b64_tr_b16 a[222:223], v18 offset:12512
  ds_read_b64_tr_b16 a[224:225], v18 offset:3136
  ds_read_b64_tr_b16 a[226:227], v18 offset:3328
  ds_read_b64_tr_b16 a[228:229], v18 offset:12352
  ds_read_b64_tr_b16 a[230:231], v18 offset:12544
  s_waitcnt lgkmcnt(0)
  s_branch L_cw_done
L_cw_w3:
  ds_read_b64_tr_b16 a[0:1], v14 offset:0
  ds_read_b64_tr_b16 a[2:3], v14 offset:192
  ds_read_b64_tr_b16 a[4:5], v14 offset:3072
  ds_read_b64_tr_b16 a[6:7], v14 offset:3264
  ds_read_b64_tr_b16 a[8:9], v14 offset:6144
  ds_read_b64_tr_b16 a[10:11], v14 offset:6336
  ds_read_b64_tr_b16 a[12:13], v14 offset:9216
  ds_read_b64_tr_b16 a[14:15], v14 offset:9408
  ds_read_b64_tr_b16 a[16:17], v14 offset:12288
  ds_read_b64_tr_b16 a[18:19], v14 offset:12480
  ds_read_b64_tr_b16 a[20:21], v14 offset:15360
  ds_read_b64_tr_b16 a[22:23], v14 offset:15552
  s_waitcnt lgkmcnt(0)
  ds_read_b64_tr_b16 a[24:25], v14 offset:18432
  ds_read_b64_tr_b16 a[26:27], v14 offset:18624
  ds_read_b64_tr_b16 a[28:29], v14 offset:21504
  ds_read_b64_tr_b16 a[30:31], v14 offset:21696
  ds_read_b64_tr_b16 a[32:33], v14 offset:24576
  ds_read_b64_tr_b16 a[34:35], v14 offset:24768
  ds_read_b64_tr_b16 a[36:37], v14 offset:27648
  ds_read_b64_tr_b16 a[38:39], v14 offset:27840
  ds_read_b64_tr_b16 a[40:41], v14 offset:30720
  ds_read_b64_tr_b16 a[42:43], v14 offset:30912
  ds_read_b64_tr_b16 a[44:45], v14 offset:33792
  ds_read_b64_tr_b16 a[46:47], v14 offset:33984
  s_waitcnt lgkmcnt(0)
  ds_read_b64_tr_b16 a[48:49], v14 offset:36864
  ds_read_b64_tr_b16 a[50:51], v14 offset:37056
  ds_read_b64_tr_b16 a[52:53], v14 offset:39936
  ds_read_b64_tr_b16 a[54:55], v14 offset:40128
  ds_read_b64_tr_b16 a[56:57], v14 offset:43008
  ds_read_b64_tr_b16 a[58:59], v14 offset:43200
  ds_read_b64_tr_b16 a[60:61], v14 offset:46080
  ds_read_b64_tr_b16 a[62:63], v14 offset:46272
  ds_read_b64_tr_b16 a[64:65], v14 offset:49152
  ds_read_b64_tr_b16 a[66:67], v14 offset:49344
  ds_read_b64_tr_b16 a[68:69], v14 offset:52224
  ds_read_b64_tr_b16 a[70:71], v14 offset:52416
  s_waitcnt lgkmcnt(0)
  ds_read_b64_tr_b16 a[72:73], v14 offset:55296
  ds_read_b64_tr_b16 a[74:75], v14 offset:55488
  ds_read_b64_tr_b16 a[76:77], v14 offset:58368
  ds_read_b64_tr_b16 a[78:79], v14 offset:58560
  s_waitcnt lgkmcnt(0)
  ds_read_b64_tr_b16 a[80:81], v14 offset:32
  ds_read_b64_tr_b16 a[82:83], v14 offset:224
  ds_read_b64_tr_b16 a[84:85], v14 offset:3104
  ds_read_b64_tr_b16 a[86:87], v14 offset:3296
  ds_read_b64_tr_b16 a[88:89], v14 offset:6176
  ds_read_b64_tr_b16 a[90:91], v14 offset:6368
  ds_read_b64_tr_b16 a[92:93], v14 offset:9248
  ds_read_b64_tr_b16 a[94:95], v14 offset:9440
  ds_read_b64_tr_b16 a[96:97], v14 offset:12320
  ds_read_b64_tr_b16 a[98:99], v14 offset:12512
  ds_read_b64_tr_b16 a[100:101], v14 offset:15392
  ds_read_b64_tr_b16 a[102:103], v14 offset:15584
  s_waitcnt lgkmcnt(0)
  ds_read_b64_tr_b16 a[104:105], v14 offset:18464
  ds_read_b64_tr_b16 a[106:107], v14 offset:18656
  ds_read_b64_tr_b16 a[108:109], v14 offset:21536
  ds_read_b64_tr_b16 a[110:111], v14 offset:21728
  ds_read_b64_tr_b16 a[112:113], v14 offset:24608
  ds_read_b64_tr_b16 a[114:115], v14 offset:24800
  ds_read_b64_tr_b16 a[116:117], v14 offset:27680
  ds_read_b64_tr_b16 a[118:119], v14 offset:27872
  ds_read_b64_tr_b16 a[120:121], v14 offset:30752
  ds_read_b64_tr_b16 a[122:123], v14 offset:30944
  ds_read_b64_tr_b16 a[124:125], v14 offset:33824
  ds_read_b64_tr_b16 a[126:127], v14 offset:34016
  s_waitcnt lgkmcnt(0)
  ds_read_b64_tr_b16 a[128:129], v14 offset:36896
  ds_read_b64_tr_b16 a[130:131], v14 offset:37088
  ds_read_b64_tr_b16 a[132:133], v14 offset:39968
  ds_read_b64_tr_b16 a[134:135], v14 offset:40160
  ds_read_b64_tr_b16 a[136:137], v14 offset:43040
  ds_read_b64_tr_b16 a[138:139], v14 offset:43232
  ds_read_b64_tr_b16 a[140:141], v14 offset:46112
  ds_read_b64_tr_b16 a[142:143], v14 offset:46304
  ds_read_b64_tr_b16 a[144:145], v14 offset:49184
  ds_read_b64_tr_b16 a[146:147], v14 offset:49376
  ds_read_b64_tr_b16 a[148:149], v14 offset:52256
  ds_read_b64_tr_b16 a[150:151], v14 offset:52448
  s_waitcnt lgkmcnt(0)
  ds_read_b64_tr_b16 a[152:153], v14 offset:55328
  ds_read_b64_tr_b16 a[154:155], v14 offset:55520
  ds_read_b64_tr_b16 a[156:157], v14 offset:58400
  ds_read_b64_tr_b16 a[158:159], v14 offset:58592
  s_waitcnt lgkmcnt(0)
  ds_read_b64_tr_b16 a[160:161], v14 offset:64
  ds_read_b64_tr_b16 a[162:163], v14 offset:256
  ds_read_b64_tr_b16 a[164:165], v14 offset:3136
  ds_read_b64_tr_b16 a[166:167], v14 offset:3328
  ds_read_b64_tr_b16 a[168:169], v14 offset:6208
  ds_read_b64_tr_b16 a[170:171], v14 offset:6400
  ds_read_b64_tr_b16 a[172:173], v14 offset:9280
  ds_read_b64_tr_b16 a[174:175], v14 offset:9472
  ds_read_b64_tr_b16 a[176:177], v14 offset:12352
  ds_read_b64_tr_b16 a[178:179], v14 offset:12544
  ds_read_b64_tr_b16 a[180:181], v14 offset:15424
  ds_read_b64_tr_b16 a[182:183], v14 offset:15616
  s_waitcnt lgkmcnt(0)
  ds_read_b64_tr_b16 a[184:185], v14 offset:18496
  ds_read_b64_tr_b16 a[186:187], v14 offset:18688
  ds_read_b64_tr_b16 a[188:189], v14 offset:21568
  ds_read_b64_tr_b16 a[190:191], v14 offset:21760
  ds_read_b64_tr_b16 a[192:193], v14 offset:24640
  ds_read_b64_tr_b16 a[194:195], v14 offset:24832
  ds_read_b64_tr_b16 a[196:197], v14 offset:27712
  ds_read_b64_tr_b16 a[198:199], v14 offset:27904
  ds_read_b64_tr_b16 a[200:201], v14 offset:30784
  ds_read_b64_tr_b16 a[202:203], v14 offset:30976
  ds_read_b64_tr_b16 a[204:205], v14 offset:33856
  ds_read_b64_tr_b16 a[206:207], v14 offset:34048
  s_waitcnt lgkmcnt(0)
  ds_read_b64_tr_b16 a[208:209], v14 offset:36928
  ds_read_b64_tr_b16 a[210:211], v14 offset:37120
  ds_read_b64_tr_b16 a[212:213], v14 offset:40000
  ds_read_b64_tr_b16 a[214:215], v14 offset:40192
  ds_read_b64_tr_b16 a[216:217], v14 offset:43072
  ds_read_b64_tr_b16 a[218:219], v14 offset:43264
  ds_read_b64_tr_b16 a[220:221], v14 offset:46144
  ds_read_b64_tr_b16 a[222:223], v14 offset:46336
  ds_read_b64_tr_b16 a[224:225], v14 offset:49216
  ds_read_b64_tr_b16 a[226:227], v14 offset:49408
  ds_read_b64_tr_b16 a[228:229], v14 offset:52288
  ds_read_b64_tr_b16 a[230:231], v14 offset:52480
  s_waitcnt lgkmcnt(0)
  ds_read_b64_tr_b16 a[232:233], v14 offset:55360
  ds_read_b64_tr_b16 a[234:235], v14 offset:55552
  ds_read_b64_tr_b16 a[236:237], v14 offset:58432
  ds_read_b64_tr_b16 a[238:239], v14 offset:58624
  s_waitcnt lgkmcnt(0)
  ds_read_b64_tr_b16 a[240:241], v17 offset:0
  ds_read_b64_tr_b16 a[242:243], v17 offset:192
  ds_read_b64_tr_b16 a[244:245], v17 offset:9216
  ds_read_b64_tr_b16 a[246:247], v17 offset:9408
  ds_read_b64_tr_b16 a[248:249], v17 offset:32
  ds_read_b64_tr_b16 a[250:251], v17 offset:224
  ds_read_b64_tr_b16 a[252:253], v17 offset:9248
  ds_read_b64_tr_b16 a[254:255], v17 offset:9440
  ds_read_b64_tr_b16 v[200:201], v17 offset:64
  ds_read_b64_tr_b16 v[202:203], v17 offset:256
  ds_read_b64_tr_b16 v[204:205], v17 offset:9280
  ds_read_b64_tr_b16 v[206:207], v17 offset:9472
  s_waitcnt lgkmcnt(0)
  ds_read_b64_tr_b16 v[208:209], v17 offset:768
  ds_read_b64_tr_b16 v[210:211], v17 offset:960
  ds_read_b64_tr_b16 v[212:213], v17 offset:9984
  ds_read_b64_tr_b16 v[214:215], v17 offset:10176
  ds_read_b64_tr_b16 v[216:217], v17 offset:800
  ds_read_b64_tr_b16 v[218:219], v17 offset:992
  ds_read_b64_tr_b16 v[220:221], v17 offset:10016
  ds_read_b64_tr_b16 v[222:223], v17 offset:10208
  ds_read_b64_tr_b16 v[224:225], v17 offset:832
  ds_read_b64_tr_b16 v[226:227], v17 offset:1024
  ds_read_b64_tr_b16 v[228:229], v17 offset:10048
  ds_read_b64_tr_b16 v[230:231], v17 offset:10240
  s_waitcnt lgkmcnt(0)
  ds_read_b64_tr_b16 v[232:233], v18 offset:3072
  ds_read_b64_tr_b16 v[234:235], v18 offset:3264
  ds_read_b64_tr_b16 v[236:237], v18 offset:12288
  ds_read_b64_tr_b16 v[238:239], v18 offset:12480
  ds_read_b64_tr_b16 v[240:241], v18 offset:3104
  ds_read_b64_tr_b16 v[242:243], v18 offset:3296
  ds_read_b64_tr_b16 v[244:245], v18 offset:12320
  ds_read_b64_tr_b16 v[246:247], v18 offset:12512
  ds_read_b64_tr_b16 v[248:249], v18 offset:3136
  ds_read_b64_tr_b16 v[250:251], v18 offset:3328
  ds_read_b64_tr_b16 v[252:253], v18 offset:12352
  ds_read_b64_tr_b16 v[254:255], v18 offset:12544
  s_waitcnt lgkmcnt(0)
L_cw_done:
  s_barrier
  s_mov_b32 s28, 131072
  s_mov_b32 s29, 1
  v_lshlrev_b32 v1, 2, v0
L_wc_ch:
  buffer_load_dword v2, v1, s[12:15], 0 offen sc1
  s_waitcnt vmcnt(0)
  s_sub_u32 s28, s28, 1
  s_cbranch_scc1 L_abort
  v_readlane_b32 s64, v2, 0
  v_readlane_b32 s65, v2, 1
  v_readlane_b32 s66, v2, 2
  v_readlane_b32 s67, v2, 3
  v_readlane_b32 s68, v2, 4
  v_readlane_b32 s69, v2, 5
  v_readlane_b32 s70, v2, 6
  v_readlane_b32 s71, v2, 7
  s_add_u32 s3, s64, s65
  s_add_u32 s3, s3, s66
  s_add_u32 s3, s3, s67
  s_add_u32 s3, s3, s68
  s_add_u32 s3, s3, s69
  s_add_u32 s3, s3, s70
  s_add_u32 s3, s3, s71
  s_cmp_ge_u32 s3, 256
  s_cbranch_scc0 L_wc_ch
  s_cmp_eq_u32 s24, 0
  s_cbranch_scc0 L_wd_iwch
  s_mov_b32 s28, 131072
  s_mov_b32 s29, 2
  v_mov_b32 v18, 36
L_wn_iwch:
  buffer_load_dword v19, v18, s[12:15], 0 offen sc1
  s_waitcnt vmcnt(0)
  v_readfirstlane_b32 s3, v19
  s_sub_u32 s28, s28, 1
  s_cbranch_scc1 L_abort
  s_cmp_ge_u32 s3, 256
  s_cbranch_scc1 L_wd_iwch
  s_sleep 8
  s_branch L_wn_iwch
L_wd_iwch:
  s_barrier
  s_cmp_eq_u32 s24, 0
  s_cbranch_scc0 L_wd_par
  s_mov_b32 s28, 131072
  s_mov_b32 s29, 3
  v_mov_b32 v18, 44
L_wn_par:
  buffer_load_dword v19, v18, s[12:15], 0 offen sc1
  s_waitcnt vmcnt(0)
  v_readfirstlane_b32 s3, v19
  s_sub_u32 s28, s28, 1
  s_cbranch_scc1 L_abort
  s_cmp_ge_u32 s3, 1
  s_cbranch_scc1 L_wd_par
  s_sleep 4
  s_branch L_wn_par
L_wd_par:
  s_barrier
  v_mov_b32 v1, 44
  buffer_load_dword v2, v1, s[12:15], 0 offen sc1
  s_waitcnt vmcnt(0)
  v_readfirstlane_b32 s3, v2
  s_cmp_eq_u32 s3, 2
  s_cselect_b32 s3, 8192, 0
  s_add_u32 s61, s60, s3
  s_lshl_b32 s3, s25, 0
  s_cmp_eq_u32 s25, 0
  s_cselect_b32 s3, s64, s3
  s_cmp_eq_u32 s25, 1
  s_cselect_b32 s3, s65, s3
  s_cmp_eq_u32 s25, 2
  s_cselect_b32 s3, s66, s3
  s_cmp_eq_u32 s25, 3
  s_cselect_b32 s3, s67, s3
  s_cmp_lt_u32 s3, 32
  s_cselect_b32 s27, 1, 0
  s_or_b32 s27, s27, 0
  s_cmp_eq_u32 s27, 1
  s_cbranch_scc1 L_chain_slow
  s_cmp_eq_u32 s24, 1
  s_cbranch_scc1 L_cw1f
  s_cmp_eq_u32 s24, 2
  s_cbranch_scc1 L_cw2f
  s_cmp_eq_u32 s24, 3
  s_cbranch_scc1 L_cw3f
  v_mov_b32 v142, 0
  v_mov_b32 v143, 0
  v_mov_b32 v150, 0
  v_mov_b32 v151, 0
  s_mov_b32 s30, 0
  s_mov_b32 s56, 0
  v_mov_b32 v37, 0
  s_and_b32 s58, s30, 3
  s_mul_i32 s40, s58, 40960
  s_mul_i32 s59, s25, 10240
  s_add_u32 s59, s59, 5492736
  s_add_u32 s40, s40, s59
  s_add_u32 s41, s40, 4096
  s_add_u32 s42, s40, 8192
  s_mul_i32 s45, s58, 98304
  s_add_u32 s45, s45, 905216
  s_mul_i32 s46, s58, 327680
  s_add_u32 s46, s46, s61
  s_mul_i32 s43, s58, 196608
  s_mul_i32 s3, s32, 6144
  s_add_u32 s3, s3, 118784
  s_add_u32 s43, s43, s3
  s_add_u32 s44, s43, 3072
  s_add_u32 s58, s30, 1
  s_and_b32 s58, s58, 3
  s_mul_i32 s47, s58, 40960
  s_add_u32 s47, s47, s59
  s_add_u32 s58, s30, 3
  s_and_b32 s58, s58, 3
  s_mul_i32 s51, s58, 40960
  s_add_u32 s51, s51, s59
  s_mul_i32 s48, s58, 196608
  s_add_u32 s48, s48, s3
  s_mul_i32 s49, s58, 98304
  s_add_u32 s49, s49, 905216
  s_add_u32 s58, s30, 2
  s_and_b32 s58, s58, 3
  s_mul_i32 s50, s58, 327680
  s_add_u32 s50, s50, s61
  s_mul_i32 s54, s30, 196608
  s_add_u32 s55, s54, 96358400
  s_add_u32 s54, s54, 83775488
  s_load_dwordx2 s[16:17], s[0:1], 8
  s_waitcnt lgkmcnt(0)
  s_and_b32 s17, s17, 0xffff
  s_mov_b32 s18, 10240
  s_mov_b32 s19, 0x20000
  buffer_load_dwordx4 v[104:107], v36, s[16:19], 0 offen offset:0
  buffer_load_dwordx4 v[108:111], v36, s[16:19], 0 offen offset:512
  buffer_load_dwordx4 v[112:115], v36, s[16:19], 0 offen offset:1024
  s_waitcnt vmcnt(0)
  v_mov_b32 v128, 0
  v_mov_b32 v129, 0
  v_mov_b32 v130, 0
  v_mov_b32 v131, 0
  v_mov_b32 v132, 0
  v_mov_b32 v133, 0
  v_mov_b32 v134, 0
  v_mov_b32 v135, 0
  s_branch L_have_w0f
L_step_w0f:
  s_mov_b32 s28, 131072
  s_mov_b32 s29, 20
  buffer_load_dwordx4 v[164:167], v26, s[8:11], s40 offen sc1
  buffer_load_dwordx4 v[168:171], v26, s[8:11], s41 offen sc1
  buffer_load_dwordx4 v[172:175], v26, s[8:11], s42 offen sc1
  s_sleep 1
  buffer_load_dwordx4 v[176:179], v26, s[8:11], s40 offen sc1
  buffer_load_dwordx4 v[180:183], v26, s[8:11], s41 offen sc1
  buffer_load_dwordx4 v[184:187], v26, s[8:11], s42 offen sc1
L_agp_w0f_a:
  s_waitcnt vmcnt(3)
  v_max3_u32 v188, v164, v168, v172
  v_cmp_eq_u32 vcc, -1, v188
  s_cbranch_vccz L_agp_w0f_oka
  s_sub_u32 s28, s28, 1
  s_cbranch_scc1 L_abort
  buffer_load_dwordx4 v[164:167], v26, s[8:11], s40 offen sc1
  buffer_load_dwordx4 v[168:171], v26, s[8:11], s41 offen sc1
  buffer_load_dwordx4 v[172:175], v26, s[8:11], s42 offen sc1
  s_waitcnt vmcnt(3)
  v_max3_u32 v188, v176, v180, v184
  v_cmp_eq_u32 vcc, -1, v188
  s_cbranch_vccz L_agp_w0f_okb
  s_sub_u32 s28, s28, 1
  s_cbranch_scc1 L_abort
  buffer_load_dwordx4 v[176:179], v26, s[8:11], s40 offen sc1
  buffer_load_dwordx4 v[180:183], v26, s[8:11], s41 offen sc1
  buffer_load_dwordx4 v[184:187], v26, s[8:11], s42 offen sc1
  s_branch L_agp_w0f_a
L_agp_w0f_okb:
  ds_write_b128 v27, v[176:179] offset:0
  ds_write_b128 v27, v[180:183] offset:4096
  ds_write_b128 v27, v[184:187] offset:8192
  s_branch L_agp_w0f_d
L_agp_w0f_oka:
  ds_write_b128 v27, v[164:167] offset:0
  ds_write_b128 v27, v[168:171] offset:4096
  ds_write_b128 v27, v[172:175] offset:8192
L_agp_w0f_d:
  s_branch L_staged_w0f
L_have_w0f:
  ds_write_b128 v27, v[104:107] offset:0
  ds_write_b128 v27, v[108:111] offset:4096
  ds_write_b128 v27, v[112:115] offset:8192
L_staged_w0f:
  s_waitcnt lgkmcnt(0)
  s_barrier
  ds_read_b128 v[40:43], v28 offset:0
  ds_read_b128 v[44:47], v28 offset:1024
  ds_read_b128 v[48:51], v28 offset:2048
  ds_read_b128 v[52:55], v28 offset:3072
  ds_read_b128 v[56:59], v28 offset:4096
  ds_read_b128 v[60:63], v28 offset:5120
  ds_read_b128 v[64:67], v28 offset:6144
  ds_read_b128 v[68:71], v28 offset:7168
  ds_read_b128 v[72:75], v28 offset:8192
  ds_read_b128 v[76:79], v28 offset:9216
  s_waitcnt lgkmcnt(9)
  v_smfmac_f32_16x16x64_bf16 v[128:131], v[40:43], a[0:7], v20
  v_smfmac_f32_16x16x64_bf16 v[132:135], v[40:43], a[80:87], v20
  s_waitcnt lgkmcnt(8)
  v_smfmac_f32_16x16x64_bf16 v[128:131], v[44:47], a[8:15], v20
  v_smfmac_f32_16x16x64_bf16 v[132:135], v[44:47], a[88:95], v20
  s_waitcnt lgkmcnt(7)
  v_smfmac_f32_16x16x64_bf16 v[128:131], v[48:51], a[16:23], v20
  v_smfmac_f32_16x16x64_bf16 v[132:135], v[48:51], a[96:103], v20
  buffer_store_dwordx4 v[22:25], v32, s[8:11], s50 offen sc1
  s_mov_b64 exec, 1
  v_mov_b32 v118, s30
  v_mov_b32 v119, 0
  buffer_store_dword v118, v119, s[8:11], s53 offen sc1
  s_mov_b64 exec, -1
  s_waitcnt lgkmcnt(6)
  v_smfmac_f32_16x16x64_bf16 v[128:131], v[52:55], a[24:31], v20
  v_smfmac_f32_16x16x64_bf16 v[132:135], v[52:55], a[104:111], v20
  s_waitcnt lgkmcnt(5)
  v_smfmac_f32_16x16x64_bf16 v[128:131], v[56:59], a[32:39], v20
  v_smfmac_f32_16x16x64_bf16 v[132:135], v[56:59], a[112:119], v20
  s_waitcnt lgkmcnt(4)
  v_smfmac_f32_16x16x64_bf16 v[128:131], v[60:63], a[40:47], v20
  v_smfmac_f32_16x16x64_bf16 v[132:135], v[60:63], a[120:127], v20
  s_waitcnt lgkmcnt(3)
  v_smfmac_f32_16x16x64_bf16 v[128:131], v[64:67], a[48:55], v20
  v_smfmac_f32_16x16x64_bf16 v[132:135], v[64:67], a[128:135], v20
  s_waitcnt lgkmcnt(2)
  v_smfmac_f32_16x16x64_bf16 v[128:131], v[68:71], a[56:63], v20
  v_smfmac_f32_16x16x64_bf16 v[132:135], v[68:71], a[136:143], v20
  s_waitcnt lgkmcnt(1)
  v_smfmac_f32_16x16x64_bf16 v[128:131], v[72:75], a[64:71], v20
  v_smfmac_f32_16x16x64_bf16 v[132:135], v[72:75], a[144:151], v20
  s_waitcnt lgkmcnt(0)
  v_smfmac_f32_16x16x64_bf16 v[128:131], v[76:79], a[72:79], v20
  v_smfmac_f32_16x16x64_bf16 v[132:135], v[76:79], a[152:159], v20
  s_nop 7
  v_permlane32_swap_b32 v128, v132
  v_permlane32_swap_b32 v129, v133
  v_permlane32_swap_b32 v130, v134
  v_permlane32_swap_b32 v131, v135
  v_add_f32 v128, v128, v132
  v_add_f32 v129, v129, v133
  v_add_f32 v130, v130, v134
  v_add_f32 v131, v131, v135
  v_cvt_pk_bf16_f32 v104, v128, v129
  v_cvt_pk_bf16_f32 v105, v130, v131
  ds_write_b64 v120, v[104:105]
  s_waitcnt lgkmcnt(0)
  s_barrier
  ds_read_b64_tr_b16 v[136:137], v121
  ds_read_b64_tr_b16 v[138:139], v121 offset:384
  ds_read_b64_tr_b16 v[140:141], v122
  ds_read_b64_tr_b16 v[144:145], v121 offset:1280
  ds_read_b64_tr_b16 v[146:147], v121 offset:1664
  ds_read_b64_tr_b16 v[148:149], v122 offset:1280
  s_cmp_eq_u32 s30, 63
  s_cbranch_scc1 L_last_w0f
  s_waitcnt lgkmcnt(0)
  v_mfma_f32_16x16x32_bf16 v[152:155], v[144:147], v[136:139], 0
  v_mfma_f32_16x16x32_bf16 v[152:155], v[148:151], v[140:143], v[152:155]
  s_mov_b32 exec_lo, 16711935
  s_mov_b32 exec_hi, 0
  s_nop 5
  buffer_store_dwordx4 v[152:155], v123, s[8:11], s43 offen
  s_mov_b32 exec_lo, 4294967295
  s_mov_b32 exec_hi, 4294967295
  v_mov_b32 v92, 0
  v_mov_b32 v93, 0
  v_mov_b32 v94, 0
  v_mov_b32 v95, 0
  v_mov_b32 v96, 0
  v_mov_b32 v97, 0
  v_mov_b32 v98, 0
  v_mov_b32 v99, 0
  v_mov_b32 v100, 0
  v_mov_b32 v101, 0
  v_mov_b32 v102, 0
  v_mov_b32 v103, 0
  s_barrier
  s_mov_b32 s28, 131072
  s_mov_b32 s29, 40
  buffer_load_dwordx4 v[80:83], v29, s[8:11], s45 offen offset:0 sc1
  buffer_load_dwordx4 v[84:87], v29, s[8:11], s45 offen offset:1024 sc1
  buffer_load_dwordx4 v[88:91], v29, s[8:11], s45 offen offset:2048 sc1
  s_sleep 2
  buffer_load_dwordx4 v[192:195], v29, s[8:11], s45 offen offset:0 sc1
  buffer_load_dwordx4 v[196:199], v29, s[8:11], s45 offen offset:1024 sc1
  buffer_load_dwordx4 v[200:203], v29, s[8:11], s45 offen offset:2048 sc1
L_op_w0f_a:
  s_waitcnt vmcnt(3)
  v_max3_u32 v188, v80, v84, v88
  v_cmp_eq_u32 vcc, -1, v188
  s_cbranch_vccz L_op_w0f_oka
  s_sub_u32 s28, s28, 1
  s_cbranch_scc1 L_abort
  buffer_load_dwordx4 v[80:83], v29, s[8:11], s45 offen offset:0 sc1
  buffer_load_dwordx4 v[84:87], v29, s[8:11], s45 offen offset:1024 sc1
  buffer_load_dwordx4 v[88:91], v29, s[8:11], s45 offen offset:2048 sc1
  s_waitcnt vmcnt(3)
  v_max3_u32 v188, v192, v196, v200
  v_cmp_eq_u32 vcc, -1, v188
  s_cbranch_vccz L_op_w0f_okb
  s_sub_u32 s28, s28, 1
  s_cbranch_scc1 L_abort
  buffer_load_dwordx4 v[192:195], v29, s[8:11], s45 offen offset:0 sc1
  buffer_load_dwordx4 v[196:199], v29, s[8:11], s45 offen offset:1024 sc1
  buffer_load_dwordx4 v[200:203], v29, s[8:11], s45 offen offset:2048 sc1
  s_branch L_op_w0f_a
L_op_w0f_okb:
  v_smfmac_f32_16x16x64_bf16 v[92:95], v[192:195], a[160:167], v20
  v_smfmac_f32_16x16x64_bf16 v[96:99], v[192:195], a[168:175], v20
  v_smfmac_f32_16x16x64_bf16 v[100:103], v[192:195], a[176:183], v20
  v_smfmac_f32_16x16x64_bf16 v[92:95], v[196:199], a[184:191], v20
  v_smfmac_f32_16x16x64_bf16 v[96:99], v[196:199], a[192:199], v20
  v_smfmac_f32_16x16x64_bf16 v[100:103], v[196:199], a[200:207], v20
  v_smfmac_f32_16x16x64_bf16 v[92:95], v[200:203], a[208:215], v20
  v_smfmac_f32_16x16x64_bf16 v[96:99], v[200:203], a[216:223], v20
  v_smfmac_f32_16x16x64_bf16 v[100:103], v[200:203], a[224:231], v20
  s_branch L_op_w0f_d
L_op_w0f_oka:
  v_smfmac_f32_16x16x64_bf16 v[92:95], v[80:83], a[160:167], v20
  v_smfmac_f32_16x16x64_bf16 v[96:99], v[80:83], a[168:175], v20
  v_smfmac_f32_16x16x64_bf16 v[100:103], v[80:83], a[176:183], v20
  v_smfmac_f32_16x16x64_bf16 v[92:95], v[84:87], a[184:191], v20
  v_smfmac_f32_16x16x64_bf16 v[96:99], v[84:87], a[192:199], v20
  v_smfmac_f32_16x16x64_bf16 v[100:103], v[84:87], a[200:207], v20
  v_smfmac_f32_16x16x64_bf16 v[92:95], v[88:91], a[208:215], v20
  v_smfmac_f32_16x16x64_bf16 v[96:99], v[88:91], a[216:223], v20
  v_smfmac_f32_16x16x64_bf16 v[100:103], v[88:91], a[224:231], v20
L_op_w0f_d:
  s_nop 5
  v_permlane32_swap_b32 v92, v93
  v_permlane32_swap_b32 v94, v95
  v_permlane32_swap_b32 v96, v97
  v_permlane32_swap_b32 v98, v99
  v_permlane32_swap_b32 v100, v101
  v_permlane32_swap_b32 v102, v103
  v_add_f32 v92, v92, v93
  v_add_f32 v94, v94, v95
  v_add_f32 v96, v96, v97
  v_add_f32 v98, v98, v99
  v_add_f32 v100, v100, v101
  v_add_f32 v102, v102, v103
  ds_write_b32 v30, v92 offset:0
  ds_write_b32 v30, v94 offset:128
  ds_write_b32 v30, v96 offset:512
  ds_write_b32 v30, v98 offset:640
  ds_write_b32 v30, v100 offset:1024
  ds_write_b32 v30, v102 offset:1152
  s_waitcnt lgkmcnt(0)
  s_barrier
  ds_read_b128 v[104:107], v31 offset:0
  ds_read_b128 v[108:111], v31 offset:1536
  ds_read_b128 v[112:115], v31 offset:3072
  ds_read_b128 v[116:119], v31 offset:4608
  s_waitcnt lgkmcnt(2)
  v_add_f32 v104, v104, v108
  v_add_f32 v105, v105, v109
  v_add_f32 v106, v106, v110
  v_add_f32 v107, v107, v111
  s_waitcnt lgkmcnt(0)
  v_add_f32 v112, v112, v116
  v_add_f32 v113, v113, v117
  v_add_f32 v114, v114, v118
  v_add_f32 v115, v115, v119
  v_add_f32 v104, v104, v112
  v_add_f32 v105, v105, v113
  v_add_f32 v106, v106, v114
  v_add_f32 v107, v107, v115
  buffer_store_dwordx4 v[104:107], v32, s[8:11], s46 offen sc1
  s_mov_b32 exec_lo, 16711935
  s_mov_b32 exec_hi, 16711935
  buffer_store_dwordx4 v[144:147], v126, s[8:11], s54 offen sc1
  buffer_store_dwordx2 v[148:149], v127, s[8:11], s54 offen sc1
  s_mov_b32 exec_lo, 4294967295
  s_mov_b32 exec_hi, 4294967295
  s_mov_b32 exec_lo, 16711935
  s_mov_b32 exec_hi, 0
  buffer_store_dwordx4 v[22:25], v123, s[8:11], s48 offen
  s_mov_b32 exec_lo, 4294967295
  s_mov_b32 exec_hi, 4294967295
  s_add_u32 s30, s30, 1
  s_and_b32 s58, s30, 3
  s_mul_i32 s40, s58, 40960
  s_mul_i32 s59, s25, 10240
  s_add_u32 s59, s59, 5492736
  s_add_u32 s40, s40, s59
  s_add_u32 s41, s40, 4096
  s_add_u32 s42, s40, 8192
  s_mul_i32 s45, s58, 98304
  s_add_u32 s45, s45, 905216
  s_mul_i32 s46, s58, 327680
  s_add_u32 s46, s46, s61
  s_mul_i32 s43, s58, 196608
  s_mul_i32 s3, s32, 6144
  s_add_u32 s3, s3, 118784
  s_add_u32 s43, s43, s3
  s_add_u32 s44, s43, 3072
  s_add_u32 s58, s30, 1
  s_and_b32 s58, s58, 3
  s_mul_i32 s47, s58, 40960
  s_add_u32 s47, s47, s59
  s_add_u32 s58, s30, 3
  s_and_b32 s58, s58, 3
  s_mul_i32 s51, s58, 40960
  s_add_u32 s51, s51, s59
  s_mul_i32 s48, s58, 196608
  s_add_u32 s48, s48, s3
  s_mul_i32 s49, s58, 98304
  s_add_u32 s49, s49, 905216
  s_add_u32 s58, s30, 2
  s_and_b32 s58, s58, 3
  s_mul_i32 s50, s58, 327680
  s_add_u32 s50, s50, s61
  s_mul_i32 s54, s30, 196608
  s_add_u32 s55, s54, 96358400
  s_add_u32 s54, s54, 83775488
  v_mov_b32 v128, 0
  v_mov_b32 v129, 0
  v_mov_b32 v130, 0
  v_mov_b32 v131, 0
  v_mov_b32 v132, 0
  v_mov_b32 v133, 0
  v_mov_b32 v134, 0
  v_mov_b32 v135, 0
  s_barrier
  s_branch L_step_w0f
L_last_w0f:
  s_waitcnt lgkmcnt(0)
  s_mov_b32 exec_lo, 16711935
  s_mov_b32 exec_hi, 16711935
  buffer_store_dwordx4 v[144:147], v126, s[8:11], s54 offen sc1
  buffer_store_dwordx2 v[148:149], v127, s[8:11], s54 offen sc1
  s_waitcnt vmcnt(0)
  s_mov_b64 exec, 1
  v_mov_b32 v104, 64
  v_mov_b32 v105, 0
  buffer_store_dword v104, v105, s[8:11], s53 offen sc1
  s_waitcnt vmcnt(0)
  s_mov_b64 exec, -1
  s_branch L_exit
L_cw1f:
  v_mov_b32 v142, 0
  v_mov_b32 v143, 0
  v_mov_b32 v150, 0
  v_mov_b32 v151, 0
  s_mov_b32 s30, 0
  s_mov_b32 s56, 0
  v_mov_b32 v37, 0
  s_and_b32 s58, s30, 3
  s_mul_i32 s40, s58, 40960
  s_mul_i32 s59, s25, 10240
  s_add_u32 s59, s59, 5492736
  s_add_u32 s40, s40, s59
  s_add_u32 s41, s40, 4096
  s_add_u32 s42, s40, 8192
  s_mul_i32 s45, s58, 98304
  s_add_u32 s45, s45, 905216
  s_mul_i32 s46, s58, 327680
  s_add_u32 s46, s46, s61
  s_mul_i32 s43, s58, 196608
  s_mul_i32 s3, s32, 6144
  s_add_u32 s3, s3, 118784
  s_add_u32 s43, s43, s3
  s_add_u32 s44, s43, 3072
  s_add_u32 s58, s30, 1
  s_and_b32 s58, s58, 3
  s_mul_i32 s47, s58, 40960
  s_add_u32 s47, s47, s59
  s_add_u32 s58, s30, 3
  s_and_b32 s58, s58, 3
  s_mul_i32 s51, s58, 40960
  s_add_u32 s51, s51, s59
  s_mul_i32 s48, s58, 196608
  s_add_u32 s48, s48, s3
  s_mul_i32 s49, s58, 98304
  s_add_u32 s49, s49, 905216
  s_add_u32 s58, s30, 2
  s_and_b32 s58, s58, 3
  s_mul_i32 s50, s58, 327680
  s_add_u32 s50, s50, s61
  s_mul_i32 s54, s30, 196608
  s_add_u32 s55, s54, 96358400
  s_add_u32 s54, s54, 83775488
  s_add_u32 s6, s30, 1
  s_cmp_ge_u32 s56, s6
  s_cbranch_scc1 L_fa_ok_w1fp0
  v_readlane_b32 s56, v37, 0
  v_readlane_b32 s4, v37, 1
  v_readlane_b32 s5, v37, 2
  s_min_u32 s56, s56, s4
  s_min_u32 s56, s56, s5
  s_cmp_ge_u32 s56, s6
  s_cbranch_scc1 L_fa_ok_w1fp0
  s_mov_b32 s28, 131072
  s_mov_b32 s29, 10
L_fa_w1fp0:
  buffer_load_dword v37, v35, s[8:11], 0 offen sc1
  s_waitcnt vmcnt(0)
  v_readlane_b32 s56, v37, 0
  v_readlane_b32 s4, v37, 1
  v_readlane_b32 s5, v37, 2
  s_sub_u32 s28, s28, 1
  s_cbranch_scc1 L_abort
  s_min_u32 s56, s56, s4
  s_min_u32 s56, s56, s5
  s_cmp_ge_u32 s56, s6
  s_cbranch_scc0 L_fa_w1fp0
L_fa_ok_w1fp0:
  s_add_u32 s4, s6, 3
  s_cmp_ge_u32 s56, s4
  s_cbranch_scc1 L_fa_far_w1fp0
  buffer_load_dword v37, v35, s[8:11], 0 offen sc1
L_fa_far_w1fp0:
  s_mul_i32 s4, s30, 393216
  s_add_u32 s4, s4, 33443840
  buffer_load_dwordx4 v[144:147], v124, s[8:11], s4 offen sc1
  buffer_load_dwordx2 v[148:149], v125, s[8:11], s4 offen sc1
  s_load_dwordx2 s[16:17], s[0:1], 8
  s_waitcnt lgkmcnt(0)
  s_and_b32 s17, s17, 0xffff
  s_mov_b32 s18, 10240
  s_mov_b32 s19, 0x20000
  buffer_load_dwordx4 v[104:107], v36, s[16:19], 0 offen offset:0
  buffer_load_dwordx4 v[108:111], v36, s[16:19], 0 offen offset:512
  buffer_load_dwordx4 v[112:115], v36, s[16:19], 0 offen offset:1024
  s_waitcnt vmcnt(0)
  v_mov_b32 v128, 0
  v_mov_b32 v129, 0
  v_mov_b32 v130, 0
  v_mov_b32 v131, 0
  v_mov_b32 v132, 0
  v_mov_b32 v133, 0
  v_mov_b32 v134, 0
  v_mov_b32 v135, 0
  s_branch L_have_w1f
L_step_w1f:
  s_mov_b32 s28, 131072
  s_mov_b32 s29, 21
  buffer_load_dwordx4 v[164:167], v26, s[8:11], s40 offen sc1
  buffer_load_dwordx4 v[168:171], v26, s[8:11], s41 offen sc1
  buffer_load_dwordx4 v[172:175], v26, s[8:11], s42 offen sc1
  s_sleep 1
  buffer_load_dwordx4 v[176:179], v26, s[8:11], s40 offen sc1
  buffer_load_dwordx4 v[180:183], v26, s[8:11], s41 offen sc1
  buffer_load_dwordx4 v[184:187], v26, s[8:11], s42 offen sc1
L_agp_w1f_a:
  s_waitcnt vmcnt(3)
  v_max3_u32 v188, v164, v168, v172
  v_cmp_eq_u32 vcc, -1, v188
  s_cbranch_vccz L_agp_w1f_oka
  s_sub_u32 s28, s28, 1
  s_cbranch_scc1 L_abort
  buffer_load_dwordx4 v[164:167], v26, s[8:11], s40 offen sc1
  buffer_load_dwordx4 v[168:171], v26, s[8:11], s41 offen sc1
  buffer_load_dwordx4 v[172:175], v26, s[8:11], s42 offen sc1
  s_waitcnt vmcnt(3)
  v_max3_u32 v188, v176, v180, v184
  v_cmp_eq_u32 vcc, -1, v188
  s_cbranch_vccz L_agp_w1f_okb
  s_sub_u32 s28, s28, 1
  s_cbranch_scc1 L_abort
  buffer_load_dwordx4 v[176:179], v26, s[8:11], s40 offen sc1
  buffer_load_dwordx4 v[180:183], v26, s[8:11], s41 offen sc1
  buffer_load_dwordx4 v[184:187], v26, s[8:11], s42 offen sc1
  s_branch L_agp_w1f_a
L_agp_w1f_okb:
  ds_write_b128 v27, v[176:179] offset:0
  ds_write_b128 v27, v[180:183] offset:4096
  ds_write_b128 v27, v[184:187] offset:8192
  s_branch L_agp_w1f_d
L_agp_w1f_oka:
  ds_write_b128 v27, v[164:167] offset:0
  ds_write_b128 v27, v[168:171] offset:4096
  ds_write_b128 v27, v[172:175] offset:8192
L_agp_w1f_d:
  s_branch L_staged_w1f
L_have_w1f:
  ds_write_b128 v27, v[104:107] offset:0
  ds_write_b128 v27, v[108:111] offset:4096
  ds_write_b128 v27, v[112:115] offset:8192
L_staged_w1f:
  s_waitcnt lgkmcnt(0)
  s_barrier
  ds_read_b128 v[40:43], v28 offset:0
  ds_read_b128 v[44:47], v28 offset:1024
  ds_read_b128 v[48:51], v28 offset:2048
  ds_read_b128 v[52:55], v28 offset:3072
  ds_read_b128 v[56:59], v28 offset:4096
  ds_read_b128 v[60:63], v28 offset:5120
  ds_read_b128 v[64:67], v28 offset:6144
  ds_read_b128 v[68:71], v28 offset:7168
  ds_read_b128 v[72:75], v28 offset:8192
  ds_read_b128 v[76:79], v28 offset:9216
  s_waitcnt lgkmcnt(9)
  v_smfmac_f32_16x16x64_bf16 v[128:131], v[40:43], a[0:7], v20
  v_smfmac_f32_16x16x64_bf16 v[132:135], v[40:43], a[80:87], v20
  s_waitcnt lgkmcnt(8)
  v_smfmac_f32_16x16x64_bf16 v[128:131], v[44:47], a[8:15], v20
  v_smfmac_f32_16x16x64_bf16 v[132:135], v[44:47], a[88:95], v20
  s_waitcnt lgkmcnt(7)
  v_smfmac_f32_16x16x64_bf16 v[128:131], v[48:51], a[16:23], v20
  v_smfmac_f32_16x16x64_bf16 v[132:135], v[48:51], a[96:103], v20
  s_cmp_eq_u32 s37, 0
  s_cbranch_scc1 L_xp_w1f
  s_mov_b32 exec_hi, 0
  buffer_store_dwordx4 v[22:25], v32, s[8:11], s50 offen sc1
  s_mov_b32 exec_hi, -1
L_xp_w1f:
  s_cmp_ge_u32 s30, 62
  s_cbranch_scc1 L_nopf_w1f
  s_add_u32 s7, s30, 1
  s_add_u32 s6, s7, 1
  s_cmp_ge_u32 s56, s6
  s_cbranch_scc1 L_fa_ok_w1fpf
  v_readlane_b32 s56, v37, 0
  v_readlane_b32 s4, v37, 1
  v_readlane_b32 s5, v37, 2
  s_min_u32 s56, s56, s4
  s_min_u32 s56, s56, s5
  s_cmp_ge_u32 s56, s6
  s_cbranch_scc1 L_fa_ok_w1fpf
  s_mov_b32 s28, 131072
  s_mov_b32 s29, 10
L_fa_w1fpf:
  buffer_load_dword v37, v35, s[8:11], 0 offen sc1
  s_waitcnt vmcnt(0)
  v_readlane_b32 s56, v37, 0
  v_readlane_b32 s4, v37, 1
  v_readlane_b32 s5, v37, 2
  s_sub_u32 s28, s28, 1
  s_cbranch_scc1 L_abort
  s_min_u32 s56, s56, s4
  s_min_u32 s56, s56, s5
  s_cmp_ge_u32 s56, s6
  s_cbranch_scc0 L_fa_w1fpf
L_fa_ok_w1fpf:
  s_add_u32 s4, s6, 3
  s_cmp_ge_u32 s56, s4
  s_cbranch_scc1 L_fa_far_w1fpf
  buffer_load_dword v37, v35, s[8:11], 0 offen sc1
L_fa_far_w1fpf:
  s_mul_i32 s4, s7, 393216
  s_add_u32 s4, s4, 33443840
  buffer_load_dwordx4 v[156:159], v124, s[8:11], s4 offen sc1
  buffer_load_dwordx2 v[160:161], v125, s[8:11], s4 offen sc1
L_nopf_w1f:
  s_mov_b64 exec, 1
  v_mov_b32 v118, s30
  v_mov_b32 v119, 0
  buffer_store_dword v118, v119, s[8:11], s53 offen sc1
  s_mov_b64 exec, -1
  s_waitcnt lgkmcnt(6)
  v_smfmac_f32_16x16x64_bf16 v[128:131], v[52:55], a[24:31], v20
  v_smfmac_f32_16x16x64_bf16 v[132:135], v[52:55], a[104:111], v20
  s_waitcnt lgkmcnt(5)
  v_smfmac_f32_16x16x64_bf16 v[128:131], v[56:59], a[32:39], v20
  v_smfmac_f32_16x16x64_bf16 v[132:135], v[56:59], a[112:119], v20
  s_waitcnt lgkmcnt(4)
  v_smfmac_f32_16x16x64_bf16 v[128:131], v[60:63], a[40:47], v20
  v_smfmac_f32_16x16x64_bf16 v[132:135], v[60:63], a[120:127], v20
  s_waitcnt lgkmcnt(3)
  v_smfmac_f32_16x16x64_bf16 v[128:131], v[64:67], a[48:55], v20
  v_smfmac_f32_16x16x64_bf16 v[132:135], v[64:67], a[128:135], v20
  s_waitcnt lgkmcnt(2)
  v_smfmac_f32_16x16x64_bf16 v[128:131], v[68:71], a[56:63], v20
  v_smfmac_f32_16x16x64_bf16 v[132:135], v[68:71], a[136:143], v20
  s_waitcnt lgkmcnt(1)
  v_smfmac_f32_16x16x64_bf16 v[128:131], v[72:75], a[64:71], v20
  v_smfmac_f32_16x16x64_bf16 v[132:135], v[72:75], a[144:151], v20
  s_waitcnt lgkmcnt(0)
  v_smfmac_f32_16x16x64_bf16 v[128:131], v[76:79], a[72:79], v20
  v_smfmac_f32_16x16x64_bf16 v[132:135], v[76:79], a[152:159], v20
  s_nop 7
  v_permlane32_swap_b32 v128, v132
  v_permlane32_swap_b32 v129, v133
  v_permlane32_swap_b32 v130, v134
  v_permlane32_swap_b32 v131, v135
  v_add_f32 v128, v128, v132
  v_add_f32 v129, v129, v133
  v_add_f32 v130, v130, v134
  v_add_f32 v131, v131, v135
  v_cvt_pk_bf16_f32 v104, v128, v129
  v_cvt_pk_bf16_f32 v105, v130, v131
  ds_write_b64 v120, v[104:105]
  s_waitcnt lgkmcnt(0)
  s_barrier
  ds_read_b64_tr_b16 v[136:137], v121
  ds_read_b64_tr_b16 v[138:139], v121 offset:384
  ds_read_b64_tr_b16 v[140:141], v122
  s_cmp_eq_u32 s30, 63
  s_cbranch_scc1 L_last_w1f
  s_waitcnt lgkmcnt(0)
  v_mfma_f32_16x16x32_bf16 v[152:155], v[144:147], v[136:139], 0
  v_mfma_f32_16x16x32_bf16 v[152:155], v[148:151], v[140:143], v[152:155]
  s_mov_b32 exec_lo, 16711935
  s_mov_b32 exec_hi, 16711935
  s_nop 5
  buffer_store_dwordx4 v[152:155], v123, s[8:11], s43 offen
  s_mov_b32 exec_lo, 4294967295
  s_mov_b32 exec_hi, 4294967295
  v_mov_b32 v92, 0
  v_mov_b32 v93, 0
  v_mov_b32 v94, 0
  v_mov_b32 v95, 0
  v_mov_b32 v96, 0
  v_mov_b32 v97, 0
  v_mov_b32 v98, 0
  v_mov_b32 v99, 0
  v_mov_b32 v100, 0
  v_mov_b32 v101, 0
  v_mov_b32 v102, 0
  v_mov_b32 v103, 0
  s_barrier
  s_mov_b32 s28, 131072
  s_mov_b32 s29, 41
  buffer_load_dwordx4 v[80:83], v29, s[8:11], s45 offen offset:0 sc1
  buffer_load_dwordx4 v[84:87], v29, s[8:11], s45 offen offset:1024 sc1
  buffer_load_dwordx4 v[88:91], v29, s[8:11], s45 offen offset:2048 sc1
  s_sleep 2
  buffer_load_dwordx4 v[192:195], v29, s[8:11], s45 offen offset:0 sc1
  buffer_load_dwordx4 v[196:199], v29, s[8:11], s45 offen offset:1024 sc1
  buffer_load_dwordx4 v[200:203], v29, s[8:11], s45 offen offset:2048 sc1
L_op_w1f_a:
  s_waitcnt vmcnt(3)
  v_max3_u32 v188, v80, v84, v88
  v_cmp_eq_u32 vcc, -1, v188
  s_cbranch_vccz L_op_w1f_oka
  s_sub_u32 s28, s28, 1
  s_cbranch_scc1 L_abort
  buffer_load_dwordx4 v[80:83], v29, s[8:11], s45 offen offset:0 sc1
  buffer_load_dwordx4 v[84:87], v29, s[8:11], s45 offen offset:1024 sc1
  buffer_load_dwordx4 v[88:91], v29, s[8:11], s45 offen offset:2048 sc1
  s_waitcnt vmcnt(3)
  v_max3_u32 v188, v192, v196, v200
  v_cmp_eq_u32 vcc, -1, v188
  s_cbranch_vccz L_op_w1f_okb
  s_sub_u32 s28, s28, 1
  s_cbranch_scc1 L_abort
  buffer_load_dwordx4 v[192:195], v29, s[8:11], s45 offen offset:0 sc1
  buffer_load_dwordx4 v[196:199], v29, s[8:11], s45 offen offset:1024 sc1
  buffer_load_dwordx4 v[200:203], v29, s[8:11], s45 offen offset:2048 sc1
  s_branch L_op_w1f_a
L_op_w1f_okb:
  v_smfmac_f32_16x16x64_bf16 v[92:95], v[192:195], a[160:167], v20
  v_smfmac_f32_16x16x64_bf16 v[96:99], v[192:195], a[168:175], v20
  v_smfmac_f32_16x16x64_bf16 v[100:103], v[192:195], a[176:183], v20
  v_smfmac_f32_16x16x64_bf16 v[92:95], v[196:199], a[184:191], v20
  v_smfmac_f32_16x16x64_bf16 v[96:99], v[196:199], a[192:199], v20
  v_smfmac_f32_16x16x64_bf16 v[100:103], v[196:199], a[200:207], v20
  v_smfmac_f32_16x16x64_bf16 v[92:95], v[200:203], a[208:215], v20
  v_smfmac_f32_16x16x64_bf16 v[96:99], v[200:203], a[216:223], v20
  v_smfmac_f32_16x16x64_bf16 v[100:103], v[200:203], a[224:231], v20
  s_branch L_op_w1f_d
L_op_w1f_oka:
  v_smfmac_f32_16x16x64_bf16 v[92:95], v[80:83], a[160:167], v20
  v_smfmac_f32_16x16x64_bf16 v[96:99], v[80:83], a[168:175], v20
  v_smfmac_f32_16x16x64_bf16 v[100:103], v[80:83], a[176:183], v20
  v_smfmac_f32_16x16x64_bf16 v[92:95], v[84:87], a[184:191], v20
  v_smfmac_f32_16x16x64_bf16 v[96:99], v[84:87], a[192:199], v20
  v_smfmac_f32_16x16x64_bf16 v[100:103], v[84:87], a[200:207], v20
  v_smfmac_f32_16x16x64_bf16 v[92:95], v[88:91], a[208:215], v20
  v_smfmac_f32_16x16x64_bf16 v[96:99], v[88:91], a[216:223], v20
  v_smfmac_f32_16x16x64_bf16 v[100:103], v[88:91], a[224:231], v20
L_op_w1f_d:
  v_mov_b32 v144, v156
  v_mov_b32 v145, v157
  v_mov_b32 v146, v158
  v_mov_b32 v147, v159
  v_mov_b32 v148, v160
  v_mov_b32 v149, v161
  v_permlane32_swap_b32 v92, v93
  v_permlane32_swap_b32 v94, v95
  v_permlane32_swap_b32 v96, v97
  v_permlane32_swap_b32 v98, v99
  v_permlane32_swap_b32 v100, v101
  v_permlane32_swap_b32 v102, v103
  v_add_f32 v92, v92, v93
  v_add_f32 v94, v94, v95
  v_add_f32 v96, v96, v97
  v_add_f32 v98, v98, v99
  v_add_f32 v100, v100, v101
  v_add_f32 v102, v102, v103
  ds_write_b32 v30, v92 offset:0
  ds_write_b32 v30, v94 offset:128
  ds_write_b32 v30, v96 offset:512
  ds_write_b32 v30, v98 offset:640
  ds_write_b32 v30, v100 offset:1024
  ds_write_b32 v30, v102 offset:1152
  s_waitcnt lgkmcnt(0)
  s_barrier
  s_cmp_eq_u32 s37, 0
  s_cbranch_scc1 L_nox_w1f
  ds_read_b128 v[104:107], v31 offset:0
  ds_read_b128 v[108:111], v31 offset:1536
  ds_read_b128 v[112:115], v31 offset:3072
  ds_read_b128 v[116:119], v31 offset:4608
  s_waitcnt lgkmcnt(2)
  v_add_f32 v104, v104, v108
  v_add_f32 v105, v105, v109
  v_add_f32 v106, v106, v110
  v_add_f32 v107, v107, v111
  s_waitcnt lgkmcnt(0)
  v_add_f32 v112, v112, v116
  v_add_f32 v113, v113, v117
  v_add_f32 v114, v114, v118
  v_add_f32 v115, v115, v119
  v_add_f32 v104, v104, v112
  v_add_f32 v105, v105, v113
  v_add_f32 v106, v106, v114
  v_add_f32 v107, v107, v115
  s_mov_b32 exec_hi, 0
  buffer_store_dwordx4 v[104:107], v32, s[8:11], s46 offen sc1
  s_mov_b32 exec_hi, -1
L_nox_w1f:
  s_mov_b32 exec_lo, 16711935
  s_mov_b32 exec_hi, 16711935
  buffer_store_dwordx4 v[22:25], v123, s[8:11], s48 offen
  s_mov_b32 exec_lo, 4294967295
  s_mov_b32 exec_hi, 4294967295
  s_add_u32 s30, s30, 1
  s_and_b32 s58, s30, 3
  s_mul_i32 s40, s58, 40960
  s_mul_i32 s59, s25, 10240
  s_add_u32 s59, s59, 5492736
  s_add_u32 s40, s40, s59
  s_add_u32 s41, s40, 4096
  s_add_u32 s42, s40, 8192
  s_mul_i32 s45, s58, 98304
  s_add_u32 s45, s45, 905216
  s_mul_i32 s46, s58, 327680
  s_add_u32 s46, s46, s61
  s_mul_i32 s43, s58, 196608
  s_mul_i32 s3, s32, 6144
  s_add_u32 s3, s3, 118784
  s_add_u32 s43, s43, s3
  s_add_u32 s44, s43, 3072
  s_add_u32 s58, s30, 1
  s_and_b32 s58, s58, 3
  s_mul_i32 s47, s58, 40960
  s_add_u32 s47, s47, s59
  s_add_u32 s58, s30, 3
  s_and_b32 s58, s58, 3
  s_mul_i32 s51, s58, 40960
  s_add_u32 s51, s51, s59
  s_mul_i32 s48, s58, 196608
  s_add_u32 s48, s48, s3
  s_mul_i32 s49, s58, 98304
  s_add_u32 s49, s49, 905216
  s_add_u32 s58, s30, 2
  s_and_b32 s58, s58, 3
  s_mul_i32 s50, s58, 327680
  s_add_u32 s50, s50, s61
  s_mul_i32 s54, s30, 196608
  s_add_u32 s55, s54, 96358400
  s_add_u32 s54, s54, 83775488
  v_mov_b32 v128, 0
  v_mov_b32 v129, 0
  v_mov_b32 v130, 0
  v_mov_b32 v131, 0
  v_mov_b32 v132, 0
  v_mov_b32 v133, 0
  v_mov_b32 v134, 0
  v_mov_b32 v135, 0
  s_barrier
  s_branch L_step_w1f
L_last_w1f:
  s_branch L_exit
L_cw2f:
  v_mov_b32 v142, 0
  v_mov_b32 v143, 0
  v_mov_b32 v150, 0
  v_mov_b32 v151, 0
  s_mov_b32 s30, 0
  s_mov_b32 s56, 0
  v_mov_b32 v37, 0
  s_and_b32 s58, s30, 3
  s_mul_i32 s40, s58, 40960
  s_mul_i32 s59, s25, 10240
  s_add_u32 s59, s59, 5492736
  s_add_u32 s40, s40, s59
  s_add_u32 s41, s40, 4096
  s_add_u32 s42, s40, 8192
  s_mul_i32 s45, s58, 98304
  s_add_u32 s45, s45, 905216
  s_mul_i32 s46, s58, 327680
  s_add_u32 s46, s46, s61
  s_mul_i32 s43, s58, 196608
  s_mul_i32 s3, s32, 6144
  s_add_u32 s3, s3, 118784
  s_add_u32 s43, s43, s3
  s_add_u32 s44, s43, 3072
  s_add_u32 s58, s30, 1
  s_and_b32 s58, s58, 3
  s_mul_i32 s47, s58, 40960
  s_add_u32 s47, s47, s59
  s_add_u32 s58, s30, 3
  s_and_b32 s58, s58, 3
  s_mul_i32 s51, s58, 40960
  s_add_u32 s51, s51, s59
  s_mul_i32 s48, s58, 196608
  s_add_u32 s48, s48, s3
  s_mul_i32 s49, s58, 98304
  s_add_u32 s49, s49, 905216
  s_add_u32 s58, s30, 2
  s_and_b32 s58, s58, 3
  s_mul_i32 s50, s58, 327680
  s_add_u32 s50, s50, s61
  s_mul_i32 s54, s30, 196608
  s_add_u32 s55, s54, 96358400
  s_add_u32 s54, s54, 83775488
  s_add_u32 s6, s30, 1
  s_cmp_ge_u32 s56, s6
  s_cbranch_scc1 L_fa_ok_w2fp0
  v_readlane_b32 s56, v37, 0
  v_readlane_b32 s4, v37, 1
  v_readlane_b32 s5, v37, 2
  s_min_u32 s56, s56, s4
  s_min_u32 s56, s56, s5
  s_cmp_ge_u32 s56, s6
  s_cbranch_scc1 L_fa_ok_w2fp0
  s_mov_b32 s28, 131072
  s_mov_b32 s29, 10
L_fa_w2fp0:
  buffer_load_dword v37, v35, s[8:11], 0 offen sc1
  s_waitcnt vmcnt(0)
  v_readlane_b32 s56, v37, 0
  v_readlane_b32 s4, v37, 1
  v_readlane_b32 s5, v37, 2
  s_sub_u32 s28, s28, 1
  s_cbranch_scc1 L_abort
  s_min_u32 s56, s56, s4
  s_min_u32 s56, s56, s5
  s_cmp_ge_u32 s56, s6
  s_cbranch_scc0 L_fa_w2fp0
L_fa_ok_w2fp0:
  s_add_u32 s4, s6, 3
  s_cmp_ge_u32 s56, s4
  s_cbranch_scc1 L_fa_far_w2fp0
  buffer_load_dword v37, v35, s[8:11], 0 offen sc1
L_fa_far_w2fp0:
  s_mul_i32 s4, s30, 393216
  s_add_u32 s4, s4, 33443840
  buffer_load_dwordx4 v[144:147], v124, s[8:11], s4 offen sc1
  buffer_load_dwordx2 v[148:149], v125, s[8:11], s4 offen sc1
  s_load_dwordx2 s[16:17], s[0:1], 8
  s_waitcnt lgkmcnt(0)
  s_and_b32 s17, s17, 0xffff
  s_mov_b32 s18, 10240
  s_mov_b32 s19, 0x20000
  buffer_load_dwordx4 v[104:107], v36, s[16:19], 0 offen offset:0
  buffer_load_dwordx4 v[108:111], v36, s[16:19], 0 offen offset:512
  s_waitcnt vmcnt(0)
  v_mov_b32 v128, 0
  v_mov_b32 v129, 0
  v_mov_b32 v130, 0
  v_mov_b32 v131, 0
  v_mov_b32 v132, 0
  v_mov_b32 v133, 0
  v_mov_b32 v134, 0
  v_mov_b32 v135, 0
  s_branch L_have_w2f
L_step_w2f:
  s_mov_b32 s28, 131072
  s_mov_b32 s29, 22
  buffer_load_dwordx4 v[164:167], v26, s[8:11], s40 offen sc1
  buffer_load_dwordx4 v[168:171], v26, s[8:11], s41 offen sc1
  s_sleep 1
  buffer_load_dwordx4 v[176:179], v26, s[8:11], s40 offen sc1
  buffer_load_dwordx4 v[180:183], v26, s[8:11], s41 offen sc1
L_agp_w2f_a:
  s_waitcnt vmcnt(2)
  v_max_u32 v188, v164, v168
  v_cmp_eq_u32 vcc, -1, v188
  s_cbranch_vccz L_agp_w2f_oka
  s_sub_u32 s28, s28, 1
  s_cbranch_scc1 L_abort
  buffer_load_dwordx4 v[164:167], v26, s[8:11], s40 offen sc1
  buffer_load_dwordx4 v[168:171], v26, s[8:11], s41 offen sc1
  s_waitcnt vmcnt(2)
  v_max_u32 v188, v176, v180
  v_cmp_eq_u32 vcc, -1, v188
  s_cbranch_vccz L_agp_w2f_okb
  s_sub_u32 s28, s28, 1
  s_cbranch_scc1 L_abort
  buffer_load_dwordx4 v[176:179], v26, s[8:11], s40 offen sc1
  buffer_load_dwordx4 v[180:183], v26, s[8:11], s41 offen sc1
  s_branch L_agp_w2f_a
L_agp_w2f_okb:
  ds_write_b128 v27, v[176:179] offset:0
  ds_write_b128 v27, v[180:183] offset:4096
  s_branch L_agp_w2f_d
L_agp_w2f_oka:
  ds_write_b128 v27, v[164:167] offset:0
  ds_write_b128 v27, v[168:171] offset:4096
L_agp_w2f_d:
  s_branch L_staged_w2f
L_have_w2f:
  ds_write_b128 v27, v[104:107] offset:0
  ds_write_b128 v27, v[108:111] offset:4096
L_staged_w2f:
  s_waitcnt lgkmcnt(0)
  s_barrier
  ds_read_b128 v[40:43], v28 offset:0
  ds_read_b128 v[44:47], v28 offset:1024
  ds_read_b128 v[48:51], v28 offset:2048
  ds_read_b128 v[52:55], v28 offset:3072
  ds_read_b128 v[56:59], v28 offset:4096
  ds_read_b128 v[60:63], v28 offset:5120
  ds_read_b128 v[64:67], v28 offset:6144
  ds_read_b128 v[68:71], v28 offset:7168
  ds_read_b128 v[72:75], v28 offset:8192
  ds_read_b128 v[76:79], v28 offset:9216
  s_waitcnt lgkmcnt(9)
  v_smfmac_f32_16x16x64_bf16 v[128:131], v[40:43], a[0:7], v20
  v_smfmac_f32_16x16x64_bf16 v[132:135], v[40:43], a[80:87], v20
  s_waitcnt lgkmcnt(8)
  v_smfmac_f32_16x16x64_bf16 v[128:131], v[44:47], a[8:15], v20
  v_smfmac_f32_16x16x64_bf16 v[132:135], v[44:47], a[88:95], v20
  s_waitcnt lgkmcnt(7)
  v_smfmac_f32_16x16x64_bf16 v[128:131], v[48:51], a[16:23], v20
  v_smfmac_f32_16x16x64_bf16 v[132:135], v[48:51], a[96:103], v20
  s_cmp_ge_u32 s30, 62
  s_cbranch_scc1 L_nopf_w2f
  s_add_u32 s7, s30, 1
  s_add_u32 s6, s7, 1
  s_cmp_ge_u32 s56, s6
  s_cbranch_scc1 L_fa_ok_w2fpf
  v_readlane_b32 s56, v37, 0
  v_readlane_b32 s4, v37, 1
  v_readlane_b32 s5, v37, 2
  s_min_u32 s56, s56, s4
  s_min_u32 s56, s56, s5
  s_cmp_ge_u32 s56, s6
  s_cbranch_scc1 L_fa_ok_w2fpf
  s_mov_b32 s28, 131072
  s_mov_b32 s29, 10
L_fa_w2fpf:
  buffer_load_dword v37, v35, s[8:11], 0 offen sc1
  s_waitcnt vmcnt(0)
  v_readlane_b32 s56, v37, 0
  v_readlane_b32 s4, v37, 1
  v_readlane_b32 s5, v37, 2
  s_sub_u32 s28, s28, 1
  s_cbranch_scc1 L_abort
  s_min_u32 s56, s56, s4
  s_min_u32 s56, s56, s5
  s_cmp_ge_u32 s56, s6
  s_cbranch_scc0 L_fa_w2fpf
L_fa_ok_w2fpf:
  s_add_u32 s4, s6, 3
  s_cmp_ge_u32 s56, s4
  s_cbranch_scc1 L_fa_far_w2fpf
  buffer_load_dword v37, v35, s[8:11], 0 offen sc1
L_fa_far_w2fpf:
  s_mul_i32 s4, s7, 393216
  s_add_u32 s4, s4, 33443840
  buffer_load_dwordx4 v[156:159], v124, s[8:11], s4 offen sc1
  buffer_load_dwordx2 v[160:161], v125, s[8:11], s4 offen sc1
L_nopf_w2f:
  s_waitcnt lgkmcnt(6)
  v_smfmac_f32_16x16x64_bf16 v[128:131], v[52:55], a[24:31], v20
  v_smfmac_f32_16x16x64_bf16 v[132:135], v[52:55], a[104:111], v20
  s_waitcnt lgkmcnt(5)
  v_smfmac_f32_16x16x64_bf16 v[128:131], v[56:59], a[32:39], v20
  v_smfmac_f32_16x16x64_bf16 v[132:135], v[56:59], a[112:119], v20
  s_waitcnt lgkmcnt(4)
  v_smfmac_f32_16x16x64_bf16 v[128:131], v[60:63], a[40:47], v20
  v_smfmac_f32_16x16x64_bf16 v[132:135], v[60:63], a[120:127], v20
  s_waitcnt lgkmcnt(3)
  v_smfmac_f32_16x16x64_bf16 v[128:131], v[64:67], a[48:55], v20
  v_smfmac_f32_16x16x64_bf16 v[132:135], v[64:67], a[128:135], v20
  s_waitcnt lgkmcnt(2)
  v_smfmac_f32_16x16x64_bf16 v[128:131], v[68:71], a[56:63], v20
  v_smfmac_f32_16x16x64_bf16 v[132:135], v[68:71], a[136:143], v20
  s_waitcnt lgkmcnt(1)
  v_smfmac_f32_16x16x64_bf16 v[128:131], v[72:75], a[64:71], v20
  v_smfmac_f32_16x16x64_bf16 v[132:135], v[72:75], a[144:151], v20
  s_waitcnt lgkmcnt(0)
  v_smfmac_f32_16x16x64_bf16 v[128:131], v[76:79], a[72:79], v20
  v_smfmac_f32_16x16x64_bf16 v[132:135], v[76:79], a[152:159], v20
  s_nop 7
  v_permlane32_swap_b32 v128, v132
  v_permlane32_swap_b32 v129, v133
  v_permlane32_swap_b32 v130, v134
  v_permlane32_swap_b32 v131, v135
  v_add_f32 v128, v128, v132
  v_add_f32 v129, v129, v133
  v_add_f32 v130, v130, v134
  v_add_f32 v131, v131, v135
  v_cvt_pk_bf16_f32 v104, v128, v129
  v_cvt_pk_bf16_f32 v105, v130, v131
  ds_write_b64 v120, v[104:105]
  s_waitcnt lgkmcnt(0)
  s_barrier
  ds_read_b64_tr_b16 v[136:137], v121
  ds_read_b64_tr_b16 v[138:139], v121 offset:384
  ds_read_b64_tr_b16 v[140:141], v122
  s_cmp_eq_u32 s30, 63
  s_cbranch_scc1 L_last_w2f
  s_waitcnt lgkmcnt(0)
  v_mfma_f32_16x16x32_bf16 v[152:155], v[144:147], v[136:139], 0
  v_mfma_f32_16x16x32_bf16 v[152:155], v[148:151], v[140:143], v[152:155]
  s_mov_b32 exec_lo, 16711935
  s_mov_b32 exec_hi, 16711935
  s_nop 5
  buffer_store_dwordx4 v[152:155], v123, s[8:11], s43 offen
  s_mov_b32 exec_lo, 4294967295
  s_mov_b32 exec_hi, 4294967295
  v_mov_b32 v92, 0
  v_mov_b32 v93, 0
  v_mov_b32 v94, 0
  v_mov_b32 v95, 0
  v_mov_b32 v96, 0
  v_mov_b32 v97, 0
  v_mov_b32 v98, 0
  v_mov_b32 v99, 0
  v_mov_b32 v100, 0
  v_mov_b32 v101, 0
  v_mov_b32 v102, 0
  v_mov_b32 v103, 0
  s_barrier
  s_mov_b32 s28, 131072
  s_mov_b32 s29, 42
  buffer_load_dwordx4 v[80:83], v29, s[8:11], s45 offen offset:0 sc1
  buffer_load_dwordx4 v[84:87], v29, s[8:11], s45 offen offset:1024 sc1
  buffer_load_dwordx4 v[88:91], v29, s[8:11], s45 offen offset:2048 sc1
  s_sleep 2
  buffer_load_dwordx4 v[192:195], v29, s[8:11], s45 offen offset:0 sc1
  buffer_load_dwordx4 v[196:199], v29, s[8:11], s45 offen offset:1024 sc1
  buffer_load_dwordx4 v[200:203], v29, s[8:11], s45 offen offset:2048 sc1
L_op_w2f_a:
  s_waitcnt vmcnt(3)
  v_max3_u32 v188, v80, v84, v88
  v_cmp_eq_u32 vcc, -1, v188
  s_cbranch_vccz L_op_w2f_oka
  s_sub_u32 s28, s28, 1
  s_cbranch_scc1 L_abort
  buffer_load_dwordx4 v[80:83], v29, s[8:11], s45 offen offset:0 sc1
  buffer_load_dwordx4 v[84:87], v29, s[8:11], s45 offen offset:1024 sc1
  buffer_load_dwordx4 v[88:91], v29, s[8:11], s45 offen offset:2048 sc1
  s_waitcnt vmcnt(3)
  v_max3_u32 v188, v192, v196, v200
  v_cmp_eq_u32 vcc, -1, v188
  s_cbranch_vccz L_op_w2f_okb
  s_sub_u32 s28, s28, 1
  s_cbranch_scc1 L_abort
  buffer_load_dwordx4 v[192:195], v29, s[8:11], s45 offen offset:0 sc1
  buffer_load_dwordx4 v[196:199], v29, s[8:11], s45 offen offset:1024 sc1
  buffer_load_dwordx4 v[200:203], v29, s[8:11], s45 offen offset:2048 sc1
  s_branch L_op_w2f_a
L_op_w2f_okb:
  v_smfmac_f32_16x16x64_bf16 v[92:95], v[192:195], a[160:167], v20
  v_smfmac_f32_16x16x64_bf16 v[96:99], v[192:195], a[168:175], v20
  v_smfmac_f32_16x16x64_bf16 v[100:103], v[192:195], a[176:183], v20
  v_smfmac_f32_16x16x64_bf16 v[92:95], v[196:199], a[184:191], v20
  v_smfmac_f32_16x16x64_bf16 v[96:99], v[196:199], a[192:199], v20
  v_smfmac_f32_16x16x64_bf16 v[100:103], v[196:199], a[200:207], v20
  v_smfmac_f32_16x16x64_bf16 v[92:95], v[200:203], a[208:215], v20
  v_smfmac_f32_16x16x64_bf16 v[96:99], v[200:203], a[216:223], v20
  v_smfmac_f32_16x16x64_bf16 v[100:103], v[200:203], a[224:231], v20
  s_branch L_op_w2f_d
L_op_w2f_oka:
  v_smfmac_f32_16x16x64_bf16 v[92:95], v[80:83], a[160:167], v20
  v_smfmac_f32_16x16x64_bf16 v[96:99], v[80:83], a[168:175], v20
  v_smfmac_f32_16x16x64_bf16 v[100:103], v[80:83], a[176:183], v20
  v_smfmac_f32_16x16x64_bf16 v[92:95], v[84:87], a[184:191], v20
  v_smfmac_f32_16x16x64_bf16 v[96:99], v[84:87], a[192:199], v20
  v_smfmac_f32_16x16x64_bf16 v[100:103], v[84:87], a[200:207], v20
  v_smfmac_f32_16x16x64_bf16 v[92:95], v[88:91], a[208:215], v20
  v_smfmac_f32_16x16x64_bf16 v[96:99], v[88:91], a[216:223], v20
  v_smfmac_f32_16x16x64_bf16 v[100:103], v[88:91], a[224:231], v20
L_op_w2f_d:
  v_mov_b32 v144, v156
  v_mov_b32 v145, v157
  v_mov_b32 v146, v158
  v_mov_b32 v147, v159
  v_mov_b32 v148, v160
  v_mov_b32 v149, v161
  v_permlane32_swap_b32 v92, v93
  v_permlane32_swap_b32 v94, v95
  v_permlane32_swap_b32 v96, v97
  v_permlane32_swap_b32 v98, v99
  v_permlane32_swap_b32 v100, v101
  v_permlane32_swap_b32 v102, v103
  v_add_f32 v92, v92, v93
  v_add_f32 v94, v94, v95
  v_add_f32 v96, v96, v97
  v_add_f32 v98, v98, v99
  v_add_f32 v100, v100, v101
  v_add_f32 v102, v102, v103
  ds_write_b32 v30, v92 offset:0
  ds_write_b32 v30, v94 offset:128
  ds_write_b32 v30, v96 offset:512
  ds_write_b32 v30, v98 offset:640
  ds_write_b32 v30, v100 offset:1024
  ds_write_b32 v30, v102 offset:1152
  s_mov_b32 exec_lo, 16711935
  s_mov_b32 exec_hi, 16711935
  buffer_store_dwordx4 v[22:25], v123, s[8:11], s48 offen
  s_mov_b32 exec_lo, 4294967295
  s_mov_b32 exec_hi, 4294967295
  buffer_store_dword v22, v34, s[8:11], s51 offen
  s_waitcnt lgkmcnt(0)
  s_barrier
  s_cmp_eq_u32 s39, 0
  s_cbranch_scc1 L_noown_w2f
  s_sleep 10
  s_mov_b32 s28, 131072
  s_mov_b32 s29, 52
  buffer_load_dwordx4 v[204:207], v33, s[8:11], s46 offen offset:0 sc1
  buffer_load_dwordx4 v[208:211], v33, s[8:11], s46 offen offset:1024 sc1
  buffer_load_dwordx4 v[212:215], v33, s[8:11], s46 offen offset:2048 sc1
  buffer_load_dwordx4 v[216:219], v33, s[8:11], s46 offen offset:3072 sc1
  s_sleep 4
  buffer_load_dwordx4 v[220:223], v33, s[8:11], s46 offen offset:0 sc1
  buffer_load_dwordx4 v[224:227], v33, s[8:11], s46 offen offset:1024 sc1
  buffer_load_dwordx4 v[228:231], v33, s[8:11], s46 offen offset:2048 sc1
  buffer_load_dwordx4 v[232:235], v33, s[8:11], s46 offen offset:3072 sc1
L_xq_w2f_a:
  s_waitcnt vmcnt(4)
  v_max3_u32 v188, v204, v208, v212
  v_max_u32 v188, v188, v216
  v_cmp_eq_u32 vcc, -1, v188
  s_cbranch_vccz L_xq_w2f_oka
  s_sub_u32 s28, s28, 1
  s_cbranch_scc1 L_abort
  buffer_load_dwordx4 v[204:207], v33, s[8:11], s46 offen offset:0 sc1
  buffer_load_dwordx4 v[208:211], v33, s[8:11], s46 offen offset:1024 sc1
  buffer_load_dwordx4 v[212:215], v33, s[8:11], s46 offen offset:2048 sc1
  buffer_load_dwordx4 v[216:219], v33, s[8:11], s46 offen offset:3072 sc1
  s_waitcnt vmcnt(4)
  v_max3_u32 v188, v220, v224, v228
  v_max_u32 v188, v188, v232
  v_cmp_eq_u32 vcc, -1, v188
  s_cbranch_vccz L_xq_w2f_okb
  s_sub_u32 s28, s28, 1
  s_cbranch_scc1 L_abort
  buffer_load_dwordx4 v[220:223], v33, s[8:11], s46 offen offset:0 sc1
  buffer_load_dwordx4 v[224:227], v33, s[8:11], s46 offen offset:1024 sc1
  buffer_load_dwordx4 v[228:231], v33, s[8:11], s46 offen offset:2048 sc1
  buffer_load_dwordx4 v[232:235], v33, s[8:11], s46 offen offset:3072 sc1
  s_branch L_xq_w2f_a
L_xq_w2f_okb:
  v_pk_add_f32 v[104:105], v[220:221], v[224:225]
  v_pk_add_f32 v[106:107], v[222:223], v[226:227]
  v_pk_add_f32 v[112:113], v[228:229], v[232:233]
  v_pk_add_f32 v[114:115], v[230:231], v[234:235]
  s_branch L_xq_w2f_d
L_xq_w2f_oka:
  v_pk_add_f32 v[104:105], v[204:205], v[208:209]
  v_pk_add_f32 v[106:107], v[206:207], v[210:211]
  v_pk_add_f32 v[112:113], v[212:213], v[216:217]
  v_pk_add_f32 v[114:115], v[214:215], v[218:219]
L_xq_w2f_d:
  v_pk_add_f32 v[104:105], v[104:105], v[112:113]
  v_pk_add_f32 v[106:107], v[106:107], v[114:115]
  s_nop 1
  v_permlane32_swap_b32 v104, v106
  v_permlane32_swap_b32 v105, v107
  v_add_f32 v104, v104, v106
  v_add_f32 v105, v105, v107
  v_cvt_pk_bf16_f32 v104, v104, v105
  buffer_store_dword v104, v34, s[8:11], s47 offen
L_noown_w2f:
  s_add_u32 s30, s30, 1
  s_and_b32 s58, s30, 3
  s_mul_i32 s40, s58, 40960
  s_mul_i32 s59, s25, 10240
  s_add_u32 s59, s59, 5492736
  s_add_u32 s40, s40, s59
  s_add_u32 s41, s40, 4096
  s_add_u32 s42, s40, 8192
  s_mul_i32 s45, s58, 98304
  s_add_u32 s45, s45, 905216
  s_mul_i32 s46, s58, 327680
  s_add_u32 s46, s46, s61
  s_mul_i32 s43, s58, 196608
  s_mul_i32 s3, s32, 6144
  s_add_u32 s3, s3, 118784
  s_add_u32 s43, s43, s3
  s_add_u32 s44, s43, 3072
  s_add_u32 s58, s30, 1
  s_and_b32 s58, s58, 3
  s_mul_i32 s47, s58, 40960
  s_add_u32 s47, s47, s59
  s_add_u32 s58, s30, 3
  s_and_b32 s58, s58, 3
  s_mul_i32 s51, s58, 40960
  s_add_u32 s51, s51, s59
  s_mul_i32 s48, s58, 196608
  s_add_u32 s48, s48, s3
  s_mul_i32 s49, s58, 98304
  s_add_u32 s49, s49, 905216
  s_add_u32 s58, s30, 2
  s_and_b32 s58, s58, 3
  s_mul_i32 s50, s58, 327680
  s_add_u32 s50, s50, s61
  s_mul_i32 s54, s30, 196608
  s_add_u32 s55, s54, 96358400
  s_add_u32 s54, s54, 83775488
  v_mov_b32 v128, 0
  v_mov_b32 v129, 0
  v_mov_b32 v130, 0
  v_mov_b32 v131, 0
  v_mov_b32 v132, 0
  v_mov_b32 v133, 0
  v_mov_b32 v134, 0
  v_mov_b32 v135, 0
  s_barrier
  s_branch L_step_w2f
L_last_w2f:
  s_branch L_exit
L_cw3f:
  v_mov_b32 v142, 0
  v_mov_b32 v143, 0
  v_mov_b32 v146, 0
  v_mov_b32 v147, 0
  v_mov_b32 v150, 0
  v_mov_b32 v151, 0
  v_mov_b32 v194, 0
  v_mov_b32 v195, 0
  s_mov_b32 s30, 0
  s_mov_b32 s56, 0
  v_mov_b32 v37, 0
  s_and_b32 s58, s30, 3
  s_mul_i32 s40, s58, 40960
  s_mul_i32 s59, s25, 10240
  s_add_u32 s59, s59, 5492736
  s_add_u32 s40, s40, s59
  s_add_u32 s41, s40, 4096
  s_add_u32 s42, s40, 8192
  s_mul_i32 s45, s58, 98304
  s_add_u32 s45, s45, 905216
  s_mul_i32 s46, s58, 327680
  s_add_u32 s46, s46, s61
  s_mul_i32 s43, s58, 196608
  s_mul_i32 s3, s32, 6144
  s_add_u32 s3, s3, 118784
  s_add_u32 s43, s43, s3
  s_add_u32 s44, s43, 3072
  s_add_u32 s58, s30, 1
  s_and_b32 s58, s58, 3
  s_mul_i32 s47, s58, 40960
  s_add_u32 s47, s47, s59
  s_add_u32 s58, s30, 3
  s_and_b32 s58, s58, 3
  s_mul_i32 s51, s58, 40960
  s_add_u32 s51, s51, s59
  s_mul_i32 s48, s58, 196608
  s_add_u32 s48, s48, s3
  s_mul_i32 s49, s58, 98304
  s_add_u32 s49, s49, 905216
  s_add_u32 s58, s30, 2
  s_and_b32 s58, s58, 3
  s_mul_i32 s50, s58, 327680
  s_add_u32 s50, s50, s61
  s_mul_i32 s54, s30, 196608
  s_add_u32 s55, s54, 96358400
  s_add_u32 s54, s54, 83775488
  s_add_u32 s6, s30, 1
  s_cmp_ge_u32 s56, s6
  s_cbranch_scc1 L_fa_ok_w3fp0
  v_readlane_b32 s56, v37, 0
  v_readlane_b32 s4, v37, 1
  v_readlane_b32 s5, v37, 2
  s_min_u32 s56, s56, s4
  s_min_u32 s56, s56, s5
  s_cmp_ge_u32 s56, s6
  s_cbranch_scc1 L_fa_ok_w3fp0
  s_mov_b32 s28, 131072
  s_mov_b32 s29, 10
L_fa_w3fp0:
  buffer_load_dword v37, v35, s[8:11], 0 offen sc1
  s_waitcnt vmcnt(0)
  v_readlane_b32 s56, v37, 0
  v_readlane_b32 s4, v37, 1
  v_readlane_b32 s5, v37, 2
  s_sub_u32 s28, s28, 1
  s_cbranch_scc1 L_abort
  s_min_u32 s56, s56, s4
  s_min_u32 s56, s56, s5
  s_cmp_ge_u32 s56, s6
  s_cbranch_scc0 L_fa_w3fp0
L_fa_ok_w3fp0:
  s_add_u32 s4, s6, 3
  s_cmp_ge_u32 s56, s4
  s_cbranch_scc1 L_fa_far_w3fp0
  buffer_load_dword v37, v35, s[8:11], 0 offen sc1
L_fa_far_w3fp0:
  s_mul_i32 s4, s30, 393216
  s_add_u32 s4, s4, 58609664
  buffer_load_dwordx4 v[152:155], v124, s[8:11], s4 offen offset:0 sc1
  buffer_load_dwordx4 v[156:159], v124, s[8:11], s4 offen offset:1024 sc1
  buffer_load_dwordx4 v[160:163], v124, s[8:11], s4 offen offset:2048 sc1
  s_load_dwordx2 s[16:17], s[0:1], 8
  s_waitcnt lgkmcnt(0)
  s_and_b32 s17, s17, 0xffff
  s_mov_b32 s18, 10240
  s_mov_b32 s19, 0x20000
  buffer_load_dwordx4 v[104:107], v36, s[16:19], 0 offen offset:0
  buffer_load_dwordx4 v[108:111], v36, s[16:19], 0 offen offset:512
  s_waitcnt vmcnt(0)
  v_mov_b32 v128, 0
  v_mov_b32 v129, 0
  v_mov_b32 v130, 0
  v_mov_b32 v131, 0
  v_mov_b32 v132, 0
  v_mov_b32 v133, 0
  v_mov_b32 v134, 0
  v_mov_b32 v135, 0
  v_mov_b32 v136, 0
  v_mov_b32 v137, 0
  v_mov_b32 v138, 0
  v_mov_b32 v139, 0
  s_branch L_have_w3f
L_step_w3f:
  s_mov_b32 s28, 131072
  s_mov_b32 s29, 23
  buffer_load_dwordx4 v[2:5], v26, s[8:11], s40 offen sc1
  buffer_load_dwordx4 v[6:9], v26, s[8:11], s41 offen sc1
  s_sleep 1
  buffer_load_dwordx4 v[10:13], v26, s[8:11], s40 offen sc1
  buffer_load_dwordx4 v[14:17], v26, s[8:11], s41 offen sc1
L_agp_w3f_a:
  s_waitcnt vmcnt(2)
  v_max_u32 v18, v2, v6
  v_cmp_eq_u32 vcc, -1, v18
  s_cbranch_vccz L_agp_w3f_oka
  s_sub_u32 s28, s28, 1
  s_cbranch_scc1 L_abort
  buffer_load_dwordx4 v[2:5], v26, s[8:11], s40 offen sc1
  buffer_load_dwordx4 v[6:9], v26, s[8:11], s41 offen sc1
  s_waitcnt vmcnt(2)
  v_max_u32 v18, v10, v14
  v_cmp_eq_u32 vcc, -1, v18
  s_cbranch_vccz L_agp_w3f_okb
  s_sub_u32 s28, s28, 1
  s_cbranch_scc1 L_abort
  buffer_load_dwordx4 v[10:13], v26, s[8:11], s40 offen sc1
  buffer_load_dwordx4 v[14:17], v26, s[8:11], s41 offen sc1
  s_branch L_agp_w3f_a
L_agp_w3f_okb:
  ds_write_b128 v27, v[10:13] offset:0
  ds_write_b128 v27, v[14:17] offset:4096
  s_branch L_agp_w3f_d
L_agp_w3f_oka:
  ds_write_b128 v27, v[2:5] offset:0
  ds_write_b128 v27, v[6:9] offset:4096
L_agp_w3f_d:
  s_branch L_staged_w3f
L_have_w3f:
  ds_write_b128 v27, v[104:107] offset:0
  ds_write_b128 v27, v[108:111] offset:4096
L_staged_w3f:
  s_waitcnt lgkmcnt(0)
  s_barrier
  ds_read_b128 v[40:43], v28 offset:0
  ds_read_b128 v[44:47], v28 offset:1024
  ds_read_b128 v[48:51], v28 offset:2048
  ds_read_b128 v[52:55], v28 offset:3072
  ds_read_b128 v[56:59], v28 offset:4096
  ds_read_b128 v[60:63], v28 offset:5120
  ds_read_b128 v[64:67], v28 offset:6144
  ds_read_b128 v[68:71], v28 offset:7168
  ds_read_b128 v[72:75], v28 offset:8192
  ds_read_b128 v[76:79], v28 offset:9216
  s_waitcnt lgkmcnt(9)
  v_smfmac_f32_16x16x64_bf16 v[128:131], v[40:43], a[0:7], v127
  v_smfmac_f32_16x16x64_bf16 v[132:135], v[40:43], a[80:87], v127
  v_smfmac_f32_16x16x64_bf16 v[136:139], v[40:43], a[160:167], v127
  s_waitcnt lgkmcnt(8)
  v_smfmac_f32_16x16x64_bf16 v[128:131], v[44:47], a[8:15], v127
  v_smfmac_f32_16x16x64_bf16 v[132:135], v[44:47], a[88:95], v127
  v_smfmac_f32_16x16x64_bf16 v[136:139], v[44:47], a[168:175], v127
  s_mov_b32 exec_lo, 16711935
  s_mov_b32 exec_hi, 16711935
  buffer_store_dwordx4 v[22:25], v122, s[8:11], s49 offen
  buffer_store_dwordx2 v[22:23], v123, s[8:11], s49 offen
  s_mov_b32 exec_lo, 4294967295
  s_mov_b32 exec_hi, 4294967295
  s_cmp_eq_u32 s39, 0
  s_cbranch_scc1 L_agpz_w3f
  buffer_store_dword v22, v34, s[8:11], s51 offen
L_agpz_w3f:
  s_waitcnt lgkmcnt(7)
  v_smfmac_f32_16x16x64_bf16 v[128:131], v[48:51], a[16:23], v127
  v_smfmac_f32_16x16x64_bf16 v[132:135], v[48:51], a[96:103], v127
  v_smfmac_f32_16x16x64_bf16 v[136:139], v[48:51], a[176:183], v127
  s_waitcnt lgkmcnt(6)
  v_smfmac_f32_16x16x64_bf16 v[128:131], v[52:55], a[24:31], v127
  v_smfmac_f32_16x16x64_bf16 v[132:135], v[52:55], a[104:111], v127
  v_smfmac_f32_16x16x64_bf16 v[136:139], v[52:55], a[184:191], v127
  s_waitcnt lgkmcnt(5)
  v_smfmac_f32_16x16x64_bf16 v[128:131], v[56:59], a[32:39], v127
  v_smfmac_f32_16x16x64_bf16 v[132:135], v[56:59], a[112:119], v127
  v_smfmac_f32_16x16x64_bf16 v[136:139], v[56:59], a[192:199], v127
  s_waitcnt lgkmcnt(4)
  v_smfmac_f32_16x16x64_bf16 v[128:131], v[60:63], a[40:47], v127
  v_smfmac_f32_16x16x64_bf16 v[132:135], v[60:63], a[120:127], v127
  v_smfmac_f32_16x16x64_bf16 v[136:139], v[60:63], a[200:207], v127
  s_waitcnt lgkmcnt(3)
  v_smfmac_f32_16x16x64_bf16 v[128:131], v[64:67], a[48:55], v127
  v_smfmac_f32_16x16x64_bf16 v[132:135], v[64:67], a[128:135], v127
  v_smfmac_f32_16x16x64_bf16 v[136:139], v[64:67], a[208:215], v127
  s_barrier
  s_waitcnt lgkmcnt(2)
  v_smfmac_f32_16x16x64_bf16 v[128:131], v[68:71], a[56:63], v127
  v_smfmac_f32_16x16x64_bf16 v[132:135], v[68:71], a[136:143], v127
  v_smfmac_f32_16x16x64_bf16 v[136:139], v[68:71], a[216:223], v127
  s_waitcnt lgkmcnt(1)
  v_smfmac_f32_16x16x64_bf16 v[128:131], v[72:75], a[64:71], v127
  v_smfmac_f32_16x16x64_bf16 v[132:135], v[72:75], a[144:151], v127
  v_smfmac_f32_16x16x64_bf16 v[136:139], v[72:75], a[224:231], v127
  s_waitcnt lgkmcnt(0)
  v_smfmac_f32_16x16x64_bf16 v[128:131], v[76:79], a[72:79], v127
  v_smfmac_f32_16x16x64_bf16 v[132:135], v[76:79], a[152:159], v127
  v_smfmac_f32_16x16x64_bf16 v[136:139], v[76:79], a[232:239], v127
  s_nop 5
  v_cvt_pk_bf16_f32 v140, v128, v129
  v_cvt_pk_bf16_f32 v141, v130, v131
  v_cvt_pk_bf16_f32 v144, v132, v133
  v_cvt_pk_bf16_f32 v145, v134, v135
  v_cvt_pk_bf16_f32 v148, v136, v137
  v_cvt_pk_bf16_f32 v149, v138, v139
  s_cmp_eq_u32 s30, 63
  s_cbranch_scc1 L_last_w3f
  s_mov_b32 s28, 131072
  s_mov_b32 s29, 30
  buffer_load_dwordx4 v[164:167], v120, s[8:11], s43 offen offset:0 sc1
  buffer_load_dwordx4 v[168:171], v120, s[8:11], s43 offen offset:1536 sc1
  buffer_load_dwordx4 v[172:175], v120, s[8:11], s44 offen offset:0 sc1
  buffer_load_dwordx4 v[176:179], v120, s[8:11], s44 offen offset:1536 sc1
  buffer_load_dword v180, v121, s[8:11], s43 offen offset:0 sc1
  buffer_load_dword v181, v121, s[8:11], s43 offen offset:1536 sc1
  buffer_load_dword v182, v121, s[8:11], s44 offen offset:0 sc1
  buffer_load_dword v183, v121, s[8:11], s44 offen offset:1536 sc1
  s_sleep 1
  buffer_load_dwordx4 v[40:43], v120, s[8:11], s43 offen offset:0 sc1
  buffer_load_dwordx4 v[44:47], v120, s[8:11], s43 offen offset:1536 sc1
  buffer_load_dwordx4 v[48:51], v120, s[8:11], s44 offen offset:0 sc1
  buffer_load_dwordx4 v[52:55], v120, s[8:11], s44 offen offset:1536 sc1
  buffer_load_dword v56, v121, s[8:11], s43 offen offset:0 sc1
  buffer_load_dword v57, v121, s[8:11], s43 offen offset:1536 sc1
  buffer_load_dword v58, v121, s[8:11], s44 offen offset:0 sc1
  buffer_load_dword v59, v121, s[8:11], s44 offen offset:1536 sc1
L_sp_w3f_a:
  s_waitcnt vmcnt(8)
  v_max3_u32 v18, v164, v168, v172
  v_max3_u32 v19, v176, v180, v181
  v_max3_u32 v18, v18, v182, v183
  v_max_u32 v18, v18, v19
  v_cmp_eq_u32 vcc, -1, v18
  s_cbranch_vccz L_sp_w3f_oka
  s_sub_u32 s28, s28, 1
  s_cbranch_scc1 L_abort
  buffer_load_dwordx4 v[164:167], v120, s[8:11], s43 offen offset:0 sc1
  buffer_load_dwordx4 v[168:171], v120, s[8:11], s43 offen offset:1536 sc1
  buffer_load_dwordx4 v[172:175], v120, s[8:11], s44 offen offset:0 sc1
  buffer_load_dwordx4 v[176:179], v120, s[8:11], s44 offen offset:1536 sc1
  buffer_load_dword v180, v121, s[8:11], s43 offen offset:0 sc1
  buffer_load_dword v181, v121, s[8:11], s43 offen offset:1536 sc1
  buffer_load_dword v182, v121, s[8:11], s44 offen offset:0 sc1
  buffer_load_dword v183, v121, s[8:11], s44 offen offset:1536 sc1
  s_waitcnt vmcnt(8)
  v_max3_u32 v18, v40, v44, v48
  v_max3_u32 v19, v52, v56, v57
  v_max3_u32 v18, v18, v58, v59
  v_max_u32 v18, v18, v19
  v_cmp_eq_u32 vcc, -1, v18
  s_cbranch_vccz L_sp_w3f_okb
  s_sub_u32 s28, s28, 1
  s_cbranch_scc1 L_abort
  buffer_load_dwordx4 v[40:43], v120, s[8:11], s43 offen offset:0 sc1
  buffer_load_dwordx4 v[44:47], v120, s[8:11], s43 offen offset:1536 sc1
  buffer_load_dwordx4 v[48:51], v120, s[8:11], s44 offen offset:0 sc1
  buffer_load_dwordx4 v[52:55], v120, s[8:11], s44 offen offset:1536 sc1
  buffer_load_dword v56, v121, s[8:11], s43 offen offset:0 sc1
  buffer_load_dword v57, v121, s[8:11], s43 offen offset:1536 sc1
  buffer_load_dword v58, v121, s[8:11], s44 offen offset:0 sc1
  buffer_load_dword v59, v121, s[8:11], s44 offen offset:1536 sc1
  s_branch L_sp_w3f_a
L_sp_w3f_okb:
  v_pk_add_f32 v[184:185], v[40:41], v[44:45]
  v_pk_add_f32 v[186:187], v[42:43], v[46:47]
  v_pk_add_f32 v[196:197], v[48:49], v[52:53]
  v_pk_add_f32 v[198:199], v[50:51], v[54:55]
  v_pk_add_f32 v[108:109], v[56:57], v[58:59]
  s_branch L_sp_w3f_d
L_sp_w3f_oka:
  v_pk_add_f32 v[184:185], v[164:165], v[168:169]
  v_pk_add_f32 v[186:187], v[166:167], v[170:171]
  v_pk_add_f32 v[196:197], v[172:173], v[176:177]
  v_pk_add_f32 v[198:199], v[174:175], v[178:179]
  v_pk_add_f32 v[108:109], v[180:181], v[182:183]
L_sp_w3f_d:
  v_pk_add_f32 v[184:185], v[184:185], v[196:197]
  v_pk_add_f32 v[186:187], v[186:187], v[198:199]
  v_add_f32 v108, v108, v109
  v_max3_f32 v104, v184, v185, v186
  v_max3_f32 v104, v104, v187, v108
  s_nop 1
  v_max_f32_dpp v104, v104, v104 row_ror:8 row_mask:0xf bank_mask:0xf
  v_mov_b32 v105, v104
  s_nop 1
  v_permlane16_swap_b32 v104, v105
  v_max_f32 v104, v104, v105
  v_mov_b32 v105, v104
  s_nop 1
  v_permlane32_swap_b32 v104, v105
  v_max_f32 v104, v104, v105
  v_mul_f32 v104, s57, v104
  v_fma_f32 v184, v184, s57, -v104
  v_fma_f32 v185, v185, s57, -v104
  v_fma_f32 v186, v186, s57, -v104
  v_fma_f32 v187, v187, s57, -v104
  v_fma_f32 v108, v108, s57, -v104
  v_exp_f32 v184, v184
  v_exp_f32 v185, v185
  v_exp_f32 v186, v186
  v_exp_f32 v187, v187
  v_exp_f32 v108, v108
  v_cvt_pk_bf16_f32 v188, v184, v185
  v_cvt_pk_bf16_f32 v189, v186, v187
  v_cvt_pk_bf16_f32 v190, v184, v185
  v_cvt_pk_bf16_f32 v191, v186, v187
  v_cvt_pk_bf16_f32 v105, v108, v108
  v_mov_b32_dpp v188, v188 row_ror:8 row_mask:0xf bank_mask:0xc
  v_mov_b32_dpp v189, v189 row_ror:8 row_mask:0xf bank_mask:0xc
  v_mov_b32_dpp v190, v190 row_ror:8 row_mask:0xf bank_mask:0x3
  v_mov_b32_dpp v191, v191 row_ror:8 row_mask:0xf bank_mask:0x3
  v_mov_b32_dpp v106, v105 row_ror:8 row_mask:0xf bank_mask:0xf
  v_bfi_b32 v192, v126, v105, v106
  v_bfi_b32 v193, v126, v105, v106
  v_mfma_f32_16x16x32_bf16 v[128:131], v[152:155], v[188:191], 0
  v_mfma_f32_16x16x32_bf16 v[132:135], v[156:159], v[188:191], 0
  v_mfma_f32_16x16x32_bf16 v[136:139], v[160:163], v[188:191], 0
  v_mfma_f32_16x16x32_bf16 v[128:131], v[140:143], v[192:195], v[128:131]
  v_mfma_f32_16x16x32_bf16 v[132:135], v[144:147], v[192:195], v[132:135]
  v_mfma_f32_16x16x32_bf16 v[136:139], v[148:151], v[192:195], v[136:139]
  v_pk_add_f32 v[184:185], v[184:185], v[186:187]
  v_add_f32 v104, v184, v185
  v_add_f32 v104, v104, v108
  s_nop 1
  v_add_f32_dpp v104, v104, v104 row_ror:8 row_mask:0xf bank_mask:0xf
  v_mov_b32 v105, v104
  s_nop 1
  v_permlane16_swap_b32 v104, v105
  v_add_f32 v104, v104, v105
  v_mov_b32 v105, v104
  s_nop 1
  v_permlane32_swap_b32 v104, v105
  v_add_f32 v104, v104, v105
  v_rcp_f32 v104, v104
  s_nop 0
  v_pk_mul_f32 v[128:129], v[128:129], v[104:105] op_sel_hi:[1,0]
  v_pk_mul_f32 v[130:131], v[130:131], v[104:105] op_sel_hi:[1,0]
  v_pk_mul_f32 v[132:133], v[132:133], v[104:105] op_sel_hi:[1,0]
  v_pk_mul_f32 v[134:135], v[134:135], v[104:105] op_sel_hi:[1,0]
  v_pk_mul_f32 v[136:137], v[136:137], v[104:105] op_sel_hi:[1,0]
  v_pk_mul_f32 v[138:139], v[138:139], v[104:105] op_sel_hi:[1,0]
  v_cvt_pk_bf16_f32 v108, v128, v129
  v_cvt_pk_bf16_f32 v109, v130, v131
  v_cvt_pk_bf16_f32 v110, v132, v133
  v_cvt_pk_bf16_f32 v111, v134, v135
  v_cvt_pk_bf16_f32 v112, v136, v137
  v_cvt_pk_bf16_f32 v113, v138, v139
  s_mov_b32 exec_lo, 16711935
  s_mov_b32 exec_hi, 16711935
  buffer_store_dwordx4 v[108:111], v122, s[8:11], s45 offen
  buffer_store_dwordx2 v[112:113], v123, s[8:11], s45 offen
  s_mov_b32 exec_lo, 4294967295
  s_mov_b32 exec_hi, 4294967295
  v_mov_b32 v92, 0
  v_mov_b32 v93, 0
  v_mov_b32 v94, 0
  v_mov_b32 v95, 0
  v_mov_b32 v96, 0
  v_mov_b32 v97, 0
  v_mov_b32 v98, 0
  v_mov_b32 v99, 0
  v_mov_b32 v100, 0
  v_mov_b32 v101, 0
  v_mov_b32 v102, 0
  v_mov_b32 v103, 0
  s_barrier
  s_mov_b32 s28, 131072
  s_mov_b32 s29, 43
  buffer_load_dwordx4 v[80:83], v29, s[8:11], s45 offen offset:0 sc1
  buffer_load_dwordx4 v[84:87], v29, s[8:11], s45 offen offset:1024 sc1
  buffer_load_dwordx4 v[88:91], v29, s[8:11], s45 offen offset:2048 sc1
  s_sleep 2
  buffer_load_dwordx4 v[60:63], v29, s[8:11], s45 offen offset:0 sc1
  buffer_load_dwordx4 v[64:67], v29, s[8:11], s45 offen offset:1024 sc1
  buffer_load_dwordx4 v[68:71], v29, s[8:11], s45 offen offset:2048 sc1
L_op_w3f_a:
  s_waitcnt vmcnt(3)
  v_max3_u32 v18, v80, v84, v88
  v_cmp_eq_u32 vcc, -1, v18
  s_cbranch_vccz L_op_w3f_oka
  s_sub_u32 s28, s28, 1
  s_cbranch_scc1 L_abort
  buffer_load_dwordx4 v[80:83], v29, s[8:11], s45 offen offset:0 sc1
  buffer_load_dwordx4 v[84:87], v29, s[8:11], s45 offen offset:1024 sc1
  buffer_load_dwordx4 v[88:91], v29, s[8:11], s45 offen offset:2048 sc1
  s_waitcnt vmcnt(3)
  v_max3_u32 v18, v60, v64, v68
  v_cmp_eq_u32 vcc, -1, v18
  s_cbranch_vccz L_op_w3f_okb
  s_sub_u32 s28, s28, 1
  s_cbranch_scc1 L_abort
  buffer_load_dwordx4 v[60:63], v29, s[8:11], s45 offen offset:0 sc1
  buffer_load_dwordx4 v[64:67], v29, s[8:11], s45 offen offset:1024 sc1
  buffer_load_dwordx4 v[68:71], v29, s[8:11], s45 offen offset:2048 sc1
  s_branch L_op_w3f_a
L_op_w3f_okb:
  v_smfmac_f32_16x16x64_bf16 v[92:95], v[60:63], a[240:247], v20
  v_smfmac_f32_16x16x64_bf16 v[96:99], v[60:63], a[248:255], v20
  v_smfmac_f32_16x16x64_bf16 v[100:103], v[60:63], v[200:207], v20
  v_smfmac_f32_16x16x64_bf16 v[92:95], v[64:67], v[208:215], v20
  v_smfmac_f32_16x16x64_bf16 v[96:99], v[64:67], v[216:223], v20
  v_smfmac_f32_16x16x64_bf16 v[100:103], v[64:67], v[224:231], v20
  v_smfmac_f32_16x16x64_bf16 v[92:95], v[68:71], v[232:239], v20
  v_smfmac_f32_16x16x64_bf16 v[96:99], v[68:71], v[240:247], v20
  v_smfmac_f32_16x16x64_bf16 v[100:103], v[68:71], v[248:255], v20
  s_branch L_op_w3f_d
L_op_w3f_oka:
  v_smfmac_f32_16x16x64_bf16 v[92:95], v[80:83], a[240:247], v20
  v_smfmac_f32_16x16x64_bf16 v[96:99], v[80:83], a[248:255], v20
  v_smfmac_f32_16x16x64_bf16 v[100:103], v[80:83], v[200:207], v20
  v_smfmac_f32_16x16x64_bf16 v[92:95], v[84:87], v[208:215], v20
  v_smfmac_f32_16x16x64_bf16 v[96:99], v[84:87], v[216:223], v20
  v_smfmac_f32_16x16x64_bf16 v[100:103], v[84:87], v[224:231], v20
  v_smfmac_f32_16x16x64_bf16 v[92:95], v[88:91], v[232:239], v20
  v_smfmac_f32_16x16x64_bf16 v[96:99], v[88:91], v[240:247], v20
  v_smfmac_f32_16x16x64_bf16 v[100:103], v[88:91], v[248:255], v20
L_op_w3f_d:
  s_nop 5
  v_permlane32_swap_b32 v92, v93
  v_permlane32_swap_b32 v94, v95
  v_permlane32_swap_b32 v96, v97
  v_permlane32_swap_b32 v98, v99
  v_permlane32_swap_b32 v100, v101
  v_permlane32_swap_b32 v102, v103
  v_add_f32 v92, v92, v93
  v_add_f32 v94, v94, v95
  v_add_f32 v96, v96, v97
  v_add_f32 v98, v98, v99
  v_add_f32 v100, v100, v101
  v_add_f32 v102, v102, v103
  ds_write_b32 v30, v92 offset:0
  ds_write_b32 v30, v94 offset:128
  ds_write_b32 v30, v96 offset:512
  ds_write_b32 v30, v98 offset:640
  ds_write_b32 v30, v100 offset:1024
  ds_write_b32 v30, v102 offset:1152
  s_cmp_ge_u32 s30, 62
  s_cbranch_scc1 L_nopf_w3f
  s_add_u32 s7, s30, 1
  s_add_u32 s6, s7, 1
  s_cmp_ge_u32 s56, s6
  s_cbranch_scc1 L_fa_ok_w3fpf
  v_readlane_b32 s56, v37, 0
  v_readlane_b32 s4, v37, 1
  v_readlane_b32 s5, v37, 2
  s_min_u32 s56, s56, s4
  s_min_u32 s56, s56, s5
  s_cmp_ge_u32 s56, s6
  s_cbranch_scc1 L_fa_ok_w3fpf
  s_mov_b32 s28, 131072
  s_mov_b32 s29, 10
L_fa_w3fpf:
  buffer_load_dword v37, v35, s[8:11], 0 offen sc1
  s_waitcnt vmcnt(0)
  v_readlane_b32 s56, v37, 0
  v_readlane_b32 s4, v37, 1
  v_readlane_b32 s5, v37, 2
  s_sub_u32 s28, s28, 1
  s_cbranch_scc1 L_abort
  s_min_u32 s56, s56, s4
  s_min_u32 s56, s56, s5
  s_cmp_ge_u32 s56, s6
  s_cbranch_scc0 L_fa_w3fpf
L_fa_ok_w3fpf:
  s_add_u32 s4, s6, 3
  s_cmp_ge_u32 s56, s4
  s_cbranch_scc1 L_fa_far_w3fpf
  buffer_load_dword v37, v35, s[8:11], 0 offen sc1
L_fa_far_w3fpf:
  s_mul_i32 s4, s7, 393216
  s_add_u32 s4, s4, 58609664
  buffer_load_dwordx4 v[152:155], v124, s[8:11], s4 offen offset:0 sc1
  buffer_load_dwordx4 v[156:159], v124, s[8:11], s4 offen offset:1024 sc1
  buffer_load_dwordx4 v[160:163], v124, s[8:11], s4 offen offset:2048 sc1
L_nopf_w3f:
  s_waitcnt lgkmcnt(0)
  s_barrier
  s_sleep 4
  buffer_store_dwordx2 v[140:141], v125, s[8:11], s55 offen offset:0 sc1
  buffer_store_dwordx2 v[144:145], v125, s[8:11], s55 offen offset:512 sc1
  buffer_store_dwordx2 v[148:149], v125, s[8:11], s55 offen offset:1024 sc1
  s_cmp_eq_u32 s39, 0
  s_cbranch_scc1 L_noown_w3f
  s_sleep 6
  s_mov_b32 s28, 131072
  s_mov_b32 s29, 53
  buffer_load_dwordx4 v[164:167], v33, s[8:11], s46 offen offset:0 sc1
  buffer_load_dwordx4 v[168:171], v33, s[8:11], s46 offen offset:1024 sc1
  buffer_load_dwordx4 v[172:175], v33, s[8:11], s46 offen offset:2048 sc1
  buffer_load_dwordx4 v[176:179], v33, s[8:11], s46 offen offset:3072 sc1
  s_sleep 4
  buffer_load_dwordx4 v[40:43], v33, s[8:11], s46 offen offset:0 sc1
  buffer_load_dwordx4 v[44:47], v33, s[8:11], s46 offen offset:1024 sc1
  buffer_load_dwordx4 v[48:51], v33, s[8:11], s46 offen offset:2048 sc1
  buffer_load_dwordx4 v[52:55], v33, s[8:11], s46 offen offset:3072 sc1
L_xq_w3f_a:
  s_waitcnt vmcnt(4)
  v_max3_u32 v18, v164, v168, v172
  v_max_u32 v18, v18, v176
  v_cmp_eq_u32 vcc, -1, v18
  s_cbranch_vccz L_xq_w3f_oka
  s_sub_u32 s28, s28, 1
  s_cbranch_scc1 L_abort
  buffer_load_dwordx4 v[164:167], v33, s[8:11], s46 offen offset:0 sc1
  buffer_load_dwordx4 v[168:171], v33, s[8:11], s46 offen offset:1024 sc1
  buffer_load_dwordx4 v[172:175], v33, s[8:11], s46 offen offset:2048 sc1
  buffer_load_dwordx4 v[176:179], v33, s[8:11], s46 offen offset:3072 sc1
  s_waitcnt vmcnt(4)
  v_max3_u32 v18, v40, v44, v48
  v_max_u32 v18, v18, v52
  v_cmp_eq_u32 vcc, -1, v18
  s_cbranch_vccz L_xq_w3f_okb
  s_sub_u32 s28, s28, 1
  s_cbranch_scc1 L_abort
  buffer_load_dwordx4 v[40:43], v33, s[8:11], s46 offen offset:0 sc1
  buffer_load_dwordx4 v[44:47], v33, s[8:11], s46 offen offset:1024 sc1
  buffer_load_dwordx4 v[48:51], v33, s[8:11], s46 offen offset:2048 sc1
  buffer_load_dwordx4 v[52:55], v33, s[8:11], s46 offen offset:3072 sc1
  s_branch L_xq_w3f_a
L_xq_w3f_okb:
  v_pk_add_f32 v[104:105], v[40:41], v[44:45]
  v_pk_add_f32 v[106:107], v[42:43], v[46:47]
  v_pk_add_f32 v[112:113], v[48:49], v[52:53]
  v_pk_add_f32 v[114:115], v[50:51], v[54:55]
  s_branch L_xq_w3f_d
L_xq_w3f_oka:
  v_pk_add_f32 v[104:105], v[164:165], v[168:169]
  v_pk_add_f32 v[106:107], v[166:167], v[170:171]
  v_pk_add_f32 v[112:113], v[172:173], v[176:177]
  v_pk_add_f32 v[114:115], v[174:175], v[178:179]
L_xq_w3f_d:
  v_pk_add_f32 v[104:105], v[104:105], v[112:113]
  v_pk_add_f32 v[106:107], v[106:107], v[114:115]
  s_nop 1
  v_permlane32_swap_b32 v104, v106
  v_permlane32_swap_b32 v105, v107
  v_add_f32 v104, v104, v106
  v_add_f32 v105, v105, v107
  v_cvt_pk_bf16_f32 v104, v104, v105
  buffer_store_dword v104, v34, s[8:11], s47 offen
L_noown_w3f:
  s_add_u32 s30, s30, 1
  s_and_b32 s58, s30, 3
  s_mul_i32 s40, s58, 40960
  s_mul_i32 s59, s25, 10240
  s_add_u32 s59, s59, 5492736
  s_add_u32 s40, s40, s59
  s_add_u32 s41, s40, 4096
  s_add_u32 s42, s40, 8192
  s_mul_i32 s45, s58, 98304
  s_add_u32 s45, s45, 905216
  s_mul_i32 s46, s58, 327680
  s_add_u32 s46, s46, s61
  s_mul_i32 s43, s58, 196608
  s_mul_i32 s3, s32, 6144
  s_add_u32 s3, s3, 118784
  s_add_u32 s43, s43, s3
  s_add_u32 s44, s43, 3072
  s_add_u32 s58, s30, 1
  s_and_b32 s58, s58, 3
  s_mul_i32 s47, s58, 40960
  s_add_u32 s47, s47, s59
  s_add_u32 s58, s30, 3
  s_and_b32 s58, s58, 3
  s_mul_i32 s51, s58, 40960
  s_add_u32 s51, s51, s59
  s_mul_i32 s48, s58, 196608
  s_add_u32 s48, s48, s3
  s_mul_i32 s49, s58, 98304
  s_add_u32 s49, s49, 905216
  s_add_u32 s58, s30, 2
  s_and_b32 s58, s58, 3
  s_mul_i32 s50, s58, 327680
  s_add_u32 s50, s50, s61
  s_mul_i32 s54, s30, 196608
  s_add_u32 s55, s54, 96358400
  s_add_u32 s54, s54, 83775488
  v_mov_b32 v128, 0
  v_mov_b32 v129, 0
  v_mov_b32 v130, 0
  v_mov_b32 v131, 0
  v_mov_b32 v132, 0
  v_mov_b32 v133, 0
  v_mov_b32 v134, 0
  v_mov_b32 v135, 0
  v_mov_b32 v136, 0
  v_mov_b32 v137, 0
  v_mov_b32 v138, 0
  v_mov_b32 v139, 0
  s_barrier
  s_branch L_step_w3f
L_last_w3f:
  buffer_store_dwordx2 v[140:141], v125, s[8:11], s55 offen offset:0 sc1
  buffer_store_dwordx2 v[144:145], v125, s[8:11], s55 offen offset:512 sc1
  buffer_store_dwordx2 v[148:149], v125, s[8:11], s55 offen offset:1024 sc1
  s_add_u32 s53, s53, 16384
  s_waitcnt vmcnt(0)
  s_mov_b64 exec, 1
  v_mov_b32 v104, 64
  v_mov_b32 v105, 0
  buffer_store_dword v104, v105, s[8:11], s53 offen sc1
  s_waitcnt vmcnt(0)
  s_mov_b64 exec, -1
  s_branch L_exit
L_chain_slow:
  s_cmp_eq_u32 s24, 1
  s_cbranch_scc1 L_cw1s
  s_cmp_eq_u32 s24, 2
  s_cbranch_scc1 L_cw2s
  s_cmp_eq_u32 s24, 3
  s_cbranch_scc1 L_cw3s
  v_mov_b32 v142, 0
  v_mov_b32 v143, 0
  v_mov_b32 v150, 0
  v_mov_b32 v151, 0
  s_mov_b32 s30, 0
  s_mov_b32 s56, 0
  v_mov_b32 v37, 0
  s_and_b32 s58, s30, 3
  s_mul_i32 s40, s58, 40960
  s_mul_i32 s59, s25, 10240
  s_add_u32 s59, s59, 5492736
  s_add_u32 s40, s40, s59
  s_add_u32 s41, s40, 4096
  s_add_u32 s42, s40, 8192
  s_mul_i32 s45, s58, 98304
  s_add_u32 s45, s45, 905216
  s_mul_i32 s46, s58, 327680
  s_add_u32 s46, s46, s61
  s_mul_i32 s43, s58, 196608
  s_mul_i32 s3, s32, 6144
  s_add_u32 s3, s3, 118784
  s_add_u32 s43, s43, s3
  s_add_u32 s44, s43, 3072
  s_add_u32 s58, s30, 1
  s_and_b32 s58, s58, 3
  s_mul_i32 s47, s58, 40960
  s_add_u32 s47, s47, s59
  s_add_u32 s58, s30, 3
  s_and_b32 s58, s58, 3
  s_mul_i32 s51, s58, 40960
  s_add_u32 s51, s51, s59
  s_mul_i32 s48, s58, 196608
  s_add_u32 s48, s48, s3
  s_mul_i32 s49, s58, 98304
  s_add_u32 s49, s49, 905216
  s_add_u32 s58, s30, 2
  s_and_b32 s58, s58, 3
  s_mul_i32 s50, s58, 327680
  s_add_u32 s50, s50, s61
  s_mul_i32 s54, s30, 196608
  s_add_u32 s55, s54, 96358400
  s_add_u32 s54, s54, 83775488
  s_load_dwordx2 s[16:17], s[0:1], 8
  s_waitcnt lgkmcnt(0)
  s_and_b32 s17, s17, 0xffff
  s_mov_b32 s18, 10240
  s_mov_b32 s19, 0x20000
  buffer_load_dwordx4 v[104:107], v36, s[16:19], 0 offen offset:0
  buffer_load_dwordx4 v[108:111], v36, s[16:19], 0 offen offset:512
  buffer_load_dwordx4 v[112:115], v36, s[16:19], 0 offen offset:1024
  s_waitcnt vmcnt(0)
  v_mov_b32 v128, 0
  v_mov_b32 v129, 0
  v_mov_b32 v130, 0
  v_mov_b32 v131, 0
  v_mov_b32 v132, 0
  v_mov_b32 v133, 0
  v_mov_b32 v134, 0
  v_mov_b32 v135, 0
  s_branch L_have_w0s
L_step_w0s:
  s_mov_b32 s28, 131072
  s_mov_b32 s29, 20
  buffer_load_dwordx4 v[164:167], v26, s[8:11], s40 offen sc1
  buffer_load_dwordx4 v[168:171], v26, s[8:11], s41 offen sc1
  buffer_load_dwordx4 v[172:175], v26, s[8:11], s42 offen sc1
  s_sleep 1
  buffer_load_dwordx4 v[176:179], v26, s[8:11], s40 offen sc1
  buffer_load_dwordx4 v[180:183], v26, s[8:11], s41 offen sc1
  buffer_load_dwordx4 v[184:187], v26, s[8:11], s42 offen sc1
L_agp_w0s_a:
  s_waitcnt vmcnt(3)
  v_max3_u32 v188, v164, v168, v172
  v_cmp_eq_u32 vcc, -1, v188
  s_cbranch_vccz L_agp_w0s_oka
  s_sub_u32 s28, s28, 1
  s_cbranch_scc1 L_abort
  buffer_load_dwordx4 v[164:167], v26, s[8:11], s40 offen sc1
  buffer_load_dwordx4 v[168:171], v26, s[8:11], s41 offen sc1
  buffer_load_dwordx4 v[172:175], v26, s[8:11], s42 offen sc1
  s_waitcnt vmcnt(3)
  v_max3_u32 v188, v176, v180, v184
  v_cmp_eq_u32 vcc, -1, v188
  s_cbranch_vccz L_agp_w0s_okb
  s_sub_u32 s28, s28, 1
  s_cbranch_scc1 L_abort
  buffer_load_dwordx4 v[176:179], v26, s[8:11], s40 offen sc1
  buffer_load_dwordx4 v[180:183], v26, s[8:11], s41 offen sc1
  buffer_load_dwordx4 v[184:187], v26, s[8:11], s42 offen sc1
  s_branch L_agp_w0s_a
L_agp_w0s_okb:
  ds_write_b128 v27, v[176:179] offset:0
  ds_write_b128 v27, v[180:183] offset:4096
  ds_write_b128 v27, v[184:187] offset:8192
  s_branch L_agp_w0s_d
L_agp_w0s_oka:
  ds_write_b128 v27, v[164:167] offset:0
  ds_write_b128 v27, v[168:171] offset:4096
  ds_write_b128 v27, v[172:175] offset:8192
L_agp_w0s_d:
  s_branch L_staged_w0s
L_have_w0s:
  ds_write_b128 v27, v[104:107] offset:0
  ds_write_b128 v27, v[108:111] offset:4096
  ds_write_b128 v27, v[112:115] offset:8192
L_staged_w0s:
  s_waitcnt lgkmcnt(0)
  s_barrier
  ds_read_b128 v[40:43], v28 offset:0
  ds_read_b128 v[44:47], v28 offset:1024
  ds_read_b128 v[48:51], v28 offset:2048
  ds_read_b128 v[52:55], v28 offset:3072
  ds_read_b128 v[56:59], v28 offset:4096
  ds_read_b128 v[60:63], v28 offset:5120
  ds_read_b128 v[64:67], v28 offset:6144
  ds_read_b128 v[68:71], v28 offset:7168
  ds_read_b128 v[72:75], v28 offset:8192
  ds_read_b128 v[76:79], v28 offset:9216
  s_waitcnt lgkmcnt(9)
  v_smfmac_f32_16x16x64_bf16 v[128:131], v[40:43], a[0:7], v20
  v_smfmac_f32_16x16x64_bf16 v[132:135], v[40:43], a[80:87], v20
  s_waitcnt lgkmcnt(8)
  v_smfmac_f32_16x16x64_bf16 v[128:131], v[44:47], a[8:15], v20
  v_smfmac_f32_16x16x64_bf16 v[132:135], v[44:47], a[88:95], v20
  s_waitcnt lgkmcnt(7)
  v_smfmac_f32_16x16x64_bf16 v[128:131], v[48:51], a[16:23], v20
  v_smfmac_f32_16x16x64_bf16 v[132:135], v[48:51], a[96:103], v20
  buffer_store_dwordx4 v[22:25], v32, s[8:11], s50 offen sc1
  s_mov_b64 exec, 1
  v_mov_b32 v118, s30
  v_mov_b32 v119, 0
  buffer_store_dword v118, v119, s[8:11], s53 offen sc1
  s_mov_b64 exec, -1
  s_waitcnt lgkmcnt(6)
  v_smfmac_f32_16x16x64_bf16 v[128:131], v[52:55], a[24:31], v20
  v_smfmac_f32_16x16x64_bf16 v[132:135], v[52:55], a[104:111], v20
  s_waitcnt lgkmcnt(5)
  v_smfmac_f32_16x16x64_bf16 v[128:131], v[56:59], a[32:39], v20
  v_smfmac_f32_16x16x64_bf16 v[132:135], v[56:59], a[112:119], v20
  s_waitcnt lgkmcnt(4)
  v_smfmac_f32_16x16x64_bf16 v[128:131], v[60:63], a[40:47], v20
  v_smfmac_f32_16x16x64_bf16 v[132:135], v[60:63], a[120:127], v20
  s_waitcnt lgkmcnt(3)
  v_smfmac_f32_16x16x64_bf16 v[128:131], v[64:67], a[48:55], v20
  v_smfmac_f32_16x16x64_bf16 v[132:135], v[64:67], a[128:135], v20
  s_waitcnt lgkmcnt(2)
  v_smfmac_f32_16x16x64_bf16 v[128:131], v[68:71], a[56:63], v20
  v_smfmac_f32_16x16x64_bf16 v[132:135], v[68:71], a[136:143], v20
  s_waitcnt lgkmcnt(1)
  v_smfmac_f32_16x16x64_bf16 v[128:131], v[72:75], a[64:71], v20
  v_smfmac_f32_16x16x64_bf16 v[132:135], v[72:75], a[144:151], v20
  s_waitcnt lgkmcnt(0)
  v_smfmac_f32_16x16x64_bf16 v[128:131], v[76:79], a[72:79], v20
  v_smfmac_f32_16x16x64_bf16 v[132:135], v[76:79], a[152:159], v20
  s_nop 7
  v_permlane32_swap_b32 v128, v132
  v_permlane32_swap_b32 v129, v133
  v_permlane32_swap_b32 v130, v134
  v_permlane32_swap_b32 v131, v135
  v_add_f32 v128, v128, v132
  v_add_f32 v129, v129, v133
  v_add_f32 v130, v130, v134
  v_add_f32 v131, v131, v135
  v_cvt_pk_bf16_f32 v104, v128, v129
  v_cvt_pk_bf16_f32 v105, v130, v131
  ds_write_b64 v120, v[104:105]
  s_waitcnt lgkmcnt(0)
  s_barrier
  ds_read_b64_tr_b16 v[136:137], v121
  ds_read_b64_tr_b16 v[138:139], v121 offset:384
  ds_read_b64_tr_b16 v[140:141], v122
  ds_read_b64_tr_b16 v[144:145], v121 offset:1280
  ds_read_b64_tr_b16 v[146:147], v121 offset:1664
  ds_read_b64_tr_b16 v[148:149], v122 offset:1280
  s_cmp_eq_u32 s30, 63
  s_cbranch_scc1 L_last_w0s
  s_waitcnt lgkmcnt(0)
  v_mfma_f32_16x16x32_bf16 v[152:155], v[144:147], v[136:139], 0
  v_mfma_f32_16x16x32_bf16 v[152:155], v[148:151], v[140:143], v[152:155]
  s_mov_b32 exec_lo, 16711935
  s_mov_b32 exec_hi, 0
  s_nop 5
  buffer_store_dwordx4 v[152:155], v123, s[8:11], s43 offen sc1
  s_mov_b32 exec_lo, 4294967295
  s_mov_b32 exec_hi, 4294967295
  v_mov_b32 v92, 0
  v_mov_b32 v93, 0
  v_mov_b32 v94, 0
  v_mov_b32 v95, 0
  v_mov_b32 v96, 0
  v_mov_b32 v97, 0
  v_mov_b32 v98, 0
  v_mov_b32 v99, 0
  v_mov_b32 v100, 0
  v_mov_b32 v101, 0
  v_mov_b32 v102, 0
  v_mov_b32 v103, 0
  s_barrier
  s_mov_b32 s28, 131072
  s_mov_b32 s29, 40
  buffer_load_dwordx4 v[80:83], v29, s[8:11], s45 offen offset:0 sc1
  buffer_load_dwordx4 v[84:87], v29, s[8:11], s45 offen offset:1024 sc1
  buffer_load_dwordx4 v[88:91], v29, s[8:11], s45 offen offset:2048 sc1
  s_sleep 2
  buffer_load_dwordx4 v[192:195], v29, s[8:11], s45 offen offset:0 sc1
  buffer_load_dwordx4 v[196:199], v29, s[8:11], s45 offen offset:1024 sc1
  buffer_load_dwordx4 v[200:203], v29, s[8:11], s45 offen offset:2048 sc1
L_op_w0s_a:
  s_waitcnt vmcnt(3)
  v_max3_u32 v188, v80, v84, v88
  v_cmp_eq_u32 vcc, -1, v188
  s_cbranch_vccz L_op_w0s_oka
  s_sub_u32 s28, s28, 1
  s_cbranch_scc1 L_abort
  buffer_load_dwordx4 v[80:83], v29, s[8:11], s45 offen offset:0 sc1
  buffer_load_dwordx4 v[84:87], v29, s[8:11], s45 offen offset:1024 sc1
  buffer_load_dwordx4 v[88:91], v29, s[8:11], s45 offen offset:2048 sc1
  s_waitcnt vmcnt(3)
  v_max3_u32 v188, v192, v196, v200
  v_cmp_eq_u32 vcc, -1, v188
  s_cbranch_vccz L_op_w0s_okb
  s_sub_u32 s28, s28, 1
  s_cbranch_scc1 L_abort
  buffer_load_dwordx4 v[192:195], v29, s[8:11], s45 offen offset:0 sc1
  buffer_load_dwordx4 v[196:199], v29, s[8:11], s45 offen offset:1024 sc1
  buffer_load_dwordx4 v[200:203], v29, s[8:11], s45 offen offset:2048 sc1
  s_branch L_op_w0s_a
L_op_w0s_okb:
  v_smfmac_f32_16x16x64_bf16 v[92:95], v[192:195], a[160:167], v20
  v_smfmac_f32_16x16x64_bf16 v[96:99], v[192:195], a[168:175], v20
  v_smfmac_f32_16x16x64_bf16 v[100:103], v[192:195], a[176:183], v20
  v_smfmac_f32_16x16x64_bf16 v[92:95], v[196:199], a[184:191], v20
  v_smfmac_f32_16x16x64_bf16 v[96:99], v[196:199], a[192:199], v20
  v_smfmac_f32_16x16x64_bf16 v[100:103], v[196:199], a[200:207], v20
  v_smfmac_f32_16x16x64_bf16 v[92:95], v[200:203], a[208:215], v20
  v_smfmac_f32_16x16x64_bf16 v[96:99], v[200:203], a[216:223], v20
  v_smfmac_f32_16x16x64_bf16 v[100:103], v[200:203], a[224:231], v20
  s_branch L_op_w0s_d
L_op_w0s_oka:
  v_smfmac_f32_16x16x64_bf16 v[92:95], v[80:83], a[160:167], v20
  v_smfmac_f32_16x16x64_bf16 v[96:99], v[80:83], a[168:175], v20
  v_smfmac_f32_16x16x64_bf16 v[100:103], v[80:83], a[176:183], v20
  v_smfmac_f32_16x16x64_bf16 v[92:95], v[84:87], a[184:191], v20
  v_smfmac_f32_16x16x64_bf16 v[96:99], v[84:87], a[192:199], v20
  v_smfmac_f32_16x16x64_bf16 v[100:103], v[84:87], a[200:207], v20
  v_smfmac_f32_16x16x64_bf16 v[92:95], v[88:91], a[208:215], v20
  v_smfmac_f32_16x16x64_bf16 v[96:99], v[88:91], a[216:223], v20
  v_smfmac_f32_16x16x64_bf16 v[100:103], v[88:91], a[224:231], v20
L_op_w0s_d:
  s_nop 5
  v_permlane32_swap_b32 v92, v93
  v_permlane32_swap_b32 v94, v95
  v_permlane32_swap_b32 v96, v97
  v_permlane32_swap_b32 v98, v99
  v_permlane32_swap_b32 v100, v101
  v_permlane32_swap_b32 v102, v103
  v_add_f32 v92, v92, v93
  v_add_f32 v94, v94, v95
  v_add_f32 v96, v96, v97
  v_add_f32 v98, v98, v99
  v_add_f32 v100, v100, v101
  v_add_f32 v102, v102, v103
  ds_write_b32 v30, v92 offset:0
  ds_write_b32 v30, v94 offset:128
  ds_write_b32 v30, v96 offset:512
  ds_write_b32 v30, v98 offset:640
  ds_write_b32 v30, v100 offset:1024
  ds_write_b32 v30, v102 offset:1152
  s_waitcnt lgkmcnt(0)
  s_barrier
  ds_read_b128 v[104:107], v31 offset:0
  ds_read_b128 v[108:111], v31 offset:1536
  ds_read_b128 v[112:115], v31 offset:3072
  ds_read_b128 v[116:119], v31 offset:4608
  s_waitcnt lgkmcnt(2)
  v_add_f32 v104, v104, v108
  v_add_f32 v105, v105, v109
  v_add_f32 v106, v106, v110
  v_add_f32 v107, v107, v111
  s_waitcnt lgkmcnt(0)
  v_add_f32 v112, v112, v116
  v_add_f32 v113, v113, v117
  v_add_f32 v114, v114, v118
  v_add_f32 v115, v115, v119
  v_add_f32 v104, v104, v112
  v_add_f32 v105, v105, v113
  v_add_f32 v106, v106, v114
  v_add_f32 v107, v107, v115
  buffer_store_dwordx4 v[104:107], v32, s[8:11], s46 offen sc1
  s_mov_b32 exec_lo, 16711935
  s_mov_b32 exec_hi, 16711935
  buffer_store_dwordx4 v[144:147], v126, s[8:11], s54 offen sc1
  buffer_store_dwordx2 v[148:149], v127, s[8:11], s54 offen sc1
  s_mov_b32 exec_lo, 4294967295
  s_mov_b32 exec_hi, 4294967295
  s_mov_b32 exec_lo, 16711935
  s_mov_b32 exec_hi, 0
  buffer_store_dwordx4 v[22:25], v123, s[8:11], s48 offen sc1
  s_mov_b32 exec_lo, 4294967295
  s_mov_b32 exec_hi, 4294967295
  s_add_u32 s30, s30, 1
  s_and_b32 s58, s30, 3
  s_mul_i32 s40, s58, 40960
  s_mul_i32 s59, s25, 10240
  s_add_u32 s59, s59, 5492736
  s_add_u32 s40, s40, s59
  s_add_u32 s41, s40, 4096
  s_add_u32 s42, s40, 8192
  s_mul_i32 s45, s58, 98304
  s_add_u32 s45, s45, 905216
  s_mul_i32 s46, s58, 327680
  s_add_u32 s46, s46, s61
  s_mul_i32 s43, s58, 196608
  s_mul_i32 s3, s32, 6144
  s_add_u32 s3, s3, 118784
  s_add_u32 s43, s43, s3
  s_add_u32 s44, s43, 3072
  s_add_u32 s58, s30, 1
  s_and_b32 s58, s58, 3
  s_mul_i32 s47, s58, 40960
  s_add_u32 s47, s47, s59
  s_add_u32 s58, s30, 3
  s_and_b32 s58, s58, 3
  s_mul_i32 s51, s58, 40960
  s_add_u32 s51, s51, s59
  s_mul_i32 s48, s58, 196608
  s_add_u32 s48, s48, s3
  s_mul_i32 s49, s58, 98304
  s_add_u32 s49, s49, 905216
  s_add_u32 s58, s30, 2
  s_and_b32 s58, s58, 3
  s_mul_i32 s50, s58, 327680
  s_add_u32 s50, s50, s61
  s_mul_i32 s54, s30, 196608
  s_add_u32 s55, s54, 96358400
  s_add_u32 s54, s54, 83775488
  v_mov_b32 v128, 0
  v_mov_b32 v129, 0
  v_mov_b32 v130, 0
  v_mov_b32 v131, 0
  v_mov_b32 v132, 0
  v_mov_b32 v133, 0
  v_mov_b32 v134, 0
  v_mov_b32 v135, 0
  s_barrier
  s_branch L_step_w0s
L_last_w0s:
  s_waitcnt lgkmcnt(0)
  s_mov_b32 exec_lo, 16711935
  s_mov_b32 exec_hi, 16711935
  buffer_store_dwordx4 v[144:147], v126, s[8:11], s54 offen sc1
  buffer_store_dwordx2 v[148:149], v127, s[8:11], s54 offen sc1
  s_waitcnt vmcnt(0)
  s_mov_b64 exec, 1
  v_mov_b32 v104, 64
  v_mov_b32 v105, 0
  buffer_store_dword v104, v105, s[8:11], s53 offen sc1
  s_waitcnt vmcnt(0)
  s_mov_b64 exec, -1
  s_branch L_exit
L_cw1s:
  v_mov_b32 v142, 0
  v_mov_b32 v143, 0
  v_mov_b32 v150, 0
  v_mov_b32 v151, 0
  s_mov_b32 s30, 0
  s_mov_b32 s56, 0
  v_mov_b32 v37, 0
  s_and_b32 s58, s30, 3
  s_mul_i32 s40, s58, 40960
  s_mul_i32 s59, s25, 10240
  s_add_u32 s59, s59, 5492736
  s_add_u32 s40, s40, s59
  s_add_u32 s41, s40, 4096
  s_add_u32 s42, s40, 8192
  s_mul_i32 s45, s58, 98304
  s_add_u32 s45, s45, 905216
  s_mul_i32 s46, s58, 327680
  s_add_u32 s46, s46, s61
  s_mul_i32 s43, s58, 196608
  s_mul_i32 s3, s32, 6144
  s_add_u32 s3, s3, 118784
  s_add_u32 s43, s43, s3
  s_add_u32 s44, s43, 3072
  s_add_u32 s58, s30, 1
  s_and_b32 s58, s58, 3
  s_mul_i32 s47, s58, 40960
  s_add_u32 s47, s47, s59
  s_add_u32 s58, s30, 3
  s_and_b32 s58, s58, 3
  s_mul_i32 s51, s58, 40960
  s_add_u32 s51, s51, s59
  s_mul_i32 s48, s58, 196608
  s_add_u32 s48, s48, s3
  s_mul_i32 s49, s58, 98304
  s_add_u32 s49, s49, 905216
  s_add_u32 s58, s30, 2
  s_and_b32 s58, s58, 3
  s_mul_i32 s50, s58, 327680
  s_add_u32 s50, s50, s61
  s_mul_i32 s54, s30, 196608
  s_add_u32 s55, s54, 96358400
  s_add_u32 s54, s54, 83775488
  s_add_u32 s6, s30, 1
  s_cmp_ge_u32 s56, s6
  s_cbranch_scc1 L_fa_ok_w1sp0
  v_readlane_b32 s56, v37, 0
  v_readlane_b32 s4, v37, 1
  v_readlane_b32 s5, v37, 2
  s_min_u32 s56, s56, s4
  s_min_u32 s56, s56, s5
  s_cmp_ge_u32 s56, s6
  s_cbranch_scc1 L_fa_ok_w1sp0
  s_mov_b32 s28, 131072
  s_mov_b32 s29, 10
L_fa_w1sp0:
  buffer_load_dword v37, v35, s[8:11], 0 offen sc1
  s_waitcnt vmcnt(0)
  v_readlane_b32 s56, v37, 0
  v_readlane_b32 s4, v37, 1
  v_readlane_b32 s5, v37, 2
  s_sub_u32 s28, s28, 1
  s_cbranch_scc1 L_abort
  s_min_u32 s56, s56, s4
  s_min_u32 s56, s56, s5
  s_cmp_ge_u32 s56, s6
  s_cbranch_scc0 L_fa_w1sp0
L_fa_ok_w1sp0:
  s_add_u32 s4, s6, 3
  s_cmp_ge_u32 s56, s4
  s_cbranch_scc1 L_fa_far_w1sp0
  buffer_load_dword v37, v35, s[8:11], 0 offen sc1
L_fa_far_w1sp0:
  s_mul_i32 s4, s30, 393216
  s_add_u32 s4, s4, 33443840
  buffer_load_dwordx4 v[144:147], v124, s[8:11], s4 offen sc1
  buffer_load_dwordx2 v[148:149], v125, s[8:11], s4 offen sc1
  s_load_dwordx2 s[16:17], s[0:1], 8
  s_waitcnt lgkmcnt(0)
  s_and_b32 s17, s17, 0xffff
  s_mov_b32 s18, 10240
  s_mov_b32 s19, 0x20000
  buffer_load_dwordx4 v[104:107], v36, s[16:19], 0 offen offset:0
  buffer_load_dwordx4 v[108:111], v36, s[16:19], 0 offen offset:512
  buffer_load_dwordx4 v[112:115], v36, s[16:19], 0 offen offset:1024
  s_waitcnt vmcnt(0)
  v_mov_b32 v128, 0
  v_mov_b32 v129, 0
  v_mov_b32 v130, 0
  v_mov_b32 v131, 0
  v_mov_b32 v132, 0
  v_mov_b32 v133, 0
  v_mov_b32 v134, 0
  v_mov_b32 v135, 0
  s_branch L_have_w1s
L_step_w1s:
  s_mov_b32 s28, 131072
  s_mov_b32 s29, 21
  buffer_load_dwordx4 v[164:167], v26, s[8:11], s40 offen sc1
  buffer_load_dwordx4 v[168:171], v26, s[8:11], s41 offen sc1
  buffer_load_dwordx4 v[172:175], v26, s[8:11], s42 offen sc1
  s_sleep 1
  buffer_load_dwordx4 v[176:179], v26, s[8:11], s40 offen sc1
  buffer_load_dwordx4 v[180:183], v26, s[8:11], s41 offen sc1
  buffer_load_dwordx4 v[184:187], v26, s[8:11], s42 offen sc1
L_agp_w1s_a:
  s_waitcnt vmcnt(3)
  v_max3_u32 v188, v164, v168, v172
  v_cmp_eq_u32 vcc, -1, v188
  s_cbranch_vccz L_agp_w1s_oka
  s_sub_u32 s28, s28, 1
  s_cbranch_scc1 L_abort
  buffer_load_dwordx4 v[164:167], v26, s[8:11], s40 offen sc1
  buffer_load_dwordx4 v[168:171], v26, s[8:11], s41 offen sc1
  buffer_load_dwordx4 v[172:175], v26, s[8:11], s42 offen sc1
  s_waitcnt vmcnt(3)
  v_max3_u32 v188, v176, v180, v184
  v_cmp_eq_u32 vcc, -1, v188
  s_cbranch_vccz L_agp_w1s_okb
  s_sub_u32 s28, s28, 1
  s_cbranch_scc1 L_abort
  buffer_load_dwordx4 v[176:179], v26, s[8:11], s40 offen sc1
  buffer_load_dwordx4 v[180:183], v26, s[8:11], s41 offen sc1
  buffer_load_dwordx4 v[184:187], v26, s[8:11], s42 offen sc1
  s_branch L_agp_w1s_a
L_agp_w1s_okb:
  ds_write_b128 v27, v[176:179] offset:0
  ds_write_b128 v27, v[180:183] offset:4096
  ds_write_b128 v27, v[184:187] offset:8192
  s_branch L_agp_w1s_d
L_agp_w1s_oka:
  ds_write_b128 v27, v[164:167] offset:0
  ds_write_b128 v27, v[168:171] offset:4096
  ds_write_b128 v27, v[172:175] offset:8192
L_agp_w1s_d:
  s_branch L_staged_w1s
L_have_w1s:
  ds_write_b128 v27, v[104:107] offset:0
  ds_write_b128 v27, v[108:111] offset:4096
  ds_write_b128 v27, v[112:115] offset:8192
L_staged_w1s:
  s_waitcnt lgkmcnt(0)
  s_barrier
  ds_read_b128 v[40:43], v28 offset:0
  ds_read_b128 v[44:47], v28 offset:1024
  ds_read_b128 v[48:51], v28 offset:2048
  ds_read_b128 v[52:55], v28 offset:3072
  ds_read_b128 v[56:59], v28 offset:4096
  ds_read_b128 v[60:63], v28 offset:5120
  ds_read_b128 v[64:67], v28 offset:6144
  ds_read_b128 v[68:71], v28 offset:7168
  ds_read_b128 v[72:75], v28 offset:8192
  ds_read_b128 v[76:79], v28 offset:9216
  s_waitcnt lgkmcnt(9)
  v_smfmac_f32_16x16x64_bf16 v[128:131], v[40:43], a[0:7], v20
  v_smfmac_f32_16x16x64_bf16 v[132:135], v[40:43], a[80:87], v20
  s_waitcnt lgkmcnt(8)
  v_smfmac_f32_16x16x64_bf16 v[128:131], v[44:47], a[8:15], v20
  v_smfmac_f32_16x16x64_bf16 v[132:135], v[44:47], a[88:95], v20
  s_waitcnt lgkmcnt(7)
  v_smfmac_f32_16x16x64_bf16 v[128:131], v[48:51], a[16:23], v20
  v_smfmac_f32_16x16x64_bf16 v[132:135], v[48:51], a[96:103], v20
  s_cmp_eq_u32 s37, 0
  s_cbranch_scc1 L_xp_w1s
  s_mov_b32 exec_hi, 0
  buffer_store_dwordx4 v[22:25], v32, s[8:11], s50 offen sc1
  s_mov_b32 exec_hi, -1
L_xp_w1s:
  s_cmp_ge_u32 s30, 62
  s_cbranch_scc1 L_nopf_w1s
  s_add_u32 s7, s30, 1
  s_add_u32 s6, s7, 1
  s_cmp_ge_u32 s56, s6
  s_cbranch_scc1 L_fa_ok_w1spf
  v_readlane_b32 s56, v37, 0
  v_readlane_b32 s4, v37, 1
  v_readlane_b32 s5, v37, 2
  s_min_u32 s56, s56, s4
  s_min_u32 s56, s56, s5
  s_cmp_ge_u32 s56, s6
  s_cbranch_scc1 L_fa_ok_w1spf
  s_mov_b32 s28, 131072
  s_mov_b32 s29, 10
L_fa_w1spf:
  buffer_load_dword v37, v35, s[8:11], 0 offen sc1
  s_waitcnt vmcnt(0)
  v_readlane_b32 s56, v37, 0
  v_readlane_b32 s4, v37, 1
  v_readlane_b32 s5, v37, 2
  s_sub_u32 s28, s28, 1
  s_cbranch_scc1 L_abort
  s_min_u32 s56, s56, s4
  s_min_u32 s56, s56, s5
  s_cmp_ge_u32 s56, s6
  s_cbranch_scc0 L_fa_w1spf
L_fa_ok_w1spf:
  s_add_u32 s4, s6, 3
  s_cmp_ge_u32 s56, s4
  s_cbranch_scc1 L_fa_far_w1spf
  buffer_load_dword v37, v35, s[8:11], 0 offen sc1
L_fa_far_w1spf:
  s_mul_i32 s4, s7, 393216
  s_add_u32 s4, s4, 33443840
  buffer_load_dwordx4 v[156:159], v124, s[8:11], s4 offen sc1
  buffer_load_dwordx2 v[160:161], v125, s[8:11], s4 offen sc1
L_nopf_w1s:
  s_mov_b64 exec, 1
  v_mov_b32 v118, s30
  v_mov_b32 v119, 0
  buffer_store_dword v118, v119, s[8:11], s53 offen sc1
  s_mov_b64 exec, -1
  s_waitcnt lgkmcnt(6)
  v_smfmac_f32_16x16x64_bf16 v[128:131], v[52:55], a[24:31], v20
  v_smfmac_f32_16x16x64_bf16 v[132:135], v[52:55], a[104:111], v20
  s_waitcnt lgkmcnt(5)
  v_smfmac_f32_16x16x64_bf16 v[128:131], v[56:59], a[32:39], v20
  v_smfmac_f32_16x16x64_bf16 v[132:135], v[56:59], a[112:119], v20
  s_waitcnt lgkmcnt(4)
  v_smfmac_f32_16x16x64_bf16 v[128:131], v[60:63], a[40:47], v20
  v_smfmac_f32_16x16x64_bf16 v[132:135], v[60:63], a[120:127], v20
  s_waitcnt lgkmcnt(3)
  v_smfmac_f32_16x16x64_bf16 v[128:131], v[64:67], a[48:55], v20
  v_smfmac_f32_16x16x64_bf16 v[132:135], v[64:67], a[128:135], v20
  s_waitcnt lgkmcnt(2)
  v_smfmac_f32_16x16x64_bf16 v[128:131], v[68:71], a[56:63], v20
  v_smfmac_f32_16x16x64_bf16 v[132:135], v[68:71], a[136:143], v20
  s_waitcnt lgkmcnt(1)
  v_smfmac_f32_16x16x64_bf16 v[128:131], v[72:75], a[64:71], v20
  v_smfmac_f32_16x16x64_bf16 v[132:135], v[72:75], a[144:151], v20
  s_waitcnt lgkmcnt(0)
  v_smfmac_f32_16x16x64_bf16 v[128:131], v[76:79], a[72:79], v20
  v_smfmac_f32_16x16x64_bf16 v[132:135], v[76:79], a[152:159], v20
  s_nop 7
  v_permlane32_swap_b32 v128, v132
  v_permlane32_swap_b32 v129, v133
  v_permlane32_swap_b32 v130, v134
  v_permlane32_swap_b32 v131, v135
  v_add_f32 v128, v128, v132
  v_add_f32 v129, v129, v133
  v_add_f32 v130, v130, v134
  v_add_f32 v131, v131, v135
  v_cvt_pk_bf16_f32 v104, v128, v129
  v_cvt_pk_bf16_f32 v105, v130, v131
  ds_write_b64 v120, v[104:105]
  s_waitcnt lgkmcnt(0)
  s_barrier
  ds_read_b64_tr_b16 v[136:137], v121
  ds_read_b64_tr_b16 v[138:139], v121 offset:384
  ds_read_b64_tr_b16 v[140:141], v122
  s_cmp_eq_u32 s30, 63
  s_cbranch_scc1 L_last_w1s
  s_waitcnt lgkmcnt(0)
  v_mfma_f32_16x16x32_bf16 v[152:155], v[144:147], v[136:139], 0
  v_mfma_f32_16x16x32_bf16 v[152:155], v[148:151], v[140:143], v[152:155]
  s_mov_b32 exec_lo, 16711935
  s_mov_b32 exec_hi, 16711935
  s_nop 5
  buffer_store_dwordx4 v[152:155], v123, s[8:11], s43 offen sc1
  s_mov_b32 exec_lo, 4294967295
  s_mov_b32 exec_hi, 4294967295
  v_mov_b32 v92, 0
  v_mov_b32 v93, 0
  v_mov_b32 v94, 0
  v_mov_b32 v95, 0
  v_mov_b32 v96, 0
  v_mov_b32 v97, 0
  v_mov_b32 v98, 0
  v_mov_b32 v99, 0
  v_mov_b32 v100, 0
  v_mov_b32 v101, 0
  v_mov_b32 v102, 0
  v_mov_b32 v103, 0
  s_barrier
  s_mov_b32 s28, 131072
  s_mov_b32 s29, 41
  buffer_load_dwordx4 v[80:83], v29, s[8:11], s45 offen offset:0 sc1
  buffer_load_dwordx4 v[84:87], v29, s[8:11], s45 offen offset:1024 sc1
  buffer_load_dwordx4 v[88:91], v29, s[8:11], s45 offen offset:2048 sc1
  s_sleep 2
  buffer_load_dwordx4 v[192:195], v29, s[8:11], s45 offen offset:0 sc1
  buffer_load_dwordx4 v[196:199], v29, s[8:11], s45 offen offset:1024 sc1
  buffer_load_dwordx4 v[200:203], v29, s[8:11], s45 offen offset:2048 sc1
L_op_w1s_a:
  s_waitcnt vmcnt(3)
  v_max3_u32 v188, v80, v84, v88
  v_cmp_eq_u32 vcc, -1, v188
  s_cbranch_vccz L_op_w1s_oka
  s_sub_u32 s28, s28, 1
  s_cbranch_scc1 L_abort
  buffer_load_dwordx4 v[80:83], v29, s[8:11], s45 offen offset:0 sc1
  buffer_load_dwordx4 v[84:87], v29, s[8:11], s45 offen offset:1024 sc1
  buffer_load_dwordx4 v[88:91], v29, s[8:11], s45 offen offset:2048 sc1
  s_waitcnt vmcnt(3)
  v_max3_u32 v188, v192, v196, v200
  v_cmp_eq_u32 vcc, -1, v188
  s_cbranch_vccz L_op_w1s_okb
  s_sub_u32 s28, s28, 1
  s_cbranch_scc1 L_abort
  buffer_load_dwordx4 v[192:195], v29, s[8:11], s45 offen offset:0 sc1
  buffer_load_dwordx4 v[196:199], v29, s[8:11], s45 offen offset:1024 sc1
  buffer_load_dwordx4 v[200:203], v29, s[8:11], s45 offen offset:2048 sc1
  s_branch L_op_w1s_a
L_op_w1s_okb:
  v_smfmac_f32_16x16x64_bf16 v[92:95], v[192:195], a[160:167], v20
  v_smfmac_f32_16x16x64_bf16 v[96:99], v[192:195], a[168:175], v20
  v_smfmac_f32_16x16x64_bf16 v[100:103], v[192:195], a[176:183], v20
  v_smfmac_f32_16x16x64_bf16 v[92:95], v[196:199], a[184:191], v20
  v_smfmac_f32_16x16x64_bf16 v[96:99], v[196:199], a[192:199], v20
  v_smfmac_f32_16x16x64_bf16 v[100:103], v[196:199], a[200:207], v20
  v_smfmac_f32_16x16x64_bf16 v[92:95], v[200:203], a[208:215], v20
  v_smfmac_f32_16x16x64_bf16 v[96:99], v[200:203], a[216:223], v20
  v_smfmac_f32_16x16x64_bf16 v[100:103], v[200:203], a[224:231], v20
  s_branch L_op_w1s_d
L_op_w1s_oka:
  v_smfmac_f32_16x16x64_bf16 v[92:95], v[80:83], a[160:167], v20
  v_smfmac_f32_16x16x64_bf16 v[96:99], v[80:83], a[168:175], v20
  v_smfmac_f32_16x16x64_bf16 v[100:103], v[80:83], a[176:183], v20
  v_smfmac_f32_16x16x64_bf16 v[92:95], v[84:87], a[184:191], v20
  v_smfmac_f32_16x16x64_bf16 v[96:99], v[84:87], a[192:199], v20
  v_smfmac_f32_16x16x64_bf16 v[100:103], v[84:87], a[200:207], v20
  v_smfmac_f32_16x16x64_bf16 v[92:95], v[88:91], a[208:215], v20
  v_smfmac_f32_16x16x64_bf16 v[96:99], v[88:91], a[216:223], v20
  v_smfmac_f32_16x16x64_bf16 v[100:103], v[88:91], a[224:231], v20
L_op_w1s_d:
  v_mov_b32 v144, v156
  v_mov_b32 v145, v157
  v_mov_b32 v146, v158
  v_mov_b32 v147, v159
  v_mov_b32 v148, v160
  v_mov_b32 v149, v161
  v_permlane32_swap_b32 v92, v93
  v_permlane32_swap_b32 v94, v95
  v_permlane32_swap_b32 v96, v97
  v_permlane32_swap_b32 v98, v99
  v_permlane32_swap_b32 v100, v101
  v_permlane32_swap_b32 v102, v103
  v_add_f32 v92, v92, v93
  v_add_f32 v94, v94, v95
  v_add_f32 v96, v96, v97
  v_add_f32 v98, v98, v99
  v_add_f32 v100, v100, v101
  v_add_f32 v102, v102, v103
  ds_write_b32 v30, v92 offset:0
  ds_write_b32 v30, v94 offset:128
  ds_write_b32 v30, v96 offset:512
  ds_write_b32 v30, v98 offset:640
  ds_write_b32 v30, v100 offset:1024
  ds_write_b32 v30, v102 offset:1152
  s_waitcnt lgkmcnt(0)
  s_barrier
  s_cmp_eq_u32 s37, 0
  s_cbranch_scc1 L_nox_w1s
  ds_read_b128 v[104:107], v31 offset:0
  ds_read_b128 v[108:111], v31 offset:1536
  ds_read_b128 v[112:115], v31 offset:3072
  ds_read_b128 v[116:119], v31 offset:4608
  s_waitcnt lgkmcnt(2)
  v_add_f32 v104, v104, v108
  v_add_f32 v105, v105, v109
  v_add_f32 v106, v106, v110
  v_add_f32 v107, v107, v111
  s_waitcnt lgkmcnt(0)
  v_add_f32 v112, v112, v116
  v_add_f32 v113, v113, v117
  v_add_f32 v114, v114, v118
  v_add_f32 v115, v115, v119
  v_add_f32 v104, v104, v112
  v_add_f32 v105, v105, v113
  v_add_f32 v106, v106, v114
  v_add_f32 v107, v107, v115
  s_mov_b32 exec_hi, 0
  buffer_store_dwordx4 v[104:107], v32, s[8:11], s46 offen sc1
  s_mov_b32 exec_hi, -1
L_nox_w1s:
  s_mov_b32 exec_lo, 16711935
  s_mov_b32 exec_hi, 16711935
  buffer_store_dwordx4 v[22:25], v123, s[8:11], s48 offen sc1
  s_mov_b32 exec_lo, 4294967295
  s_mov_b32 exec_hi, 4294967295
  s_add_u32 s30, s30, 1
  s_and_b32 s58, s30, 3
  s_mul_i32 s40, s58, 40960
  s_mul_i32 s59, s25, 10240
  s_add_u32 s59, s59, 5492736
  s_add_u32 s40, s40, s59
  s_add_u32 s41, s40, 4096
  s_add_u32 s42, s40, 8192
  s_mul_i32 s45, s58, 98304
  s_add_u32 s45, s45, 905216
  s_mul_i32 s46, s58, 327680
  s_add_u32 s46, s46, s61
  s_mul_i32 s43, s58, 196608
  s_mul_i32 s3, s32, 6144
  s_add_u32 s3, s3, 118784
  s_add_u32 s43, s43, s3
  s_add_u32 s44, s43, 3072
  s_add_u32 s58, s30, 1
  s_and_b32 s58, s58, 3
  s_mul_i32 s47, s58, 40960
  s_add_u32 s47, s47, s59
  s_add_u32 s58, s30, 3
  s_and_b32 s58, s58, 3
  s_mul_i32 s51, s58, 40960
  s_add_u32 s51, s51, s59
  s_mul_i32 s48, s58, 196608
  s_add_u32 s48, s48, s3
  s_mul_i32 s49, s58, 98304
  s_add_u32 s49, s49, 905216
  s_add_u32 s58, s30, 2
  s_and_b32 s58, s58, 3
  s_mul_i32 s50, s58, 327680
  s_add_u32 s50, s50, s61
  s_mul_i32 s54, s30, 196608
  s_add_u32 s55, s54, 96358400
  s_add_u32 s54, s54, 83775488
  v_mov_b32 v128, 0
  v_mov_b32 v129, 0
  v_mov_b32 v130, 0
  v_mov_b32 v131, 0
  v_mov_b32 v132, 0
  v_mov_b32 v133, 0
  v_mov_b32 v134, 0
  v_mov_b32 v135, 0
  s_barrier
  s_branch L_step_w1s
L_last_w1s:
  s_branch L_exit
L_cw2s:
  v_mov_b32 v142, 0
  v_mov_b32 v143, 0
  v_mov_b32 v150, 0
  v_mov_b32 v151, 0
  s_mov_b32 s30, 0
  s_mov_b32 s56, 0
  v_mov_b32 v37, 0
  s_and_b32 s58, s30, 3
  s_mul_i32 s40, s58, 40960
  s_mul_i32 s59, s25, 10240
  s_add_u32 s59, s59, 5492736
  s_add_u32 s40, s40, s59
  s_add_u32 s41, s40, 4096
  s_add_u32 s42, s40, 8192
  s_mul_i32 s45, s58, 98304
  s_add_u32 s45, s45, 905216
  s_mul_i32 s46, s58, 327680
  s_add_u32 s46, s46, s61
  s_mul_i32 s43, s58, 196608
  s_mul_i32 s3, s32, 6144
  s_add_u32 s3, s3, 118784
  s_add_u32 s43, s43, s3
  s_add_u32 s44, s43, 3072
  s_add_u32 s58, s30, 1
  s_and_b32 s58, s58, 3
  s_mul_i32 s47, s58, 40960
  s_add_u32 s47, s47, s59
  s_add_u32 s58, s30, 3
  s_and_b32 s58, s58, 3
  s_mul_i32 s51, s58, 40960
  s_add_u32 s51, s51, s59
  s_mul_i32 s48, s58, 196608
  s_add_u32 s48, s48, s3
  s_mul_i32 s49, s58, 98304
  s_add_u32 s49, s49, 905216
  s_add_u32 s58, s30, 2
  s_and_b32 s58, s58, 3
  s_mul_i32 s50, s58, 327680
  s_add_u32 s50, s50, s61
  s_mul_i32 s54, s30, 196608
  s_add_u32 s55, s54, 96358400
  s_add_u32 s54, s54, 83775488
  s_add_u32 s6, s30, 1
  s_cmp_ge_u32 s56, s6
  s_cbranch_scc1 L_fa_ok_w2sp0
  v_readlane_b32 s56, v37, 0
  v_readlane_b32 s4, v37, 1
  v_readlane_b32 s5, v37, 2
  s_min_u32 s56, s56, s4
  s_min_u32 s56, s56, s5
  s_cmp_ge_u32 s56, s6
  s_cbranch_scc1 L_fa_ok_w2sp0
  s_mov_b32 s28, 131072
  s_mov_b32 s29, 10
L_fa_w2sp0:
  buffer_load_dword v37, v35, s[8:11], 0 offen sc1
  s_waitcnt vmcnt(0)
  v_readlane_b32 s56, v37, 0
  v_readlane_b32 s4, v37, 1
  v_readlane_b32 s5, v37, 2
  s_sub_u32 s28, s28, 1
  s_cbranch_scc1 L_abort
  s_min_u32 s56, s56, s4
  s_min_u32 s56, s56, s5
  s_cmp_ge_u32 s56, s6
  s_cbranch_scc0 L_fa_w2sp0
L_fa_ok_w2sp0:
  s_add_u32 s4, s6, 3
  s_cmp_ge_u32 s56, s4
  s_cbranch_scc1 L_fa_far_w2sp0
  buffer_load_dword v37, v35, s[8:11], 0 offen sc1
L_fa_far_w2sp0:
  s_mul_i32 s4, s30, 393216
  s_add_u32 s4, s4, 33443840
  buffer_load_dwordx4 v[144:147], v124, s[8:11], s4 offen sc1
  buffer_load_dwordx2 v[148:149], v125, s[8:11], s4 offen sc1
  s_load_dwordx2 s[16:17], s[0:1], 8
  s_waitcnt lgkmcnt(0)
  s_and_b32 s17, s17, 0xffff
  s_mov_b32 s18, 10240
  s_mov_b32 s19, 0x20000
  buffer_load_dwordx4 v[104:107], v36, s[16:19], 0 offen offset:0
  buffer_load_dwordx4 v[108:111], v36, s[16:19], 0 offen offset:512
  s_waitcnt vmcnt(0)
  v_mov_b32 v128, 0
  v_mov_b32 v129, 0
  v_mov_b32 v130, 0
  v_mov_b32 v131, 0
  v_mov_b32 v132, 0
  v_mov_b32 v133, 0
  v_mov_b32 v134, 0
  v_mov_b32 v135, 0
  s_branch L_have_w2s
L_step_w2s:
  s_mov_b32 s28, 131072
  s_mov_b32 s29, 22
  buffer_load_dwordx4 v[164:167], v26, s[8:11], s40 offen sc1
  buffer_load_dwordx4 v[168:171], v26, s[8:11], s41 offen sc1
  s_sleep 1
  buffer_load_dwordx4 v[176:179], v26, s[8:11], s40 offen sc1
  buffer_load_dwordx4 v[180:183], v26, s[8:11], s41 offen sc1
L_agp_w2s_a:
  s_waitcnt vmcnt(2)
  v_max_u32 v188, v164, v168
  v_cmp_eq_u32 vcc, -1, v188
  s_cbranch_vccz L_agp_w2s_oka
  s_sub_u32 s28, s28, 1
  s_cbranch_scc1 L_abort
  buffer_load_dwordx4 v[164:167], v26, s[8:11], s40 offen sc1
  buffer_load_dwordx4 v[168:171], v26, s[8:11], s41 offen sc1
  s_waitcnt vmcnt(2)
  v_max_u32 v188, v176, v180
  v_cmp_eq_u32 vcc, -1, v188
  s_cbranch_vccz L_agp_w2s_okb
  s_sub_u32 s28, s28, 1
  s_cbranch_scc1 L_abort
  buffer_load_dwordx4 v[176:179], v26, s[8:11], s40 offen sc1
  buffer_load_dwordx4 v[180:183], v26, s[8:11], s41 offen sc1
  s_branch L_agp_w2s_a
L_agp_w2s_okb:
  ds_write_b128 v27, v[176:179] offset:0
  ds_write_b128 v27, v[180:183] offset:4096
  s_branch L_agp_w2s_d
L_agp_w2s_oka:
  ds_write_b128 v27, v[164:167] offset:0
  ds_write_b128 v27, v[168:171] offset:4096
L_agp_w2s_d:
  s_branch L_staged_w2s
L_have_w2s:
  ds_write_b128 v27, v[104:107] offset:0
  ds_write_b128 v27, v[108:111] offset:4096
L_staged_w2s:
  s_waitcnt lgkmcnt(0)
  s_barrier
  ds_read_b128 v[40:43], v28 offset:0
  ds_read_b128 v[44:47], v28 offset:1024
  ds_read_b128 v[48:51], v28 offset:2048
  ds_read_b128 v[52:55], v28 offset:3072
  ds_read_b128 v[56:59], v28 offset:4096
  ds_read_b128 v[60:63], v28 offset:5120
  ds_read_b128 v[64:67], v28 offset:6144
  ds_read_b128 v[68:71], v28 offset:7168
  ds_read_b128 v[72:75], v28 offset:8192
  ds_read_b128 v[76:79], v28 offset:9216
  s_waitcnt lgkmcnt(9)
  v_smfmac_f32_16x16x64_bf16 v[128:131], v[40:43], a[0:7], v20
  v_smfmac_f32_16x16x64_bf16 v[132:135], v[40:43], a[80:87], v20
  s_waitcnt lgkmcnt(8)
  v_smfmac_f32_16x16x64_bf16 v[128:131], v[44:47], a[8:15], v20
  v_smfmac_f32_16x16x64_bf16 v[132:135], v[44:47], a[88:95], v20
  s_waitcnt lgkmcnt(7)
  v_smfmac_f32_16x16x64_bf16 v[128:131], v[48:51], a[16:23], v20
  v_smfmac_f32_16x16x64_bf16 v[132:135], v[48:51], a[96:103], v20
  s_cmp_ge_u32 s30, 62
  s_cbranch_scc1 L_nopf_w2s
  s_add_u32 s7, s30, 1
  s_add_u32 s6, s7, 1
  s_cmp_ge_u32 s56, s6
  s_cbranch_scc1 L_fa_ok_w2spf
  v_readlane_b32 s56, v37, 0
  v_readlane_b32 s4, v37, 1
  v_readlane_b32 s5, v37, 2
  s_min_u32 s56, s56, s4
  s_min_u32 s56, s56, s5
  s_cmp_ge_u32 s56, s6
  s_cbranch_scc1 L_fa_ok_w2spf
  s_mov_b32 s28, 131072
  s_mov_b32 s29, 10
L_fa_w2spf:
  buffer_load_dword v37, v35, s[8:11], 0 offen sc1
  s_waitcnt vmcnt(0)
  v_readlane_b32 s56, v37, 0
  v_readlane_b32 s4, v37, 1
  v_readlane_b32 s5, v37, 2
  s_sub_u32 s28, s28, 1
  s_cbranch_scc1 L_abort
  s_min_u32 s56, s56, s4
  s_min_u32 s56, s56, s5
  s_cmp_ge_u32 s56, s6
  s_cbranch_scc0 L_fa_w2spf
L_fa_ok_w2spf:
  s_add_u32 s4, s6, 3
  s_cmp_ge_u32 s56, s4
  s_cbranch_scc1 L_fa_far_w2spf
  buffer_load_dword v37, v35, s[8:11], 0 offen sc1
L_fa_far_w2spf:
  s_mul_i32 s4, s7, 393216
  s_add_u32 s4, s4, 33443840
  buffer_load_dwordx4 v[156:159], v124, s[8:11], s4 offen sc1
  buffer_load_dwordx2 v[160:161], v125, s[8:11], s4 offen sc1
L_nopf_w2s:
  s_waitcnt lgkmcnt(6)
  v_smfmac_f32_16x16x64_bf16 v[128:131], v[52:55], a[24:31], v20
  v_smfmac_f32_16x16x64_bf16 v[132:135], v[52:55], a[104:111], v20
  s_waitcnt lgkmcnt(5)
  v_smfmac_f32_16x16x64_bf16 v[128:131], v[56:59], a[32:39], v20
  v_smfmac_f32_16x16x64_bf16 v[132:135], v[56:59], a[112:119], v20
  s_waitcnt lgkmcnt(4)
  v_smfmac_f32_16x16x64_bf16 v[128:131], v[60:63], a[40:47], v20
  v_smfmac_f32_16x16x64_bf16 v[132:135], v[60:63], a[120:127], v20
  s_waitcnt lgkmcnt(3)
  v_smfmac_f32_16x16x64_bf16 v[128:131], v[64:67], a[48:55], v20
  v_smfmac_f32_16x16x64_bf16 v[132:135], v[64:67], a[128:135], v20
  s_waitcnt lgkmcnt(2)
  v_smfmac_f32_16x16x64_bf16 v[128:131], v[68:71], a[56:63], v20
  v_smfmac_f32_16x16x64_bf16 v[132:135], v[68:71], a[136:143], v20
  s_waitcnt lgkmcnt(1)
  v_smfmac_f32_16x16x64_bf16 v[128:131], v[72:75], a[64:71], v20
  v_smfmac_f32_16x16x64_bf16 v[132:135], v[72:75], a[144:151], v20
  s_waitcnt lgkmcnt(0)
  v_smfmac_f32_16x16x64_bf16 v[128:131], v[76:79], a[72:79], v20
  v_smfmac_f32_16x16x64_bf16 v[132:135], v[76:79], a[152:159], v20
  s_nop 7
  v_permlane32_swap_b32 v128, v132
  v_permlane32_swap_b32 v129, v133
  v_permlane32_swap_b32 v130, v134
  v_permlane32_swap_b32 v131, v135
  v_add_f32 v128, v128, v132
  v_add_f32 v129, v129, v133
  v_add_f32 v130, v130, v134
  v_add_f32 v131, v131, v135
  v_cvt_pk_bf16_f32 v104, v128, v129
  v_cvt_pk_bf16_f32 v105, v130, v131
  ds_write_b64 v120, v[104:105]
  s_waitcnt lgkmcnt(0)
  s_barrier
  ds_read_b64_tr_b16 v[136:137], v121
  ds_read_b64_tr_b16 v[138:139], v121 offset:384
  ds_read_b64_tr_b16 v[140:141], v122
  s_cmp_eq_u32 s30, 63
  s_cbranch_scc1 L_last_w2s
  s_waitcnt lgkmcnt(0)
  v_mfma_f32_16x16x32_bf16 v[152:155], v[144:147], v[136:139], 0
  v_mfma_f32_16x16x32_bf16 v[152:155], v[148:151], v[140:143], v[152:155]
  s_mov_b32 exec_lo, 16711935
  s_mov_b32 exec_hi, 16711935
  s_nop 5
  buffer_store_dwordx4 v[152:155], v123, s[8:11], s43 offen sc1
  s_mov_b32 exec_lo, 4294967295
  s_mov_b32 exec_hi, 4294967295
  v_mov_b32 v92, 0
  v_mov_b32 v93, 0
  v_mov_b32 v94, 0
  v_mov_b32 v95, 0
  v_mov_b32 v96, 0
  v_mov_b32 v97, 0
  v_mov_b32 v98, 0
  v_mov_b32 v99, 0
  v_mov_b32 v100, 0
  v_mov_b32 v101, 0
  v_mov_b32 v102, 0
  v_mov_b32 v103, 0
  s_barrier
  s_mov_b32 s28, 131072
  s_mov_b32 s29, 42
  buffer_load_dwordx4 v[80:83], v29, s[8:11], s45 offen offset:0 sc1
  buffer_load_dwordx4 v[84:87], v29, s[8:11], s45 offen offset:1024 sc1
  buffer_load_dwordx4 v[88:91], v29, s[8:11], s45 offen offset:2048 sc1
  s_sleep 2
  buffer_load_dwordx4 v[192:195], v29, s[8:11], s45 offen offset:0 sc1
  buffer_load_dwordx4 v[196:199], v29, s[8:11], s45 offen offset:1024 sc1
  buffer_load_dwordx4 v[200:203], v29, s[8:11], s45 offen offset:2048 sc1
L_op_w2s_a:
  s_waitcnt vmcnt(3)
  v_max3_u32 v188, v80, v84, v88
  v_cmp_eq_u32 vcc, -1, v188
  s_cbranch_vccz L_op_w2s_oka
  s_sub_u32 s28, s28, 1
  s_cbranch_scc1 L_abort
  buffer_load_dwordx4 v[80:83], v29, s[8:11], s45 offen offset:0 sc1
  buffer_load_dwordx4 v[84:87], v29, s[8:11], s45 offen offset:1024 sc1
  buffer_load_dwordx4 v[88:91], v29, s[8:11], s45 offen offset:2048 sc1
  s_waitcnt vmcnt(3)
  v_max3_u32 v188, v192, v196, v200
  v_cmp_eq_u32 vcc, -1, v188
  s_cbranch_vccz L_op_w2s_okb
  s_sub_u32 s28, s28, 1
  s_cbranch_scc1 L_abort
  buffer_load_dwordx4 v[192:195], v29, s[8:11], s45 offen offset:0 sc1
  buffer_load_dwordx4 v[196:199], v29, s[8:11], s45 offen offset:1024 sc1
  buffer_load_dwordx4 v[200:203], v29, s[8:11], s45 offen offset:2048 sc1
  s_branch L_op_w2s_a
L_op_w2s_okb:
  v_smfmac_f32_16x16x64_bf16 v[92:95], v[192:195], a[160:167], v20
  v_smfmac_f32_16x16x64_bf16 v[96:99], v[192:195], a[168:175], v20
  v_smfmac_f32_16x16x64_bf16 v[100:103], v[192:195], a[176:183], v20
  v_smfmac_f32_16x16x64_bf16 v[92:95], v[196:199], a[184:191], v20
  v_smfmac_f32_16x16x64_bf16 v[96:99], v[196:199], a[192:199], v20
  v_smfmac_f32_16x16x64_bf16 v[100:103], v[196:199], a[200:207], v20
  v_smfmac_f32_16x16x64_bf16 v[92:95], v[200:203], a[208:215], v20
  v_smfmac_f32_16x16x64_bf16 v[96:99], v[200:203], a[216:223], v20
  v_smfmac_f32_16x16x64_bf16 v[100:103], v[200:203], a[224:231], v20
  s_branch L_op_w2s_d
L_op_w2s_oka:
  v_smfmac_f32_16x16x64_bf16 v[92:95], v[80:83], a[160:167], v20
  v_smfmac_f32_16x16x64_bf16 v[96:99], v[80:83], a[168:175], v20
  v_smfmac_f32_16x16x64_bf16 v[100:103], v[80:83], a[176:183], v20
  v_smfmac_f32_16x16x64_bf16 v[92:95], v[84:87], a[184:191], v20
  v_smfmac_f32_16x16x64_bf16 v[96:99], v[84:87], a[192:199], v20
  v_smfmac_f32_16x16x64_bf16 v[100:103], v[84:87], a[200:207], v20
  v_smfmac_f32_16x16x64_bf16 v[92:95], v[88:91], a[208:215], v20
  v_smfmac_f32_16x16x64_bf16 v[96:99], v[88:91], a[216:223], v20
  v_smfmac_f32_16x16x64_bf16 v[100:103], v[88:91], a[224:231], v20
L_op_w2s_d:
  v_mov_b32 v144, v156
  v_mov_b32 v145, v157
  v_mov_b32 v146, v158
  v_mov_b32 v147, v159
  v_mov_b32 v148, v160
  v_mov_b32 v149, v161
  v_permlane32_swap_b32 v92, v93
  v_permlane32_swap_b32 v94, v95
  v_permlane32_swap_b32 v96, v97
  v_permlane32_swap_b32 v98, v99
  v_permlane32_swap_b32 v100, v101
  v_permlane32_swap_b32 v102, v103
  v_add_f32 v92, v92, v93
  v_add_f32 v94, v94, v95
  v_add_f32 v96, v96, v97
  v_add_f32 v98, v98, v99
  v_add_f32 v100, v100, v101
  v_add_f32 v102, v102, v103
  ds_write_b32 v30, v92 offset:0
  ds_write_b32 v30, v94 offset:128
  ds_write_b32 v30, v96 offset:512
  ds_write_b32 v30, v98 offset:640
  ds_write_b32 v30, v100 offset:1024
  ds_write_b32 v30, v102 offset:1152
  s_mov_b32 exec_lo, 16711935
  s_mov_b32 exec_hi, 16711935
  buffer_store_dwordx4 v[22:25], v123, s[8:11], s48 offen sc1
  s_mov_b32 exec_lo, 4294967295
  s_mov_b32 exec_hi, 4294967295
  buffer_store_dword v22, v34, s[8:11], s51 offen sc1
  s_waitcnt lgkmcnt(0)
  s_barrier
  s_cmp_eq_u32 s39, 0
  s_cbranch_scc1 L_noown_w2s
  s_sleep 10
  s_mov_b32 s28, 131072
  s_mov_b32 s29, 52
  buffer_load_dwordx4 v[204:207], v33, s[8:11], s46 offen offset:0 sc1
  buffer_load_dwordx4 v[208:211], v33, s[8:11], s46 offen offset:1024 sc1
  buffer_load_dwordx4 v[212:215], v33, s[8:11], s46 offen offset:2048 sc1
  buffer_load_dwordx4 v[216:219], v33, s[8:11], s46 offen offset:3072 sc1
  s_sleep 4
  buffer_load_dwordx4 v[220:223], v33, s[8:11], s46 offen offset:0 sc1
  buffer_load_dwordx4 v[224:227], v33, s[8:11], s46 offen offset:1024 sc1
  buffer_load_dwordx4 v[228:231], v33, s[8:11], s46 offen offset:2048 sc1
  buffer_load_dwordx4 v[232:235], v33, s[8:11], s46 offen offset:3072 sc1
L_xq_w2s_a:
  s_waitcnt vmcnt(4)
  v_max3_u32 v188, v204, v208, v212
  v_max_u32 v188, v188, v216
  v_cmp_eq_u32 vcc, -1, v188
  s_cbranch_vccz L_xq_w2s_oka
  s_sub_u32 s28, s28, 1
  s_cbranch_scc1 L_abort
  buffer_load_dwordx4 v[204:207], v33, s[8:11], s46 offen offset:0 sc1
  buffer_load_dwordx4 v[208:211], v33, s[8:11], s46 offen offset:1024 sc1
  buffer_load_dwordx4 v[212:215], v33, s[8:11], s46 offen offset:2048 sc1
  buffer_load_dwordx4 v[216:219], v33, s[8:11], s46 offen offset:3072 sc1
  s_waitcnt vmcnt(4)
  v_max3_u32 v188, v220, v224, v228
  v_max_u32 v188, v188, v232
  v_cmp_eq_u32 vcc, -1, v188
  s_cbranch_vccz L_xq_w2s_okb
  s_sub_u32 s28, s28, 1
  s_cbranch_scc1 L_abort
  buffer_load_dwordx4 v[220:223], v33, s[8:11], s46 offen offset:0 sc1
  buffer_load_dwordx4 v[224:227], v33, s[8:11], s46 offen offset:1024 sc1
  buffer_load_dwordx4 v[228:231], v33, s[8:11], s46 offen offset:2048 sc1
  buffer_load_dwordx4 v[232:235], v33, s[8:11], s46 offen offset:3072 sc1
  s_branch L_xq_w2s_a
L_xq_w2s_okb:
  v_pk_add_f32 v[104:105], v[220:221], v[224:225]
  v_pk_add_f32 v[106:107], v[222:223], v[226:227]
  v_pk_add_f32 v[112:113], v[228:229], v[232:233]
  v_pk_add_f32 v[114:115], v[230:231], v[234:235]
  s_branch L_xq_w2s_d
L_xq_w2s_oka:
  v_pk_add_f32 v[104:105], v[204:205], v[208:209]
  v_pk_add_f32 v[106:107], v[206:207], v[210:211]
  v_pk_add_f32 v[112:113], v[212:213], v[216:217]
  v_pk_add_f32 v[114:115], v[214:215], v[218:219]
L_xq_w2s_d:
  v_pk_add_f32 v[104:105], v[104:105], v[112:113]
  v_pk_add_f32 v[106:107], v[106:107], v[114:115]
  s_nop 1
  v_permlane32_swap_b32 v104, v106
  v_permlane32_swap_b32 v105, v107
  v_add_f32 v104, v104, v106
  v_add_f32 v105, v105, v107
  v_cvt_pk_bf16_f32 v104, v104, v105
  buffer_store_dword v104, v34, s[8:11], s47 offen sc1
L_noown_w2s:
  s_add_u32 s30, s30, 1
  s_and_b32 s58, s30, 3
  s_mul_i32 s40, s58, 40960
  s_mul_i32 s59, s25, 10240
  s_add_u32 s59, s59, 5492736
  s_add_u32 s40, s40, s59
  s_add_u32 s41, s40, 4096
  s_add_u32 s42, s40, 8192
  s_mul_i32 s45, s58, 98304
  s_add_u32 s45, s45, 905216
  s_mul_i32 s46, s58, 327680
  s_add_u32 s46, s46, s61
  s_mul_i32 s43, s58, 196608
  s_mul_i32 s3, s32, 6144
  s_add_u32 s3, s3, 118784
  s_add_u32 s43, s43, s3
  s_add_u32 s44, s43, 3072
  s_add_u32 s58, s30, 1
  s_and_b32 s58, s58, 3
  s_mul_i32 s47, s58, 40960
  s_add_u32 s47, s47, s59
  s_add_u32 s58, s30, 3
  s_and_b32 s58, s58, 3
  s_mul_i32 s51, s58, 40960
  s_add_u32 s51, s51, s59
  s_mul_i32 s48, s58, 196608
  s_add_u32 s48, s48, s3
  s_mul_i32 s49, s58, 98304
  s_add_u32 s49, s49, 905216
  s_add_u32 s58, s30, 2
  s_and_b32 s58, s58, 3
  s_mul_i32 s50, s58, 327680
  s_add_u32 s50, s50, s61
  s_mul_i32 s54, s30, 196608
  s_add_u32 s55, s54, 96358400
  s_add_u32 s54, s54, 83775488
  v_mov_b32 v128, 0
  v_mov_b32 v129, 0
  v_mov_b32 v130, 0
  v_mov_b32 v131, 0
  v_mov_b32 v132, 0
  v_mov_b32 v133, 0
  v_mov_b32 v134, 0
  v_mov_b32 v135, 0
  s_barrier
  s_branch L_step_w2s
L_last_w2s:
  s_branch L_exit
L_cw3s:
  v_mov_b32 v142, 0
  v_mov_b32 v143, 0
  v_mov_b32 v146, 0
  v_mov_b32 v147, 0
  v_mov_b32 v150, 0
  v_mov_b32 v151, 0
  v_mov_b32 v194, 0
  v_mov_b32 v195, 0
  s_mov_b32 s30, 0
  s_mov_b32 s56, 0
  v_mov_b32 v37, 0
  s_and_b32 s58, s30, 3
  s_mul_i32 s40, s58, 40960
  s_mul_i32 s59, s25, 10240
  s_add_u32 s59, s59, 5492736
  s_add_u32 s40, s40, s59
  s_add_u32 s41, s40, 4096
  s_add_u32 s42, s40, 8192
  s_mul_i32 s45, s58, 98304
  s_add_u32 s45, s45, 905216
  s_mul_i32 s46, s58, 327680
  s_add_u32 s46, s46, s61
  s_mul_i32 s43, s58, 196608
  s_mul_i32 s3, s32, 6144
  s_add_u32 s3, s3, 118784
  s_add_u32 s43, s43, s3
  s_add_u32 s44, s43, 3072
  s_add_u32 s58, s30, 1
  s_and_b32 s58, s58, 3
  s_mul_i32 s47, s58, 40960
  s_add_u32 s47, s47, s59
  s_add_u32 s58, s30, 3
  s_and_b32 s58, s58, 3
  s_mul_i32 s51, s58, 40960
  s_add_u32 s51, s51, s59
  s_mul_i32 s48, s58, 196608
  s_add_u32 s48, s48, s3
  s_mul_i32 s49, s58, 98304
  s_add_u32 s49, s49, 905216
  s_add_u32 s58, s30, 2
  s_and_b32 s58, s58, 3
  s_mul_i32 s50, s58, 327680
  s_add_u32 s50, s50, s61
  s_mul_i32 s54, s30, 196608
  s_add_u32 s55, s54, 96358400
  s_add_u32 s54, s54, 83775488
  s_add_u32 s6, s30, 1
  s_cmp_ge_u32 s56, s6
  s_cbranch_scc1 L_fa_ok_w3sp0
  v_readlane_b32 s56, v37, 0
  v_readlane_b32 s4, v37, 1
  v_readlane_b32 s5, v37, 2
  s_min_u32 s56, s56, s4
  s_min_u32 s56, s56, s5
  s_cmp_ge_u32 s56, s6
  s_cbranch_scc1 L_fa_ok_w3sp0
  s_mov_b32 s28, 131072
  s_mov_b32 s29, 10
L_fa_w3sp0:
  buffer_load_dword v37, v35, s[8:11], 0 offen sc1
  s_waitcnt vmcnt(0)
  v_readlane_b32 s56, v37, 0
  v_readlane_b32 s4, v37, 1
  v_readlane_b32 s5, v37, 2
  s_sub_u32 s28, s28, 1
  s_cbranch_scc1 L_abort
  s_min_u32 s56, s56, s4
  s_min_u32 s56, s56, s5
  s_cmp_ge_u32 s56, s6
  s_cbranch_scc0 L_fa_w3sp0
L_fa_ok_w3sp0:
  s_add_u32 s4, s6, 3
  s_cmp_ge_u32 s56, s4
  s_cbranch_scc1 L_fa_far_w3sp0
  buffer_load_dword v37, v35, s[8:11], 0 offen sc1
L_fa_far_w3sp0:
  s_mul_i32 s4, s30, 393216
  s_add_u32 s4, s4, 58609664
  buffer_load_dwordx4 v[152:155], v124, s[8:11], s4 offen offset:0 sc1
  buffer_load_dwordx4 v[156:159], v124, s[8:11], s4 offen offset:1024 sc1
  buffer_load_dwordx4 v[160:163], v124, s[8:11], s4 offen offset:2048 sc1
  s_load_dwordx2 s[16:17], s[0:1], 8
  s_waitcnt lgkmcnt(0)
  s_and_b32 s17, s17, 0xffff
  s_mov_b32 s18, 10240
  s_mov_b32 s19, 0x20000
  buffer_load_dwordx4 v[104:107], v36, s[16:19], 0 offen offset:0
  buffer_load_dwordx4 v[108:111], v36, s[16:19], 0 offen offset:512
  s_waitcnt vmcnt(0)
  v_mov_b32 v128, 0
  v_mov_b32 v129, 0
  v_mov_b32 v130, 0
  v_mov_b32 v131, 0
  v_mov_b32 v132, 0
  v_mov_b32 v133, 0
  v_mov_b32 v134, 0
  v_mov_b32 v135, 0
  v_mov_b32 v136, 0
  v_mov_b32 v137, 0
  v_mov_b32 v138, 0
  v_mov_b32 v139, 0
  s_branch L_have_w3s
L_step_w3s:
  s_mov_b32 s28, 131072
  s_mov_b32 s29, 23
  buffer_load_dwordx4 v[2:5], v26, s[8:11], s40 offen sc1
  buffer_load_dwordx4 v[6:9], v26, s[8:11], s41 offen sc1
  s_sleep 1
  buffer_load_dwordx4 v[10:13], v26, s[8:11], s40 offen sc1
  buffer_load_dwordx4 v[14:17], v26, s[8:11], s41 offen sc1
L_agp_w3s_a:
  s_waitcnt vmcnt(2)
  v_max_u32 v18, v2, v6
  v_cmp_eq_u32 vcc, -1, v18
  s_cbranch_vccz L_agp_w3s_oka
  s_sub_u32 s28, s28, 1
  s_cbranch_scc1 L_abort
  buffer_load_dwordx4 v[2:5], v26, s[8:11], s40 offen sc1
  buffer_load_dwordx4 v[6:9], v26, s[8:11], s41 offen sc1
  s_waitcnt vmcnt(2)
  v_max_u32 v18, v10, v14
  v_cmp_eq_u32 vcc, -1, v18
  s_cbranch_vccz L_agp_w3s_okb
  s_sub_u32 s28, s28, 1
  s_cbranch_scc1 L_abort
  buffer_load_dwordx4 v[10:13], v26, s[8:11], s40 offen sc1
  buffer_load_dwordx4 v[14:17], v26, s[8:11], s41 offen sc1
  s_branch L_agp_w3s_a
L_agp_w3s_okb:
  ds_write_b128 v27, v[10:13] offset:0
  ds_write_b128 v27, v[14:17] offset:4096
  s_branch L_agp_w3s_d
L_agp_w3s_oka:
  ds_write_b128 v27, v[2:5] offset:0
  ds_write_b128 v27, v[6:9] offset:4096
L_agp_w3s_d:
  s_branch L_staged_w3s
L_have_w3s:
  ds_write_b128 v27, v[104:107] offset:0
  ds_write_b128 v27, v[108:111] offset:4096
L_staged_w3s:
  s_waitcnt lgkmcnt(0)
  s_barrier
  ds_read_b128 v[40:43], v28 offset:0
  ds_read_b128 v[44:47], v28 offset:1024
  ds_read_b128 v[48:51], v28 offset:2048
  ds_read_b128 v[52:55], v28 offset:3072
  ds_read_b128 v[56:59], v28 offset:4096
  ds_read_b128 v[60:63], v28 offset:5120
  ds_read_b128 v[64:67], v28 offset:6144
  ds_read_b128 v[68:71], v28 offset:7168
  ds_read_b128 v[72:75], v28 offset:8192
  ds_read_b128 v[76:79], v28 offset:9216
  s_waitcnt lgkmcnt(9)
  v_smfmac_f32_16x16x64_bf16 v[128:131], v[40:43], a[0:7], v127
  v_smfmac_f32_16x16x64_bf16 v[132:135], v[40:43], a[80:87], v127
  v_smfmac_f32_16x16x64_bf16 v[136:139], v[40:43], a[160:167], v127
  s_waitcnt lgkmcnt(8)
  v_smfmac_f32_16x16x64_bf16 v[128:131], v[44:47], a[8:15], v127
  v_smfmac_f32_16x16x64_bf16 v[132:135], v[44:47], a[88:95], v127
  v_smfmac_f32_16x16x64_bf16 v[136:139], v[44:47], a[168:175], v127
  s_mov_b32 exec_lo, 16711935
  s_mov_b32 exec_hi, 16711935
  buffer_store_dwordx4 v[22:25], v122, s[8:11], s49 offen sc1
  buffer_store_dwordx2 v[22:23], v123, s[8:11], s49 offen sc1
  s_mov_b32 exec_lo, 4294967295
  s_mov_b32 exec_hi, 4294967295
  s_cmp_eq_u32 s39, 0
  s_cbranch_scc1 L_agpz_w3s
  buffer_store_dword v22, v34, s[8:11], s51 offen sc1
L_agpz_w3s:
  s_waitcnt lgkmcnt(7)
  v_smfmac_f32_16x16x64_bf16 v[128:131], v[48:51], a[16:23], v127
  v_smfmac_f32_16x16x64_bf16 v[132:135], v[48:51], a[96:103], v127
  v_smfmac_f32_16x16x64_bf16 v[136:139], v[48:51], a[176:183], v127
  s_waitcnt lgkmcnt(6)
  v_smfmac_f32_16x16x64_bf16 v[128:131], v[52:55], a[24:31], v127
  v_smfmac_f32_16x16x64_bf16 v[132:135], v[52:55], a[104:111], v127
  v_smfmac_f32_16x16x64_bf16 v[136:139], v[52:55], a[184:191], v127
  s_waitcnt lgkmcnt(5)
  v_smfmac_f32_16x16x64_bf16 v[128:131], v[56:59], a[32:39], v127
  v_smfmac_f32_16x16x64_bf16 v[132:135], v[56:59], a[112:119], v127
  v_smfmac_f32_16x16x64_bf16 v[136:139], v[56:59], a[192:199], v127
  s_waitcnt lgkmcnt(4)
  v_smfmac_f32_16x16x64_bf16 v[128:131], v[60:63], a[40:47], v127
  v_smfmac_f32_16x16x64_bf16 v[132:135], v[60:63], a[120:127], v127
  v_smfmac_f32_16x16x64_bf16 v[136:139], v[60:63], a[200:207], v127
  s_waitcnt lgkmcnt(3)
  v_smfmac_f32_16x16x64_bf16 v[128:131], v[64:67], a[48:55], v127
  v_smfmac_f32_16x16x64_bf16 v[132:135], v[64:67], a[128:135], v127
  v_smfmac_f32_16x16x64_bf16 v[136:139], v[64:67], a[208:215], v127
  s_barrier
  s_waitcnt lgkmcnt(2)
  v_smfmac_f32_16x16x64_bf16 v[128:131], v[68:71], a[56:63], v127
  v_smfmac_f32_16x16x64_bf16 v[132:135], v[68:71], a[136:143], v127
  v_smfmac_f32_16x16x64_bf16 v[136:139], v[68:71], a[216:223], v127
  s_waitcnt lgkmcnt(1)
  v_smfmac_f32_16x16x64_bf16 v[128:131], v[72:75], a[64:71], v127
  v_smfmac_f32_16x16x64_bf16 v[132:135], v[72:75], a[144:151], v127
  v_smfmac_f32_16x16x64_bf16 v[136:139], v[72:75], a[224:231], v127
  s_waitcnt lgkmcnt(0)
  v_smfmac_f32_16x16x64_bf16 v[128:131], v[76:79], a[72:79], v127
  v_smfmac_f32_16x16x64_bf16 v[132:135], v[76:79], a[152:159], v127
  v_smfmac_f32_16x16x64_bf16 v[136:139], v[76:79], a[232:239], v127
  s_nop 5
  v_cvt_pk_bf16_f32 v140, v128, v129
  v_cvt_pk_bf16_f32 v141, v130, v131
  v_cvt_pk_bf16_f32 v144, v132, v133
  v_cvt_pk_bf16_f32 v145, v134, v135
  v_cvt_pk_bf16_f32 v148, v136, v137
  v_cvt_pk_bf16_f32 v149, v138, v139
  s_cmp_eq_u32 s30, 63
  s_cbranch_scc1 L_last_w3s
  s_mov_b32 s28, 131072
  s_mov_b32 s29, 30
  buffer_load_dwordx4 v[164:167], v120, s[8:11], s43 offen offset:0 sc1
  buffer_load_dwordx4 v[168:171], v120, s[8:11], s43 offen offset:1536 sc1
  buffer_load_dwordx4 v[172:175], v120, s[8:11], s44 offen offset:0 sc1
  buffer_load_dwordx4 v[176:179], v120, s[8:11], s44 offen offset:1536 sc1
  buffer_load_dword v180, v121, s[8:11], s43 offen offset:0 sc1
  buffer_load_dword v181, v121, s[8:11], s43 offen offset:1536 sc1
  buffer_load_dword v182, v121, s[8:11], s44 offen offset:0 sc1
  buffer_load_dword v183, v121, s[8:11], s44 offen offset:1536 sc1
  s_sleep 1
  buffer_load_dwordx4 v[40:43], v120, s[8:11], s43 offen offset:0 sc1
  buffer_load_dwordx4 v[44:47], v120, s[8:11], s43 offen offset:1536 sc1
  buffer_load_dwordx4 v[48:51], v120, s[8:11], s44 offen offset:0 sc1
  buffer_load_dwordx4 v[52:55], v120, s[8:11], s44 offen offset:1536 sc1
  buffer_load_dword v56, v121, s[8:11], s43 offen offset:0 sc1
  buffer_load_dword v57, v121, s[8:11], s43 offen offset:1536 sc1
  buffer_load_dword v58, v121, s[8:11], s44 offen offset:0 sc1
  buffer_load_dword v59, v121, s[8:11], s44 offen offset:1536 sc1
L_sp_w3s_a:
  s_waitcnt vmcnt(8)
  v_max3_u32 v18, v164, v168, v172
  v_max3_u32 v19, v176, v180, v181
  v_max3_u32 v18, v18, v182, v183
  v_max_u32 v18, v18, v19
  v_cmp_eq_u32 vcc, -1, v18
  s_cbranch_vccz L_sp_w3s_oka
  s_sub_u32 s28, s28, 1
  s_cbranch_scc1 L_abort
  buffer_load_dwordx4 v[164:167], v120, s[8:11], s43 offen offset:0 sc1
  buffer_load_dwordx4 v[168:171], v120, s[8:11], s43 offen offset:1536 sc1
  buffer_load_dwordx4 v[172:175], v120, s[8:11], s44 offen offset:0 sc1
  buffer_load_dwordx4 v[176:179], v120, s[8:11], s44 offen offset:1536 sc1
  buffer_load_dword v180, v121, s[8:11], s43 offen offset:0 sc1
  buffer_load_dword v181, v121, s[8:11], s43 offen offset:1536 sc1
  buffer_load_dword v182, v121, s[8:11], s44 offen offset:0 sc1
  buffer_load_dword v183, v121, s[8:11], s44 offen offset:1536 sc1
  s_waitcnt vmcnt(8)
  v_max3_u32 v18, v40, v44, v48
  v_max3_u32 v19, v52, v56, v57
  v_max3_u32 v18, v18, v58, v59
  v_max_u32 v18, v18, v19
  v_cmp_eq_u32 vcc, -1, v18
  s_cbranch_vccz L_sp_w3s_okb
  s_sub_u32 s28, s28, 1
  s_cbranch_scc1 L_abort
  buffer_load_dwordx4 v[40:43], v120, s[8:11], s43 offen offset:0 sc1
  buffer_load_dwordx4 v[44:47], v120, s[8:11], s43 offen offset:1536 sc1
  buffer_load_dwordx4 v[48:51], v120, s[8:11], s44 offen offset:0 sc1
  buffer_load_dwordx4 v[52:55], v120, s[8:11], s44 offen offset:1536 sc1
  buffer_load_dword v56, v121, s[8:11], s43 offen offset:0 sc1
  buffer_load_dword v57, v121, s[8:11], s43 offen offset:1536 sc1
  buffer_load_dword v58, v121, s[8:11], s44 offen offset:0 sc1
  buffer_load_dword v59, v121, s[8:11], s44 offen offset:1536 sc1
  s_branch L_sp_w3s_a
L_sp_w3s_okb:
  v_pk_add_f32 v[184:185], v[40:41], v[44:45]
  v_pk_add_f32 v[186:187], v[42:43], v[46:47]
  v_pk_add_f32 v[196:197], v[48:49], v[52:53]
  v_pk_add_f32 v[198:199], v[50:51], v[54:55]
  v_pk_add_f32 v[108:109], v[56:57], v[58:59]
  s_branch L_sp_w3s_d
L_sp_w3s_oka:
  v_pk_add_f32 v[184:185], v[164:165], v[168:169]
  v_pk_add_f32 v[186:187], v[166:167], v[170:171]
  v_pk_add_f32 v[196:197], v[172:173], v[176:177]
  v_pk_add_f32 v[198:199], v[174:175], v[178:179]
  v_pk_add_f32 v[108:109], v[180:181], v[182:183]
L_sp_w3s_d:
  v_pk_add_f32 v[184:185], v[184:185], v[196:197]
  v_pk_add_f32 v[186:187], v[186:187], v[198:199]
  v_add_f32 v108, v108, v109
  v_max3_f32 v104, v184, v185, v186
  v_max3_f32 v104, v104, v187, v108
  s_nop 1
  v_max_f32_dpp v104, v104, v104 row_ror:8 row_mask:0xf bank_mask:0xf
  v_mov_b32 v105, v104
  s_nop 1
  v_permlane16_swap_b32 v104, v105
  v_max_f32 v104, v104, v105
  v_mov_b32 v105, v104
  s_nop 1
  v_permlane32_swap_b32 v104, v105
  v_max_f32 v104, v104, v105
  v_mul_f32 v104, s57, v104
  v_fma_f32 v184, v184, s57, -v104
  v_fma_f32 v185, v185, s57, -v104
  v_fma_f32 v186, v186, s57, -v104
  v_fma_f32 v187, v187, s57, -v104
  v_fma_f32 v108, v108, s57, -v104
  v_exp_f32 v184, v184
  v_exp_f32 v185, v185
  v_exp_f32 v186, v186
  v_exp_f32 v187, v187
  v_exp_f32 v108, v108
  v_cvt_pk_bf16_f32 v188, v184, v185
  v_cvt_pk_bf16_f32 v189, v186, v187
  v_cvt_pk_bf16_f32 v190, v184, v185
  v_cvt_pk_bf16_f32 v191, v186, v187
  v_cvt_pk_bf16_f32 v105, v108, v108
  v_mov_b32_dpp v188, v188 row_ror:8 row_mask:0xf bank_mask:0xc
  v_mov_b32_dpp v189, v189 row_ror:8 row_mask:0xf bank_mask:0xc
  v_mov_b32_dpp v190, v190 row_ror:8 row_mask:0xf bank_mask:0x3
  v_mov_b32_dpp v191, v191 row_ror:8 row_mask:0xf bank_mask:0x3
  v_mov_b32_dpp v106, v105 row_ror:8 row_mask:0xf bank_mask:0xf
  v_bfi_b32 v192, v126, v105, v106
  v_bfi_b32 v193, v126, v105, v106
  v_mfma_f32_16x16x32_bf16 v[128:131], v[152:155], v[188:191], 0
  v_mfma_f32_16x16x32_bf16 v[132:135], v[156:159], v[188:191], 0
  v_mfma_f32_16x16x32_bf16 v[136:139], v[160:163], v[188:191], 0
  v_mfma_f32_16x16x32_bf16 v[128:131], v[140:143], v[192:195], v[128:131]
  v_mfma_f32_16x16x32_bf16 v[132:135], v[144:147], v[192:195], v[132:135]
  v_mfma_f32_16x16x32_bf16 v[136:139], v[148:151], v[192:195], v[136:139]
  v_pk_add_f32 v[184:185], v[184:185], v[186:187]
  v_add_f32 v104, v184, v185
  v_add_f32 v104, v104, v108
  s_nop 1
  v_add_f32_dpp v104, v104, v104 row_ror:8 row_mask:0xf bank_mask:0xf
  v_mov_b32 v105, v104
  s_nop 1
  v_permlane16_swap_b32 v104, v105
  v_add_f32 v104, v104, v105
  v_mov_b32 v105, v104
  s_nop 1
  v_permlane32_swap_b32 v104, v105
  v_add_f32 v104, v104, v105
  v_rcp_f32 v104, v104
  s_nop 0
  v_pk_mul_f32 v[128:129], v[128:129], v[104:105] op_sel_hi:[1,0]
  v_pk_mul_f32 v[130:131], v[130:131], v[104:105] op_sel_hi:[1,0]
  v_pk_mul_f32 v[132:133], v[132:133], v[104:105] op_sel_hi:[1,0]
  v_pk_mul_f32 v[134:135], v[134:135], v[104:105] op_sel_hi:[1,0]
  v_pk_mul_f32 v[136:137], v[136:137], v[104:105] op_sel_hi:[1,0]
  v_pk_mul_f32 v[138:139], v[138:139], v[104:105] op_sel_hi:[1,0]
  v_cvt_pk_bf16_f32 v108, v128, v129
  v_cvt_pk_bf16_f32 v109, v130, v131
  v_cvt_pk_bf16_f32 v110, v132, v133
  v_cvt_pk_bf16_f32 v111, v134, v135
  v_cvt_pk_bf16_f32 v112, v136, v137
  v_cvt_pk_bf16_f32 v113, v138, v139
  s_mov_b32 exec_lo, 16711935
  s_mov_b32 exec_hi, 16711935
  buffer_store_dwordx4 v[108:111], v122, s[8:11], s45 offen sc1
  buffer_store_dwordx2 v[112:113], v123, s[8:11], s45 offen sc1
  s_mov_b32 exec_lo, 4294967295
  s_mov_b32 exec_hi, 4294967295
  v_mov_b32 v92, 0
  v_mov_b32 v93, 0
  v_mov_b32 v94, 0
  v_mov_b32 v95, 0
  v_mov_b32 v96, 0
  v_mov_b32 v97, 0
  v_mov_b32 v98, 0
  v_mov_b32 v99, 0
  v_mov_b32 v100, 0
  v_mov_b32 v101, 0
  v_mov_b32 v102, 0
  v_mov_b32 v103, 0
  s_barrier
  s_mov_b32 s28, 131072
  s_mov_b32 s29, 43
  buffer_load_dwordx4 v[80:83], v29, s[8:11], s45 offen offset:0 sc1
  buffer_load_dwordx4 v[84:87], v29, s[8:11], s45 offen offset:1024 sc1
  buffer_load_dwordx4 v[88:91], v29, s[8:11], s45 offen offset:2048 sc1
  s_sleep 2
  buffer_load_dwordx4 v[60:63], v29, s[8:11], s45 offen offset:0 sc1
  buffer_load_dwordx4 v[64:67], v29, s[8:11], s45 offen offset:1024 sc1
  buffer_load_dwordx4 v[68:71], v29, s[8:11], s45 offen offset:2048 sc1
L_op_w3s_a:
  s_waitcnt vmcnt(3)
  v_max3_u32 v18, v80, v84, v88
  v_cmp_eq_u32 vcc, -1, v18
  s_cbranch_vccz L_op_w3s_oka
  s_sub_u32 s28, s28, 1
  s_cbranch_scc1 L_abort
  buffer_load_dwordx4 v[80:83], v29, s[8:11], s45 offen offset:0 sc1
  buffer_load_dwordx4 v[84:87], v29, s[8:11], s45 offen offset:1024 sc1
  buffer_load_dwordx4 v[88:91], v29, s[8:11], s45 offen offset:2048 sc1
  s_waitcnt vmcnt(3)
  v_max3_u32 v18, v60, v64, v68
  v_cmp_eq_u32 vcc, -1, v18
  s_cbranch_vccz L_op_w3s_okb
  s_sub_u32 s28, s28, 1
  s_cbranch_scc1 L_abort
  buffer_load_dwordx4 v[60:63], v29, s[8:11], s45 offen offset:0 sc1
  buffer_load_dwordx4 v[64:67], v29, s[8:11], s45 offen offset:1024 sc1
  buffer_load_dwordx4 v[68:71], v29, s[8:11], s45 offen offset:2048 sc1
  s_branch L_op_w3s_a
L_op_w3s_okb:
  v_smfmac_f32_16x16x64_bf16 v[92:95], v[60:63], a[240:247], v20
  v_smfmac_f32_16x16x64_bf16 v[96:99], v[60:63], a[248:255], v20
  v_smfmac_f32_16x16x64_bf16 v[100:103], v[60:63], v[200:207], v20
  v_smfmac_f32_16x16x64_bf16 v[92:95], v[64:67], v[208:215], v20
  v_smfmac_f32_16x16x64_bf16 v[96:99], v[64:67], v[216:223], v20
  v_smfmac_f32_16x16x64_bf16 v[100:103], v[64:67], v[224:231], v20
  v_smfmac_f32_16x16x64_bf16 v[92:95], v[68:71], v[232:239], v20
  v_smfmac_f32_16x16x64_bf16 v[96:99], v[68:71], v[240:247], v20
  v_smfmac_f32_16x16x64_bf16 v[100:103], v[68:71], v[248:255], v20
  s_branch L_op_w3s_d
L_op_w3s_oka:
  v_smfmac_f32_16x16x64_bf16 v[92:95], v[80:83], a[240:247], v20
  v_smfmac_f32_16x16x64_bf16 v[96:99], v[80:83], a[248:255], v20
  v_smfmac_f32_16x16x64_bf16 v[100:103], v[80:83], v[200:207], v20
  v_smfmac_f32_16x16x64_bf16 v[92:95], v[84:87], v[208:215], v20
  v_smfmac_f32_16x16x64_bf16 v[96:99], v[84:87], v[216:223], v20
  v_smfmac_f32_16x16x64_bf16 v[100:103], v[84:87], v[224:231], v20
  v_smfmac_f32_16x16x64_bf16 v[92:95], v[88:91], v[232:239], v20
  v_smfmac_f32_16x16x64_bf16 v[96:99], v[88:91], v[240:247], v20
  v_smfmac_f32_16x16x64_bf16 v[100:103], v[88:91], v[248:255], v20
L_op_w3s_d:
  s_nop 5
  v_permlane32_swap_b32 v92, v93
  v_permlane32_swap_b32 v94, v95
  v_permlane32_swap_b32 v96, v97
  v_permlane32_swap_b32 v98, v99
  v_permlane32_swap_b32 v100, v101
  v_permlane32_swap_b32 v102, v103
  v_add_f32 v92, v92, v93
  v_add_f32 v94, v94, v95
  v_add_f32 v96, v96, v97
  v_add_f32 v98, v98, v99
  v_add_f32 v100, v100, v101
  v_add_f32 v102, v102, v103
  ds_write_b32 v30, v92 offset:0
  ds_write_b32 v30, v94 offset:128
  ds_write_b32 v30, v96 offset:512
  ds_write_b32 v30, v98 offset:640
  ds_write_b32 v30, v100 offset:1024
  ds_write_b32 v30, v102 offset:1152
  s_cmp_ge_u32 s30, 62
  s_cbranch_scc1 L_nopf_w3s
  s_add_u32 s7, s30, 1
  s_add_u32 s6, s7, 1
  s_cmp_ge_u32 s56, s6
  s_cbranch_scc1 L_fa_ok_w3spf
  v_readlane_b32 s56, v37, 0
  v_readlane_b32 s4, v37, 1
  v_readlane_b32 s5, v37, 2
  s_min_u32 s56, s56, s4
  s_min_u32 s56, s56, s5
  s_cmp_ge_u32 s56, s6
  s_cbranch_scc1 L_fa_ok_w3spf
  s_mov_b32 s28, 131072
  s_mov_b32 s29, 10
L_fa_w3spf:
  buffer_load_dword v37, v35, s[8:11], 0 offen sc1
  s_waitcnt vmcnt(0)
  v_readlane_b32 s56, v37, 0
  v_readlane_b32 s4, v37, 1
  v_readlane_b32 s5, v37, 2
  s_sub_u32 s28, s28, 1
  s_cbranch_scc1 L_abort
  s_min_u32 s56, s56, s4
  s_min_u32 s56, s56, s5
  s_cmp_ge_u32 s56, s6
  s_cbranch_scc0 L_fa_w3spf
L_fa_ok_w3spf:
  s_add_u32 s4, s6, 3
  s_cmp_ge_u32 s56, s4
  s_cbranch_scc1 L_fa_far_w3spf
  buffer_load_dword v37, v35, s[8:11], 0 offen sc1
L_fa_far_w3spf:
  s_mul_i32 s4, s7, 393216
  s_add_u32 s4, s4, 58609664
  buffer_load_dwordx4 v[152:155], v124, s[8:11], s4 offen offset:0 sc1
  buffer_load_dwordx4 v[156:159], v124, s[8:11], s4 offen offset:1024 sc1
  buffer_load_dwordx4 v[160:163], v124, s[8:11], s4 offen offset:2048 sc1
L_nopf_w3s:
  s_waitcnt lgkmcnt(0)
  s_barrier
  s_sleep 4
  buffer_store_dwordx2 v[140:141], v125, s[8:11], s55 offen offset:0 sc1
  buffer_store_dwordx2 v[144:145], v125, s[8:11], s55 offen offset:512 sc1
  buffer_store_dwordx2 v[148:149], v125, s[8:11], s55 offen offset:1024 sc1
  s_cmp_eq_u32 s39, 0
  s_cbranch_scc1 L_noown_w3s
  s_sleep 6
  s_mov_b32 s28, 131072
  s_mov_b32 s29, 53
  buffer_load_dwordx4 v[164:167], v33, s[8:11], s46 offen offset:0 sc1
  buffer_load_dwordx4 v[168:171], v33, s[8:11], s46 offen offset:1024 sc1
  buffer_load_dwordx4 v[172:175], v33, s[8:11], s46 offen offset:2048 sc1
  buffer_load_dwordx4 v[176:179], v33, s[8:11], s46 offen offset:3072 sc1
  s_sleep 4
  buffer_load_dwordx4 v[40:43], v33, s[8:11], s46 offen offset:0 sc1
  buffer_load_dwordx4 v[44:47], v33, s[8:11], s46 offen offset:1024 sc1
  buffer_load_dwordx4 v[48:51], v33, s[8:11], s46 offen offset:2048 sc1
  buffer_load_dwordx4 v[52:55], v33, s[8:11], s46 offen offset:3072 sc1
L_xq_w3s_a:
  s_waitcnt vmcnt(4)
  v_max3_u32 v18, v164, v168, v172
  v_max_u32 v18, v18, v176
  v_cmp_eq_u32 vcc, -1, v18
  s_cbranch_vccz L_xq_w3s_oka
  s_sub_u32 s28, s28, 1
  s_cbranch_scc1 L_abort
  buffer_load_dwordx4 v[164:167], v33, s[8:11], s46 offen offset:0 sc1
  buffer_load_dwordx4 v[168:171], v33, s[8:11], s46 offen offset:1024 sc1
  buffer_load_dwordx4 v[172:175], v33, s[8:11], s46 offen offset:2048 sc1
  buffer_load_dwordx4 v[176:179], v33, s[8:11], s46 offen offset:3072 sc1
  s_waitcnt vmcnt(4)
  v_max3_u32 v18, v40, v44, v48
  v_max_u32 v18, v18, v52
  v_cmp_eq_u32 vcc, -1, v18
  s_cbranch_vccz L_xq_w3s_okb
  s_sub_u32 s28, s28, 1
  s_cbranch_scc1 L_abort
  buffer_load_dwordx4 v[40:43], v33, s[8:11], s46 offen offset:0 sc1
  buffer_load_dwordx4 v[44:47], v33, s[8:11], s46 offen offset:1024 sc1
  buffer_load_dwordx4 v[48:51], v33, s[8:11], s46 offen offset:2048 sc1
  buffer_load_dwordx4 v[52:55], v33, s[8:11], s46 offen offset:3072 sc1
  s_branch L_xq_w3s_a
L_xq_w3s_okb:
  v_pk_add_f32 v[104:105], v[40:41], v[44:45]
  v_pk_add_f32 v[106:107], v[42:43], v[46:47]
  v_pk_add_f32 v[112:113], v[48:49], v[52:53]
  v_pk_add_f32 v[114:115], v[50:51], v[54:55]
  s_branch L_xq_w3s_d
L_xq_w3s_oka:
  v_pk_add_f32 v[104:105], v[164:165], v[168:169]
  v_pk_add_f32 v[106:107], v[166:167], v[170:171]
  v_pk_add_f32 v[112:113], v[172:173], v[176:177]
  v_pk_add_f32 v[114:115], v[174:175], v[178:179]
L_xq_w3s_d:
  v_pk_add_f32 v[104:105], v[104:105], v[112:113]
  v_pk_add_f32 v[106:107], v[106:107], v[114:115]
  s_nop 1
  v_permlane32_swap_b32 v104, v106
  v_permlane32_swap_b32 v105, v107
  v_add_f32 v104, v104, v106
  v_add_f32 v105, v105, v107
  v_cvt_pk_bf16_f32 v104, v104, v105
  buffer_store_dword v104, v34, s[8:11], s47 offen sc1
L_noown_w3s:
  s_add_u32 s30, s30, 1
  s_and_b32 s58, s30, 3
  s_mul_i32 s40, s58, 40960
  s_mul_i32 s59, s25, 10240
  s_add_u32 s59, s59, 5492736
  s_add_u32 s40, s40, s59
  s_add_u32 s41, s40, 4096
  s_add_u32 s42, s40, 8192
  s_mul_i32 s45, s58, 98304
  s_add_u32 s45, s45, 905216
  s_mul_i32 s46, s58, 327680
  s_add_u32 s46, s46, s61
  s_mul_i32 s43, s58, 196608
  s_mul_i32 s3, s32, 6144
  s_add_u32 s3, s3, 118784
  s_add_u32 s43, s43, s3
  s_add_u32 s44, s43, 3072
  s_add_u32 s58, s30, 1
  s_and_b32 s58, s58, 3
  s_mul_i32 s47, s58, 40960
  s_add_u32 s47, s47, s59
  s_add_u32 s58, s30, 3
  s_and_b32 s58, s58, 3
  s_mul_i32 s51, s58, 40960
  s_add_u32 s51, s51, s59
  s_mul_i32 s48, s58, 196608
  s_add_u32 s48, s48, s3
  s_mul_i32 s49, s58, 98304
  s_add_u32 s49, s49, 905216
  s_add_u32 s58, s30, 2
  s_and_b32 s58, s58, 3
  s_mul_i32 s50, s58, 327680
  s_add_u32 s50, s50, s61
  s_mul_i32 s54, s30, 196608
  s_add_u32 s55, s54, 96358400
  s_add_u32 s54, s54, 83775488
  v_mov_b32 v128, 0
  v_mov_b32 v129, 0
  v_mov_b32 v130, 0
  v_mov_b32 v131, 0
  v_mov_b32 v132, 0
  v_mov_b32 v133, 0
  v_mov_b32 v134, 0
  v_mov_b32 v135, 0
  v_mov_b32 v136, 0
  v_mov_b32 v137, 0
  v_mov_b32 v138, 0
  v_mov_b32 v139, 0
  s_barrier
  s_branch L_step_w3s
L_last_w3s:
  buffer_store_dwordx2 v[140:141], v125, s[8:11], s55 offen offset:0 sc1
  buffer_store_dwordx2 v[144:145], v125, s[8:11], s55 offen offset:512 sc1
  buffer_store_dwordx2 v[148:149], v125, s[8:11], s55 offen offset:1024 sc1
  s_add_u32 s53, s53, 16384
  s_waitcnt vmcnt(0)
  s_mov_b64 exec, 1
  v_mov_b32 v104, 64
  v_mov_b32 v105, 0
  buffer_store_dword v104, v105, s[8:11], s53 offen sc1
  s_waitcnt vmcnt(0)
  s_mov_b64 exec, -1
  s_branch L_exit
L_abort:
  s_mov_b64 exec, 1
  v_mov_b32 v1, 40
  v_mov_b32 v2, s29
  buffer_store_dword v2, v1, s[12:15], 0 offen sc1
  s_waitcnt vmcnt(0)
L_exit:
  s_endpgm
.section .rodata,"a"
.p2align 6
.amdhsa_kernel sequential_preLN__memory_aug_recurrent_mem_tr__swiglu_ffn__prompt_kernel
  .amdhsa_next_free_vgpr 512
  .amdhsa_next_free_sgpr 102
  .amdhsa_accum_offset 256
  .amdhsa_group_segment_fixed_size 0
  .amdhsa_kernarg_size 112
  .amdhsa_user_sgpr_count 2
  .amdhsa_user_sgpr_kernarg_segment_ptr 1
  .amdhsa_system_sgpr_workgroup_id_x 1
.end_amdhsa_kernel
```
